```python
import torch

def _softmax(x, axis=-1):
    return torch.softmax(x, dim=axis)
def _gelu(x):
    return torch.nn.functional.gelu(x, approximate="tanh")
def _silu(x):
    return torch.nn.functional.silu(x)
def _sigmoid(x):
    return torch.sigmoid(x)
def _layernorm(x, axis=-1, eps=1e-5):
    m = x.mean(dim=axis, keepdim=True)
    v = x.var(dim=axis, keepdim=True, unbiased=False)
    return (x - m) / torch.sqrt(v + eps)
def _scatter_add(tgt, idx, src, axis=0):
    return tgt.clone().index_add_(axis, idx, src)
def _segment_sum(src, seg, n):
    out = torch.zeros((n,) + src.shape[1:], dtype=src.dtype)
    return out.index_add_(0, seg, src)
def _pad(x, pw):
    flat = tuple(v for pair in reversed(pw) for v in pair)
    return torch.nn.functional.pad(x, flat)

kernel_name = 'interleave_layers__sliding_local_dilated__mixer_s_mlp__prompt'

def setup_inputs():

    _w = (lambda a: (lambda t: t.to(torch.bfloat16) if t.is_floating_point() else t)(torch.as_tensor(a)))
    def _A_setup():
        B, S, D = 1, 2048, 512
        return {
            "x": _w((lambda *s: torch.randn(*s, dtype=torch.bfloat16) * 0.05)(B, S, D)),
            "wqkv": _w((lambda *s: torch.randn(*s, dtype=torch.bfloat16) * 0.1)(D, 3 * D)),
            "wo": _w((lambda *s: torch.randn(*s, dtype=torch.bfloat16) * 0.1)(D, D)),
        }
    _A_in = _A_setup()

    def _B_setup():
        B, S, D, F = 1, 2048, 512, 1792
        return {
            "x":  _w((lambda *s: torch.randn(*s, dtype=torch.bfloat16) * 0.05)(B, S, D)),
            "w1": _w((lambda *s: torch.randn(*s, dtype=torch.bfloat16) * 3.2)(D, D) * (D ** -0.5)),
            "w2": _w((lambda *s: torch.randn(*s, dtype=torch.bfloat16) * 3.2)(D, D) * (D ** -0.5)),
            "w3": _w((lambda *s: torch.randn(*s, dtype=torch.bfloat16) * 3.2)(D, F) * (D ** -0.5)),
            "w4": _w((lambda *s: torch.randn(*s, dtype=torch.bfloat16) * 3.2)(F, D) * (F ** -0.5)),
        }
    _B_in = _B_setup()

    return {
        "A_x": _A_in["x"],
        "A_wqkv": _A_in["wqkv"],
        "A_wo": _A_in["wo"],
        "B_x": _B_in["x"],
        "B_w1": _B_in["w1"],
        "B_w2": _B_in["w2"],
        "B_w3": _B_in["w3"],
        "B_w4": _B_in["w4"],
    }

def reference(A_x, A_wqkv, A_wo, B_x, B_w1, B_w2, B_w3, B_w4):
    def _A_ref(x, wqkv, wo):
        B, S, D = x.shape
        H = 32; Dh = D // H
        W, dil = 8, 2
        qkv = (lambda x, *d: x.permute(*d))((x @ wqkv).reshape(B, S, 3, H, Dh), 2, 0, 3, 1, 4)
        q, k, v = qkv[0], qkv[1], qkv[2]
        scale = Dh ** -0.5
        pos = torch.arange(S)
        off = torch.arange(W) * dil
        idx = pos[:, None] - off[None, :]
        mask = idx >= 0
        idx_c = torch.where(mask, idx, 0).reshape(-1)
        kg = k[:, :, idx_c, :].reshape(B, H, S, W, Dh)
        vg = v[:, :, idx_c, :].reshape(B, H, S, W, Dh)
        logits = torch.einsum("bhsd,bhswd->bhsw", q, kg) * scale
        logits = torch.where(mask[None, None, :, :], logits, -1e9)
        attn = _softmax(logits, axis=-1)
        o = torch.einsum("bhsw,bhswd->bhsd", attn, vg)
        return (lambda x, *d: x.permute(*d))(o, 0, 2, 1, 3).reshape(B, S, D) @ wo

    def _B_ref(x, w1, w2, w3, w4):
        B, S, D = x.shape
        h = _gelu(_layernorm(x, axis=-1) @ w1)
        c = D // 4
        g0 = _pad(h[:, :, 0*c:1*c], ((0, 0), (1, 0), (0, 0)))[:, :S, :]
        g1 = _pad(h[:, :, 1*c:2*c], ((0, 0), (0, 1), (0, 0)))[:, 1:, :]
        g2 = _pad(h[:, :, 2*c:3*c], ((0, 0), (2, 0), (0, 0)))[:, :S, :]
        g3 = _pad(h[:, :, 3*c:   ], ((0, 0), (0, 2), (0, 0)))[:, 2:, :]
        hs = torch.concatenate([g0, g1, g2, g3], axis=-1) @ w2
        x1 = x + hs
        h2 = _gelu(_layernorm(x1, axis=-1) @ w3) @ w4
        return x1 + h2

    x = A_x
    x = x + _A_ref(_layernorm(x, axis=-1), A_wqkv, A_wo)
    x = x + _B_ref(_layernorm(x, axis=-1), B_w1, B_w2, B_w3, B_w4)
    x = x + _A_ref(_layernorm(x, axis=-1), A_wqkv, A_wo)
    x = x + _B_ref(_layernorm(x, axis=-1), B_w1, B_w2, B_w3, B_w4)
    return x
```

```asm
; @launch grid=(256,1,1) block=(512,1,1) lds=163840
.amdgcn_target "amdgcn-amd-amdhsa--gfx950"
.text
.globl interleave_layers__sliding_local_dilated__mixer_s_mlp__prompt_kernel
.p2align 8
.type interleave_layers__sliding_local_dilated__mixer_s_mlp__prompt_kernel,@function
interleave_layers__sliding_local_dilated__mixer_s_mlp__prompt_kernel:
.set CODE_BYTES, L_END - interleave_layers__sliding_local_dilated__mixer_s_mlp__prompt_kernel - 1024
  s_cmp_ge_u32 s2, 256
  s_cbranch_scc1 L_END
  s_getpc_b64 s[62:63]
  s_load_dwordx2 s[8:9], s[0:1], 0
  s_load_dwordx2 s[12:13], s[0:1], 8
  s_load_dwordx2 s[4:5], s[0:1], 80
  s_load_dwordx2 s[16:17], s[0:1], 16
  s_load_dwordx2 s[20:21], s[0:1], 32
  s_load_dwordx2 s[24:25], s[0:1], 40
  s_load_dwordx2 s[28:29], s[0:1], 48
  s_load_dwordx2 s[32:33], s[0:1], 56
  s_load_dwordx2 s[36:37], s[0:1], 64
  s_load_dwordx2 s[40:41], s[0:1], 72
  v_lshrrev_b32 v1, 6, v0
  s_nop 0
  v_readfirstlane_b32 s93, v1
  v_and_b32 v1, 63, v0
  s_and_b32 s44, s93, 3
  s_lshr_b32 s45, s2, 3
  s_and_b32 s45, s45, 7
  s_and_b32 s46, s2, 7
  s_lshl_b32 s46, s46, 2
  s_lshr_b32 s53, s2, 6
  s_add_u32 s46, s46, s53
  s_lshl_b32 s47, s44, 10
  s_mul_i32 s73, s44, 1088
  s_lshr_b32 s61, s44, 1
  s_and_b32 s64, s44, 1
  s_mov_b32 s10, 2097152
  s_mov_b32 s11, 0x20000
  s_mov_b32 s14, 1572864
  s_mov_b32 s15, 0x20000
  s_mov_b32 s6, 10747904
  s_mov_b32 s7, 0x20000
  s_mov_b32 s18, 524288
  s_mov_b32 s19, 0x20000
  s_mov_b32 s22, 524288
  s_mov_b32 s23, 0x20000
  s_mov_b32 s26, 524288
  s_mov_b32 s27, 0x20000
  s_mov_b32 s30, 1835008
  s_mov_b32 s31, 0x20000
  s_mov_b32 s34, 1835008
  s_mov_b32 s35, 0x20000
  s_mov_b32 s38, 2097152
  s_mov_b32 s39, 0x20000
  s_mov_b32 s42, 256
  s_mov_b32 s43, 0x20000
  s_mov_b32 s79, 0x20000
  s_mov_b32 s60, 0x3f803f80
  s_mov_b32 s52, 0
  s_mov_b32 s51, 0
  v_lshlrev_b32 v6, 4, v1
  v_add_u32 v6, s47, v6
  s_lshl_b32 s69, s46, 16
  s_sub_u32 s69, s69, 16384
  s_add_u32 s70, s69, s47
  v_lshrrev_b32_e64 v29, 3, v1
  v_lshl_add_u32 v29, s44, 3, v29
  v_bfe_u32 v30, v1, 4, 1
  v_lshlrev_b32 v30, 1, v30
  v_lshrrev_b32 v31, 5, v1
  v_xor_b32 v31, s64, v31
  v_or_b32 v30, v30, v31
  v_lshlrev_b32 v30, 1, v30
  v_and_b32 v31, 7, v1
  v_xor_b32 v30, v30, v31
  v_lshlrev_b32 v30, 4, v30
  v_mul_u32_u24 v2, 1024, v29
  v_add_u32_e64 v2, v2, v30
  v_mul_u32_u24 v3, 3072, v29
  v_add_u32_e64 v3, v3, v30
  v_mul_u32_u24 v4, 3584, v29
  v_add_u32_e64 v4, v4, v30
  s_mul_i32 s53, s45, 10240
  s_mul_i32 s54, s44, 2560
  s_add_u32 s53, s53, s54
  s_add_u32 s53, s53, s69
  v_lshlrev_b32 v31, 7, v1
  v_add_u32 v29, s53, v31
  s_waitcnt lgkmcnt(0)
  s_cmp_lt_u32 s93, 4
  s_cbranch_scc1 L_COMPUTE
  s_mov_b64 exec, 0xfffff
  buffer_load_dword v21, v29, s[8:11], 0 offen nt
  s_mov_b64 exec, -1
  s_mul_i32 s90, s2, 6144
  s_mul_i32 s91, s44, 1536
  s_add_u32 s90, s90, s91
  v_lshlrev_b32 v0, 7, v1
  s_mov_b64 exec, 0xfff
  buffer_load_dword v21, v0, s[12:15], s90 offen
  s_mov_b64 exec, -1
  s_lshl_b32 s90, s2, 11
  s_mul_i32 s91, s44, 512
  s_add_u32 s90, s90, s91
  v_lshlrev_b32 v0, 7, v1
  s_mov_b64 exec, 0xf
  buffer_load_dword v21, v0, s[16:19], s90 offen
  s_mov_b64 exec, -1
  s_cmp_lg_u32 s44, 1
  s_cbranch_scc1 HSK_1
  s_lshr_b32 s53, s2, 3
  s_mul_i32 s53, s53, 3072
  v_lshlrev_b32 v29, 7, v1
  v_add_u32_e64 v29, s53, v29
  s_mov_b32 s54, CODE_BYTES
  v_min_u32_e64 v29, s54, v29
  s_mov_b64 exec, 0xffffff
  global_load_dword v21, v29, s[62:63]
  s_mov_b64 exec, -1
HSK_1:
  v_lshrrev_b32 v29, 4, v1
  v_lshl_add_u32 v29, s64, 2, v29
  v_and_b32 v30, 7, v1
  v_xor_b32 v29, v29, v30
  v_lshrrev_b32_e64 v30, 3, v1
  v_lshl_add_u32 v30, s44, 3, v30
  v_lshlrev_b32_e64 v30, 10, v30
  v_lshl_add_u32 v29, v29, 4, v30
  v_add_u32_e64 v40, s69, v29
  v_add_u32 v41, 0x8000, v40
  s_cmp_lt_u32 s44, 2
  s_cselect_b32 s53, 0, 2130706432
  s_add_u32 s53, s53, 0x10000
  v_add_u32 v42, s53, v40
  s_lshl_b32 s98, s45, 1
  s_add_u32 m0, s47, 0
  s_add_u32 s48, s45, 0
  s_and_b32 s48, s48, 7
  s_mul_i32 s48, s48, 128
  buffer_load_dwordx4 v40, s[8:11], s48 offen lds
  s_add_u32 m0, s47, 4096
  s_add_u32 s48, s45, 0
  s_and_b32 s48, s48, 7
  s_mul_i32 s48, s48, 128
  buffer_load_dwordx4 v41, s[8:11], s48 offen lds
  s_add_u32 m0, s47, 8192
  s_add_u32 s48, s45, 0
  s_and_b32 s48, s48, 7
  s_mul_i32 s48, s48, 128
  buffer_load_dwordx4 v42, s[8:11], s48 offen lds
  s_add_u32 m0, s47, 12288
  s_add_u32 s48, s45, 1
  s_and_b32 s48, s48, 7
  s_mul_i32 s48, s48, 128
  buffer_load_dwordx4 v40, s[8:11], s48 offen lds
  s_add_u32 m0, s47, 16384
  s_add_u32 s48, s45, 1
  s_and_b32 s48, s48, 7
  s_mul_i32 s48, s48, 128
  buffer_load_dwordx4 v41, s[8:11], s48 offen lds
  s_add_u32 m0, s47, 20480
  s_add_u32 s48, s45, 1
  s_and_b32 s48, s48, 7
  s_mul_i32 s48, s48, 128
  buffer_load_dwordx4 v42, s[8:11], s48 offen lds
  s_mov_b32 s76, s28
  s_mov_b32 s77, s29
  s_cmp_lt_u32 s2, 224
  s_cselect_b32 s78, s30, 0
  s_lshr_b32 s53, s2, 3
  s_lshl_b32 s53, s53, 7
  s_and_b32 s54, s2, 7
  s_mul_i32 s82, s54, 229376
  s_add_u32 s82, s82, s53
  s_lshl_b32 s57, s46, 7
  s_lshl_b32 s53, s45, 2
  s_add_u32 s57, s57, s53
  s_lshr_b32 s53, s45, 1
  s_and_b32 s54, s53, 1
  s_lshl_b32 s54, s54, 1
  s_add_u32 s69, s46, 1
  s_sub_u32 s69, s69, s54
  s_lshl_b32 s72, s69, 11
  s_lshl_b32 s53, s53, 9
  s_add_u32 s72, s72, s53
  s_and_b32 s53, s45, 1
  s_lshl_b32 s53, s53, 7
  s_add_u32 s72, s72, s53
  s_add_u32 s72, s72, 65536
  s_cmp_lt_u32 s69, 32
  s_cselect_b32 s72, s72, 2130706432
  s_cmp_lg_u32 s44, 2
  s_cbranch_scc1 HSK_2
  v_mov_b32 v112, 0
  v_lshlrev_b32 v29, 12, v1
  s_mov_b64 exec, 3
  buffer_store_dword v112, v29, s[4:7], s57 offen sc1
  s_lshl_b32 s53, s2, 2
  s_add_u32 s53, s53, 8192
  s_mov_b64 exec, 1
  buffer_store_dword v112, v29, s[4:7], s53 offen sc1
  s_mov_b64 exec, -1
  v_mov_b32 v116, -1
  v_mov_b32 v117, -1
  v_mov_b32 v118, -1
  v_mov_b32 v119, -1
  v_and_b32 v29, 7, v1
  v_lshlrev_b32 v29, 4, v29
  v_bfe_u32 v30, v1, 3, 1
  v_lshl_add_u32 v29, v30, 8, v29
  v_bfe_u32 v30, v1, 4, 1
  v_lshl_add_u32 v29, v30, 16, v29
  s_mov_b32 exec_hi, 0
  buffer_store_dwordx4 v[116:119], v29, s[4:7], s72 offen sc1
  s_mov_b64 exec, -1
HSK_2:
  s_lshl_b32 s53, s45, 7
  s_add_u32 s12, s12, s53
  s_addc_u32 s13, s13, 0
  s_sub_u32 s14, s14, s53
  s_add_u32 s16, s16, s53
  s_addc_u32 s17, s17, 0
  s_sub_u32 s18, s18, s53
  s_add_u32 s20, s20, s53
  s_addc_u32 s21, s21, 0
  s_sub_u32 s22, s22, s53
  s_add_u32 s24, s24, s53
  s_addc_u32 s25, s25, 0
  s_sub_u32 s26, s26, s53
  s_add_u32 s32, s32, s53
  s_addc_u32 s33, s33, 0
  s_sub_u32 s34, s34, s53
  s_mul_i32 s53, s45, 448
  s_add_u32 s28, s28, s53
  s_addc_u32 s29, s29, 0
  s_sub_u32 s30, s30, s53
  s_lshr_b32 s90, s2, 3
  s_lshl_b32 s90, s90, 2
  s_add_u32 s90, s90, s44
  s_mul_i32 s90, s90, 12288
  s_lshl_b32 s91, s45, 7
  s_sub_u32 s90, s90, s91
  s_add_u32 s90, s90, 384
  v_mul_u32_u24 v0, 1024, v1
  v_add_u32_e64 v0, s90, v0
  s_mov_b64 exec, 0xfff
  buffer_load_dword v21, v0, s[12:15], 0 offen
  s_mov_b64 exec, -1
  s_lshr_b32 s90, s2, 3
  s_lshl_b32 s90, s90, 2
  s_add_u32 s90, s90, s44
  s_mul_i32 s90, s90, 4096
  s_lshl_b32 s91, s45, 7
  s_sub_u32 s90, s90, s91
  s_add_u32 s90, s90, 384
  v_mul_u32_u24 v0, 1024, v1
  v_add_u32 v0, s90, v0
  s_mov_b64 exec, 0xf
  buffer_load_dword v21, v0, s[16:19], 0 offen
  s_mov_b64 exec, -1
  s_add_u32 m0, s47, 65536
  s_add_u32 s48, s98, 0
  s_and_b32 s48, s48, 15
  s_mul_i32 s48, s48, 98304
  buffer_load_dwordx4 v3, s[12:15], s48 offen lds
  s_add_u32 m0, s47, 69632
  s_add_u32 s48, s98, 0
  s_and_b32 s48, s48, 15
  s_mul_i32 s48, s48, 98304
  s_add_u32 s48, s48, 1024
  buffer_load_dwordx4 v3, s[12:15], s48 offen lds
  s_add_u32 m0, s47, 73728
  s_add_u32 s48, s98, 0
  s_and_b32 s48, s48, 15
  s_mul_i32 s48, s48, 98304
  s_add_u32 s48, s48, 2048
  buffer_load_dwordx4 v3, s[12:15], s48 offen lds
  s_waitcnt vmcnt(13)
  s_add_u32 m0, s47, 77824
  s_add_u32 s48, s98, 1
  s_and_b32 s48, s48, 15
  s_mul_i32 s48, s48, 98304
  buffer_load_dwordx4 v3, s[12:15], s48 offen lds
  s_waitcnt vmcnt(13)
  s_add_u32 m0, s47, 81920
  s_add_u32 s48, s98, 1
  s_and_b32 s48, s48, 15
  s_mul_i32 s48, s48, 98304
  s_add_u32 s48, s48, 1024
  buffer_load_dwordx4 v3, s[12:15], s48 offen lds
  s_waitcnt vmcnt(13)
  s_add_u32 m0, s47, 86016
  s_add_u32 s48, s98, 1
  s_and_b32 s48, s48, 15
  s_mul_i32 s48, s48, 98304
  s_add_u32 s48, s48, 2048
  buffer_load_dwordx4 v3, s[12:15], s48 offen lds
  v_lshrrev_b32_e64 v29, 2, v1
  v_lshl_add_u32 v29, s44, 4, v29
  v_mul_u32_u24 v5, 3584, v29
  v_and_b32_e64 v30, 3, v1
  v_lshl_add_u32 v5, v30, 4, v5
  v_lshlrev_b32 v28, 2, v1
  s_and_b32 s53, s45, 1
  s_lshl_b32 s55, s53, 6
  s_cmp_eq_u32 s53, 0
  s_cselect_b32 s56, 384, 0
  s_mul_i32 s49, s46, 229376
  s_add_u32 s49, s49, 3145728
  s_lshl_b32 s50, s46, 16
  s_add_u32 s50, s50, 1048576
  s_lshl_b32 s54, s45, 13
  s_add_u32 s65, s49, s54
  s_add_u32 s66, s50, s54
  s_lshl_b32 s80, s46, 13
  s_add_u32 s80, s80, 10485760
  s_lshl_b32 s54, s45, 1
  s_add_u32 s54, s54, s64
  s_lshl_b32 s54, s54, 8
  s_lshl_b32 s69, s61, 12
  s_add_u32 s54, s54, s69
  s_add_u32 s81, s80, s54
  s_mul_i32 s54, s45, 28672
  s_add_u32 s54, s54, s49
  s_mov_b32 s83, s54
  s_lshl_b32 s69, s55, 6
  s_add_u32 s67, s54, s69
  s_lshl_b32 s69, s56, 6
  s_add_u32 s68, s54, s69
  s_mul_i32 s59, s46, 18432
  s_add_u32 s59, s59, 262144
  s_cmp_eq_u32 s46, 0
  s_cselect_b32 s59, 2130706432, s59
  s_getreg_b32 s71, hwreg(HW_REG_XCC_ID)
  s_and_b32 s71, s71, 15
  s_or_b32 s71, s71, 0x80
  v_and_b32_e64 v29, 31, v1
  v_lshl_add_u32 v29, s61, 5, v29
  v_lshrrev_b32 v30, 5, v1
  v_lshlrev_b32 v16, 4, v29
  v_lshl_add_u32 v16, v30, 10, v16
  s_lshl_b32 s53, s64, 12
  v_add_u32 v16, s53, v16
  s_lshl_b32 s53, s64, 7
  s_add_u32 s53, s53, 161792
  v_lshlrev_b32 v27, 4, v30
  v_add_u32 v27, s53, v27
  s_lshl_b32 s92, s46, 7
  s_lshl_b32 s98, s45, 1
  s_mul_i32 s99, s45, 7
  s_add_u32 s101, s98, s44
  s_lshr_b32 s53, s45, 2
  s_add_u32 s53, s53, 1
  s_sub_u32 s54, 64, s53
  s_bitcmp1_b32 s45, 1
  s_cselect_b32 s54, 0, s54
  v_subrev_u32_e64 v31, s54, v29
  v_cmp_gt_u32 s[62:63], s53, v31
  v_lshlrev_b32_e64 v31, 8, v31
  v_lshl_add_u32 v31, v30, 4, v31
  s_lshl_b32 s54, s64, 6
  v_add_u32 v31, s54, v31
  v_mov_b32 v20, 2130706432
  v_cndmask_b32 v20, v20, v31, s[62:63]
  v_mov_b32 v24, 0
  v_mov_b32 v25, 0
  s_mov_b32 s84, 0xaaaaaaaa
  s_mov_b32 s85, 0xaaaaaaaa
  s_mov_b32 s86, 0xfff0ffff
  s_mov_b32 s87, 0xf000ff00
  s_mov_b32 s88, 0xffc0fffc
  s_mov_b32 s89, 0xc000fc00
  v_bfe_u32 v29, v1, 4, 1
  v_bfe_u32 v30, v1, 2, 2
  v_lshl_add_u32 v17, v29, 3, v30
  v_lshrrev_b32_e64 v31, 5, v1
  v_lshl_add_u32 v17, v31, 4, v17
  v_lshlrev_b32 v17, 7, v17
  v_and_b32 v30, 2, v30
  v_or_b32 v29, v29, v30
  v_xor_b32 v29, s44, v29
  v_lshl_add_u32 v17, v29, 5, v17
  v_and_b32_e64 v30, 3, v1
  v_lshl_add_u32 v17, v30, 3, v17
  v_add_u32 v18, 0x20000, v17
  v_add_u32 v17, 0x10000, v17
  v_bfe_u32 v29, v1, 4, 1
  v_bfe_u32 v30, v1, 2, 2
  v_lshl_add_u32 v22, v29, 3, v30
  v_add_u32 v22, 4, v22
  v_lshrrev_b32 v31, 5, v1
  v_lshl_add_u32 v22, v31, 4, v22
  v_lshlrev_b32 v22, 7, v22
  v_and_b32 v30, 2, v30
  v_xor_b32 v29, 1, v29
  v_or_b32 v29, v29, v30
  v_xor_b32_e64 v29, s44, v29
  v_lshl_add_u32 v22, v29, 5, v22
  v_and_b32_e64 v30, 3, v1
  v_lshl_add_u32 v22, v30, 3, v22
  v_add_u32 v23, 0x20000, v22
  v_add_u32 v22, 0x10000, v22
  v_lshrrev_b32_e64 v29, 5, v1
  v_bfe_u32 v30, v1, 2, 2
  v_lshl_add_u32 v10, v29, 2, v30
  v_lshlrev_b32 v10, 7, v10
  v_and_b32 v30, 2, v30
  v_or_b32_e64 v29, v29, v30
  v_bfe_u32 v30, v1, 4, 1
  v_lshl_add_u32 v30, s64, 1, v30
  v_xor_b32_e64 v29, v29, v30
  v_lshl_add_u32 v10, v29, 5, v10
  v_and_b32_e64 v30, 3, v1
  v_lshl_add_u32 v10, v30, 3, v10
  v_add_u32 v12, 0x20000, v10
  v_add_u32 v11, 0x10000, v10
  v_lshrrev_b32_e64 v29, 5, v1
  v_bfe_u32 v30, v1, 2, 2
  v_lshl_add_u32 v13, v29, 2, v30
  v_add_u32 v13, 8, v13
  v_lshlrev_b32 v13, 7, v13
  v_and_b32 v30, 2, v30
  v_xor_b32 v29, 1, v29
  v_or_b32_e64 v29, v29, v30
  v_bfe_u32 v30, v1, 4, 1
  v_lshl_add_u32 v30, s64, 1, v30
  v_xor_b32_e64 v29, v29, v30
  v_lshl_add_u32 v13, v29, 5, v13
  v_and_b32_e64 v30, 3, v1
  v_lshl_add_u32 v13, v30, 3, v13
  v_add_u32 v15, 0x20000, v13
  v_add_u32 v14, 0x10000, v13
  v_and_b32 v29, 15, v1
  v_lshrrev_b32 v30, 4, v1
  v_lshrrev_b32 v31, 1, v29
  v_xor_b32 v30, v30, v31
  v_lshlrev_b32 v29, 7, v29
  v_xor_b32 v31, 0, v30
  v_lshl_add_u32 v248, v31, 4, v29
  s_add_u32 s53, s44, 1
  s_lshl_b32 s53, s53, 11
  v_add_u32 v250, s53, v248
  s_lshl_b32 s53, s44, 2
  v_add_u32 v252, s53, v248
  v_xor_b32 v31, 4, v30
  v_lshl_add_u32 v249, v31, 4, v29
  s_add_u32 s53, s44, 1
  s_lshl_b32 s53, s53, 11
  v_add_u32 v251, s53, v249
  s_lshl_b32 s53, s44, 2
  v_add_u32_e64 v253, s53, v249
  v_add_u32 v7, 0x10000, v6
  v_add_u32 v9, 0x20000, v6
  s_branch L_HELPER
L_TRAMP:
  s_setpc_b64 s[96:97]
  .p2align 12
L_COMPUTE:
PAD_0:
  s_cbranch_execz L_TRAMP
  s_nop 0
  s_setprio 2
  s_lshl_b32 s57, s46, 7
  s_lshl_b32 s53, s45, 2
  s_add_u32 s57, s57, s53
  s_lshr_b32 s53, s45, 1
  s_and_b32 s54, s53, 1
  s_lshl_b32 s54, s54, 1
  s_add_u32 s69, s46, 1
  s_sub_u32 s69, s69, s54
  s_lshl_b32 s72, s69, 11
  s_lshl_b32 s53, s53, 9
  s_add_u32 s72, s72, s53
  s_and_b32 s53, s45, 1
  s_lshl_b32 s53, s53, 7
  s_add_u32 s72, s72, s53
  s_add_u32 s72, s72, 65536
  s_cmp_lt_u32 s69, 32
  s_cselect_b32 s72, s72, 2130706432
  v_lshrrev_b32_e64 v29, 2, v1
  v_lshl_add_u32 v29, s44, 4, v29
  v_mul_u32_u24 v5, 3584, v29
  v_and_b32_e64 v30, 3, v1
  v_lshl_add_u32 v5, v30, 4, v5
  v_lshlrev_b32 v28, 2, v1
  s_and_b32 s53, s45, 1
  s_lshl_b32 s55, s53, 6
  s_cmp_eq_u32 s53, 0
  s_cselect_b32 s56, 384, 0
  s_mul_i32 s49, s46, 229376
  s_add_u32 s49, s49, 3145728
  s_lshl_b32 s50, s46, 16
  s_add_u32 s50, s50, 1048576
  s_lshl_b32 s54, s45, 13
  s_add_u32 s65, s49, s54
  s_add_u32 s66, s50, s54
  s_lshl_b32 s80, s46, 13
  s_add_u32 s80, s80, 10485760
  s_lshl_b32 s54, s45, 1
  s_add_u32 s54, s54, s64
  s_lshl_b32 s54, s54, 8
  s_lshl_b32 s69, s61, 12
  s_add_u32 s54, s54, s69
  s_add_u32 s81, s80, s54
  s_mul_i32 s54, s45, 28672
  s_add_u32 s54, s54, s49
  s_mov_b32 s83, s54
  s_lshl_b32 s69, s55, 6
  s_add_u32 s67, s54, s69
  s_lshl_b32 s69, s56, 6
  s_add_u32 s68, s54, s69
  s_mul_i32 s59, s46, 18432
  s_add_u32 s59, s59, 262144
  s_cmp_eq_u32 s46, 0
  s_cselect_b32 s59, 2130706432, s59
  s_getreg_b32 s71, hwreg(HW_REG_XCC_ID)
  s_and_b32 s71, s71, 15
  s_or_b32 s71, s71, 0x80
  v_and_b32_e64 v29, 31, v1
  v_lshl_add_u32 v29, s61, 5, v29
  v_lshrrev_b32 v30, 5, v1
  v_lshlrev_b32 v16, 4, v29
  v_lshl_add_u32 v16, v30, 10, v16
  s_lshl_b32 s53, s64, 12
  v_add_u32 v16, s53, v16
  s_lshl_b32 s53, s64, 7
  s_add_u32 s53, s53, 161792
  v_lshlrev_b32 v27, 4, v30
  v_add_u32 v27, s53, v27
  s_lshl_b32 s92, s46, 7
  s_lshl_b32 s98, s45, 1
  s_mul_i32 s99, s45, 7
  s_add_u32 s101, s98, s44
  s_lshr_b32 s53, s45, 2
  s_add_u32 s53, s53, 1
  s_sub_u32 s54, 64, s53
  s_bitcmp1_b32 s45, 1
  s_cselect_b32 s54, 0, s54
  v_subrev_u32_e64 v31, s54, v29
  v_cmp_gt_u32 s[62:63], s53, v31
  v_lshlrev_b32_e64 v31, 8, v31
  v_lshl_add_u32 v31, v30, 4, v31
  s_lshl_b32 s54, s64, 6
  v_add_u32 v31, s54, v31
  v_mov_b32 v20, 2130706432
  v_cndmask_b32 v20, v20, v31, s[62:63]
  v_mov_b32 v24, 0
  v_mov_b32 v25, 0
  s_mov_b32 s84, 0xaaaaaaaa
  s_mov_b32 s85, 0xaaaaaaaa
  s_mov_b32 s86, 0xfff0ffff
  s_mov_b32 s87, 0xf000ff00
  s_mov_b32 s88, 0xffc0fffc
  s_mov_b32 s89, 0xc000fc00
  v_bfe_u32 v29, v1, 4, 1
  v_bfe_u32 v30, v1, 2, 2
  v_lshl_add_u32 v17, v29, 3, v30
  v_lshrrev_b32_e64 v31, 5, v1
  v_lshl_add_u32 v17, v31, 4, v17
  v_lshlrev_b32 v17, 7, v17
  v_and_b32 v30, 2, v30
  v_or_b32 v29, v29, v30
  v_xor_b32 v29, s44, v29
  v_lshl_add_u32 v17, v29, 5, v17
  v_and_b32_e64 v30, 3, v1
  v_lshl_add_u32 v17, v30, 3, v17
  v_add_u32 v18, 0x20000, v17
  v_add_u32 v17, 0x10000, v17
  v_bfe_u32 v29, v1, 4, 1
  v_bfe_u32 v30, v1, 2, 2
  v_lshl_add_u32 v22, v29, 3, v30
  v_add_u32 v22, 4, v22
  v_lshrrev_b32 v31, 5, v1
  v_lshl_add_u32 v22, v31, 4, v22
  v_lshlrev_b32 v22, 7, v22
  v_and_b32 v30, 2, v30
  v_xor_b32 v29, 1, v29
  v_or_b32 v29, v29, v30
  v_xor_b32_e64 v29, s44, v29
  v_lshl_add_u32 v22, v29, 5, v22
  v_and_b32_e64 v30, 3, v1
  v_lshl_add_u32 v22, v30, 3, v22
  v_add_u32 v23, 0x20000, v22
  v_add_u32 v22, 0x10000, v22
  v_lshrrev_b32_e64 v29, 5, v1
  v_bfe_u32 v30, v1, 2, 2
  v_lshl_add_u32 v10, v29, 2, v30
  v_lshlrev_b32 v10, 7, v10
  v_and_b32 v30, 2, v30
  v_or_b32_e64 v29, v29, v30
  v_bfe_u32 v30, v1, 4, 1
  v_lshl_add_u32 v30, s64, 1, v30
  v_xor_b32_e64 v29, v29, v30
  v_lshl_add_u32 v10, v29, 5, v10
  v_and_b32_e64 v30, 3, v1
  v_lshl_add_u32 v10, v30, 3, v10
  v_add_u32 v12, 0x20000, v10
  v_add_u32 v11, 0x10000, v10
  v_lshrrev_b32_e64 v29, 5, v1
  v_bfe_u32 v30, v1, 2, 2
  v_lshl_add_u32 v13, v29, 2, v30
  v_add_u32 v13, 8, v13
  v_lshlrev_b32 v13, 7, v13
  v_and_b32 v30, 2, v30
  v_xor_b32 v29, 1, v29
  v_or_b32_e64 v29, v29, v30
  v_bfe_u32 v30, v1, 4, 1
  v_lshl_add_u32 v30, s64, 1, v30
  v_xor_b32_e64 v29, v29, v30
  v_lshl_add_u32 v13, v29, 5, v13
  v_and_b32_e64 v30, 3, v1
  v_lshl_add_u32 v13, v30, 3, v13
  v_add_u32 v15, 0x20000, v13
  v_add_u32 v14, 0x10000, v13
  v_and_b32 v29, 15, v1
  v_lshrrev_b32 v30, 4, v1
  v_lshrrev_b32 v31, 1, v29
  v_xor_b32 v30, v30, v31
  v_lshlrev_b32 v29, 7, v29
  v_xor_b32 v31, 0, v30
  v_lshl_add_u32 v248, v31, 4, v29
  s_add_u32 s53, s44, 1
  s_lshl_b32 s53, s53, 11
  v_add_u32 v250, s53, v248
  s_lshl_b32 s53, s44, 2
  v_add_u32 v252, s53, v248
  v_xor_b32 v31, 4, v30
  v_lshl_add_u32 v249, v31, 4, v29
  s_add_u32 s53, s44, 1
  s_lshl_b32 s53, s53, 11
  v_add_u32 v251, s53, v249
  s_lshl_b32 s53, s44, 2
  v_add_u32 v253, s53, v249
  v_and_b32 v29, 31, v1
  v_lshl_add_u32 v29, s61, 5, v29
  v_lshlrev_b32_e64 v29, 2, v29
  v_add_u32 v26, 159744, v29
  s_mov_b64 exec, 0
  s_cmp_lg_u32 s44, 0
  s_cbranch_scc1 CPF_1
  s_call_b64 s[96:97], L_TRAMP
  s_call_b64 s[96:97], L_TRAMP
CPF_1:
  s_cmp_lg_u32 s44, 1
  s_cbranch_scc1 CPF_2
  s_call_b64 s[96:97], L_TRAMP
  s_call_b64 s[96:97], PAD_18
CPF_2:
  s_cmp_lg_u32 s44, 2
  s_cbranch_scc1 CPF_3
  s_call_b64 s[96:97], PAD_0
  s_call_b64 s[96:97], PAD_1
CPF_3:
  s_cmp_lg_u32 s44, 3
  s_cbranch_scc1 CPF_4
  s_call_b64 s[96:97], PAD_2
  s_call_b64 s[96:97], PAD_19
CPF_4:
  s_mov_b64 exec, -1
  v_mov_b32 v31, 0x0c0c0c0c
  v_mov_b32 v29, 0xc0c0100
  v_mov_b32 v30, 0x1000c0c
  v_cndmask_b32 v29, v29, v30, s[84:85]
  v_cndmask_b32 v92, v31, v29, s[86:87]
  v_cndmask_b32 v94, v29, v31, s[86:87]
  v_mov_b32 v29, 0xc0c0302
  v_mov_b32 v30, 0x3020c0c
  v_cndmask_b32 v29, v29, v30, s[84:85]
  v_cndmask_b32 v93, v31, v29, s[88:89]
  v_cndmask_b32 v95, v29, v31, s[88:89]
  v_and_b32 v122, 15, v1
  v_lshlrev_b32 v122, 2, v122
  v_add_u32 v122, 159744, v122
  v_and_b32_e64 v31, 48, v1
  v_add_u32 v120, 159744, v31
  s_lshl_b32 s53, s44, 6
  s_add_u32 s53, s53, 2048
  v_add_u32 v126, s53, v120
  v_add_u32_e64 v127, s53, v122
  v_bfe_u32 v29, v1, 4, 1
  v_lshrrev_b32_e64 v30, 5, v1
  v_lshl_add_u32 v31, v29, 1, v30
  v_lshl_add_u32 v123, v31, 6, v122
  v_and_b32 v31, 15, v1
  v_lshlrev_b32 v31, 4, v31
  v_lshl_add_u32 v31, v29, 10, v31
  v_lshl_add_u32 v31, v30, 8, v31
  s_lshl_b32 s53, s44, 11
  v_add_u32 v121, s53, v31
  v_mov_b32 v96, s60
  v_mov_b32 v97, s60
  v_mov_b32 v98, s60
  v_mov_b32 v99, s60
  v_and_b32_e64 v31, 31, v1
  v_lshl_add_u32 v31, s61, 5, v31
  v_add_u32 v31, 16, v31
  v_lshlrev_b32 v31, 7, v31
  v_lshrrev_b32_e64 v30, 5, v1
  v_lshl_add_u32 v31, v30, 3, v31
  v_bfe_u32 v30, v1, 1, 3
  s_lshl_b32 s53, s64, 2
  v_xor_b32 v30, s53, v30
  v_xor_b32_e64 v116, 0, v30
  v_lshl_add_u32 v116, v116, 4, v31
  v_xor_b32_e64 v117, 1, v30
  v_lshl_add_u32 v117, v117, 4, v31
  v_xor_b32_e64 v118, 2, v30
  v_lshl_add_u32 v118, v118, 4, v31
  v_xor_b32_e64 v119, 3, v30
  v_lshl_add_u32 v119, v119, 4, v31
  v_lshrrev_b32_e64 v30, 5, v1
  v_lshl_add_u32 v112, v30, 6, v122
  s_lshl_b32 s53, s44, 7
  v_add_u32 v112, s53, v112
  s_lshl_b32 s53, s44, 6
  s_add_u32 s53, s53, 64
  v_add_u32_e64 v113, s53, v122
  v_add_u32 v114, 1024, v122
  s_barrier
  ds_read_b64 v[48:49], v116
  ds_read_b64 v[50:51], v117
  ds_read_b64 v[52:53], v118
  ds_read_b64 v[54:55], v119
  s_waitcnt lgkmcnt(3)
  v_lshlrev_b32_e64 v32, 16, v48
  v_and_b32 v33, 0xffff0000, v48
  v_lshlrev_b32_e64 v34, 16, v49
  v_and_b32 v35, 0xffff0000, v49
  s_waitcnt lgkmcnt(2)
  v_lshlrev_b32 v36, 16, v50
  v_and_b32 v37, 0xffff0000, v50
  v_lshlrev_b32_e64 v38, 16, v51
  v_and_b32 v39, 0xffff0000, v51
  s_waitcnt lgkmcnt(1)
  v_lshlrev_b32 v40, 16, v52
  v_and_b32 v41, 0xffff0000, v52
  v_lshlrev_b32_e64 v42, 16, v53
  v_and_b32 v43, 0xffff0000, v53
  s_waitcnt lgkmcnt(0)
  v_lshlrev_b32 v44, 16, v54
  v_and_b32 v45, 0xffff0000, v54
  v_lshlrev_b32_e64 v46, 16, v55
  v_and_b32 v47, 0xffff0000, v55
  s_barrier
  s_nop 0
  ds_read_b64_tr_b16 v[224:225], v17 offset:0
  ds_read_b64_tr_b16 v[226:227], v22 offset:0
  ds_read_b128 v[188:191], v248 offset:2048
  ds_read_b64_tr_b16 v[228:229], v17 offset:4096
  ds_read_b64_tr_b16 v[230:231], v22 offset:4096
  ds_read_b64_tr_b16 v[232:233], v17 offset:8192
  ds_read_b64_tr_b16 v[234:235], v22 offset:8192
  ds_read_b128 v[192:195], v248 offset:4096
  ds_read_b128 v[196:199], v248 offset:6144
  ds_read_b128 v[200:203], v248 offset:8192
  ds_read_b128 v[184:187], v248 offset:0
  ds_read_b128 v[64:67], v250 offset:0
  ds_read_b32 v68, v252 offset:0
  s_waitcnt lgkmcnt(1)
  s_nop 0
  v_dot2_f32_bf16 v24, v64, s60, 0
  v_dot2_f32_bf16 v25, v64, v64, 0
  v_dot2_f32_bf16 v24, v65, s60, v24
  v_dot2_f32_bf16 v25, v65, v65, v25
  v_dot2_f32_bf16 v24, v66, s60, v24
  v_dot2_f32_bf16 v25, v66, v66, v25
  v_dot2_f32_bf16 v24, v67, s60, v24
  v_dot2_f32_bf16 v25, v67, v67, v25
  s_waitcnt lgkmcnt(0)
  v_dot2_f32_bf16 v62, v68, s60, 0
  v_dot2_f32_bf16 v63, v68, v68, 0
  v_mfma_f32_16x16x32_bf16 v[128:131], v[224:227], v[188:191], 0
  s_barrier
  v_mfma_f32_16x16x32_bf16 v[148:151], v[228:231], v[188:191], 0
  ds_read_b64_tr_b16 v[236:237], v17 offset:12288
  v_mfma_f32_16x16x32_bf16 v[168:171], v[188:191], v[232:235], 0
  ds_read_b64_tr_b16 v[238:239], v22 offset:12288
  v_mfma_f32_16x16x32_bf16 v[132:135], v[224:227], v[192:195], 0
  ds_read_b128 v[208:211], v249 offset:2048
  v_mfma_f32_16x16x32_bf16 v[152:155], v[228:231], v[192:195], 0
  ds_read_b64_tr_b16 v[240:241], v17 offset:16384
  v_mfma_f32_16x16x32_bf16 v[172:175], v[192:195], v[232:235], 0
  ds_read_b64_tr_b16 v[242:243], v22 offset:16384
  v_mfma_f32_16x16x32_bf16 v[136:139], v[224:227], v[196:199], 0
  ds_read_b64_tr_b16 v[244:245], v17 offset:20480
  v_mfma_f32_16x16x32_bf16 v[156:159], v[228:231], v[196:199], 0
  ds_read_b64_tr_b16 v[246:247], v22 offset:20480
  v_mfma_f32_16x16x32_bf16 v[176:179], v[196:199], v[232:235], 0
  ds_read_b128 v[212:215], v249 offset:4096
  v_mfma_f32_16x16x32_bf16 v[140:143], v[224:227], v[200:203], 0
  ds_read_b128 v[216:219], v249 offset:6144
  v_mfma_f32_16x16x32_bf16 v[160:163], v[228:231], v[200:203], 0
  ds_read_b128 v[220:223], v249 offset:8192
  v_mfma_f32_16x16x32_bf16 v[180:183], v[200:203], v[232:235], 0
  ds_read_b128 v[204:207], v249 offset:0
  v_mfma_f32_16x16x32_bf16 v[144:147], v[228:231], v[184:187], 0
  ds_read_b128 v[72:75], v251 offset:0
  v_mfma_f32_16x16x32_bf16 v[164:167], v[184:187], v[232:235], 0
  ds_read_b32 v76, v253 offset:0
  v_mfma_f32_16x16x32_bf16 v[80:83], v[224:227], v[96:99], 0
  v_mfma_f32_16x16x32_bf16 v[84:87], v[228:231], v[96:99], 0
  v_mfma_f32_16x16x32_bf16 v[88:91], v[96:99], v[232:235], 0
  s_waitcnt lgkmcnt(1)
  s_nop 0
  v_dot2_f32_bf16 v24, v72, s60, v24
  v_dot2_f32_bf16 v25, v72, v72, v25
  v_dot2_f32_bf16 v24, v73, s60, v24
  v_dot2_f32_bf16 v25, v73, v73, v25
  v_dot2_f32_bf16 v24, v74, s60, v24
  v_dot2_f32_bf16 v25, v74, v74, v25
  v_dot2_f32_bf16 v24, v75, s60, v24
  v_dot2_f32_bf16 v25, v75, v75, v25
  s_waitcnt lgkmcnt(0)
  v_dot2_f32_bf16 v62, v76, s60, v62
  v_dot2_f32_bf16 v63, v76, v76, v63
  v_mfma_f32_16x16x32_bf16 v[128:131], v[236:239], v[208:211], v[128:131]
  s_barrier
  v_mfma_f32_16x16x32_bf16 v[148:151], v[240:243], v[208:211], v[148:151]
  ds_read_b64_tr_b16 v[224:225], v17 offset:24576
  v_mfma_f32_16x16x32_bf16 v[168:171], v[208:211], v[244:247], v[168:171]
  ds_read_b64_tr_b16 v[226:227], v22 offset:24576
  v_mfma_f32_16x16x32_bf16 v[132:135], v[236:239], v[212:215], v[132:135]
  ds_read_b128 v[188:191], v248 offset:14336
  v_mfma_f32_16x16x32_bf16 v[152:155], v[240:243], v[212:215], v[152:155]
  ds_read_b64_tr_b16 v[228:229], v17 offset:28672
  v_mfma_f32_16x16x32_bf16 v[172:175], v[212:215], v[244:247], v[172:175]
  ds_read_b64_tr_b16 v[230:231], v22 offset:28672
  v_mfma_f32_16x16x32_bf16 v[136:139], v[236:239], v[216:219], v[136:139]
  ds_read_b64_tr_b16 v[232:233], v17 offset:32768
  v_mfma_f32_16x16x32_bf16 v[156:159], v[240:243], v[216:219], v[156:159]
  ds_read_b64_tr_b16 v[234:235], v22 offset:32768
  v_mfma_f32_16x16x32_bf16 v[176:179], v[216:219], v[244:247], v[176:179]
  ds_read_b128 v[192:195], v248 offset:16384
  v_mfma_f32_16x16x32_bf16 v[140:143], v[236:239], v[220:223], v[140:143]
  ds_read_b128 v[196:199], v248 offset:18432
  v_mfma_f32_16x16x32_bf16 v[160:163], v[240:243], v[220:223], v[160:163]
  ds_read_b128 v[200:203], v248 offset:20480
  v_mfma_f32_16x16x32_bf16 v[180:183], v[220:223], v[244:247], v[180:183]
  ds_read_b128 v[184:187], v248 offset:12288
  v_mfma_f32_16x16x32_bf16 v[144:147], v[240:243], v[204:207], v[144:147]
  ds_read_b128 v[64:67], v250 offset:12288
  v_mfma_f32_16x16x32_bf16 v[164:167], v[204:207], v[244:247], v[164:167]
  ds_read_b32 v68, v252 offset:12288
  v_mfma_f32_16x16x32_bf16 v[80:83], v[236:239], v[96:99], v[80:83]
  v_mfma_f32_16x16x32_bf16 v[84:87], v[240:243], v[96:99], v[84:87]
  v_mfma_f32_16x16x32_bf16 v[88:91], v[96:99], v[244:247], v[88:91]
  s_waitcnt lgkmcnt(1)
  s_nop 0
  v_dot2_f32_bf16 v24, v64, s60, v24
  v_dot2_f32_bf16 v25, v64, v64, v25
  v_dot2_f32_bf16 v24, v65, s60, v24
  v_dot2_f32_bf16 v25, v65, v65, v25
  v_dot2_f32_bf16 v24, v66, s60, v24
  v_dot2_f32_bf16 v25, v66, v66, v25
  v_dot2_f32_bf16 v24, v67, s60, v24
  v_dot2_f32_bf16 v25, v67, v67, v25
  s_waitcnt lgkmcnt(0)
  v_dot2_f32_bf16 v62, v68, s60, v62
  v_dot2_f32_bf16 v63, v68, v68, v63
  v_mfma_f32_16x16x32_bf16 v[128:131], v[224:227], v[188:191], v[128:131]
  s_barrier
  v_mfma_f32_16x16x32_bf16 v[148:151], v[228:231], v[188:191], v[148:151]
  ds_read_b64_tr_b16 v[236:237], v17 offset:36864
  v_mfma_f32_16x16x32_bf16 v[168:171], v[188:191], v[232:235], v[168:171]
  ds_read_b64_tr_b16 v[238:239], v22 offset:36864
  v_mfma_f32_16x16x32_bf16 v[132:135], v[224:227], v[192:195], v[132:135]
  ds_read_b128 v[208:211], v249 offset:14336
  v_mfma_f32_16x16x32_bf16 v[152:155], v[228:231], v[192:195], v[152:155]
  ds_read_b64_tr_b16 v[240:241], v17 offset:40960
  v_mfma_f32_16x16x32_bf16 v[172:175], v[192:195], v[232:235], v[172:175]
  ds_read_b64_tr_b16 v[242:243], v22 offset:40960
  v_mfma_f32_16x16x32_bf16 v[136:139], v[224:227], v[196:199], v[136:139]
  ds_read_b64_tr_b16 v[244:245], v17 offset:45056
  v_mfma_f32_16x16x32_bf16 v[156:159], v[228:231], v[196:199], v[156:159]
  ds_read_b64_tr_b16 v[246:247], v22 offset:45056
  v_mfma_f32_16x16x32_bf16 v[176:179], v[196:199], v[232:235], v[176:179]
  ds_read_b128 v[212:215], v249 offset:16384
  v_mfma_f32_16x16x32_bf16 v[140:143], v[224:227], v[200:203], v[140:143]
  ds_read_b128 v[216:219], v249 offset:18432
  v_mfma_f32_16x16x32_bf16 v[160:163], v[228:231], v[200:203], v[160:163]
  ds_read_b128 v[220:223], v249 offset:20480
  v_mfma_f32_16x16x32_bf16 v[180:183], v[200:203], v[232:235], v[180:183]
  ds_read_b128 v[204:207], v249 offset:12288
  v_mfma_f32_16x16x32_bf16 v[144:147], v[228:231], v[184:187], v[144:147]
  ds_read_b128 v[72:75], v251 offset:12288
  v_mfma_f32_16x16x32_bf16 v[164:167], v[184:187], v[232:235], v[164:167]
  ds_read_b32 v76, v253 offset:12288
  v_mfma_f32_16x16x32_bf16 v[80:83], v[224:227], v[96:99], v[80:83]
  v_mfma_f32_16x16x32_bf16 v[84:87], v[228:231], v[96:99], v[84:87]
  v_mfma_f32_16x16x32_bf16 v[88:91], v[96:99], v[232:235], v[88:91]
  s_waitcnt lgkmcnt(1)
  s_nop 0
  v_dot2_f32_bf16 v24, v72, s60, v24
  v_dot2_f32_bf16 v25, v72, v72, v25
  v_dot2_f32_bf16 v24, v73, s60, v24
  v_dot2_f32_bf16 v25, v73, v73, v25
  v_dot2_f32_bf16 v24, v74, s60, v24
  v_dot2_f32_bf16 v25, v74, v74, v25
  v_dot2_f32_bf16 v24, v75, s60, v24
  v_dot2_f32_bf16 v25, v75, v75, v25
  s_waitcnt lgkmcnt(0)
  v_dot2_f32_bf16 v62, v76, s60, v62
  v_dot2_f32_bf16 v63, v76, v76, v63
  v_mfma_f32_16x16x32_bf16 v[128:131], v[236:239], v[208:211], v[128:131]
  s_barrier
  v_mfma_f32_16x16x32_bf16 v[148:151], v[240:243], v[208:211], v[148:151]
  ds_read_b64_tr_b16 v[224:225], v17 offset:0
  v_mfma_f32_16x16x32_bf16 v[168:171], v[208:211], v[244:247], v[168:171]
  ds_read_b64_tr_b16 v[226:227], v22 offset:0
  v_mfma_f32_16x16x32_bf16 v[132:135], v[236:239], v[212:215], v[132:135]
  ds_read_b128 v[188:191], v248 offset:26624
  v_mfma_f32_16x16x32_bf16 v[152:155], v[240:243], v[212:215], v[152:155]
  ds_read_b64_tr_b16 v[228:229], v17 offset:4096
  v_mfma_f32_16x16x32_bf16 v[172:175], v[212:215], v[244:247], v[172:175]
  ds_read_b64_tr_b16 v[230:231], v22 offset:4096
  v_mfma_f32_16x16x32_bf16 v[136:139], v[236:239], v[216:219], v[136:139]
  ds_read_b64_tr_b16 v[232:233], v17 offset:8192
  v_mfma_f32_16x16x32_bf16 v[156:159], v[240:243], v[216:219], v[156:159]
  ds_read_b64_tr_b16 v[234:235], v22 offset:8192
  v_mfma_f32_16x16x32_bf16 v[176:179], v[216:219], v[244:247], v[176:179]
  ds_read_b128 v[192:195], v248 offset:28672
  v_mfma_f32_16x16x32_bf16 v[140:143], v[236:239], v[220:223], v[140:143]
  ds_read_b128 v[196:199], v248 offset:30720
  v_mfma_f32_16x16x32_bf16 v[160:163], v[240:243], v[220:223], v[160:163]
  ds_read_b128 v[200:203], v248 offset:32768
  v_mfma_f32_16x16x32_bf16 v[180:183], v[220:223], v[244:247], v[180:183]
  ds_read_b128 v[184:187], v248 offset:24576
  v_mfma_f32_16x16x32_bf16 v[144:147], v[240:243], v[204:207], v[144:147]
  ds_read_b128 v[64:67], v250 offset:24576
  v_mfma_f32_16x16x32_bf16 v[164:167], v[204:207], v[244:247], v[164:167]
  ds_read_b32 v68, v252 offset:24576
  v_mfma_f32_16x16x32_bf16 v[80:83], v[236:239], v[96:99], v[80:83]
  v_mfma_f32_16x16x32_bf16 v[84:87], v[240:243], v[96:99], v[84:87]
  v_mfma_f32_16x16x32_bf16 v[88:91], v[96:99], v[244:247], v[88:91]
  s_waitcnt lgkmcnt(1)
  s_nop 0
  v_dot2_f32_bf16 v24, v64, s60, v24
  v_dot2_f32_bf16 v25, v64, v64, v25
  v_dot2_f32_bf16 v24, v65, s60, v24
  v_dot2_f32_bf16 v25, v65, v65, v25
  v_dot2_f32_bf16 v24, v66, s60, v24
  v_dot2_f32_bf16 v25, v66, v66, v25
  v_dot2_f32_bf16 v24, v67, s60, v24
  v_dot2_f32_bf16 v25, v67, v67, v25
  s_waitcnt lgkmcnt(0)
  v_dot2_f32_bf16 v62, v68, s60, v62
  v_dot2_f32_bf16 v63, v68, v68, v63
  v_mfma_f32_16x16x32_bf16 v[128:131], v[224:227], v[188:191], v[128:131]
  s_barrier
  v_mfma_f32_16x16x32_bf16 v[148:151], v[228:231], v[188:191], v[148:151]
  ds_read_b64_tr_b16 v[236:237], v17 offset:12288
  v_mfma_f32_16x16x32_bf16 v[168:171], v[188:191], v[232:235], v[168:171]
  ds_read_b64_tr_b16 v[238:239], v22 offset:12288
  v_mfma_f32_16x16x32_bf16 v[132:135], v[224:227], v[192:195], v[132:135]
  ds_read_b128 v[208:211], v249 offset:26624
  v_mfma_f32_16x16x32_bf16 v[152:155], v[228:231], v[192:195], v[152:155]
  ds_read_b64_tr_b16 v[240:241], v17 offset:16384
  v_mfma_f32_16x16x32_bf16 v[172:175], v[192:195], v[232:235], v[172:175]
  ds_read_b64_tr_b16 v[242:243], v22 offset:16384
  v_mfma_f32_16x16x32_bf16 v[136:139], v[224:227], v[196:199], v[136:139]
  ds_read_b64_tr_b16 v[244:245], v17 offset:20480
  v_mfma_f32_16x16x32_bf16 v[156:159], v[228:231], v[196:199], v[156:159]
  ds_read_b64_tr_b16 v[246:247], v22 offset:20480
  v_mfma_f32_16x16x32_bf16 v[176:179], v[196:199], v[232:235], v[176:179]
  ds_read_b128 v[212:215], v249 offset:28672
  v_mfma_f32_16x16x32_bf16 v[140:143], v[224:227], v[200:203], v[140:143]
  ds_read_b128 v[216:219], v249 offset:30720
  v_mfma_f32_16x16x32_bf16 v[160:163], v[228:231], v[200:203], v[160:163]
  ds_read_b128 v[220:223], v249 offset:32768
  v_mfma_f32_16x16x32_bf16 v[180:183], v[200:203], v[232:235], v[180:183]
  ds_read_b128 v[204:207], v249 offset:24576
  v_mfma_f32_16x16x32_bf16 v[144:147], v[228:231], v[184:187], v[144:147]
  ds_read_b128 v[72:75], v251 offset:24576
  v_mfma_f32_16x16x32_bf16 v[164:167], v[184:187], v[232:235], v[164:167]
  ds_read_b32 v76, v253 offset:24576
  v_mfma_f32_16x16x32_bf16 v[80:83], v[224:227], v[96:99], v[80:83]
  v_mfma_f32_16x16x32_bf16 v[84:87], v[228:231], v[96:99], v[84:87]
  v_mfma_f32_16x16x32_bf16 v[88:91], v[96:99], v[232:235], v[88:91]
  s_waitcnt lgkmcnt(1)
  s_nop 0
  v_dot2_f32_bf16 v24, v72, s60, v24
  v_dot2_f32_bf16 v25, v72, v72, v25
  v_dot2_f32_bf16 v24, v73, s60, v24
  v_dot2_f32_bf16 v25, v73, v73, v25
  v_dot2_f32_bf16 v24, v74, s60, v24
  v_dot2_f32_bf16 v25, v74, v74, v25
  v_dot2_f32_bf16 v24, v75, s60, v24
  v_dot2_f32_bf16 v25, v75, v75, v25
  s_waitcnt lgkmcnt(0)
  v_dot2_f32_bf16 v62, v76, s60, v62
  v_dot2_f32_bf16 v63, v76, v76, v63
  v_mfma_f32_16x16x32_bf16 v[128:131], v[236:239], v[208:211], v[128:131]
  s_barrier
  v_mfma_f32_16x16x32_bf16 v[148:151], v[240:243], v[208:211], v[148:151]
  ds_read_b64_tr_b16 v[224:225], v17 offset:24576
  v_mfma_f32_16x16x32_bf16 v[168:171], v[208:211], v[244:247], v[168:171]
  ds_read_b64_tr_b16 v[226:227], v22 offset:24576
  v_mfma_f32_16x16x32_bf16 v[132:135], v[236:239], v[212:215], v[132:135]
  ds_read_b128 v[188:191], v248 offset:38912
  v_mfma_f32_16x16x32_bf16 v[152:155], v[240:243], v[212:215], v[152:155]
  ds_read_b64_tr_b16 v[228:229], v17 offset:28672
  v_mfma_f32_16x16x32_bf16 v[172:175], v[212:215], v[244:247], v[172:175]
  ds_read_b64_tr_b16 v[230:231], v22 offset:28672
  v_mfma_f32_16x16x32_bf16 v[136:139], v[236:239], v[216:219], v[136:139]
  ds_read_b64_tr_b16 v[232:233], v17 offset:32768
  v_mfma_f32_16x16x32_bf16 v[156:159], v[240:243], v[216:219], v[156:159]
  ds_read_b64_tr_b16 v[234:235], v22 offset:32768
  v_mfma_f32_16x16x32_bf16 v[176:179], v[216:219], v[244:247], v[176:179]
  ds_read_b128 v[192:195], v248 offset:40960
  v_mfma_f32_16x16x32_bf16 v[140:143], v[236:239], v[220:223], v[140:143]
  ds_read_b128 v[196:199], v248 offset:43008
  v_mfma_f32_16x16x32_bf16 v[160:163], v[240:243], v[220:223], v[160:163]
  ds_read_b128 v[200:203], v248 offset:45056
  v_mfma_f32_16x16x32_bf16 v[180:183], v[220:223], v[244:247], v[180:183]
  ds_read_b128 v[184:187], v248 offset:36864
  v_mfma_f32_16x16x32_bf16 v[144:147], v[240:243], v[204:207], v[144:147]
  ds_read_b128 v[64:67], v250 offset:36864
  v_mfma_f32_16x16x32_bf16 v[164:167], v[204:207], v[244:247], v[164:167]
  ds_read_b32 v68, v252 offset:36864
  v_mfma_f32_16x16x32_bf16 v[80:83], v[236:239], v[96:99], v[80:83]
  v_mfma_f32_16x16x32_bf16 v[84:87], v[240:243], v[96:99], v[84:87]
  v_mfma_f32_16x16x32_bf16 v[88:91], v[96:99], v[244:247], v[88:91]
  s_waitcnt lgkmcnt(1)
  s_nop 0
  v_dot2_f32_bf16 v24, v64, s60, v24
  v_dot2_f32_bf16 v25, v64, v64, v25
  v_dot2_f32_bf16 v24, v65, s60, v24
  v_dot2_f32_bf16 v25, v65, v65, v25
  v_dot2_f32_bf16 v24, v66, s60, v24
  v_dot2_f32_bf16 v25, v66, v66, v25
  v_dot2_f32_bf16 v24, v67, s60, v24
  v_dot2_f32_bf16 v25, v67, v67, v25
  s_waitcnt lgkmcnt(0)
  v_dot2_f32_bf16 v62, v68, s60, v62
  v_dot2_f32_bf16 v63, v68, v68, v63
  v_mfma_f32_16x16x32_bf16 v[128:131], v[224:227], v[188:191], v[128:131]
  s_barrier
  v_mfma_f32_16x16x32_bf16 v[148:151], v[228:231], v[188:191], v[148:151]
  ds_read_b64_tr_b16 v[236:237], v17 offset:49152
  v_mfma_f32_16x16x32_bf16 v[168:171], v[188:191], v[232:235], v[168:171]
  ds_read_b64_tr_b16 v[238:239], v22 offset:49152
  v_mfma_f32_16x16x32_bf16 v[132:135], v[224:227], v[192:195], v[132:135]
  ds_read_b128 v[208:211], v249 offset:38912
  v_mfma_f32_16x16x32_bf16 v[152:155], v[228:231], v[192:195], v[152:155]
  ds_read_b64_tr_b16 v[240:241], v17 offset:53248
  v_mfma_f32_16x16x32_bf16 v[172:175], v[192:195], v[232:235], v[172:175]
  ds_read_b64_tr_b16 v[242:243], v22 offset:53248
  v_mfma_f32_16x16x32_bf16 v[136:139], v[224:227], v[196:199], v[136:139]
  ds_read_b64_tr_b16 v[244:245], v17 offset:36864
  v_mfma_f32_16x16x32_bf16 v[156:159], v[228:231], v[196:199], v[156:159]
  ds_read_b64_tr_b16 v[246:247], v22 offset:36864
  v_mfma_f32_16x16x32_bf16 v[176:179], v[196:199], v[232:235], v[176:179]
  ds_read_b128 v[212:215], v249 offset:40960
  v_mfma_f32_16x16x32_bf16 v[140:143], v[224:227], v[200:203], v[140:143]
  ds_read_b128 v[216:219], v249 offset:43008
  v_mfma_f32_16x16x32_bf16 v[160:163], v[228:231], v[200:203], v[160:163]
  ds_read_b128 v[220:223], v249 offset:45056
  v_mfma_f32_16x16x32_bf16 v[180:183], v[200:203], v[232:235], v[180:183]
  ds_read_b128 v[204:207], v249 offset:36864
  v_mfma_f32_16x16x32_bf16 v[144:147], v[228:231], v[184:187], v[144:147]
  ds_read_b128 v[72:75], v251 offset:36864
PAD_1:
  s_cbranch_execz L_TRAMP
  s_nop 0
  v_mfma_f32_16x16x32_bf16 v[164:167], v[184:187], v[232:235], v[164:167]
  ds_read_b32 v76, v253 offset:36864
  v_mfma_f32_16x16x32_bf16 v[80:83], v[224:227], v[96:99], v[80:83]
  v_mfma_f32_16x16x32_bf16 v[84:87], v[228:231], v[96:99], v[84:87]
  v_mfma_f32_16x16x32_bf16 v[88:91], v[96:99], v[232:235], v[88:91]
  s_waitcnt lgkmcnt(1)
  s_nop 0
  v_dot2_f32_bf16 v24, v72, s60, v24
  v_dot2_f32_bf16 v25, v72, v72, v25
  v_dot2_f32_bf16 v24, v73, s60, v24
  v_dot2_f32_bf16 v25, v73, v73, v25
  v_dot2_f32_bf16 v24, v74, s60, v24
  v_dot2_f32_bf16 v25, v74, v74, v25
  v_dot2_f32_bf16 v24, v75, s60, v24
  v_dot2_f32_bf16 v25, v75, v75, v25
  s_waitcnt lgkmcnt(0)
  v_dot2_f32_bf16 v62, v76, s60, v62
  v_dot2_f32_bf16 v63, v76, v76, v63
  v_mfma_f32_16x16x32_bf16 v[128:131], v[236:239], v[208:211], v[128:131]
  s_barrier
  v_mfma_f32_16x16x32_bf16 v[148:151], v[240:243], v[208:211], v[148:151]
  ds_read_b64_tr_b16 v[224:225], v17 offset:40960
  v_mfma_f32_16x16x32_bf16 v[168:171], v[208:211], v[244:247], v[168:171]
  ds_read_b64_tr_b16 v[226:227], v22 offset:40960
  v_mfma_f32_16x16x32_bf16 v[132:135], v[236:239], v[212:215], v[132:135]
  ds_read_b128 v[188:191], v248 offset:51200
  v_mfma_f32_16x16x32_bf16 v[152:155], v[240:243], v[212:215], v[152:155]
  ds_read_b64_tr_b16 v[228:229], v17 offset:45056
  v_mfma_f32_16x16x32_bf16 v[172:175], v[212:215], v[244:247], v[172:175]
  ds_read_b64_tr_b16 v[230:231], v22 offset:45056
  v_mfma_f32_16x16x32_bf16 v[136:139], v[236:239], v[216:219], v[136:139]
  ds_read_b64_tr_b16 v[232:233], v17 offset:0
  v_mfma_f32_16x16x32_bf16 v[156:159], v[240:243], v[216:219], v[156:159]
  ds_read_b64_tr_b16 v[234:235], v22 offset:0
  v_mfma_f32_16x16x32_bf16 v[176:179], v[216:219], v[244:247], v[176:179]
  ds_read_b128 v[192:195], v248 offset:53248
  v_mfma_f32_16x16x32_bf16 v[140:143], v[236:239], v[220:223], v[140:143]
  ds_read_b128 v[196:199], v248 offset:55296
  v_mfma_f32_16x16x32_bf16 v[160:163], v[240:243], v[220:223], v[160:163]
  ds_read_b128 v[200:203], v248 offset:57344
  v_mfma_f32_16x16x32_bf16 v[180:183], v[220:223], v[244:247], v[180:183]
  ds_read_b128 v[184:187], v248 offset:49152
  v_mfma_f32_16x16x32_bf16 v[144:147], v[240:243], v[204:207], v[144:147]
  ds_read_b128 v[64:67], v250 offset:49152
  v_mfma_f32_16x16x32_bf16 v[164:167], v[204:207], v[244:247], v[164:167]
  ds_read_b32 v68, v252 offset:49152
  v_mfma_f32_16x16x32_bf16 v[80:83], v[236:239], v[96:99], v[80:83]
  v_mfma_f32_16x16x32_bf16 v[84:87], v[240:243], v[96:99], v[84:87]
  v_mfma_f32_16x16x32_bf16 v[88:91], v[96:99], v[244:247], v[88:91]
  s_waitcnt lgkmcnt(1)
  s_nop 0
  v_dot2_f32_bf16 v24, v64, s60, v24
  v_dot2_f32_bf16 v25, v64, v64, v25
  v_dot2_f32_bf16 v24, v65, s60, v24
  v_dot2_f32_bf16 v25, v65, v65, v25
  v_dot2_f32_bf16 v24, v66, s60, v24
  v_dot2_f32_bf16 v25, v66, v66, v25
  v_dot2_f32_bf16 v24, v67, s60, v24
  v_dot2_f32_bf16 v25, v67, v67, v25
  s_waitcnt lgkmcnt(0)
  v_dot2_f32_bf16 v62, v68, s60, v62
  v_dot2_f32_bf16 v63, v68, v68, v63
  v_mfma_f32_16x16x32_bf16 v[128:131], v[224:227], v[188:191], v[128:131]
  s_barrier
  v_mfma_f32_16x16x32_bf16 v[148:151], v[228:231], v[188:191], v[148:151]
  ds_read_b64_tr_b16 v[236:237], v17 offset:4096
  v_mfma_f32_16x16x32_bf16 v[168:171], v[188:191], v[232:235], v[168:171]
  ds_read_b64_tr_b16 v[238:239], v22 offset:4096
  v_mfma_f32_16x16x32_bf16 v[132:135], v[224:227], v[192:195], v[132:135]
  ds_read_b128 v[208:211], v249 offset:51200
  v_mfma_f32_16x16x32_bf16 v[152:155], v[228:231], v[192:195], v[152:155]
  ds_read_b64_tr_b16 v[240:241], v17 offset:8192
  v_mfma_f32_16x16x32_bf16 v[172:175], v[192:195], v[232:235], v[172:175]
  ds_read_b64_tr_b16 v[242:243], v22 offset:8192
  v_mfma_f32_16x16x32_bf16 v[136:139], v[224:227], v[196:199], v[136:139]
  ds_read_b64_tr_b16 v[244:245], v17 offset:57344
  v_mfma_f32_16x16x32_bf16 v[156:159], v[228:231], v[196:199], v[156:159]
  ds_read_b64_tr_b16 v[246:247], v22 offset:57344
  v_mfma_f32_16x16x32_bf16 v[176:179], v[196:199], v[232:235], v[176:179]
  ds_read_b128 v[212:215], v249 offset:53248
  v_mfma_f32_16x16x32_bf16 v[140:143], v[224:227], v[200:203], v[140:143]
  ds_read_b128 v[216:219], v249 offset:55296
  v_mfma_f32_16x16x32_bf16 v[160:163], v[228:231], v[200:203], v[160:163]
  ds_read_b128 v[220:223], v249 offset:57344
  v_mfma_f32_16x16x32_bf16 v[180:183], v[200:203], v[232:235], v[180:183]
  ds_read_b128 v[204:207], v249 offset:49152
  v_mfma_f32_16x16x32_bf16 v[144:147], v[228:231], v[184:187], v[144:147]
  ds_read_b128 v[72:75], v251 offset:49152
  v_mfma_f32_16x16x32_bf16 v[164:167], v[184:187], v[232:235], v[164:167]
  ds_read_b32 v76, v253 offset:49152
  v_mfma_f32_16x16x32_bf16 v[80:83], v[224:227], v[96:99], v[80:83]
  v_mfma_f32_16x16x32_bf16 v[84:87], v[228:231], v[96:99], v[84:87]
  v_mfma_f32_16x16x32_bf16 v[88:91], v[96:99], v[232:235], v[88:91]
  s_waitcnt lgkmcnt(1)
  s_nop 0
  v_dot2_f32_bf16 v24, v72, s60, v24
  v_dot2_f32_bf16 v25, v72, v72, v25
  v_dot2_f32_bf16 v24, v73, s60, v24
  v_dot2_f32_bf16 v25, v73, v73, v25
  v_dot2_f32_bf16 v24, v74, s60, v24
  v_dot2_f32_bf16 v25, v74, v74, v25
  v_dot2_f32_bf16 v24, v75, s60, v24
  v_dot2_f32_bf16 v25, v75, v75, v25
  s_waitcnt lgkmcnt(0)
  v_dot2_f32_bf16 v62, v76, s60, v62
  v_dot2_f32_bf16 v63, v76, v76, v63
  v_mfma_f32_16x16x32_bf16 v[128:131], v[236:239], v[208:211], v[128:131]
  s_barrier
  v_mfma_f32_16x16x32_bf16 v[148:151], v[240:243], v[208:211], v[148:151]
  ds_read_b64_tr_b16 v[224:225], v17 offset:12288
  v_mfma_f32_16x16x32_bf16 v[168:171], v[208:211], v[244:247], v[168:171]
  ds_read_b64_tr_b16 v[226:227], v22 offset:12288
  v_mfma_f32_16x16x32_bf16 v[132:135], v[236:239], v[212:215], v[132:135]
  ds_read_b128 v[188:191], v248 offset:2048
  v_mfma_f32_16x16x32_bf16 v[152:155], v[240:243], v[212:215], v[152:155]
  ds_read_b64_tr_b16 v[228:229], v17 offset:16384
  v_mfma_f32_16x16x32_bf16 v[172:175], v[212:215], v[244:247], v[172:175]
  ds_read_b64_tr_b16 v[230:231], v22 offset:16384
  v_mfma_f32_16x16x32_bf16 v[136:139], v[236:239], v[216:219], v[136:139]
  ds_read_b64_tr_b16 v[232:233], v17 offset:20480
  v_mfma_f32_16x16x32_bf16 v[156:159], v[240:243], v[216:219], v[156:159]
  ds_read_b64_tr_b16 v[234:235], v22 offset:20480
  v_mfma_f32_16x16x32_bf16 v[176:179], v[216:219], v[244:247], v[176:179]
  ds_read_b128 v[192:195], v248 offset:4096
  v_mfma_f32_16x16x32_bf16 v[140:143], v[236:239], v[220:223], v[140:143]
  ds_read_b128 v[196:199], v248 offset:6144
  v_mfma_f32_16x16x32_bf16 v[160:163], v[240:243], v[220:223], v[160:163]
  ds_read_b128 v[200:203], v248 offset:8192
  v_mfma_f32_16x16x32_bf16 v[180:183], v[220:223], v[244:247], v[180:183]
  ds_read_b128 v[184:187], v248 offset:0
  v_mfma_f32_16x16x32_bf16 v[144:147], v[240:243], v[204:207], v[144:147]
  ds_read_b128 v[64:67], v250 offset:0
  v_mfma_f32_16x16x32_bf16 v[164:167], v[204:207], v[244:247], v[164:167]
  ds_read_b32 v68, v252 offset:0
  v_mfma_f32_16x16x32_bf16 v[80:83], v[236:239], v[96:99], v[80:83]
  v_mfma_f32_16x16x32_bf16 v[84:87], v[240:243], v[96:99], v[84:87]
  v_mfma_f32_16x16x32_bf16 v[88:91], v[96:99], v[244:247], v[88:91]
  s_waitcnt lgkmcnt(1)
  s_nop 0
  v_dot2_f32_bf16 v24, v64, s60, v24
  v_dot2_f32_bf16 v25, v64, v64, v25
  v_dot2_f32_bf16 v24, v65, s60, v24
  v_dot2_f32_bf16 v25, v65, v65, v25
  v_dot2_f32_bf16 v24, v66, s60, v24
  v_dot2_f32_bf16 v25, v66, v66, v25
  v_dot2_f32_bf16 v24, v67, s60, v24
  v_dot2_f32_bf16 v25, v67, v67, v25
  s_waitcnt lgkmcnt(0)
  v_dot2_f32_bf16 v62, v68, s60, v62
  v_dot2_f32_bf16 v63, v68, v68, v63
  v_mfma_f32_16x16x32_bf16 v[128:131], v[224:227], v[188:191], v[128:131]
  s_barrier
  v_mfma_f32_16x16x32_bf16 v[148:151], v[228:231], v[188:191], v[148:151]
  ds_read_b64_tr_b16 v[236:237], v17 offset:61440
  v_mfma_f32_16x16x32_bf16 v[168:171], v[188:191], v[232:235], v[168:171]
  ds_read_b64_tr_b16 v[238:239], v22 offset:61440
  v_mfma_f32_16x16x32_bf16 v[132:135], v[224:227], v[192:195], v[132:135]
  ds_read_b128 v[208:211], v249 offset:2048
  v_mfma_f32_16x16x32_bf16 v[152:155], v[228:231], v[192:195], v[152:155]
  ds_read_b64_tr_b16 v[240:241], v17 offset:24576
  v_mfma_f32_16x16x32_bf16 v[172:175], v[192:195], v[232:235], v[172:175]
  ds_read_b64_tr_b16 v[242:243], v22 offset:24576
  v_mfma_f32_16x16x32_bf16 v[136:139], v[224:227], v[196:199], v[136:139]
  ds_read_b64_tr_b16 v[244:245], v17 offset:28672
  v_mfma_f32_16x16x32_bf16 v[156:159], v[228:231], v[196:199], v[156:159]
  ds_read_b64_tr_b16 v[246:247], v22 offset:28672
  v_mfma_f32_16x16x32_bf16 v[176:179], v[196:199], v[232:235], v[176:179]
  ds_read_b128 v[212:215], v249 offset:4096
  v_mfma_f32_16x16x32_bf16 v[140:143], v[224:227], v[200:203], v[140:143]
  ds_read_b128 v[216:219], v249 offset:6144
  v_mfma_f32_16x16x32_bf16 v[160:163], v[228:231], v[200:203], v[160:163]
  ds_read_b128 v[220:223], v249 offset:8192
  v_mfma_f32_16x16x32_bf16 v[180:183], v[200:203], v[232:235], v[180:183]
  ds_read_b128 v[204:207], v249 offset:0
  v_mfma_f32_16x16x32_bf16 v[144:147], v[228:231], v[184:187], v[144:147]
  ds_read_b128 v[72:75], v251 offset:0
  v_mfma_f32_16x16x32_bf16 v[164:167], v[184:187], v[232:235], v[164:167]
  ds_read_b32 v76, v253 offset:0
  v_mfma_f32_16x16x32_bf16 v[80:83], v[224:227], v[96:99], v[80:83]
  v_mfma_f32_16x16x32_bf16 v[84:87], v[228:231], v[96:99], v[84:87]
  v_mfma_f32_16x16x32_bf16 v[88:91], v[96:99], v[232:235], v[88:91]
  s_waitcnt lgkmcnt(1)
  s_nop 0
  v_dot2_f32_bf16 v24, v72, s60, v24
  v_dot2_f32_bf16 v25, v72, v72, v25
  v_dot2_f32_bf16 v24, v73, s60, v24
  v_dot2_f32_bf16 v25, v73, v73, v25
  v_dot2_f32_bf16 v24, v74, s60, v24
  v_dot2_f32_bf16 v25, v74, v74, v25
  v_dot2_f32_bf16 v24, v75, s60, v24
  v_dot2_f32_bf16 v25, v75, v75, v25
  s_waitcnt lgkmcnt(0)
  v_dot2_f32_bf16 v62, v76, s60, v62
  v_dot2_f32_bf16 v63, v76, v76, v63
  v_mfma_f32_16x16x32_bf16 v[128:131], v[236:239], v[208:211], v[128:131]
  s_barrier
  v_mfma_f32_16x16x32_bf16 v[148:151], v[240:243], v[208:211], v[148:151]
  ds_read_b64_tr_b16 v[224:225], v17 offset:32768
  v_mfma_f32_16x16x32_bf16 v[168:171], v[208:211], v[244:247], v[168:171]
  ds_read_b64_tr_b16 v[226:227], v22 offset:32768
  v_mfma_f32_16x16x32_bf16 v[132:135], v[236:239], v[212:215], v[132:135]
  ds_read_b128 v[188:191], v248 offset:14336
  v_mfma_f32_16x16x32_bf16 v[152:155], v[240:243], v[212:215], v[152:155]
  ds_read_b64_tr_b16 v[228:229], v17 offset:36864
  v_mfma_f32_16x16x32_bf16 v[172:175], v[212:215], v[244:247], v[172:175]
  ds_read_b64_tr_b16 v[230:231], v22 offset:36864
  v_mfma_f32_16x16x32_bf16 v[136:139], v[236:239], v[216:219], v[136:139]
  ds_read_b64_tr_b16 v[232:233], v17 offset:49152
  v_mfma_f32_16x16x32_bf16 v[156:159], v[240:243], v[216:219], v[156:159]
  ds_read_b64_tr_b16 v[234:235], v22 offset:49152
  v_mfma_f32_16x16x32_bf16 v[176:179], v[216:219], v[244:247], v[176:179]
  ds_read_b128 v[192:195], v248 offset:16384
  v_mfma_f32_16x16x32_bf16 v[140:143], v[236:239], v[220:223], v[140:143]
  ds_read_b128 v[196:199], v248 offset:18432
  v_mfma_f32_16x16x32_bf16 v[160:163], v[240:243], v[220:223], v[160:163]
  ds_read_b128 v[200:203], v248 offset:20480
  v_mfma_f32_16x16x32_bf16 v[180:183], v[220:223], v[244:247], v[180:183]
  ds_read_b128 v[184:187], v248 offset:12288
  v_mfma_f32_16x16x32_bf16 v[144:147], v[240:243], v[204:207], v[144:147]
  ds_read_b128 v[64:67], v250 offset:12288
  v_mfma_f32_16x16x32_bf16 v[164:167], v[204:207], v[244:247], v[164:167]
  ds_read_b32 v68, v252 offset:12288
  v_mfma_f32_16x16x32_bf16 v[80:83], v[236:239], v[96:99], v[80:83]
  v_mfma_f32_16x16x32_bf16 v[84:87], v[240:243], v[96:99], v[84:87]
  v_mfma_f32_16x16x32_bf16 v[88:91], v[96:99], v[244:247], v[88:91]
  s_waitcnt lgkmcnt(1)
  s_nop 0
  v_dot2_f32_bf16 v24, v64, s60, v24
  v_dot2_f32_bf16 v25, v64, v64, v25
  v_dot2_f32_bf16 v24, v65, s60, v24
  v_dot2_f32_bf16 v25, v65, v65, v25
  v_dot2_f32_bf16 v24, v66, s60, v24
  v_dot2_f32_bf16 v25, v66, v66, v25
  v_dot2_f32_bf16 v24, v67, s60, v24
  v_dot2_f32_bf16 v25, v67, v67, v25
  s_waitcnt lgkmcnt(0)
  v_dot2_f32_bf16 v62, v68, s60, v62
  v_dot2_f32_bf16 v63, v68, v68, v63
  v_mfma_f32_16x16x32_bf16 v[128:131], v[224:227], v[188:191], v[128:131]
  s_barrier
  v_mfma_f32_16x16x32_bf16 v[148:151], v[228:231], v[188:191], v[148:151]
  ds_read_b64_tr_b16 v[236:237], v17 offset:53248
  v_mfma_f32_16x16x32_bf16 v[168:171], v[188:191], v[232:235], v[168:171]
  ds_read_b64_tr_b16 v[238:239], v22 offset:53248
  v_mfma_f32_16x16x32_bf16 v[132:135], v[224:227], v[192:195], v[132:135]
  ds_read_b128 v[208:211], v249 offset:14336
  v_mfma_f32_16x16x32_bf16 v[152:155], v[228:231], v[192:195], v[152:155]
  ds_read_b64_tr_b16 v[240:241], v18 offset:0
  v_mfma_f32_16x16x32_bf16 v[172:175], v[192:195], v[232:235], v[172:175]
  ds_read_b64_tr_b16 v[242:243], v23 offset:0
  v_mfma_f32_16x16x32_bf16 v[136:139], v[224:227], v[196:199], v[136:139]
  ds_read_b64_tr_b16 v[244:245], v18 offset:4096
  v_mfma_f32_16x16x32_bf16 v[156:159], v[228:231], v[196:199], v[156:159]
  ds_read_b64_tr_b16 v[246:247], v23 offset:4096
  v_mfma_f32_16x16x32_bf16 v[176:179], v[196:199], v[232:235], v[176:179]
  ds_read_b128 v[212:215], v249 offset:16384
  v_mfma_f32_16x16x32_bf16 v[140:143], v[224:227], v[200:203], v[140:143]
  ds_read_b128 v[216:219], v249 offset:18432
  v_mfma_f32_16x16x32_bf16 v[160:163], v[228:231], v[200:203], v[160:163]
  ds_read_b128 v[220:223], v249 offset:20480
  v_mfma_f32_16x16x32_bf16 v[180:183], v[200:203], v[232:235], v[180:183]
  ds_read_b128 v[204:207], v249 offset:12288
  v_mfma_f32_16x16x32_bf16 v[144:147], v[228:231], v[184:187], v[144:147]
  ds_read_b128 v[72:75], v251 offset:12288
  v_mfma_f32_16x16x32_bf16 v[164:167], v[184:187], v[232:235], v[164:167]
  ds_read_b32 v76, v253 offset:12288
  v_mfma_f32_16x16x32_bf16 v[80:83], v[224:227], v[96:99], v[80:83]
  v_mfma_f32_16x16x32_bf16 v[84:87], v[228:231], v[96:99], v[84:87]
  v_mfma_f32_16x16x32_bf16 v[88:91], v[96:99], v[232:235], v[88:91]
  s_waitcnt lgkmcnt(1)
  s_nop 0
  v_dot2_f32_bf16 v24, v72, s60, v24
  v_dot2_f32_bf16 v25, v72, v72, v25
  v_dot2_f32_bf16 v24, v73, s60, v24
  v_dot2_f32_bf16 v25, v73, v73, v25
  v_dot2_f32_bf16 v24, v74, s60, v24
  v_dot2_f32_bf16 v25, v74, v74, v25
  v_dot2_f32_bf16 v24, v75, s60, v24
  v_dot2_f32_bf16 v25, v75, v75, v25
  s_waitcnt lgkmcnt(0)
  v_dot2_f32_bf16 v62, v76, s60, v62
  v_dot2_f32_bf16 v63, v76, v76, v63
  v_mfma_f32_16x16x32_bf16 v[128:131], v[236:239], v[208:211], v[128:131]
  s_barrier
  v_mfma_f32_16x16x32_bf16 v[148:151], v[240:243], v[208:211], v[148:151]
  ds_read_b64_tr_b16 v[224:225], v17 offset:0
  v_mfma_f32_16x16x32_bf16 v[168:171], v[208:211], v[244:247], v[168:171]
  ds_read_b64_tr_b16 v[226:227], v22 offset:0
  v_mfma_f32_16x16x32_bf16 v[132:135], v[236:239], v[212:215], v[132:135]
  ds_read_b128 v[188:191], v248 offset:26624
  v_mfma_f32_16x16x32_bf16 v[152:155], v[240:243], v[212:215], v[152:155]
  ds_read_b64_tr_b16 v[228:229], v17 offset:40960
  v_mfma_f32_16x16x32_bf16 v[172:175], v[212:215], v[244:247], v[172:175]
  ds_read_b64_tr_b16 v[230:231], v22 offset:40960
  v_mfma_f32_16x16x32_bf16 v[136:139], v[236:239], v[216:219], v[136:139]
  ds_read_b64_tr_b16 v[232:233], v17 offset:45056
  v_mfma_f32_16x16x32_bf16 v[156:159], v[240:243], v[216:219], v[156:159]
  ds_read_b64_tr_b16 v[234:235], v22 offset:45056
  v_mfma_f32_16x16x32_bf16 v[176:179], v[216:219], v[244:247], v[176:179]
  ds_read_b128 v[192:195], v248 offset:28672
  v_mfma_f32_16x16x32_bf16 v[140:143], v[236:239], v[220:223], v[140:143]
  ds_read_b128 v[196:199], v248 offset:30720
  v_mfma_f32_16x16x32_bf16 v[160:163], v[240:243], v[220:223], v[160:163]
  ds_read_b128 v[200:203], v248 offset:32768
  v_mfma_f32_16x16x32_bf16 v[180:183], v[220:223], v[244:247], v[180:183]
  ds_read_b128 v[184:187], v248 offset:24576
  v_mfma_f32_16x16x32_bf16 v[144:147], v[240:243], v[204:207], v[144:147]
  ds_read_b128 v[64:67], v250 offset:24576
  v_mfma_f32_16x16x32_bf16 v[164:167], v[204:207], v[244:247], v[164:167]
  ds_read_b32 v68, v252 offset:24576
  v_mfma_f32_16x16x32_bf16 v[80:83], v[236:239], v[96:99], v[80:83]
  v_mfma_f32_16x16x32_bf16 v[84:87], v[240:243], v[96:99], v[84:87]
  v_mfma_f32_16x16x32_bf16 v[88:91], v[96:99], v[244:247], v[88:91]
  s_waitcnt lgkmcnt(1)
  s_nop 0
  v_dot2_f32_bf16 v24, v64, s60, v24
  v_dot2_f32_bf16 v25, v64, v64, v25
  v_dot2_f32_bf16 v24, v65, s60, v24
  v_dot2_f32_bf16 v25, v65, v65, v25
  v_dot2_f32_bf16 v24, v66, s60, v24
  v_dot2_f32_bf16 v25, v66, v66, v25
  v_dot2_f32_bf16 v24, v67, s60, v24
  v_dot2_f32_bf16 v25, v67, v67, v25
  s_waitcnt lgkmcnt(0)
  v_dot2_f32_bf16 v62, v68, s60, v62
  v_dot2_f32_bf16 v63, v68, v68, v63
  v_mfma_f32_16x16x32_bf16 v[128:131], v[224:227], v[188:191], v[128:131]
  s_barrier
  v_mfma_f32_16x16x32_bf16 v[148:151], v[228:231], v[188:191], v[148:151]
  ds_read_b64_tr_b16 v[236:237], v18 offset:8192
  v_mfma_f32_16x16x32_bf16 v[168:171], v[188:191], v[232:235], v[168:171]
  ds_read_b64_tr_b16 v[238:239], v23 offset:8192
  v_mfma_f32_16x16x32_bf16 v[132:135], v[224:227], v[192:195], v[132:135]
  ds_read_b128 v[208:211], v249 offset:26624
  v_mfma_f32_16x16x32_bf16 v[152:155], v[228:231], v[192:195], v[152:155]
  ds_read_b64_tr_b16 v[240:241], v18 offset:12288
  v_mfma_f32_16x16x32_bf16 v[172:175], v[192:195], v[232:235], v[172:175]
  ds_read_b64_tr_b16 v[242:243], v23 offset:12288
  v_mfma_f32_16x16x32_bf16 v[136:139], v[224:227], v[196:199], v[136:139]
  ds_read_b64_tr_b16 v[244:245], v17 offset:4096
  v_mfma_f32_16x16x32_bf16 v[156:159], v[228:231], v[196:199], v[156:159]
  ds_read_b64_tr_b16 v[246:247], v22 offset:4096
  v_mfma_f32_16x16x32_bf16 v[176:179], v[196:199], v[232:235], v[176:179]
  ds_read_b128 v[212:215], v249 offset:28672
  v_mfma_f32_16x16x32_bf16 v[140:143], v[224:227], v[200:203], v[140:143]
  ds_read_b128 v[216:219], v249 offset:30720
  v_mfma_f32_16x16x32_bf16 v[160:163], v[228:231], v[200:203], v[160:163]
  ds_read_b128 v[220:223], v249 offset:32768
  v_mfma_f32_16x16x32_bf16 v[180:183], v[200:203], v[232:235], v[180:183]
  ds_read_b128 v[204:207], v249 offset:24576
  v_mfma_f32_16x16x32_bf16 v[144:147], v[228:231], v[184:187], v[144:147]
  ds_read_b128 v[72:75], v251 offset:24576
  v_mfma_f32_16x16x32_bf16 v[164:167], v[184:187], v[232:235], v[164:167]
  ds_read_b32 v76, v253 offset:24576
  v_mfma_f32_16x16x32_bf16 v[80:83], v[224:227], v[96:99], v[80:83]
  v_mfma_f32_16x16x32_bf16 v[84:87], v[228:231], v[96:99], v[84:87]
  v_mfma_f32_16x16x32_bf16 v[88:91], v[96:99], v[232:235], v[88:91]
  s_waitcnt lgkmcnt(1)
  s_nop 0
  v_dot2_f32_bf16 v24, v72, s60, v24
  v_dot2_f32_bf16 v25, v72, v72, v25
  v_dot2_f32_bf16 v24, v73, s60, v24
  v_dot2_f32_bf16 v25, v73, v73, v25
  v_dot2_f32_bf16 v24, v74, s60, v24
  v_dot2_f32_bf16 v25, v74, v74, v25
  v_dot2_f32_bf16 v24, v75, s60, v24
  v_dot2_f32_bf16 v25, v75, v75, v25
  s_waitcnt lgkmcnt(0)
  v_dot2_f32_bf16 v62, v76, s60, v62
  v_dot2_f32_bf16 v63, v76, v76, v63
  v_mfma_f32_16x16x32_bf16 v[128:131], v[236:239], v[208:211], v[128:131]
  s_nop 1
  v_permlane32_swap_b32 v62, v63
  v_permlane32_swap_b32 v24, v25
  v_mfma_f32_16x16x32_bf16 v[148:151], v[240:243], v[208:211], v[148:151]
  v_add_f32 v62, v62, v63
  v_add_f32 v29, v24, v25
  v_mfma_f32_16x16x32_bf16 v[168:171], v[208:211], v[244:247], v[168:171]
  v_mov_b32 v63, v62
  v_mov_b32 v30, v29
  v_mfma_f32_16x16x32_bf16 v[132:135], v[236:239], v[212:215], v[132:135]
  s_nop 0
  v_permlane16_swap_b32 v62, v63
  v_mfma_f32_16x16x32_bf16 v[152:155], v[240:243], v[212:215], v[152:155]
  v_permlane16_swap_b32 v29, v30
  v_add_f32 v62, v62, v63
  v_mfma_f32_16x16x32_bf16 v[172:175], v[212:215], v[244:247], v[172:175]
  v_add_f32 v29, v29, v30
  v_mov_b32 v30, v29
  v_mfma_f32_16x16x32_bf16 v[136:139], v[236:239], v[216:219], v[136:139]
  ds_write_b32 v112, v62 offset:1024
  v_permlane32_swap_b32_e64 v29, v30
  v_mfma_f32_16x16x32_bf16 v[156:159], v[240:243], v[216:219], v[156:159]
  v_mul_f32 v29, 0xbb000000, v29
  v_mul_f32 v30, 0x3b000000, v30
  v_mfma_f32_16x16x32_bf16 v[176:179], v[216:219], v[244:247], v[176:179]
  v_fma_f32 v30, -v29, v29, v30
  v_max_f32_e64 v30, 0, v30
  v_mfma_f32_16x16x32_bf16 v[140:143], v[236:239], v[220:223], v[140:143]
  v_add_f32 v30, 0x3727c5ac, v30
  v_rsq_f32_e64 v30, v30
  v_mfma_f32_16x16x32_bf16 v[160:163], v[240:243], v[220:223], v[160:163]
  ds_write_b32 v113, v29 offset:512
  ds_write_b32 v113, v30 offset:0
  v_mfma_f32_16x16x32_bf16 v[180:183], v[220:223], v[244:247], v[180:183]
  v_mfma_f32_16x16x32_bf16 v[144:147], v[240:243], v[204:207], v[144:147]
  v_mfma_f32_16x16x32_bf16 v[164:167], v[204:207], v[244:247], v[164:167]
  v_mfma_f32_16x16x32_bf16 v[80:83], v[236:239], v[96:99], v[80:83]
  v_mfma_f32_16x16x32_bf16 v[84:87], v[240:243], v[96:99], v[84:87]
  v_mfma_f32_16x16x32_bf16 v[88:91], v[96:99], v[244:247], v[88:91]
  s_waitcnt lgkmcnt(0)
  s_barrier
  ds_read2_b32 v[48:49], v114 offset0:0 offset1:16
  ds_read2_b32 v[50:51], v114 offset0:32 offset1:48
  ds_read2_b32 v[52:53], v114 offset0:64 offset1:80
  ds_read2_b32 v[54:55], v114 offset0:96 offset1:112
  ds_read2_b32 v[66:67], v122 offset0:16 offset1:144
  ds_read2_b32 v[68:69], v122 offset0:32 offset1:160
  ds_read2_b32 v[70:71], v122 offset0:48 offset1:176
  ds_read2_b32 v[72:73], v122 offset0:64 offset1:192
  ds_read_b128 v[188:191], v120 offset:576
  ds_read_b128 v[208:211], v120 offset:64
  ds_read_b128 v[192:195], v120 offset:640
  ds_read_b128 v[212:215], v120 offset:128
  ds_read_b128 v[196:199], v120 offset:704
  ds_read_b128 v[216:219], v120 offset:192
  ds_read_b128 v[200:203], v120 offset:768
  ds_read_b128 v[220:223], v120 offset:256
  s_waitcnt lgkmcnt(14)
  v_pk_add_f32 v[48:49], v[48:49], v[50:51]
  s_waitcnt lgkmcnt(12)
  v_pk_add_f32 v[52:53], v[52:53], v[54:55]
  v_add_f32 v29, v48, v52
  v_add_f32 v30, v49, v53
  v_mul_f32 v29, 0xbb000000, v29
  v_mul_f32 v30, 0x3b000000, v30
  v_fma_f32 v30, -v29, v29, v30
  v_max_f32_e64 v30, 0, v30
  v_add_f32 v30, 0x3727c5ac, v30
  v_rsq_f32_e64 v30, v30
  ds_write_b32 v122, v29 offset:512
  ds_write_b32 v122, v30 offset:0
  v_mov_b32 v64, v30
  v_mov_b32 v65, v29
  ds_read_b128 v[184:187], v120 offset:512
  ds_read_b128 v[204:207], v120 offset:0
  ds_read_b32 v124, v123 offset:64
  s_waitcnt lgkmcnt(15)
  s_nop 0
  v_pk_fma_f32 v[148:149], v[84:85], v[66:67], v[148:149] op_sel:[0,1,0] op_sel_hi:[1,1,1]
  v_pk_fma_f32 v[150:151], v[86:87], v[66:67], v[150:151] op_sel:[0,1,0] op_sel_hi:[1,1,1]
  v_pk_fma_f32 v[128:129], v[80:81], v[66:67], v[128:129] op_sel:[0,1,0] op_sel_hi:[1,1,1]
  v_pk_fma_f32 v[130:131], v[82:83], v[66:67], v[130:131] op_sel:[0,1,0] op_sel_hi:[1,1,1]
  v_pk_mul_f32 v[148:149], v[148:149], v[66:67] op_sel_hi:[1,0]
  v_pk_mul_f32 v[150:151], v[150:151], v[66:67] op_sel_hi:[1,0]
  s_waitcnt lgkmcnt(15)
  s_nop 0
  v_pk_fma_f32 v[152:153], v[84:85], v[68:69], v[152:153] op_sel:[0,1,0] op_sel_hi:[1,1,1]
  v_pk_fma_f32 v[154:155], v[86:87], v[68:69], v[154:155] op_sel:[0,1,0] op_sel_hi:[1,1,1]
  v_pk_fma_f32 v[132:133], v[80:81], v[68:69], v[132:133] op_sel:[0,1,0] op_sel_hi:[1,1,1]
  v_pk_fma_f32 v[134:135], v[82:83], v[68:69], v[134:135] op_sel:[0,1,0] op_sel_hi:[1,1,1]
  v_pk_mul_f32 v[152:153], v[152:153], v[68:69] op_sel_hi:[1,0]
  v_pk_mul_f32 v[154:155], v[154:155], v[68:69] op_sel_hi:[1,0]
  s_waitcnt lgkmcnt(14)
  s_nop 0
  v_pk_fma_f32 v[156:157], v[84:85], v[70:71], v[156:157] op_sel:[0,1,0] op_sel_hi:[1,1,1]
  v_pk_fma_f32 v[158:159], v[86:87], v[70:71], v[158:159] op_sel:[0,1,0] op_sel_hi:[1,1,1]
  v_pk_fma_f32 v[136:137], v[80:81], v[70:71], v[136:137] op_sel:[0,1,0] op_sel_hi:[1,1,1]
  v_pk_fma_f32 v[138:139], v[82:83], v[70:71], v[138:139] op_sel:[0,1,0] op_sel_hi:[1,1,1]
  v_pk_mul_f32 v[156:157], v[156:157], v[70:71] op_sel_hi:[1,0]
  v_pk_mul_f32 v[158:159], v[158:159], v[70:71] op_sel_hi:[1,0]
  s_waitcnt lgkmcnt(13)
  s_nop 0
  v_pk_fma_f32 v[160:161], v[84:85], v[72:73], v[160:161] op_sel:[0,1,0] op_sel_hi:[1,1,1]
  v_pk_fma_f32 v[162:163], v[86:87], v[72:73], v[162:163] op_sel:[0,1,0] op_sel_hi:[1,1,1]
  v_pk_fma_f32 v[140:141], v[80:81], v[72:73], v[140:141] op_sel:[0,1,0] op_sel_hi:[1,1,1]
  v_pk_fma_f32 v[142:143], v[82:83], v[72:73], v[142:143] op_sel:[0,1,0] op_sel_hi:[1,1,1]
  v_pk_mul_f32 v[160:161], v[160:161], v[72:73] op_sel_hi:[1,0]
  v_pk_mul_f32 v[162:163], v[162:163], v[72:73] op_sel_hi:[1,0]
  v_pk_fma_f32 v[144:145], v[84:85], v[64:65], v[144:145] op_sel:[0,1,0] op_sel_hi:[1,1,1]
  v_pk_fma_f32 v[146:147], v[86:87], v[64:65], v[146:147] op_sel:[0,1,0] op_sel_hi:[1,1,1]
  v_pk_mul_f32 v[144:145], v[144:145], v[64:65] op_sel_hi:[1,0]
  v_pk_mul_f32 v[146:147], v[146:147], v[64:65] op_sel_hi:[1,0]
  s_waitcnt lgkmcnt(12)
  v_pk_fma_f32 v[168:169], v[188:189], v[88:89], v[168:169] op_sel_hi:[1,0,1]
  v_pk_fma_f32 v[170:171], v[190:191], v[88:89], v[170:171] op_sel_hi:[1,0,1]
  s_waitcnt lgkmcnt(10)
  v_pk_fma_f32 v[172:173], v[192:193], v[88:89], v[172:173] op_sel_hi:[1,0,1]
  v_pk_fma_f32 v[174:175], v[194:195], v[88:89], v[174:175] op_sel_hi:[1,0,1]
  s_waitcnt lgkmcnt(8)
  v_pk_fma_f32 v[176:177], v[196:197], v[88:89], v[176:177] op_sel_hi:[1,0,1]
  v_pk_fma_f32 v[178:179], v[198:199], v[88:89], v[178:179] op_sel_hi:[1,0,1]
  s_waitcnt lgkmcnt(6)
  v_pk_fma_f32 v[180:181], v[200:201], v[88:89], v[180:181] op_sel_hi:[1,0,1]
  v_pk_fma_f32 v[182:183], v[202:203], v[88:89], v[182:183] op_sel_hi:[1,0,1]
  s_waitcnt lgkmcnt(2)
  s_nop 0
  v_pk_fma_f32 v[164:165], v[184:185], v[88:89], v[164:165] op_sel_hi:[1,0,1]
  v_pk_fma_f32 v[166:167], v[186:187], v[88:89], v[166:167] op_sel_hi:[1,0,1]
  v_pk_mul_f32 v[168:169], v[168:169], v[208:209]
  v_pk_mul_f32 v[170:171], v[170:171], v[210:211]
  v_pk_mul_f32 v[172:173], v[172:173], v[212:213]
  v_pk_mul_f32 v[174:175], v[174:175], v[214:215]
  v_pk_mul_f32 v[176:177], v[176:177], v[216:217]
  v_pk_mul_f32 v[178:179], v[178:179], v[218:219]
  v_pk_mul_f32 v[180:181], v[180:181], v[220:221]
  v_pk_mul_f32 v[182:183], v[182:183], v[222:223]
  s_waitcnt lgkmcnt(1)
  v_pk_mul_f32 v[164:165], v[164:165], v[204:205]
  v_pk_mul_f32 v[166:167], v[166:167], v[206:207]
  v_cvt_pk_bf16_f32 v144, v144, v145
  v_cvt_pk_bf16_f32 v145, v146, v147
  v_cvt_pk_bf16_f32 v164, v164, v165
  v_cvt_pk_bf16_f32 v165, v166, v167
  v_cvt_pk_bf16_f32 v148, v148, v149
  v_cvt_pk_bf16_f32 v149, v150, v151
  v_cvt_pk_bf16_f32 v132, v132, v133
  v_cvt_pk_bf16_f32 v133, v134, v135
  v_cvt_pk_bf16_f32 v152, v152, v153
  v_cvt_pk_bf16_f32 v153, v154, v155
  v_mfma_f32_16x16x16_bf16 v[236:239], v[148:149], v[132:133], 0
  v_cvt_pk_bf16_f32 v136, v136, v137
  v_cvt_pk_bf16_f32 v137, v138, v139
  v_mfma_f32_16x16x16_bf16 v[232:235], v[152:153], v[132:133], 0
  v_cvt_pk_bf16_f32 v156, v156, v157
  v_cvt_pk_bf16_f32 v157, v158, v159
  v_mfma_f32_16x16x16_bf16 v[244:247], v[152:153], v[136:137], 0
  v_cvt_pk_bf16_f32 v140, v140, v141
  v_cvt_pk_bf16_f32 v141, v142, v143
  v_mfma_f32_16x16x16_bf16 v[240:243], v[156:157], v[136:137], 0
  v_cvt_pk_bf16_f32 v160, v160, v161
  v_cvt_pk_bf16_f32 v161, v162, v163
  v_mfma_f32_16x16x16_bf16 v[252:255], v[156:157], v[140:141], 0
  v_cvt_pk_bf16_f32 v128, v128, v129
  v_cvt_pk_bf16_f32 v129, v130, v131
  v_mfma_f32_16x16x16_bf16 v[248:251], v[160:161], v[140:141], 0
  v_cvt_pk_bf16_f32 v168, v168, v169
  v_cvt_pk_bf16_f32 v169, v170, v171
  v_mfma_f32_16x16x16_bf16 v[224:227], v[148:149], v[128:129], 0
  v_cvt_pk_bf16_f32 v172, v172, v173
  v_cvt_pk_bf16_f32 v173, v174, v175
  v_cvt_pk_bf16_f32 v176, v176, v177
  v_cvt_pk_bf16_f32 v177, v178, v179
  v_cvt_pk_bf16_f32 v180, v180, v181
  v_cvt_pk_bf16_f32 v181, v182, v183
  v_cndmask_b32 v232, v232, v233, s[84:85]
  v_cndmask_b32 v236, v236, v237, s[84:85]
PAD_2:
  s_cbranch_execz L_TRAMP
  s_nop 0
  v_cndmask_b32 v234, v234, v235, s[84:85]
  v_cndmask_b32 v238, v238, v239, s[84:85]
  v_cndmask_b32 v97, v236, v232, s[86:87]
  v_cndmask_b32 v101, v238, v234, s[88:89]
  v_cndmask_b32 v240, v240, v241, s[84:85]
  v_cndmask_b32 v244, v244, v245, s[84:85]
  v_cndmask_b32 v242, v242, v243, s[84:85]
  v_cndmask_b32 v246, v246, v247, s[84:85]
  v_cndmask_b32 v98, v244, v240, s[86:87]
  v_cndmask_b32 v102, v246, v242, s[88:89]
  s_barrier
  v_cndmask_b32 v248, v248, v249, s[84:85]
  v_cndmask_b32 v252, v252, v253, s[84:85]
  v_cndmask_b32 v250, v250, v251, s[84:85]
  v_cndmask_b32 v254, v254, v255, s[84:85]
  v_cndmask_b32 v99, v252, v248, s[86:87]
  v_cndmask_b32 v103, v254, v250, s[88:89]
  s_waitcnt lgkmcnt(0)
  v_mul_f32 v124, 0x3eb8aa3b, v124
  v_mfma_f32_16x16x16_bf16 v[228:231], v[144:145], v[128:129], 0
  v_permlane32_swap_b32 v98, v99
  v_permlane32_swap_b32 v102, v103
  s_cmp_lg_u32 s46, 0
  s_cbranch_scc1 CSK_5
  s_nop 3
  v_mov_b32 v228, 0xf149f2ca
  v_mov_b32 v229, 0xf149f2ca
  v_mov_b32 v230, 0xf149f2ca
  v_mov_b32 v231, 0xf149f2ca
CSK_5:
  v_cndmask_b32 v224, v224, v225, s[84:85]
  s_nop 0
  s_nop 2
  v_cndmask_b32 v228, v228, v229, s[84:85]
  v_cndmask_b32 v226, v226, v227, s[84:85]
  v_cndmask_b32 v230, v230, v231, s[84:85]
  v_cndmask_b32 v96, v228, v224, s[86:87]
  v_cndmask_b32 v100, v230, v226, s[88:89]
  s_nop 0
  v_permlane32_swap_b32 v96, v97
  v_permlane32_swap_b32 v100, v101
  s_nop 0
  v_permlane16_swap_b32 v96, v98
  v_permlane16_swap_b32 v97, v99
  v_permlane16_swap_b32 v100, v102
  v_permlane16_swap_b32 v101, v103
  v_max3_f32 v29, v96, v98, v97
  v_max3_f32 v30, v99, v100, v102
  v_max3_f32 v29, v29, v101, v103
  v_max_f32_e64 v29, v29, v30
  v_mul_f32 v125, -v29, v124
  v_pk_fma_f32 v[96:97], v[96:97], v[124:125], v[124:125] op_sel:[0,0,1] op_sel_hi:[1,0,1]
  v_pk_fma_f32 v[98:99], v[98:99], v[124:125], v[124:125] op_sel:[0,0,1] op_sel_hi:[1,0,1]
  v_pk_fma_f32 v[100:101], v[100:101], v[124:125], v[124:125] op_sel:[0,0,1] op_sel_hi:[1,0,1]
  v_pk_fma_f32 v[102:103], v[102:103], v[124:125], v[124:125] op_sel:[0,0,1] op_sel_hi:[1,0,1]
  v_exp_f32 v96, v96
  v_exp_f32 v97, v97
  v_exp_f32 v98, v98
  v_exp_f32 v99, v99
  v_exp_f32 v100, v100
  v_exp_f32 v101, v101
  v_exp_f32 v102, v102
  v_exp_f32 v103, v103
  v_pk_add_f32 v[112:113], v[96:97], v[98:99]
  v_pk_add_f32 v[114:115], v[100:101], v[102:103]
  v_pk_add_f32 v[112:113], v[112:113], v[114:115]
  v_add_f32 v124, v112, v113
  v_rcp_f32 v124, v124
  s_nop 0
  s_nop 0
  v_pk_mul_f32 v[96:97], v[96:97], v[124:125] op_sel_hi:[1,0]
  v_pk_mul_f32 v[98:99], v[98:99], v[124:125] op_sel_hi:[1,0]
  v_pk_mul_f32 v[100:101], v[100:101], v[124:125] op_sel_hi:[1,0]
  v_pk_mul_f32 v[102:103], v[102:103], v[124:125] op_sel_hi:[1,0]
  v_cvt_pk_bf16_f32 v104, v96, v100
  v_cvt_pk_bf16_f32 v106, v98, v102
  v_cvt_pk_bf16_f32 v105, v97, v101
  v_cvt_pk_bf16_f32 v107, v99, v103
  v_permlane16_swap_b32 v104, v106
  s_nop 0
  v_permlane16_swap_b32 v105, v107
  s_nop 1
  v_permlane32_swap_b32 v104, v105
  v_permlane32_swap_b32 v106, v107
  v_perm_b32 v184, v104, v104, v92
  v_perm_b32 v185, v104, v104, v93
  v_perm_b32 v186, v104, v104, v94
  v_perm_b32 v187, v104, v104, v95
  v_perm_b32 v188, v105, v105, v92
  v_perm_b32 v189, v105, v105, v93
  v_perm_b32 v190, v105, v105, v94
  v_perm_b32 v191, v105, v105, v95
  v_mfma_f32_16x16x16_bf16 v[200:203], v[168:169], v[184:185], 0
  v_mfma_f32_16x16x16_bf16 v[200:203], v[164:165], v[186:187], v[200:203]
  v_perm_b32 v192, v106, v106, v92
  v_perm_b32 v193, v106, v106, v93
  v_perm_b32 v194, v106, v106, v94
  v_perm_b32 v195, v106, v106, v95
  v_mfma_f32_16x16x16_bf16 v[204:207], v[172:173], v[188:189], 0
  v_mfma_f32_16x16x16_bf16 v[204:207], v[168:169], v[190:191], v[204:207]
  v_perm_b32 v196, v107, v107, v92
  v_perm_b32 v197, v107, v107, v93
  v_perm_b32 v198, v107, v107, v94
  v_perm_b32 v199, v107, v107, v95
  v_mfma_f32_16x16x16_bf16 v[208:211], v[176:177], v[192:193], 0
  v_mfma_f32_16x16x16_bf16 v[208:211], v[172:173], v[194:195], v[208:211]
  v_mfma_f32_16x16x16_bf16 v[212:215], v[180:181], v[196:197], 0
  v_mfma_f32_16x16x16_bf16 v[212:215], v[176:177], v[198:199], v[212:215]
  v_cvt_pk_bf16_f32 v48, v200, v201
  v_cvt_pk_bf16_f32 v49, v202, v203
  v_cvt_pk_bf16_f32 v50, v204, v205
  v_cvt_pk_bf16_f32 v51, v206, v207
  s_nop 0
  v_permlane32_swap_b32 v48, v50
  v_permlane32_swap_b32_e64 v49, v51
  v_cvt_pk_bf16_f32 v52, v208, v209
  v_cvt_pk_bf16_f32 v53, v210, v211
  v_cvt_pk_bf16_f32 v54, v212, v213
  v_cvt_pk_bf16_f32 v55, v214, v215
  s_nop 0
  v_permlane32_swap_b32 v52, v54
  v_permlane32_swap_b32_e64 v53, v55
  buffer_store_dwordx4 v[48:51], v121, s[4:7], s65 offen offset:0 sc1
  buffer_store_dwordx4 v[52:55], v121, s[4:7], s65 offen offset:512 sc1
  s_barrier
  s_nop 0
  ds_read_b64_tr_b16 v[128:129], v10 offset:36864
  ds_read_b64_tr_b16 v[130:131], v13 offset:36864
  ds_read_b64_tr_b16 v[132:133], v10 offset:38912
  ds_read_b64_tr_b16 v[134:135], v13 offset:38912
  ds_read_b64_tr_b16 v[136:137], v10 offset:40960
  ds_read_b64_tr_b16 v[138:139], v13 offset:40960
  ds_read_b64_tr_b16 v[140:141], v10 offset:43008
  ds_read_b64_tr_b16 v[142:143], v13 offset:43008
  ds_read_b64_tr_b16 v[144:145], v10 offset:45056
  ds_read_b64_tr_b16 v[146:147], v13 offset:45056
  ds_read_b64_tr_b16 v[148:149], v10 offset:47104
  ds_read_b64_tr_b16 v[150:151], v13 offset:47104
  ds_read_b64_tr_b16 v[152:153], v10 offset:49152
  ds_read_b64_tr_b16 v[154:155], v13 offset:49152
  ds_read_b64_tr_b16 v[156:157], v10 offset:51200
  ds_read_b64_tr_b16 v[158:159], v13 offset:51200
  ds_read_b64_tr_b16 v[160:161], v10 offset:53248
  ds_read_b64_tr_b16 v[162:163], v13 offset:53248
  ds_read_b64_tr_b16 v[164:165], v10 offset:55296
  ds_read_b64_tr_b16 v[166:167], v13 offset:55296
  ds_read_b64_tr_b16 v[168:169], v10 offset:20480
  ds_read_b64_tr_b16 v[170:171], v13 offset:20480
  ds_read_b64_tr_b16 v[172:173], v10 offset:22528
  ds_read_b64_tr_b16 v[174:175], v13 offset:22528
  ds_read_b64_tr_b16 v[176:177], v10 offset:24576
  ds_read_b64_tr_b16 v[178:179], v13 offset:24576
  ds_read_b64_tr_b16 v[180:181], v10 offset:26624
  ds_read_b64_tr_b16 v[182:183], v13 offset:26624
  ds_read_b64_tr_b16 v[184:185], v10 offset:28672
  ds_read_b64_tr_b16 v[186:187], v13 offset:28672
  ds_read_b64_tr_b16 v[188:189], v10 offset:30720
  ds_read_b64_tr_b16 v[190:191], v13 offset:30720
  ds_read_b64_tr_b16 v[192:193], v10 offset:32768
  ds_read_b64_tr_b16 v[194:195], v13 offset:32768
  ds_read_b64_tr_b16 v[196:197], v10 offset:34816
  ds_read_b64_tr_b16 v[198:199], v13 offset:34816
  ds_read_b64_tr_b16 v[200:201], v10 offset:57344
  ds_read_b64_tr_b16 v[202:203], v13 offset:57344
  ds_read_b64_tr_b16 v[204:205], v10 offset:59392
  ds_read_b64_tr_b16 v[206:207], v13 offset:59392
  s_waitcnt vmcnt(0)
  s_barrier
  ds_write_b128 v121, v[48:51] offset:0
  ds_write_b128 v121, v[52:55] offset:512
  v_and_b32_e64 v29, 31, v1
  v_lshl_add_u32 v29, s61, 5, v29
  v_lshlrev_b32 v7, 4, v29
  v_lshrrev_b32 v30, 5, v1
  v_mul_u32_u24 v30, 1024, v30
  v_add_u32_e64 v7, v7, v30
  v_add_u32 v9, 0x20000, v7
  v_add_u32 v8, 0x10000, v7
  s_mov_b32 exec_lo, 0x10001
  s_mov_b32 exec_hi, 0x10001
  ds_write_b128 v126, v[80:83] offset:0
  ds_write_b128 v126, v[84:87] offset:256
  s_mov_b64 exec, 0xffff
  ds_write_b32 v127, v88 offset:512
  s_mov_b64 exec, -1
  s_nop 0
  ds_read_b64_tr_b16 v[208:209], v10 offset:61440
  ds_read_b64_tr_b16 v[210:211], v13 offset:61440
  ds_read_b64_tr_b16 v[212:213], v10 offset:63488
  ds_read_b64_tr_b16 v[214:215], v13 offset:63488
  ds_read_b64_tr_b16 v[216:217], v11 offset:0
  ds_read_b64_tr_b16 v[218:219], v14 offset:0
  ds_read_b64_tr_b16 v[220:221], v11 offset:2048
  ds_read_b64_tr_b16 v[222:223], v14 offset:2048
  ds_read_b64_tr_b16 v[224:225], v11 offset:4096
  ds_read_b64_tr_b16 v[226:227], v14 offset:4096
  ds_read_b64_tr_b16 v[228:229], v11 offset:6144
  ds_read_b64_tr_b16 v[230:231], v14 offset:6144
  ds_read_b64_tr_b16 v[232:233], v11 offset:8192
  ds_read_b64_tr_b16 v[234:235], v14 offset:8192
  ds_read_b64_tr_b16 v[236:237], v11 offset:10240
  ds_read_b64_tr_b16 v[238:239], v14 offset:10240
  ds_read_b64_tr_b16 v[240:241], v11 offset:12288
  ds_read_b64_tr_b16 v[242:243], v14 offset:12288
  ds_read_b64_tr_b16 v[244:245], v11 offset:14336
  ds_read_b64_tr_b16 v[246:247], v14 offset:14336
  ds_read_b64_tr_b16 v[248:249], v11 offset:16384
  ds_read_b64_tr_b16 v[250:251], v14 offset:16384
  ds_read_b64_tr_b16 v[252:253], v11 offset:18432
  ds_read_b64_tr_b16 v[254:255], v14 offset:18432
  s_waitcnt lgkmcnt(0)
  s_barrier
  v_mov_b32 v96, s60
  v_mov_b32 v97, s60
  v_mov_b32 v98, s60
  v_mov_b32 v99, s60
  ds_read_b64_tr_b16 v[80:81], v11 offset:57344
  ds_read_b64_tr_b16 v[82:83], v14 offset:57344
  ds_read_b64_tr_b16 v[84:85], v11 offset:59392
  ds_read_b64_tr_b16 v[86:87], v14 offset:59392
  ds_read_b64_tr_b16 v[88:89], v12 offset:16384
  ds_read_b64_tr_b16 v[90:91], v15 offset:16384
  s_waitcnt lgkmcnt(4)
  v_mfma_f32_32x32x16_bf16 v[48:63], v[80:83], v[96:99], 0
  ds_read_b64_tr_b16 v[92:93], v12 offset:18432
  ds_read_b64_tr_b16 v[94:95], v15 offset:18432
  s_waitcnt lgkmcnt(4)
  v_mfma_f32_32x32x16_bf16 v[48:63], v[84:87], v[96:99], v[48:63]
  s_waitcnt lgkmcnt(2)
  v_mfma_f32_32x32x16_bf16 v[48:63], v[88:91], v[96:99], v[48:63]
  s_waitcnt lgkmcnt(0)
  v_mfma_f32_32x32x16_bf16 v[48:63], v[92:95], v[96:99], v[48:63]
  v_lshrrev_b32 v29, 1, v1
  v_and_b32 v30, 31, v1
  v_add_u32_e64 v30, s61, v30
  v_cmp_eq_u32 s[62:63], 0, v30
  v_mov_b32 v30, 2130706432
  s_lshr_b32 s53, s2, 3
  s_lshl_b32 s53, s53, 8
  s_and_b32 s54, s2, 7
  s_mul_i32 s54, s54, 7168
  s_add_u32 s53, s53, s54
  s_lshl_b32 s54, s64, 7
  s_add_u32 s53, s53, s54
  s_add_u32 s53, s53, 196608
  s_cmp_lt_u32 s2, 224
  s_cselect_b32 s53, s53, 2130706432
  v_cndmask_b32 v29, v30, v29, s[62:63]
  buffer_store_dwordx4 v[48:51], v29, s[4:7], s53 offen offset:0 sc1
  buffer_store_dwordx4 v[52:55], v29, s[4:7], s53 offen offset:32 sc1
  buffer_store_dwordx4 v[56:59], v29, s[4:7], s53 offen offset:64 sc1
  buffer_store_dwordx4 v[60:63], v29, s[4:7], s53 offen offset:96 sc1
  s_barrier
  ds_read_b128 v[96:99], v7 offset:0
  ds_read_b128 v[100:103], v7 offset:2048
  ds_read_b128 v[104:107], v7 offset:4096
  s_waitcnt lgkmcnt(2)
  v_mfma_f32_32x32x16_bf16 v[32:47], v[128:131], v[96:99], v[32:47]
  ds_read_b128 v[108:111], v7 offset:6144
  s_waitcnt lgkmcnt(2)
  v_mfma_f32_32x32x16_bf16 v[32:47], v[132:135], v[100:103], v[32:47]
  s_barrier
  ds_read_b128 v[96:99], v7 offset:8192
  s_waitcnt lgkmcnt(2)
  v_mfma_f32_32x32x16_bf16 v[32:47], v[136:139], v[104:107], v[32:47]
  ds_read_b128 v[100:103], v7 offset:10240
  s_waitcnt lgkmcnt(2)
  v_mfma_f32_32x32x16_bf16 v[32:47], v[140:143], v[108:111], v[32:47]
  ds_read_b128 v[104:107], v7 offset:12288
  s_waitcnt lgkmcnt(2)
  v_mfma_f32_32x32x16_bf16 v[32:47], v[144:147], v[96:99], v[32:47]
  ds_read_b128 v[108:111], v7 offset:14336
  s_waitcnt lgkmcnt(2)
  v_mfma_f32_32x32x16_bf16 v[32:47], v[148:151], v[100:103], v[32:47]
  s_barrier
  ds_read_b128 v[96:99], v7 offset:16384
  s_waitcnt lgkmcnt(2)
  v_mfma_f32_32x32x16_bf16 v[32:47], v[152:155], v[104:107], v[32:47]
  ds_read_b128 v[100:103], v7 offset:18432
  s_waitcnt lgkmcnt(2)
  v_mfma_f32_32x32x16_bf16 v[32:47], v[156:159], v[108:111], v[32:47]
  ds_read_b128 v[104:107], v7 offset:20480
  s_waitcnt lgkmcnt(2)
  v_mfma_f32_32x32x16_bf16 v[32:47], v[160:163], v[96:99], v[32:47]
  ds_read_b128 v[108:111], v7 offset:22528
  s_waitcnt lgkmcnt(2)
  v_mfma_f32_32x32x16_bf16 v[32:47], v[164:167], v[100:103], v[32:47]
  s_barrier
  ds_read_b128 v[96:99], v7 offset:24576
  s_waitcnt lgkmcnt(2)
  v_mfma_f32_32x32x16_bf16 v[32:47], v[168:171], v[104:107], v[32:47]
  ds_read_b128 v[100:103], v7 offset:26624
  s_waitcnt lgkmcnt(2)
  v_mfma_f32_32x32x16_bf16 v[32:47], v[172:175], v[108:111], v[32:47]
  ds_read_b128 v[104:107], v7 offset:28672
  s_waitcnt lgkmcnt(2)
  v_mfma_f32_32x32x16_bf16 v[32:47], v[176:179], v[96:99], v[32:47]
  ds_read_b128 v[108:111], v7 offset:30720
  s_waitcnt lgkmcnt(2)
  v_mfma_f32_32x32x16_bf16 v[32:47], v[180:183], v[100:103], v[32:47]
  s_barrier
  ds_read_b128 v[96:99], v7 offset:32768
  s_waitcnt lgkmcnt(2)
  v_mfma_f32_32x32x16_bf16 v[32:47], v[184:187], v[104:107], v[32:47]
  ds_read_b128 v[100:103], v7 offset:34816
  s_waitcnt lgkmcnt(2)
  v_mfma_f32_32x32x16_bf16 v[32:47], v[188:191], v[108:111], v[32:47]
  ds_read_b128 v[104:107], v7 offset:36864
  s_waitcnt lgkmcnt(2)
  v_mfma_f32_32x32x16_bf16 v[32:47], v[192:195], v[96:99], v[32:47]
  ds_read_b128 v[108:111], v7 offset:38912
  s_waitcnt lgkmcnt(2)
  v_mfma_f32_32x32x16_bf16 v[32:47], v[196:199], v[100:103], v[32:47]
  s_barrier
  ds_read_b128 v[96:99], v7 offset:40960
  s_waitcnt lgkmcnt(2)
  v_mfma_f32_32x32x16_bf16 v[32:47], v[200:203], v[104:107], v[32:47]
  ds_read_b128 v[100:103], v7 offset:43008
  s_waitcnt lgkmcnt(2)
  v_mfma_f32_32x32x16_bf16 v[32:47], v[204:207], v[108:111], v[32:47]
  ds_read_b128 v[104:107], v7 offset:45056
  s_waitcnt lgkmcnt(2)
  v_mfma_f32_32x32x16_bf16 v[32:47], v[208:211], v[96:99], v[32:47]
  ds_read_b128 v[108:111], v7 offset:47104
  s_waitcnt lgkmcnt(2)
  v_mfma_f32_32x32x16_bf16 v[32:47], v[212:215], v[100:103], v[32:47]
  s_barrier
  ds_read_b128 v[96:99], v7 offset:49152
  s_waitcnt lgkmcnt(2)
  v_mfma_f32_32x32x16_bf16 v[32:47], v[216:219], v[104:107], v[32:47]
  ds_read_b128 v[100:103], v7 offset:51200
  s_waitcnt lgkmcnt(2)
  v_mfma_f32_32x32x16_bf16 v[32:47], v[220:223], v[108:111], v[32:47]
  ds_read_b128 v[104:107], v7 offset:53248
  s_waitcnt lgkmcnt(2)
  v_mfma_f32_32x32x16_bf16 v[32:47], v[224:227], v[96:99], v[32:47]
  ds_read_b128 v[108:111], v7 offset:55296
  s_waitcnt lgkmcnt(2)
  v_mfma_f32_32x32x16_bf16 v[32:47], v[228:231], v[100:103], v[32:47]
  s_barrier
  ds_read_b128 v[96:99], v7 offset:57344
  s_waitcnt lgkmcnt(2)
  v_mfma_f32_32x32x16_bf16 v[32:47], v[232:235], v[104:107], v[32:47]
  ds_read_b128 v[100:103], v7 offset:59392
  s_waitcnt lgkmcnt(2)
  v_mfma_f32_32x32x16_bf16 v[32:47], v[236:239], v[108:111], v[32:47]
  ds_read_b128 v[104:107], v7 offset:61440
  s_waitcnt lgkmcnt(2)
  v_mfma_f32_32x32x16_bf16 v[32:47], v[240:243], v[96:99], v[32:47]
  ds_read_b128 v[108:111], v7 offset:63488
  s_waitcnt lgkmcnt(2)
  v_mfma_f32_32x32x16_bf16 v[32:47], v[244:247], v[100:103], v[32:47]
  s_waitcnt lgkmcnt(1)
  v_mfma_f32_32x32x16_bf16 v[32:47], v[248:251], v[104:107], v[32:47]
  s_waitcnt lgkmcnt(0)
  v_mfma_f32_32x32x16_bf16 v[32:47], v[252:255], v[108:111], v[32:47]
  s_nop 0
  s_nop 11
  v_cvt_pk_bf16_f32 v96, v32, v33
  v_cvt_pk_bf16_f32 v97, v34, v35
  v_cvt_pk_bf16_f32 v98, v36, v37
  v_cvt_pk_bf16_f32 v99, v38, v39
  v_cvt_pk_bf16_f32 v100, v40, v41
  v_cvt_pk_bf16_f32 v101, v42, v43
  v_cvt_pk_bf16_f32 v102, v44, v45
  v_cvt_pk_bf16_f32 v103, v46, v47
  buffer_store_dwordx4 v[96:99], v16, s[4:7], s66 offen sc1
  buffer_store_dwordx4 v[100:103], v16, s[4:7], s66 offen offset:2048 sc1
  v_pk_add_f32 v[112:113], v[32:33], v[34:35]
  v_pk_add_f32 v[114:115], v[36:37], v[38:39]
  v_pk_add_f32 v[116:117], v[40:41], v[42:43]
  v_pk_add_f32 v[118:119], v[44:45], v[46:47]
  v_pk_mul_f32 v[120:121], v[32:33], v[32:33]
  v_pk_fma_f32 v[120:121], v[34:35], v[34:35], v[120:121]
  v_pk_fma_f32 v[120:121], v[36:37], v[36:37], v[120:121]
  v_pk_fma_f32 v[120:121], v[38:39], v[38:39], v[120:121]
  v_pk_fma_f32 v[120:121], v[40:41], v[40:41], v[120:121]
  v_pk_fma_f32 v[120:121], v[42:43], v[42:43], v[120:121]
  v_pk_fma_f32 v[120:121], v[44:45], v[44:45], v[120:121]
  v_pk_fma_f32 v[120:121], v[46:47], v[46:47], v[120:121]
  v_pk_add_f32 v[112:113], v[112:113], v[114:115]
  v_pk_add_f32 v[116:117], v[116:117], v[118:119]
  v_add_f32_e64 v120, v120, v121
  v_pk_add_f32 v[112:113], v[112:113], v[116:117]
  v_add_f32 v112, v112, v113
  s_nop 1
  v_permlane32_swap_b32 v112, v120
  v_add_f32 v112, v112, v120
  buffer_store_dword v112, v28, s[4:7], s81 offen sc1
  s_barrier
  s_nop 0
  ds_read_b64_tr_b16 v[128:129], v11 offset:20480
  ds_read_b64_tr_b16 v[130:131], v14 offset:20480
  ds_read_b64_tr_b16 v[132:133], v11 offset:22528
  ds_read_b64_tr_b16 v[134:135], v14 offset:22528
  ds_read_b64_tr_b16 v[136:137], v11 offset:24576
  ds_read_b64_tr_b16 v[138:139], v14 offset:24576
  ds_read_b64_tr_b16 v[140:141], v11 offset:26624
  ds_read_b64_tr_b16 v[142:143], v14 offset:26624
  ds_read_b64_tr_b16 v[144:145], v11 offset:28672
  ds_read_b64_tr_b16 v[146:147], v14 offset:28672
  ds_read_b64_tr_b16 v[148:149], v11 offset:30720
  ds_read_b64_tr_b16 v[150:151], v14 offset:30720
  ds_read_b64_tr_b16 v[152:153], v11 offset:32768
  ds_read_b64_tr_b16 v[154:155], v14 offset:32768
  ds_read_b64_tr_b16 v[156:157], v11 offset:34816
  ds_read_b64_tr_b16 v[158:159], v14 offset:34816
  ds_read_b64_tr_b16 v[160:161], v11 offset:36864
  ds_read_b64_tr_b16 v[162:163], v14 offset:36864
  ds_read_b64_tr_b16 v[164:165], v11 offset:38912
  ds_read_b64_tr_b16 v[166:167], v14 offset:38912
  ds_read_b64_tr_b16 v[168:169], v11 offset:40960
  ds_read_b64_tr_b16 v[170:171], v14 offset:40960
  ds_read_b64_tr_b16 v[172:173], v11 offset:43008
  ds_read_b64_tr_b16 v[174:175], v14 offset:43008
  ds_read_b64_tr_b16 v[176:177], v11 offset:45056
  ds_read_b64_tr_b16 v[178:179], v14 offset:45056
  ds_read_b64_tr_b16 v[180:181], v11 offset:47104
  ds_read_b64_tr_b16 v[182:183], v14 offset:47104
  ds_read_b64_tr_b16 v[184:185], v11 offset:49152
  ds_read_b64_tr_b16 v[186:187], v14 offset:49152
  ds_read_b64_tr_b16 v[188:189], v11 offset:51200
  ds_read_b64_tr_b16 v[190:191], v14 offset:51200
  ds_read_b64_tr_b16 v[192:193], v11 offset:53248
  ds_read_b64_tr_b16 v[194:195], v14 offset:53248
  ds_read_b64_tr_b16 v[196:197], v11 offset:55296
  ds_read_b64_tr_b16 v[198:199], v14 offset:55296
  ds_read_b64_tr_b16 v[200:201], v11 offset:61440
  ds_read_b64_tr_b16 v[202:203], v14 offset:61440
  ds_read_b64_tr_b16 v[204:205], v11 offset:63488
  ds_read_b64_tr_b16 v[206:207], v14 offset:63488
  ds_read_b64_tr_b16 v[208:209], v12 offset:0
  ds_read_b64_tr_b16 v[210:211], v15 offset:0
  ds_read_b64_tr_b16 v[212:213], v12 offset:2048
  ds_read_b64_tr_b16 v[214:215], v15 offset:2048
  ds_read_b64_tr_b16 v[216:217], v12 offset:4096
  ds_read_b64_tr_b16 v[218:219], v15 offset:4096
  ds_read_b64_tr_b16 v[220:221], v12 offset:6144
  ds_read_b64_tr_b16 v[222:223], v15 offset:6144
  ds_read_b64_tr_b16 v[224:225], v12 offset:8192
  ds_read_b64_tr_b16 v[226:227], v15 offset:8192
  ds_read_b64_tr_b16 v[228:229], v12 offset:10240
  ds_read_b64_tr_b16 v[230:231], v15 offset:10240
  ds_read_b64_tr_b16 v[232:233], v12 offset:12288
  ds_read_b64_tr_b16 v[234:235], v15 offset:12288
  ds_read_b64_tr_b16 v[236:237], v12 offset:14336
  ds_read_b64_tr_b16 v[238:239], v15 offset:14336
  ds_read_b64_tr_b16 v[240:241], v11 offset:0
  ds_read_b64_tr_b16 v[242:243], v14 offset:0
  ds_read_b64_tr_b16 v[244:245], v11 offset:2048
  ds_read_b64_tr_b16 v[246:247], v14 offset:2048
  ds_read_b64_tr_b16 v[248:249], v11 offset:4096
  ds_read_b64_tr_b16 v[250:251], v14 offset:4096
  ds_read_b64_tr_b16 v[252:253], v11 offset:6144
  ds_read_b64_tr_b16 v[254:255], v14 offset:6144
  s_waitcnt vmcnt(0)
  s_barrier
  ds_write_b128 v16, v[96:99] offset:0
  ds_write_b128 v16, v[100:103] offset:2048
  v_mov_b32 v116, s60
  v_mov_b32 v117, s60
  v_mov_b32 v118, s60
  v_mov_b32 v119, s60
  s_cmp_lg_u32 s61, 0
  s_cbranch_scc1 CV1_6
  s_waitcnt lgkmcnt(15)
  v_mfma_f32_32x32x16_bf16 v[64:79], v[128:131], v[116:119], 0
  s_waitcnt lgkmcnt(15)
  v_mfma_f32_32x32x16_bf16 v[64:79], v[132:135], v[116:119], v[64:79]
  s_waitcnt lgkmcnt(15)
  v_mfma_f32_32x32x16_bf16 v[64:79], v[136:139], v[116:119], v[64:79]
  s_waitcnt lgkmcnt(15)
  v_mfma_f32_32x32x16_bf16 v[64:79], v[140:143], v[116:119], v[64:79]
  s_waitcnt lgkmcnt(15)
  v_mfma_f32_32x32x16_bf16 v[64:79], v[144:147], v[116:119], v[64:79]
  s_waitcnt lgkmcnt(15)
  v_mfma_f32_32x32x16_bf16 v[64:79], v[148:151], v[116:119], v[64:79]
  s_waitcnt lgkmcnt(15)
  v_mfma_f32_32x32x16_bf16 v[64:79], v[152:155], v[116:119], v[64:79]
  s_waitcnt lgkmcnt(15)
  v_mfma_f32_32x32x16_bf16 v[64:79], v[156:159], v[116:119], v[64:79]
  s_waitcnt lgkmcnt(15)
  v_mfma_f32_32x32x16_bf16 v[64:79], v[160:163], v[116:119], v[64:79]
  s_waitcnt lgkmcnt(15)
  v_mfma_f32_32x32x16_bf16 v[64:79], v[164:167], v[116:119], v[64:79]
  s_waitcnt lgkmcnt(15)
  v_mfma_f32_32x32x16_bf16 v[64:79], v[168:171], v[116:119], v[64:79]
  s_waitcnt lgkmcnt(15)
  v_mfma_f32_32x32x16_bf16 v[64:79], v[172:175], v[116:119], v[64:79]
  s_waitcnt lgkmcnt(15)
  v_mfma_f32_32x32x16_bf16 v[64:79], v[176:179], v[116:119], v[64:79]
  s_waitcnt lgkmcnt(15)
  v_mfma_f32_32x32x16_bf16 v[64:79], v[180:183], v[116:119], v[64:79]
  s_waitcnt lgkmcnt(15)
  v_mfma_f32_32x32x16_bf16 v[64:79], v[184:187], v[116:119], v[64:79]
  s_waitcnt lgkmcnt(15)
  v_mfma_f32_32x32x16_bf16 v[64:79], v[188:191], v[116:119], v[64:79]
  s_waitcnt lgkmcnt(0)
  s_branch CVE_7
CV1_6:
PAD_3:
  s_cbranch_execz L_TRAMP
  s_nop 0
  s_waitcnt lgkmcnt(15)
  v_mfma_f32_32x32x16_bf16 v[64:79], v[192:195], v[116:119], 0
  s_waitcnt lgkmcnt(15)
  v_mfma_f32_32x32x16_bf16 v[64:79], v[196:199], v[116:119], v[64:79]
  s_waitcnt lgkmcnt(15)
  v_mfma_f32_32x32x16_bf16 v[64:79], v[200:203], v[116:119], v[64:79]
  s_waitcnt lgkmcnt(15)
  v_mfma_f32_32x32x16_bf16 v[64:79], v[204:207], v[116:119], v[64:79]
  s_waitcnt lgkmcnt(15)
  v_mfma_f32_32x32x16_bf16 v[64:79], v[208:211], v[116:119], v[64:79]
  s_waitcnt lgkmcnt(15)
  v_mfma_f32_32x32x16_bf16 v[64:79], v[212:215], v[116:119], v[64:79]
  s_waitcnt lgkmcnt(15)
  v_mfma_f32_32x32x16_bf16 v[64:79], v[216:219], v[116:119], v[64:79]
  s_waitcnt lgkmcnt(15)
  v_mfma_f32_32x32x16_bf16 v[64:79], v[220:223], v[116:119], v[64:79]
  s_waitcnt lgkmcnt(15)
  v_mfma_f32_32x32x16_bf16 v[64:79], v[224:227], v[116:119], v[64:79]
  s_waitcnt lgkmcnt(14)
  v_mfma_f32_32x32x16_bf16 v[64:79], v[228:231], v[116:119], v[64:79]
  s_waitcnt lgkmcnt(12)
  v_mfma_f32_32x32x16_bf16 v[64:79], v[232:235], v[116:119], v[64:79]
  s_waitcnt lgkmcnt(10)
  v_mfma_f32_32x32x16_bf16 v[64:79], v[236:239], v[116:119], v[64:79]
  s_waitcnt lgkmcnt(8)
  v_mfma_f32_32x32x16_bf16 v[64:79], v[240:243], v[116:119], v[64:79]
  s_waitcnt lgkmcnt(6)
  v_mfma_f32_32x32x16_bf16 v[64:79], v[244:247], v[116:119], v[64:79]
  s_waitcnt lgkmcnt(4)
  v_mfma_f32_32x32x16_bf16 v[64:79], v[248:251], v[116:119], v[64:79]
  s_waitcnt lgkmcnt(2)
  v_mfma_f32_32x32x16_bf16 v[64:79], v[252:255], v[116:119], v[64:79]
  s_waitcnt lgkmcnt(0)
CVE_7:
  s_lshl_b32 s53, s61, 8
  s_add_u32 s53, s53, -512
  v_add_u32 v29, s53, v27
  s_mov_b32 exec_lo, 1
  s_mov_b32 exec_hi, 1
  s_nop 2
  s_nop 2
  ds_write_b128 v29, v[64:67] offset:0
  ds_write_b128 v29, v[68:71] offset:32
  ds_write_b128 v29, v[72:75] offset:64
  ds_write_b128 v29, v[76:79] offset:96
  s_mov_b64 exec, -1
  s_waitcnt lgkmcnt(0)
  s_barrier
  s_barrier
  ds_read_b128 v[96:99], v7 offset:0
  ds_read_b128 v[100:103], v7 offset:2048
  ds_read_b128 v[104:107], v7 offset:4096
  s_waitcnt lgkmcnt(2)
  v_mfma_f32_32x32x16_bf16 v[48:63], v[128:131], v[96:99], 0
  ds_read_b128 v[108:111], v7 offset:6144
  s_waitcnt lgkmcnt(2)
  v_mfma_f32_32x32x16_bf16 v[48:63], v[132:135], v[100:103], v[48:63]
  s_barrier
  ds_read_b128 v[96:99], v7 offset:8192
  s_waitcnt lgkmcnt(2)
  v_mfma_f32_32x32x16_bf16 v[48:63], v[136:139], v[104:107], v[48:63]
  ds_read_b128 v[100:103], v7 offset:10240
  s_waitcnt lgkmcnt(2)
  v_mfma_f32_32x32x16_bf16 v[48:63], v[140:143], v[108:111], v[48:63]
  ds_read_b128 v[104:107], v7 offset:12288
  s_waitcnt lgkmcnt(2)
  v_mfma_f32_32x32x16_bf16 v[48:63], v[144:147], v[96:99], v[48:63]
  ds_read_b128 v[108:111], v7 offset:14336
  s_waitcnt lgkmcnt(2)
  v_mfma_f32_32x32x16_bf16 v[48:63], v[148:151], v[100:103], v[48:63]
  s_barrier
  ds_read_b128 v[96:99], v7 offset:16384
  s_mul_i32 s69, s61, 4096
  s_add_u32 s69, s69, 65536
  v_add_u32 v29, s69, v28
  s_waitcnt lgkmcnt(2)
  v_mfma_f32_32x32x16_bf16 v[48:63], v[152:155], v[104:107], v[48:63]
  ds_read_b128 v[100:103], v7 offset:18432
  ds_read2st64_b32 v[80:81], v29 offset0:0 offset1:1
  ds_read2st64_b32 v[82:83], v29 offset0:2 offset1:3
  ds_read2st64_b32 v[84:85], v29 offset0:4 offset1:5
  ds_read2st64_b32 v[86:87], v29 offset0:6 offset1:7
  ds_read2st64_b32 v[88:89], v29 offset0:8 offset1:9
  ds_read2st64_b32 v[90:91], v29 offset0:10 offset1:11
  ds_read2st64_b32 v[92:93], v29 offset0:12 offset1:13
  ds_read2st64_b32 v[94:95], v29 offset0:14 offset1:15
  s_waitcnt lgkmcnt(10)
  v_mfma_f32_32x32x16_bf16 v[48:63], v[156:159], v[108:111], v[48:63]
  ds_read_b128 v[104:107], v7 offset:20480
  s_waitcnt lgkmcnt(10)
  v_mfma_f32_32x32x16_bf16 v[48:63], v[160:163], v[96:99], v[48:63]
  ds_read_b128 v[108:111], v7 offset:22528
  s_waitcnt lgkmcnt(9)
  v_add_f32 v80, v80, v81
  s_waitcnt lgkmcnt(8)
  v_add_f32 v82, v82, v83
  s_waitcnt lgkmcnt(7)
  v_add_f32_e64 v84, v84, v85
  v_mfma_f32_32x32x16_bf16 v[48:63], v[164:167], v[100:103], v[48:63]
  s_barrier
  ds_read_b128 v[96:99], v7 offset:24576
  s_waitcnt lgkmcnt(7)
  v_add_f32 v86, v86, v87
  s_waitcnt lgkmcnt(6)
  v_add_f32 v88, v88, v89
  s_waitcnt lgkmcnt(5)
  v_add_f32 v90, v90, v91
  s_waitcnt lgkmcnt(2)
PAD_4:
  s_cbranch_execz L_TRAMP
  s_nop 0
  v_mfma_f32_32x32x16_bf16 v[48:63], v[168:171], v[104:107], v[48:63]
  ds_read_b128 v[100:103], v7 offset:26624
  v_add_f32 v92, v92, v93
  v_add_f32 v94, v94, v95
  v_add_f32 v80, v80, v82
  s_waitcnt lgkmcnt(2)
  v_mfma_f32_32x32x16_bf16 v[48:63], v[172:175], v[108:111], v[48:63]
  ds_read_b128 v[104:107], v7 offset:28672
  v_add_f32 v84, v84, v86
  v_add_f32 v88, v88, v90
  v_add_f32 v92, v92, v94
  v_add_f32 v80, v80, v84
  s_waitcnt lgkmcnt(2)
  v_mfma_f32_32x32x16_bf16 v[48:63], v[176:179], v[96:99], v[48:63]
  ds_read_b128 v[108:111], v7 offset:30720
  v_add_f32 v88, v88, v92
  v_add_f32 v80, v80, v88
  v_mov_b32 v30, v80
  s_waitcnt lgkmcnt(2)
  v_mfma_f32_32x32x16_bf16 v[48:63], v[180:183], v[100:103], v[48:63]
  s_barrier
  ds_read_b128 v[96:99], v7 offset:32768
  v_permlane32_swap_b32_e64 v80, v30
  v_mul_f32 v122, 0xbb000000, v80
  v_mul_f32 v30, 0x3b000000, v30
  s_waitcnt lgkmcnt(2)
  v_mfma_f32_32x32x16_bf16 v[48:63], v[184:187], v[104:107], v[48:63]
  ds_read_b128 v[100:103], v7 offset:34816
  v_fma_f32 v30, -v122, v122, v30
  v_max_f32 v30, 0, v30
  v_add_f32 v29, 0x3727c5ac, v30
  s_waitcnt lgkmcnt(2)
  v_mfma_f32_32x32x16_bf16 v[48:63], v[188:191], v[108:111], v[48:63]
  ds_read_b128 v[104:107], v7 offset:36864
  v_rsq_f32 v126, v29
  s_nop 0
  v_mul_f32 v30, v30, v126
  v_mul_f32_e64 v30, v30, v126
  v_add_f32 v30, 0x3727c5ac, v30
  s_waitcnt lgkmcnt(2)
  v_mfma_f32_32x32x16_bf16 v[48:63], v[192:195], v[96:99], v[48:63]
  ds_read_b128 v[108:111], v7 offset:38912
  v_rsq_f32 v30, v30
  v_mul_f32 v127, v122, v126
  v_mul_f32 v29, v30, v126
  s_waitcnt lgkmcnt(2)
  v_mfma_f32_32x32x16_bf16 v[48:63], v[196:199], v[100:103], v[48:63]
  s_barrier
  ds_read_b128 v[96:99], v7 offset:40960
  v_rcp_f32_e64 v125, v29
  v_mul_f32 v123, 0xc0135761, v29
  v_mul_f32 v30, v29, v29
  s_waitcnt lgkmcnt(2)
  v_mfma_f32_32x32x16_bf16 v[48:63], v[200:203], v[104:107], v[48:63]
  ds_read_b128 v[100:103], v7 offset:43008
  v_mul_f32_e64 v30, v30, v29
  v_mul_f32 v124, 0xbdd2d3e8, v30
  s_xor_b32 s53, s61, 1
  s_waitcnt lgkmcnt(2)
  v_mfma_f32_32x32x16_bf16 v[48:63], v[204:207], v[108:111], v[48:63]
  ds_read_b128 v[104:107], v7 offset:45056
  s_lshl_b32 s53, s53, 8
  s_add_u32 s53, s53, -512
  v_add_u32 v112, s53, v27
  s_waitcnt lgkmcnt(2)
  v_mfma_f32_32x32x16_bf16 v[48:63], v[208:211], v[96:99], v[48:63]
  ds_read_b128 v[108:111], v7 offset:47104
  ds_read_b128 v[80:83], v112 offset:0
  ds_read_b128 v[84:87], v112 offset:32
  ds_read_b128 v[88:91], v112 offset:64
  ds_read_b128 v[92:95], v112 offset:96
  s_waitcnt lgkmcnt(6)
  v_mfma_f32_32x32x16_bf16 v[48:63], v[212:215], v[100:103], v[48:63]
  s_barrier
  ds_read_b128 v[96:99], v7 offset:49152
  s_waitcnt lgkmcnt(4)
  v_add_f32 v64, v64, v80
  v_add_f32 v65, v65, v81
  v_add_f32_e64 v66, v66, v82
  v_mfma_f32_32x32x16_bf16 v[48:63], v[216:219], v[104:107], v[48:63]
  ds_read_b128 v[100:103], v7 offset:51200
  v_add_f32 v67, v67, v83
  s_waitcnt lgkmcnt(4)
  v_add_f32 v68, v68, v84
  v_add_f32 v69, v69, v85
  v_mfma_f32_32x32x16_bf16 v[48:63], v[220:223], v[108:111], v[48:63]
  ds_read_b128 v[104:107], v7 offset:53248
  v_add_f32 v70, v70, v86
  v_add_f32 v71, v71, v87
  s_waitcnt lgkmcnt(4)
  v_add_f32 v72, v72, v88
  v_add_f32 v73, v73, v89
  s_waitcnt lgkmcnt(2)
  v_mfma_f32_32x32x16_bf16 v[48:63], v[224:227], v[96:99], v[48:63]
  ds_read_b128 v[108:111], v7 offset:55296
  v_add_f32 v74, v74, v90
  v_add_f32 v75, v75, v91
  v_add_f32 v76, v76, v92
  s_waitcnt lgkmcnt(2)
  v_mfma_f32_32x32x16_bf16 v[48:63], v[228:231], v[100:103], v[48:63]
  s_barrier
  ds_read_b128 v[96:99], v7 offset:57344
  v_add_f32 v77, v77, v93
  v_add_f32 v78, v78, v94
  v_add_f32 v79, v79, v95
  s_waitcnt lgkmcnt(2)
  v_mfma_f32_32x32x16_bf16 v[48:63], v[232:235], v[104:107], v[48:63]
  ds_read_b128 v[100:103], v7 offset:59392
  s_waitcnt lgkmcnt(2)
  v_mfma_f32_32x32x16_bf16 v[48:63], v[236:239], v[108:111], v[48:63]
  ds_read_b128 v[104:107], v7 offset:61440
  s_waitcnt lgkmcnt(2)
  v_mfma_f32_32x32x16_bf16 v[48:63], v[240:243], v[96:99], v[48:63]
  ds_read_b128 v[108:111], v7 offset:63488
  s_waitcnt lgkmcnt(2)
  v_mfma_f32_32x32x16_bf16 v[48:63], v[244:247], v[100:103], v[48:63]
  s_waitcnt lgkmcnt(1)
  v_mfma_f32_32x32x16_bf16 v[48:63], v[248:251], v[104:107], v[48:63]
  s_waitcnt lgkmcnt(0)
  v_mfma_f32_32x32x16_bf16 v[48:63], v[252:255], v[108:111], v[48:63]
  s_nop 0
  s_nop 11
  v_pk_fma_f32 v[48:49], v[64:65], v[122:123], v[48:49] op_sel:[0,0,0] op_sel_hi:[1,0,1]
  v_pk_fma_f32 v[50:51], v[66:67], v[122:123], v[50:51] op_sel:[0,0,0] op_sel_hi:[1,0,1]
  v_pk_mul_f32 v[112:113], v[48:49], v[48:49] op_sel:[0,0] op_sel_hi:[1,1]
  v_pk_mul_f32 v[114:115], v[50:51], v[50:51] op_sel:[0,0] op_sel_hi:[1,1]
  v_pk_fma_f32 v[112:113], v[112:113], v[124:125], v[122:123] op_sel:[0,0,1] op_sel_hi:[1,0,1]
  v_pk_fma_f32 v[114:115], v[114:115], v[124:125], v[122:123] op_sel:[0,0,1] op_sel_hi:[1,0,1]
  v_pk_mul_f32 v[112:113], v[112:113], v[48:49] op_sel:[0,0] op_sel_hi:[1,1]
  v_pk_mul_f32 v[114:115], v[114:115], v[50:51] op_sel:[0,0] op_sel_hi:[1,1]
  v_exp_f32 v112, v112
  v_exp_f32 v113, v113
  v_exp_f32 v114, v114
  v_exp_f32 v115, v115
  v_pk_fma_f32 v[112:113], v[112:113], v[124:125], v[124:125] op_sel:[0,1,1] op_sel_hi:[1,1,1]
  v_pk_fma_f32 v[114:115], v[114:115], v[124:125], v[124:125] op_sel:[0,1,1] op_sel_hi:[1,1,1]
  v_rcp_f32 v112, v112
  v_rcp_f32 v113, v113
  v_rcp_f32 v114, v114
  v_rcp_f32 v115, v115
  v_pk_mul_f32 v[112:113], v[112:113], v[48:49] op_sel:[0,0] op_sel_hi:[1,1]
  v_pk_mul_f32 v[114:115], v[114:115], v[50:51] op_sel:[0,0] op_sel_hi:[1,1]
  v_cvt_pk_bf16_f32 v96, v112, v113
  v_cvt_pk_bf16_f32 v97, v114, v115
  v_pk_fma_f32 v[52:53], v[68:69], v[122:123], v[52:53] op_sel:[0,0,0] op_sel_hi:[1,0,1]
  v_pk_fma_f32 v[54:55], v[70:71], v[122:123], v[54:55] op_sel:[0,0,0] op_sel_hi:[1,0,1]
  v_pk_mul_f32 v[112:113], v[52:53], v[52:53] op_sel:[0,0] op_sel_hi:[1,1]
  v_pk_mul_f32 v[114:115], v[54:55], v[54:55] op_sel:[0,0] op_sel_hi:[1,1]
  v_pk_fma_f32 v[112:113], v[112:113], v[124:125], v[122:123] op_sel:[0,0,1] op_sel_hi:[1,0,1]
  v_pk_fma_f32 v[114:115], v[114:115], v[124:125], v[122:123] op_sel:[0,0,1] op_sel_hi:[1,0,1]
  v_pk_mul_f32 v[112:113], v[112:113], v[52:53] op_sel:[0,0] op_sel_hi:[1,1]
  v_pk_mul_f32 v[114:115], v[114:115], v[54:55] op_sel:[0,0] op_sel_hi:[1,1]
  v_exp_f32 v112, v112
  v_exp_f32 v113, v113
  v_exp_f32 v114, v114
  v_exp_f32 v115, v115
  v_pk_fma_f32 v[112:113], v[112:113], v[124:125], v[124:125] op_sel:[0,1,1] op_sel_hi:[1,1,1]
  v_pk_fma_f32 v[114:115], v[114:115], v[124:125], v[124:125] op_sel:[0,1,1] op_sel_hi:[1,1,1]
  v_rcp_f32 v112, v112
  v_rcp_f32 v113, v113
  v_rcp_f32 v114, v114
  v_rcp_f32 v115, v115
  v_pk_mul_f32 v[112:113], v[112:113], v[52:53] op_sel:[0,0] op_sel_hi:[1,1]
  v_pk_mul_f32 v[114:115], v[114:115], v[54:55] op_sel:[0,0] op_sel_hi:[1,1]
  v_cvt_pk_bf16_f32 v98, v112, v113
  v_cvt_pk_bf16_f32 v99, v114, v115
  v_pk_fma_f32 v[56:57], v[72:73], v[122:123], v[56:57] op_sel:[0,0,0] op_sel_hi:[1,0,1]
  v_pk_fma_f32 v[58:59], v[74:75], v[122:123], v[58:59] op_sel:[0,0,0] op_sel_hi:[1,0,1]
  v_pk_mul_f32 v[112:113], v[56:57], v[56:57] op_sel:[0,0] op_sel_hi:[1,1]
  v_pk_mul_f32 v[114:115], v[58:59], v[58:59] op_sel:[0,0] op_sel_hi:[1,1]
  v_pk_fma_f32 v[112:113], v[112:113], v[124:125], v[122:123] op_sel:[0,0,1] op_sel_hi:[1,0,1]
  v_pk_fma_f32 v[114:115], v[114:115], v[124:125], v[122:123] op_sel:[0,0,1] op_sel_hi:[1,0,1]
  v_pk_mul_f32 v[112:113], v[112:113], v[56:57] op_sel:[0,0] op_sel_hi:[1,1]
  v_pk_mul_f32 v[114:115], v[114:115], v[58:59] op_sel:[0,0] op_sel_hi:[1,1]
  v_exp_f32 v112, v112
  v_exp_f32 v113, v113
  v_exp_f32 v114, v114
  v_exp_f32 v115, v115
  v_pk_fma_f32 v[112:113], v[112:113], v[124:125], v[124:125] op_sel:[0,1,1] op_sel_hi:[1,1,1]
  v_pk_fma_f32 v[114:115], v[114:115], v[124:125], v[124:125] op_sel:[0,1,1] op_sel_hi:[1,1,1]
  v_rcp_f32 v112, v112
  v_rcp_f32 v113, v113
  v_rcp_f32 v114, v114
  v_rcp_f32 v115, v115
  v_pk_mul_f32 v[112:113], v[112:113], v[56:57] op_sel:[0,0] op_sel_hi:[1,1]
  v_pk_mul_f32 v[114:115], v[114:115], v[58:59] op_sel:[0,0] op_sel_hi:[1,1]
  v_cvt_pk_bf16_f32 v100, v112, v113
  v_cvt_pk_bf16_f32 v101, v114, v115
  v_pk_fma_f32 v[60:61], v[76:77], v[122:123], v[60:61] op_sel:[0,0,0] op_sel_hi:[1,0,1]
  v_pk_fma_f32 v[62:63], v[78:79], v[122:123], v[62:63] op_sel:[0,0,0] op_sel_hi:[1,0,1]
  v_pk_mul_f32 v[112:113], v[60:61], v[60:61] op_sel:[0,0] op_sel_hi:[1,1]
  v_pk_mul_f32 v[114:115], v[62:63], v[62:63] op_sel:[0,0] op_sel_hi:[1,1]
  v_pk_fma_f32 v[112:113], v[112:113], v[124:125], v[122:123] op_sel:[0,0,1] op_sel_hi:[1,0,1]
  v_pk_fma_f32 v[114:115], v[114:115], v[124:125], v[122:123] op_sel:[0,0,1] op_sel_hi:[1,0,1]
  v_pk_mul_f32 v[112:113], v[112:113], v[60:61] op_sel:[0,0] op_sel_hi:[1,1]
  v_pk_mul_f32 v[114:115], v[114:115], v[62:63] op_sel:[0,0] op_sel_hi:[1,1]
  v_exp_f32 v112, v112
  v_exp_f32 v113, v113
  v_exp_f32 v114, v114
  v_exp_f32 v115, v115
  v_pk_fma_f32 v[112:113], v[112:113], v[124:125], v[124:125] op_sel:[0,1,1] op_sel_hi:[1,1,1]
  v_pk_fma_f32 v[114:115], v[114:115], v[124:125], v[124:125] op_sel:[0,1,1] op_sel_hi:[1,1,1]
  v_rcp_f32 v112, v112
  v_rcp_f32 v113, v113
  v_rcp_f32 v114, v114
  v_rcp_f32 v115, v115
  v_pk_mul_f32 v[112:113], v[112:113], v[60:61] op_sel:[0,0] op_sel_hi:[1,1]
  v_pk_mul_f32 v[114:115], v[114:115], v[62:63] op_sel:[0,0] op_sel_hi:[1,1]
  v_cvt_pk_bf16_f32 v102, v112, v113
  v_cvt_pk_bf16_f32 v103, v114, v115
  buffer_store_dwordx4 v[96:99], v16, s[4:7], s65 offen
  buffer_store_dwordx4 v[100:103], v16, s[4:7], s65 offen offset:2048
  v_min_u32 v104, -2, v96
  v_min_u32 v105, -2, v97
  v_min_u32 v106, -2, v98
  v_min_u32 v107, -2, v99
  v_min_u32 v108, -2, v100
  v_min_u32 v109, -2, v101
  v_min_u32 v110, -2, v102
  v_min_u32 v111, -2, v103
  s_add_u32 s53, s72, 0
  buffer_store_dwordx4 v[104:107], v20, s[4:7], s53 offen sc1
  buffer_store_dwordx4 v[108:111], v20, s[4:7], s53 offen offset:32 sc1
  s_barrier
  ds_read_b64_tr_b16 v[128:129], v11 offset:8192
  ds_read_b64_tr_b16 v[130:131], v14 offset:8192
  ds_read_b64_tr_b16 v[132:133], v11 offset:10240
  ds_read_b64_tr_b16 v[134:135], v14 offset:10240
  ds_read_b64_tr_b16 v[136:137], v11 offset:12288
  ds_read_b64_tr_b16 v[138:139], v14 offset:12288
  ds_read_b64_tr_b16 v[140:141], v11 offset:14336
  ds_read_b64_tr_b16 v[142:143], v14 offset:14336
  ds_read_b64_tr_b16 v[144:145], v11 offset:16384
  ds_read_b64_tr_b16 v[146:147], v14 offset:16384
  ds_read_b64_tr_b16 v[148:149], v11 offset:18432
  ds_read_b64_tr_b16 v[150:151], v14 offset:18432
  ds_read_b64_tr_b16 v[152:153], v11 offset:57344
  ds_read_b64_tr_b16 v[154:155], v14 offset:57344
  ds_read_b64_tr_b16 v[156:157], v11 offset:59392
  ds_read_b64_tr_b16 v[158:159], v14 offset:59392
  ds_read_b64_tr_b16 v[160:161], v12 offset:16384
  ds_read_b64_tr_b16 v[162:163], v15 offset:16384
  ds_read_b64_tr_b16 v[164:165], v12 offset:18432
  ds_read_b64_tr_b16 v[166:167], v15 offset:18432
  ds_read_b64_tr_b16 v[168:169], v12 offset:20480
  ds_read_b64_tr_b16 v[170:171], v15 offset:20480
  ds_read_b64_tr_b16 v[172:173], v12 offset:22528
  ds_read_b64_tr_b16 v[174:175], v15 offset:22528
  ds_read_b64_tr_b16 v[176:177], v12 offset:24576
  ds_read_b64_tr_b16 v[178:179], v15 offset:24576
  ds_read_b64_tr_b16 v[180:181], v12 offset:26624
  ds_read_b64_tr_b16 v[182:183], v15 offset:26624
  ds_read_b64_tr_b16 v[184:185], v11 offset:4096
  ds_read_b64_tr_b16 v[186:187], v14 offset:4096
  ds_read_b64_tr_b16 v[188:189], v11 offset:6144
  ds_read_b64_tr_b16 v[190:191], v14 offset:6144
  ds_read_b64_tr_b16 v[192:193], v11 offset:20480
  ds_read_b64_tr_b16 v[194:195], v14 offset:20480
  ds_read_b64_tr_b16 v[196:197], v11 offset:22528
  ds_read_b64_tr_b16 v[198:199], v14 offset:22528
  ds_read_b64_tr_b16 v[200:201], v11 offset:24576
  ds_read_b64_tr_b16 v[202:203], v14 offset:24576
  ds_read_b64_tr_b16 v[204:205], v11 offset:26624
  ds_read_b64_tr_b16 v[206:207], v14 offset:26624
  s_waitcnt vmcnt(2)
  s_barrier
  s_mov_b32 exec_lo, 1
  s_mov_b32 exec_hi, 1
  ds_write_b128 v27, v[64:67] offset:768
  ds_write_b128 v27, v[68:71] offset:800
  ds_write_b128 v27, v[72:75] offset:832
  ds_write_b128 v27, v[76:79] offset:864
  s_mov_b64 exec, -1
  s_nop 0
  v_pk_fma_f32 v[64:65], v[32:33], v[126:127], v[126:127] op_sel:[0,0,1] op_sel_hi:[1,0,1]
  v_pk_fma_f32 v[66:67], v[34:35], v[126:127], v[126:127] op_sel:[0,0,1] op_sel_hi:[1,0,1]
  v_pk_fma_f32 v[68:69], v[36:37], v[126:127], v[126:127] op_sel:[0,0,1] op_sel_hi:[1,0,1]
  v_pk_fma_f32 v[70:71], v[38:39], v[126:127], v[126:127] op_sel:[0,0,1] op_sel_hi:[1,0,1]
  v_pk_fma_f32 v[72:73], v[40:41], v[126:127], v[126:127] op_sel:[0,0,1] op_sel_hi:[1,0,1]
  v_pk_fma_f32 v[74:75], v[42:43], v[126:127], v[126:127] op_sel:[0,0,1] op_sel_hi:[1,0,1]
  v_pk_fma_f32 v[76:77], v[44:45], v[126:127], v[126:127] op_sel:[0,0,1] op_sel_hi:[1,0,1]
  v_pk_fma_f32 v[78:79], v[46:47], v[126:127], v[126:127] op_sel:[0,0,1] op_sel_hi:[1,0,1]
  v_and_b32_e64 v29, 31, v1
  v_lshl_add_u32 v29, s61, 5, v29
  v_lshlrev_b32 v7, 4, v29
  v_lshrrev_b32 v30, 5, v1
  v_mul_u32_u24 v30, 1088, v30
  v_add_u32_e64 v7, v7, v30
  v_add_u32 v9, 0x20000, v7
  v_add_u32 v8, 0x10000, v7
  ds_read_b64_tr_b16 v[208:209], v11 offset:28672
  ds_read_b64_tr_b16 v[210:211], v14 offset:28672
  ds_read_b64_tr_b16 v[212:213], v11 offset:30720
  ds_read_b64_tr_b16 v[214:215], v14 offset:30720
  ds_read_b64_tr_b16 v[216:217], v11 offset:32768
  ds_read_b64_tr_b16 v[218:219], v14 offset:32768
  ds_read_b64_tr_b16 v[220:221], v11 offset:34816
  ds_read_b64_tr_b16 v[222:223], v14 offset:34816
  ds_read_b64_tr_b16 v[224:225], v11 offset:36864
  ds_read_b64_tr_b16 v[226:227], v14 offset:36864
  ds_read_b64_tr_b16 v[228:229], v11 offset:38912
  ds_read_b64_tr_b16 v[230:231], v14 offset:38912
  ds_read_b64_tr_b16 v[232:233], v11 offset:40960
  ds_read_b64_tr_b16 v[234:235], v14 offset:40960
  ds_read_b64_tr_b16 v[236:237], v11 offset:43008
  ds_read_b64_tr_b16 v[238:239], v14 offset:43008
  ds_read_b64_tr_b16 v[240:241], v11 offset:45056
  ds_read_b64_tr_b16 v[242:243], v14 offset:45056
  ds_read_b64_tr_b16 v[244:245], v11 offset:47104
  ds_read_b64_tr_b16 v[246:247], v14 offset:47104
  ds_read_b64_tr_b16 v[248:249], v11 offset:49152
  ds_read_b64_tr_b16 v[250:251], v14 offset:49152
  ds_read_b64_tr_b16 v[252:253], v11 offset:51200
  ds_read_b64_tr_b16 v[254:255], v14 offset:51200
  s_waitcnt lgkmcnt(0)
  s_barrier
  s_cmp_lg_u32 s61, 0
  s_cbranch_scc1 CV1_8
  s_barrier
  ds_read_b128 v[96:99], v7 offset:17456
  ds_read_b128 v[100:103], v7 offset:19632
  ds_read_b128 v[104:107], v7 offset:21808
  s_waitcnt lgkmcnt(2)
  v_mfma_f32_32x32x16_bf16 v[64:79], v[160:163], v[96:99], v[64:79]
  ds_read_b128 v[108:111], v7 offset:23984
  s_waitcnt lgkmcnt(2)
  v_mfma_f32_32x32x16_bf16 v[64:79], v[164:167], v[100:103], v[64:79]
  s_barrier
  ds_read_b128 v[96:99], v7 offset:26160
  s_waitcnt lgkmcnt(2)
  v_mfma_f32_32x32x16_bf16 v[64:79], v[168:171], v[104:107], v[64:79]
  ds_read_b128 v[100:103], v7 offset:28336
  s_waitcnt lgkmcnt(2)
  v_mfma_f32_32x32x16_bf16 v[64:79], v[172:175], v[108:111], v[64:79]
  ds_read_b128 v[104:107], v7 offset:30512
  s_waitcnt lgkmcnt(2)
  v_mfma_f32_32x32x16_bf16 v[64:79], v[176:179], v[96:99], v[64:79]
  ds_read_b128 v[108:111], v7 offset:32688
  s_waitcnt lgkmcnt(2)
  v_mfma_f32_32x32x16_bf16 v[64:79], v[180:183], v[100:103], v[64:79]
  s_barrier
  ds_read_b128 v[96:99], v7 offset:52288
  s_waitcnt lgkmcnt(2)
  v_mfma_f32_32x32x16_bf16 v[64:79], v[184:187], v[104:107], v[64:79]
  ds_read_b128 v[100:103], v7 offset:54464
  s_waitcnt lgkmcnt(2)
  v_mfma_f32_32x32x16_bf16 v[64:79], v[188:191], v[108:111], v[64:79]
  ds_read_b128 v[104:107], v7 offset:56640
  s_waitcnt lgkmcnt(2)
  v_mfma_f32_32x32x16_bf16 v[64:79], v[224:227], v[96:99], v[64:79]
  ds_read_b128 v[108:111], v7 offset:58816
  s_waitcnt lgkmcnt(2)
  v_mfma_f32_32x32x16_bf16 v[64:79], v[228:231], v[100:103], v[64:79]
  s_barrier
  ds_read_b128 v[96:99], v7 offset:60992
  s_waitcnt lgkmcnt(2)
  v_mfma_f32_32x32x16_bf16 v[64:79], v[232:235], v[104:107], v[64:79]
  ds_read_b128 v[100:103], v7 offset:63168
  s_waitcnt lgkmcnt(2)
  v_mfma_f32_32x32x16_bf16 v[64:79], v[236:239], v[108:111], v[64:79]
  ds_read_b128 v[104:107], v7 offset:65344
  s_waitcnt lgkmcnt(2)
  v_mfma_f32_32x32x16_bf16 v[64:79], v[240:243], v[96:99], v[64:79]
  ds_read_b128 v[108:111], v8 offset:1984
  s_waitcnt lgkmcnt(2)
  v_mfma_f32_32x32x16_bf16 v[64:79], v[244:247], v[100:103], v[64:79]
  s_barrier
  ds_read_b128 v[96:99], v7 offset:16
  s_waitcnt lgkmcnt(2)
  v_mfma_f32_32x32x16_bf16 v[64:79], v[248:251], v[104:107], v[64:79]
  ds_read_b128 v[100:103], v7 offset:2192
  s_waitcnt lgkmcnt(2)
  v_mfma_f32_32x32x16_bf16 v[64:79], v[252:255], v[108:111], v[64:79]
  ds_read_b128 v[104:107], v7 offset:4368
  s_waitcnt lgkmcnt(2)
  v_mfma_f32_32x32x16_bf16 v[64:79], v[128:131], v[96:99], v[64:79]
  ds_read_b128 v[108:111], v7 offset:6544
  s_waitcnt lgkmcnt(2)
  v_mfma_f32_32x32x16_bf16 v[64:79], v[132:135], v[100:103], v[64:79]
  ds_read_b128 v[96:99], v7 offset:8720
  s_waitcnt lgkmcnt(2)
  v_mfma_f32_32x32x16_bf16 v[64:79], v[136:139], v[104:107], v[64:79]
  ds_read_b128 v[100:103], v7 offset:10896
  s_waitcnt lgkmcnt(2)
  v_mfma_f32_32x32x16_bf16 v[64:79], v[140:143], v[108:111], v[64:79]
  ds_read_b128 v[104:107], v7 offset:13072
  s_waitcnt lgkmcnt(2)
  v_mfma_f32_32x32x16_bf16 v[64:79], v[144:147], v[96:99], v[64:79]
  ds_read_b128 v[108:111], v7 offset:15248
  s_waitcnt lgkmcnt(2)
  v_mfma_f32_32x32x16_bf16 v[64:79], v[148:151], v[100:103], v[64:79]
  s_barrier
  ds_read_b128 v[96:99], v7 offset:34816
  s_waitcnt lgkmcnt(2)
  v_mfma_f32_32x32x16_bf16 v[64:79], v[152:155], v[104:107], v[64:79]
  ds_read_b128 v[100:103], v7 offset:36992
  s_waitcnt lgkmcnt(2)
  v_mfma_f32_32x32x16_bf16 v[64:79], v[156:159], v[108:111], v[64:79]
  ds_read_b128 v[104:107], v7 offset:39168
  s_waitcnt lgkmcnt(2)
  v_mfma_f32_32x32x16_bf16 v[64:79], v[192:195], v[96:99], v[64:79]
  ds_read_b128 v[108:111], v7 offset:41344
  s_waitcnt lgkmcnt(2)
  v_mfma_f32_32x32x16_bf16 v[64:79], v[196:199], v[100:103], v[64:79]
  ds_read_b128 v[96:99], v7 offset:43520
  s_waitcnt lgkmcnt(2)
  v_mfma_f32_32x32x16_bf16 v[64:79], v[200:203], v[104:107], v[64:79]
  ds_read_b128 v[100:103], v7 offset:45696
  s_waitcnt lgkmcnt(2)
  v_mfma_f32_32x32x16_bf16 v[64:79], v[204:207], v[108:111], v[64:79]
  ds_read_b128 v[104:107], v7 offset:47872
  s_waitcnt lgkmcnt(2)
  v_mfma_f32_32x32x16_bf16 v[64:79], v[208:211], v[96:99], v[64:79]
  ds_read_b128 v[108:111], v7 offset:50048
  s_waitcnt lgkmcnt(2)
  v_mfma_f32_32x32x16_bf16 v[64:79], v[212:215], v[100:103], v[64:79]
  s_waitcnt lgkmcnt(1)
  v_mfma_f32_32x32x16_bf16 v[64:79], v[216:219], v[104:107], v[64:79]
  s_waitcnt lgkmcnt(0)
  v_mfma_f32_32x32x16_bf16 v[64:79], v[220:223], v[108:111], v[64:79]
  s_branch CVE_9
CV1_8:
PAD_5:
  s_cbranch_execz L_TRAMP
  s_nop 0
  s_barrier
  ds_read_b128 v[96:99], v7 offset:16
  ds_read_b128 v[100:103], v7 offset:2192
  ds_read_b128 v[104:107], v7 offset:4368
  s_waitcnt lgkmcnt(2)
  v_mfma_f32_32x32x16_bf16 v[64:79], v[128:131], v[96:99], v[64:79]
  ds_read_b128 v[108:111], v7 offset:6544
  s_waitcnt lgkmcnt(2)
  v_mfma_f32_32x32x16_bf16 v[64:79], v[132:135], v[100:103], v[64:79]
  s_barrier
  ds_read_b128 v[96:99], v7 offset:8720
  s_waitcnt lgkmcnt(2)
  v_mfma_f32_32x32x16_bf16 v[64:79], v[136:139], v[104:107], v[64:79]
  ds_read_b128 v[100:103], v7 offset:10896
  s_waitcnt lgkmcnt(2)
  v_mfma_f32_32x32x16_bf16 v[64:79], v[140:143], v[108:111], v[64:79]
  ds_read_b128 v[104:107], v7 offset:13072
  s_waitcnt lgkmcnt(2)
  v_mfma_f32_32x32x16_bf16 v[64:79], v[144:147], v[96:99], v[64:79]
  ds_read_b128 v[108:111], v7 offset:15248
  s_waitcnt lgkmcnt(2)
  v_mfma_f32_32x32x16_bf16 v[64:79], v[148:151], v[100:103], v[64:79]
  s_barrier
  ds_read_b128 v[96:99], v7 offset:34816
  s_waitcnt lgkmcnt(2)
  v_mfma_f32_32x32x16_bf16 v[64:79], v[152:155], v[104:107], v[64:79]
  ds_read_b128 v[100:103], v7 offset:36992
  s_waitcnt lgkmcnt(2)
  v_mfma_f32_32x32x16_bf16 v[64:79], v[156:159], v[108:111], v[64:79]
  ds_read_b128 v[104:107], v7 offset:39168
  s_waitcnt lgkmcnt(2)
  v_mfma_f32_32x32x16_bf16 v[64:79], v[192:195], v[96:99], v[64:79]
  ds_read_b128 v[108:111], v7 offset:41344
  s_waitcnt lgkmcnt(2)
  v_mfma_f32_32x32x16_bf16 v[64:79], v[196:199], v[100:103], v[64:79]
  s_barrier
  ds_read_b128 v[96:99], v7 offset:43520
  s_waitcnt lgkmcnt(2)
  v_mfma_f32_32x32x16_bf16 v[64:79], v[200:203], v[104:107], v[64:79]
  ds_read_b128 v[100:103], v7 offset:45696
  s_waitcnt lgkmcnt(2)
  v_mfma_f32_32x32x16_bf16 v[64:79], v[204:207], v[108:111], v[64:79]
  ds_read_b128 v[104:107], v7 offset:47872
  s_waitcnt lgkmcnt(2)
  v_mfma_f32_32x32x16_bf16 v[64:79], v[208:211], v[96:99], v[64:79]
  ds_read_b128 v[108:111], v7 offset:50048
  s_waitcnt lgkmcnt(2)
  v_mfma_f32_32x32x16_bf16 v[64:79], v[212:215], v[100:103], v[64:79]
  s_barrier
  ds_read_b128 v[96:99], v7 offset:17456
  s_waitcnt lgkmcnt(2)
  v_mfma_f32_32x32x16_bf16 v[64:79], v[216:219], v[104:107], v[64:79]
  ds_read_b128 v[100:103], v7 offset:19632
  s_waitcnt lgkmcnt(2)
  v_mfma_f32_32x32x16_bf16 v[64:79], v[220:223], v[108:111], v[64:79]
  ds_read_b128 v[104:107], v7 offset:21808
  s_waitcnt lgkmcnt(2)
  v_mfma_f32_32x32x16_bf16 v[64:79], v[160:163], v[96:99], v[64:79]
  ds_read_b128 v[108:111], v7 offset:23984
  s_waitcnt lgkmcnt(2)
  v_mfma_f32_32x32x16_bf16 v[64:79], v[164:167], v[100:103], v[64:79]
  ds_read_b128 v[96:99], v7 offset:26160
  s_waitcnt lgkmcnt(2)
  v_mfma_f32_32x32x16_bf16 v[64:79], v[168:171], v[104:107], v[64:79]
  ds_read_b128 v[100:103], v7 offset:28336
  s_waitcnt lgkmcnt(2)
  v_mfma_f32_32x32x16_bf16 v[64:79], v[172:175], v[108:111], v[64:79]
  ds_read_b128 v[104:107], v7 offset:30512
  s_waitcnt lgkmcnt(2)
  v_mfma_f32_32x32x16_bf16 v[64:79], v[176:179], v[96:99], v[64:79]
  ds_read_b128 v[108:111], v7 offset:32688
  s_waitcnt lgkmcnt(2)
  v_mfma_f32_32x32x16_bf16 v[64:79], v[180:183], v[100:103], v[64:79]
  s_barrier
  ds_read_b128 v[96:99], v7 offset:52288
  s_waitcnt lgkmcnt(2)
  v_mfma_f32_32x32x16_bf16 v[64:79], v[184:187], v[104:107], v[64:79]
  ds_read_b128 v[100:103], v7 offset:54464
  s_waitcnt lgkmcnt(2)
  v_mfma_f32_32x32x16_bf16 v[64:79], v[188:191], v[108:111], v[64:79]
  ds_read_b128 v[104:107], v7 offset:56640
  s_waitcnt lgkmcnt(2)
  v_mfma_f32_32x32x16_bf16 v[64:79], v[224:227], v[96:99], v[64:79]
  ds_read_b128 v[108:111], v7 offset:58816
  s_waitcnt lgkmcnt(2)
  v_mfma_f32_32x32x16_bf16 v[64:79], v[228:231], v[100:103], v[64:79]
  ds_read_b128 v[96:99], v7 offset:60992
  s_waitcnt lgkmcnt(2)
  v_mfma_f32_32x32x16_bf16 v[64:79], v[232:235], v[104:107], v[64:79]
  ds_read_b128 v[100:103], v7 offset:63168
  s_waitcnt lgkmcnt(2)
  v_mfma_f32_32x32x16_bf16 v[64:79], v[236:239], v[108:111], v[64:79]
  ds_read_b128 v[104:107], v7 offset:65344
  s_waitcnt lgkmcnt(2)
  v_mfma_f32_32x32x16_bf16 v[64:79], v[240:243], v[96:99], v[64:79]
  ds_read_b128 v[108:111], v8 offset:1984
  s_waitcnt lgkmcnt(2)
  v_mfma_f32_32x32x16_bf16 v[64:79], v[244:247], v[100:103], v[64:79]
  s_waitcnt lgkmcnt(1)
  v_mfma_f32_32x32x16_bf16 v[64:79], v[248:251], v[104:107], v[64:79]
  s_waitcnt lgkmcnt(0)
  v_mfma_f32_32x32x16_bf16 v[64:79], v[252:255], v[108:111], v[64:79]
CVE_9:
  s_nop 8
  s_nop 0
  s_nop 2
  v_cvt_pk_bf16_f32 v96, v64, v65
  v_cvt_pk_bf16_f32 v97, v66, v67
  v_cvt_pk_bf16_f32 v98, v68, v69
  v_cvt_pk_bf16_f32 v99, v70, v71
  v_cvt_pk_bf16_f32 v100, v72, v73
  v_cvt_pk_bf16_f32 v101, v74, v75
  v_cvt_pk_bf16_f32 v102, v76, v77
  v_cvt_pk_bf16_f32 v103, v78, v79
  buffer_store_dwordx4 v[96:99], v16, s[4:7], s66 offen
  buffer_store_dwordx4 v[100:103], v16, s[4:7], s66 offen offset:2048
  v_pk_add_f32 v[112:113], v[64:65], v[66:67]
  v_pk_add_f32 v[114:115], v[68:69], v[70:71]
  v_pk_add_f32 v[116:117], v[72:73], v[74:75]
  v_pk_add_f32 v[118:119], v[76:77], v[78:79]
  v_pk_mul_f32 v[120:121], v[64:65], v[64:65]
  v_pk_fma_f32 v[120:121], v[66:67], v[66:67], v[120:121]
  v_pk_fma_f32 v[120:121], v[68:69], v[68:69], v[120:121]
  v_pk_fma_f32 v[120:121], v[70:71], v[70:71], v[120:121]
  v_pk_fma_f32 v[120:121], v[72:73], v[72:73], v[120:121]
  v_pk_fma_f32 v[120:121], v[74:75], v[74:75], v[120:121]
  v_pk_fma_f32 v[120:121], v[76:77], v[76:77], v[120:121]
  v_pk_fma_f32 v[120:121], v[78:79], v[78:79], v[120:121]
  v_pk_add_f32 v[112:113], v[112:113], v[114:115]
  v_pk_add_f32 v[116:117], v[116:117], v[118:119]
  v_add_f32_e64 v120, v120, v121
  v_pk_add_f32 v[112:113], v[112:113], v[116:117]
  v_add_f32 v112, v112, v113
  s_nop 1
  v_permlane32_swap_b32 v112, v120
  v_add_f32 v112, v112, v120
  buffer_store_dword v112, v28, s[4:7], s81 offen
  s_barrier
  s_waitcnt vmcnt(0)
  s_barrier
  s_nop 0
  ds_write_b128 v16, v[96:99] offset:0
  ds_write_b128 v16, v[100:103] offset:2048
  v_pk_add_f32 v[32:33], v[32:33], v[64:65]
  v_pk_add_f32 v[34:35], v[34:35], v[66:67]
  v_pk_add_f32 v[36:37], v[36:37], v[68:69]
  v_pk_add_f32 v[38:39], v[38:39], v[70:71]
  v_pk_add_f32 v[40:41], v[40:41], v[72:73]
  v_pk_add_f32 v[42:43], v[42:43], v[74:75]
  v_pk_add_f32 v[44:45], v[44:45], v[76:77]
  v_pk_add_f32 v[46:47], v[46:47], v[78:79]
  v_and_b32_e64 v29, 31, v1
  v_lshl_add_u32 v29, s61, 5, v29
  v_lshlrev_b32 v7, 4, v29
  v_lshrrev_b32 v30, 5, v1
  v_mul_u32_u24 v30, 1024, v30
  v_add_u32_e64 v7, v7, v30
  v_add_u32 v9, 0x20000, v7
  v_add_u32 v8, 0x10000, v7
  s_waitcnt lgkmcnt(0)
  s_barrier
  s_lshl_b32 s53, s55, 1
  v_add_u32 v111, s53, v27
  v_lshrrev_b32_e64 v29, 5, v1
  v_bfe_u32 v30, v1, 2, 2
  v_lshl_add_u32 v104, v29, 2, v30
  v_lshlrev_b32_e64 v104, 6, v104
  v_bfe_u32 v29, v1, 4, 1
  v_lshl_add_u32 v104, v29, 5, v104
  v_and_b32_e64 v29, 3, v1
  v_lshl_add_u32 v104, v29, 3, v104
  v_add_u32 v104, 0x10000, v104
  v_lshrrev_b32_e64 v29, 5, v1
  v_bfe_u32 v30, v1, 2, 2
  v_lshl_add_u32 v105, v29, 2, v30
  v_add_u32 v105, 8, v105
  v_lshlrev_b32 v105, 6, v105
  v_bfe_u32 v29, v1, 4, 1
  v_lshl_add_u32 v105, v29, 5, v105
  v_and_b32_e64 v29, 3, v1
  v_lshl_add_u32 v105, v29, 3, v105
  v_add_u32 v105, 0x10000, v105
  s_barrier
  s_nop 0
  ds_read_b64_tr_b16 v[80:81], v11 offset:53248
  ds_read_b64_tr_b16 v[82:83], v14 offset:53248
  ds_read_b128 v[128:131], v7 offset:0
  ds_read_b64_tr_b16 v[84:85], v11 offset:55296
  ds_read_b64_tr_b16 v[86:87], v14 offset:55296
  ds_read_b128 v[132:135], v7 offset:2048
  ds_read_b64_tr_b16 v[88:89], v11 offset:61440
  ds_read_b64_tr_b16 v[90:91], v14 offset:61440
  ds_read_b128 v[136:139], v7 offset:4096
  s_waitcnt lgkmcnt(6)
  v_mfma_f32_32x32x16_bf16 v[48:63], v[80:83], v[128:131], 0
  ds_read_b64_tr_b16 v[92:93], v11 offset:63488
  ds_read_b64_tr_b16 v[94:95], v14 offset:63488
  ds_read_b128 v[140:143], v7 offset:6144
  s_waitcnt lgkmcnt(6)
PAD_6:
  s_cbranch_execz L_TRAMP
  s_nop 0
  v_mfma_f32_32x32x16_bf16 v[48:63], v[84:87], v[132:135], v[48:63]
  s_barrier
  ds_read_b64_tr_b16 v[80:81], v12 offset:0
  ds_read_b64_tr_b16 v[82:83], v15 offset:0
  ds_read_b128 v[144:147], v7 offset:8192
  s_waitcnt lgkmcnt(6)
  v_mfma_f32_32x32x16_bf16 v[48:63], v[88:91], v[136:139], v[48:63]
  ds_read_b64_tr_b16 v[84:85], v12 offset:2048
  ds_read_b64_tr_b16 v[86:87], v15 offset:2048
  ds_read_b128 v[148:151], v7 offset:10240
  s_waitcnt lgkmcnt(6)
  v_mfma_f32_32x32x16_bf16 v[48:63], v[92:95], v[140:143], v[48:63]
  ds_read_b64_tr_b16 v[88:89], v12 offset:4096
  ds_read_b64_tr_b16 v[90:91], v15 offset:4096
  ds_read_b128 v[152:155], v7 offset:12288
  s_waitcnt lgkmcnt(6)
  v_mfma_f32_32x32x16_bf16 v[48:63], v[80:83], v[144:147], v[48:63]
  ds_read_b64_tr_b16 v[92:93], v12 offset:6144
  ds_read_b64_tr_b16 v[94:95], v15 offset:6144
  ds_read_b128 v[156:159], v7 offset:14336
  s_waitcnt lgkmcnt(6)
  v_mfma_f32_32x32x16_bf16 v[48:63], v[84:87], v[148:151], v[48:63]
  s_barrier
  ds_read_b64_tr_b16 v[80:81], v11 offset:4096
  ds_read_b64_tr_b16 v[82:83], v14 offset:4096
  ds_read_b128 v[160:163], v7 offset:16384
  s_mul_i32 s69, s61, 86016
  s_add_u32 s69, s69, 65536
  v_add_u32 v29, s69, v28
  s_waitcnt lgkmcnt(6)
  v_mfma_f32_32x32x16_bf16 v[48:63], v[88:91], v[152:155], v[48:63]
  ds_read_b64_tr_b16 v[84:85], v11 offset:6144
  ds_read_b64_tr_b16 v[86:87], v14 offset:6144
  ds_read_b128 v[164:167], v7 offset:18432
  ds_read2st64_b32 v[64:65], v29 offset0:0 offset1:1
  ds_read2st64_b32 v[66:67], v29 offset0:2 offset1:3
  ds_read2st64_b32 v[68:69], v29 offset0:4 offset1:5
  ds_read2st64_b32 v[70:71], v29 offset0:6 offset1:7
  s_waitcnt lgkmcnt(10)
  v_mfma_f32_32x32x16_bf16 v[48:63], v[92:95], v[156:159], v[48:63]
  ds_read_b64_tr_b16 v[88:89], v11 offset:8192
  ds_read_b64_tr_b16 v[90:91], v14 offset:8192
  ds_read_b128 v[168:171], v7 offset:20480
  ds_read2st64_b32 v[72:73], v29 offset0:8 offset1:9
  ds_read2st64_b32 v[74:75], v29 offset0:10 offset1:11
  s_waitcnt lgkmcnt(12)
  v_mfma_f32_32x32x16_bf16 v[48:63], v[80:83], v[160:163], v[48:63]
  ds_read_b64_tr_b16 v[92:93], v11 offset:10240
  ds_read_b64_tr_b16 v[94:95], v14 offset:10240
  ds_read_b128 v[172:175], v7 offset:22528
  ds_read2st64_b32 v[76:77], v29 offset0:12 offset1:13
  s_waitcnt lgkmcnt(13)
  v_mfma_f32_32x32x16_bf16 v[48:63], v[84:87], v[164:167], v[48:63]
  s_barrier
  ds_read_b64_tr_b16 v[80:81], v11 offset:12288
  ds_read_b64_tr_b16 v[82:83], v14 offset:12288
  ds_read_b128 v[176:179], v7 offset:24576
  ds_read2st64_b32 v[78:79], v29 offset0:14 offset1:15
  s_waitcnt lgkmcnt(10)
  v_mfma_f32_32x32x16_bf16 v[48:63], v[88:91], v[168:171], v[48:63]
  ds_read_b64_tr_b16 v[84:85], v11 offset:14336
  ds_read_b64_tr_b16 v[86:87], v14 offset:14336
  ds_read_b128 v[180:183], v7 offset:26624
  s_waitcnt lgkmcnt(8)
  v_mfma_f32_32x32x16_bf16 v[48:63], v[92:95], v[172:175], v[48:63]
  ds_read_b64_tr_b16 v[88:89], v11 offset:16384
  ds_read_b64_tr_b16 v[90:91], v14 offset:16384
  ds_read_b128 v[184:187], v7 offset:28672
  s_waitcnt lgkmcnt(7)
  v_mfma_f32_32x32x16_bf16 v[48:63], v[80:83], v[176:179], v[48:63]
  ds_read_b64_tr_b16 v[92:93], v11 offset:18432
  ds_read_b64_tr_b16 v[94:95], v14 offset:18432
  ds_read_b128 v[188:191], v7 offset:30720
  v_add_f32 v64, v64, v65
  v_add_f32 v66, v66, v67
  s_waitcnt lgkmcnt(6)
  v_mfma_f32_32x32x16_bf16 v[48:63], v[84:87], v[180:183], v[48:63]
  s_barrier
  ds_read_b64_tr_b16 v[80:81], v11 offset:20480
  ds_read_b64_tr_b16 v[82:83], v14 offset:20480
  ds_read_b128 v[192:195], v7 offset:32768
  v_add_f32 v68, v68, v69
  s_waitcnt lgkmcnt(6)
  v_mfma_f32_32x32x16_bf16 v[48:63], v[88:91], v[184:187], v[48:63]
  ds_read_b64_tr_b16 v[84:85], v11 offset:22528
  ds_read_b64_tr_b16 v[86:87], v14 offset:22528
  ds_read_b128 v[196:199], v7 offset:34816
  v_add_f32 v70, v70, v71
  v_add_f32 v72, v72, v73
  s_waitcnt lgkmcnt(6)
  v_mfma_f32_32x32x16_bf16 v[48:63], v[92:95], v[188:191], v[48:63]
  ds_read_b64_tr_b16 v[88:89], v11 offset:24576
  ds_read_b64_tr_b16 v[90:91], v14 offset:24576
  ds_read_b128 v[200:203], v7 offset:36864
  v_add_f32 v74, v74, v75
  s_waitcnt lgkmcnt(6)
  v_mfma_f32_32x32x16_bf16 v[48:63], v[80:83], v[192:195], v[48:63]
  ds_read_b64_tr_b16 v[92:93], v11 offset:26624
  ds_read_b64_tr_b16 v[94:95], v14 offset:26624
  ds_read_b128 v[204:207], v7 offset:38912
  v_add_f32 v76, v76, v77
  v_add_f32 v78, v78, v79
  s_waitcnt lgkmcnt(6)
  v_mfma_f32_32x32x16_bf16 v[48:63], v[84:87], v[196:199], v[48:63]
  s_barrier
  ds_read_b64_tr_b16 v[80:81], v11 offset:28672
  ds_read_b64_tr_b16 v[82:83], v14 offset:28672
  ds_read_b128 v[208:211], v7 offset:40960
  v_add_f32 v64, v64, v66
  s_waitcnt lgkmcnt(6)
  v_mfma_f32_32x32x16_bf16 v[48:63], v[88:91], v[200:203], v[48:63]
  ds_read_b64_tr_b16 v[84:85], v11 offset:30720
  ds_read_b64_tr_b16 v[86:87], v14 offset:30720
  ds_read_b128 v[212:215], v7 offset:43008
  v_add_f32 v68, v68, v70
  v_add_f32 v72, v72, v74
  s_waitcnt lgkmcnt(6)
  v_mfma_f32_32x32x16_bf16 v[48:63], v[92:95], v[204:207], v[48:63]
  ds_read_b64_tr_b16 v[88:89], v11 offset:32768
  ds_read_b64_tr_b16 v[90:91], v14 offset:32768
  ds_read_b128 v[216:219], v7 offset:45056
  v_add_f32 v76, v76, v78
  s_waitcnt lgkmcnt(6)
  v_mfma_f32_32x32x16_bf16 v[48:63], v[80:83], v[208:211], v[48:63]
  ds_read_b64_tr_b16 v[92:93], v11 offset:34816
  ds_read_b64_tr_b16 v[94:95], v14 offset:34816
  ds_read_b128 v[220:223], v7 offset:47104
  v_add_f32 v64, v64, v68
  v_add_f32 v72, v72, v76
  s_waitcnt lgkmcnt(6)
  v_mfma_f32_32x32x16_bf16 v[48:63], v[84:87], v[212:215], v[48:63]
  s_barrier
  ds_read_b64_tr_b16 v[80:81], v11 offset:36864
  ds_read_b64_tr_b16 v[82:83], v14 offset:36864
  ds_read_b128 v[224:227], v7 offset:49152
  v_add_f32 v64, v64, v72
  s_waitcnt lgkmcnt(6)
  v_mfma_f32_32x32x16_bf16 v[48:63], v[88:91], v[216:219], v[48:63]
  ds_read_b64_tr_b16 v[84:85], v11 offset:38912
  ds_read_b64_tr_b16 v[86:87], v14 offset:38912
  ds_read_b128 v[228:231], v7 offset:51200
  v_mov_b32 v30, v64
  s_nop 1
  v_permlane32_swap_b32 v64, v30
  s_waitcnt lgkmcnt(6)
  v_mfma_f32_32x32x16_bf16 v[48:63], v[92:95], v[220:223], v[48:63]
  ds_read_b64_tr_b16 v[88:89], v11 offset:40960
  ds_read_b64_tr_b16 v[90:91], v14 offset:40960
  ds_read_b128 v[232:235], v7 offset:53248
  v_mul_f32 v122, 0xbb000000, v64
  s_waitcnt lgkmcnt(6)
  v_mfma_f32_32x32x16_bf16 v[48:63], v[80:83], v[224:227], v[48:63]
  ds_read_b64_tr_b16 v[92:93], v11 offset:43008
  ds_read_b64_tr_b16 v[94:95], v14 offset:43008
  ds_read_b128 v[236:239], v7 offset:55296
  v_mul_f32 v30, 0x3b000000, v30
  v_fma_f32 v30, -v122, v122, v30
  s_waitcnt lgkmcnt(6)
  v_mfma_f32_32x32x16_bf16 v[48:63], v[84:87], v[228:231], v[48:63]
  s_barrier
  ds_read_b64_tr_b16 v[80:81], v11 offset:45056
  ds_read_b64_tr_b16 v[82:83], v14 offset:45056
  ds_read_b128 v[240:243], v7 offset:57344
  v_max_f32 v30, 0, v30
  s_waitcnt lgkmcnt(6)
  v_mfma_f32_32x32x16_bf16 v[48:63], v[88:91], v[232:235], v[48:63]
  ds_read_b64_tr_b16 v[84:85], v11 offset:47104
  ds_read_b64_tr_b16 v[86:87], v14 offset:47104
  ds_read_b128 v[244:247], v7 offset:59392
  v_add_f32 v29, 0x3727c5ac, v30
  v_rsq_f32 v126, v29
  s_waitcnt lgkmcnt(6)
  v_mfma_f32_32x32x16_bf16 v[48:63], v[92:95], v[236:239], v[48:63]
  ds_read_b64_tr_b16 v[88:89], v11 offset:49152
  ds_read_b64_tr_b16 v[90:91], v14 offset:49152
  ds_read_b128 v[248:251], v7 offset:61440
  v_mul_f32 v127, v122, v126
  s_waitcnt lgkmcnt(6)
  v_mfma_f32_32x32x16_bf16 v[48:63], v[80:83], v[240:243], v[48:63]
  ds_read_b64_tr_b16 v[92:93], v11 offset:51200
  ds_read_b64_tr_b16 v[94:95], v14 offset:51200
  ds_read_b128 v[252:255], v7 offset:63488
  v_mov_b32 v29, v126
  v_rcp_f32 v125, v29
  s_waitcnt lgkmcnt(6)
  v_mfma_f32_32x32x16_bf16 v[48:63], v[84:87], v[244:247], v[48:63]
  v_mul_f32 v123, 0xc0135761, v29
  s_waitcnt lgkmcnt(3)
  v_mfma_f32_32x32x16_bf16 v[48:63], v[88:91], v[248:251], v[48:63]
  v_mul_f32 v30, v29, v29
  v_mul_f32 v30, v30, v29
  s_waitcnt lgkmcnt(0)
  v_mfma_f32_32x32x16_bf16 v[48:63], v[92:95], v[252:255], v[48:63]
  v_mul_f32 v124, 0xbdd2d3e8, v30
  s_barrier
  ds_read_b64_tr_b16 v[80:81], v11 offset:57344
  ds_read_b64_tr_b16 v[82:83], v14 offset:57344
  ds_read_b64_tr_b16 v[84:85], v11 offset:59392
  ds_read_b64_tr_b16 v[86:87], v14 offset:59392
  ds_read_b64_tr_b16 v[88:89], v12 offset:8192
  ds_read_b64_tr_b16 v[90:91], v15 offset:8192
  s_waitcnt lgkmcnt(4)
  v_mfma_f32_32x32x16_bf16 v[64:79], v[80:83], v[128:131], 0
  ds_read_b64_tr_b16 v[92:93], v12 offset:10240
  ds_read_b64_tr_b16 v[94:95], v15 offset:10240
  ds_read_b128 v[116:119], v111 offset:1024
  ds_read_b128 v[106:109], v111 offset:1056
  s_waitcnt lgkmcnt(1)
  v_fmac_f32 v48, v116, v122
  v_fmac_f32 v49, v117, v122
  v_fmac_f32 v50, v118, v122
  v_fmac_f32 v51, v119, v122
  v_mfma_f32_32x32x16_bf16 v[64:79], v[84:87], v[132:135], v[64:79]
  ds_read_b64_tr_b16 v[80:81], v12 offset:12288
  ds_read_b64_tr_b16 v[82:83], v15 offset:12288
  ds_read_b128 v[116:119], v111 offset:1088
  v_mul_f32 v112, v48, v48
  v_mul_f32 v113, v49, v49
  v_mul_f32 v114, v50, v50
  v_mul_f32 v115, v51, v51
  v_mfma_f32_32x32x16_bf16 v[64:79], v[88:91], v[136:139], v[64:79]
  ds_read_b64_tr_b16 v[84:85], v12 offset:14336
  ds_read_b64_tr_b16 v[86:87], v15 offset:14336
  v_fma_f32 v112, v112, v124, v123
  v_fma_f32 v113, v113, v124, v123
  v_fma_f32 v114, v114, v124, v123
  v_fma_f32 v115, v115, v124, v123
  v_mul_f32 v112, v112, v48
  v_mul_f32 v113, v113, v49
  v_mfma_f32_32x32x16_bf16 v[64:79], v[92:95], v[140:143], v[64:79]
  ds_read_b64_tr_b16 v[88:89], v12 offset:16384
  ds_read_b64_tr_b16 v[90:91], v15 offset:16384
  v_mul_f32 v114, v114, v50
  v_mul_f32 v115, v115, v51
  v_exp_f32 v112, v112
  v_exp_f32 v113, v113
  s_waitcnt lgkmcnt(5)
  v_mfma_f32_32x32x16_bf16 v[64:79], v[80:83], v[144:147], v[64:79]
  ds_read_b64_tr_b16 v[92:93], v12 offset:18432
  ds_read_b64_tr_b16 v[94:95], v15 offset:18432
  v_exp_f32 v114, v114
  v_exp_f32_e64 v115, v115
  v_fma_f32 v112, v112, v125, v125
  s_waitcnt lgkmcnt(4)
  v_mfma_f32_32x32x16_bf16 v[64:79], v[84:87], v[148:151], v[64:79]
  s_barrier
  ds_read_b64_tr_b16 v[80:81], v11 offset:4096
  ds_read_b64_tr_b16 v[82:83], v14 offset:4096
  v_fma_f32 v113, v113, v125, v125
  v_fma_f32 v114, v114, v125, v125
  v_fma_f32 v115, v115, v125, v125
  v_rcp_f32 v112, v112
  s_waitcnt lgkmcnt(4)
  v_mfma_f32_32x32x16_bf16 v[64:79], v[88:91], v[152:155], v[64:79]
  ds_read_b64_tr_b16 v[84:85], v11 offset:6144
  ds_read_b64_tr_b16 v[86:87], v14 offset:6144
  v_rcp_f32 v113, v113
  v_rcp_f32 v114, v114
  v_rcp_f32 v115, v115
  s_waitcnt lgkmcnt(4)
  v_mfma_f32_32x32x16_bf16 v[64:79], v[92:95], v[156:159], v[64:79]
  ds_read_b64_tr_b16 v[88:89], v11 offset:53248
  ds_read_b64_tr_b16 v[90:91], v14 offset:53248
  v_mul_f32 v112, v112, v48
  v_mul_f32 v113, v113, v49
  v_mul_f32 v114, v114, v50
  v_mul_f32 v115, v115, v51
  v_cvt_pk_bf16_f32 v96, v112, v113
  s_waitcnt lgkmcnt(4)
  v_mfma_f32_32x32x16_bf16 v[64:79], v[80:83], v[160:163], v[64:79]
  ds_read_b64_tr_b16 v[92:93], v11 offset:55296
  ds_read_b64_tr_b16 v[94:95], v14 offset:55296
  v_cvt_pk_bf16_f32 v97, v114, v115
  v_fmac_f32 v52, v106, v122
  v_fmac_f32 v53, v107, v122
  v_fmac_f32 v54, v108, v122
  v_fmac_f32 v55, v109, v122
  s_waitcnt lgkmcnt(4)
  v_mfma_f32_32x32x16_bf16 v[64:79], v[84:87], v[164:167], v[64:79]
  ds_read_b64_tr_b16 v[80:81], v11 offset:61440
  ds_read_b64_tr_b16 v[82:83], v14 offset:61440
  ds_read_b128 v[106:109], v111 offset:1120
  v_mul_f32 v112, v52, v52
  v_mul_f32 v113, v53, v53
  v_mul_f32 v114, v54, v54
  v_mul_f32 v115, v55, v55
  v_fma_f32 v112, v112, v124, v123
  s_waitcnt lgkmcnt(5)
  v_mfma_f32_32x32x16_bf16 v[64:79], v[88:91], v[168:171], v[64:79]
  ds_read_b64_tr_b16 v[84:85], v11 offset:63488
  ds_read_b64_tr_b16 v[86:87], v14 offset:63488
  v_fma_f32 v113, v113, v124, v123
  v_fma_f32 v114, v114, v124, v123
  v_fma_f32 v115, v115, v124, v123
  v_mul_f32 v112, v112, v52
  v_mul_f32 v113, v113, v53
  v_mul_f32 v114, v114, v54
  s_waitcnt lgkmcnt(5)
  v_mfma_f32_32x32x16_bf16 v[64:79], v[92:95], v[172:175], v[64:79]
  ds_read_b64_tr_b16 v[88:89], v12 offset:0
  ds_read_b64_tr_b16 v[90:91], v15 offset:0
  v_mul_f32 v115, v115, v55
  v_exp_f32 v112, v112
  v_exp_f32 v113, v113
  s_waitcnt lgkmcnt(5)
  v_mfma_f32_32x32x16_bf16 v[64:79], v[80:83], v[176:179], v[64:79]
  ds_read_b64_tr_b16 v[92:93], v12 offset:2048
  ds_read_b64_tr_b16 v[94:95], v15 offset:2048
  v_exp_f32 v114, v114
  v_exp_f32_e64 v115, v115
  v_fma_f32 v112, v112, v125, v125
  v_fma_f32 v113, v113, v125, v125
  s_waitcnt lgkmcnt(4)
  v_mfma_f32_32x32x16_bf16 v[64:79], v[84:87], v[180:183], v[64:79]
  s_barrier
  ds_read_b64_tr_b16 v[80:81], v10 offset:28672
  ds_read_b64_tr_b16 v[82:83], v13 offset:28672
  v_fma_f32 v114, v114, v125, v125
  v_fma_f32 v115, v115, v125, v125
  v_rcp_f32 v112, v112
  v_rcp_f32 v113, v113
  s_waitcnt lgkmcnt(4)
  v_mfma_f32_32x32x16_bf16 v[64:79], v[88:91], v[184:187], v[64:79]
  ds_read_b64_tr_b16 v[84:85], v10 offset:30720
  ds_read_b64_tr_b16 v[86:87], v13 offset:30720
  v_rcp_f32 v114, v114
  v_rcp_f32 v115, v115
  v_mul_f32 v112, v112, v52
  s_waitcnt lgkmcnt(4)
  v_mfma_f32_32x32x16_bf16 v[64:79], v[92:95], v[188:191], v[64:79]
  ds_read_b64_tr_b16 v[88:89], v10 offset:32768
  ds_read_b64_tr_b16 v[90:91], v13 offset:32768
  v_mul_f32 v113, v113, v53
  v_mul_f32 v114, v114, v54
  v_mul_f32 v115, v115, v55
  v_cvt_pk_bf16_f32 v98, v112, v113
  v_cvt_pk_bf16_f32 v99, v114, v115
  s_waitcnt lgkmcnt(4)
  v_mfma_f32_32x32x16_bf16 v[64:79], v[80:83], v[192:195], v[64:79]
  ds_read_b64_tr_b16 v[92:93], v10 offset:34816
  ds_read_b64_tr_b16 v[94:95], v13 offset:34816
  v_fmac_f32 v56, v116, v122
  v_fmac_f32 v57, v117, v122
  v_fmac_f32 v58, v118, v122
  v_fmac_f32 v59, v119, v122
  v_mul_f32 v112, v56, v56
  v_mul_f32 v113, v57, v57
  s_waitcnt lgkmcnt(4)
  v_mfma_f32_32x32x16_bf16 v[64:79], v[84:87], v[196:199], v[64:79]
  ds_read_b64_tr_b16 v[80:81], v10 offset:36864
  ds_read_b64_tr_b16 v[82:83], v13 offset:36864
  v_mul_f32 v114, v58, v58
  v_mul_f32 v115, v59, v59
  v_fma_f32 v112, v112, v124, v123
  v_fma_f32 v113, v113, v124, v123
  v_fma_f32 v114, v114, v124, v123
  s_waitcnt lgkmcnt(4)
  v_mfma_f32_32x32x16_bf16 v[64:79], v[88:91], v[200:203], v[64:79]
  ds_read_b64_tr_b16 v[84:85], v10 offset:38912
  ds_read_b64_tr_b16 v[86:87], v13 offset:38912
  v_fma_f32 v115, v115, v124, v123
  v_mul_f32 v112, v112, v56
  v_mul_f32 v113, v113, v57
  v_mul_f32 v114, v114, v58
  v_mul_f32 v115, v115, v59
  s_waitcnt lgkmcnt(4)
  v_mfma_f32_32x32x16_bf16 v[64:79], v[92:95], v[204:207], v[64:79]
  ds_read_b64_tr_b16 v[88:89], v10 offset:40960
  ds_read_b64_tr_b16 v[90:91], v13 offset:40960
  v_exp_f32 v112, v112
  v_exp_f32 v113, v113
  v_exp_f32 v114, v114
  s_waitcnt lgkmcnt(4)
  v_mfma_f32_32x32x16_bf16 v[64:79], v[80:83], v[208:211], v[64:79]
  ds_read_b64_tr_b16 v[92:93], v10 offset:43008
  ds_read_b64_tr_b16 v[94:95], v13 offset:43008
  v_exp_f32_e64 v115, v115
  v_fma_f32 v112, v112, v125, v125
  v_fma_f32 v113, v113, v125, v125
  v_fma_f32 v114, v114, v125, v125
  v_fma_f32 v115, v115, v125, v125
  s_waitcnt lgkmcnt(4)
  v_mfma_f32_32x32x16_bf16 v[64:79], v[84:87], v[212:215], v[64:79]
  s_barrier
  ds_read_b64_tr_b16 v[80:81], v10 offset:45056
  ds_read_b64_tr_b16 v[82:83], v13 offset:45056
  v_rcp_f32 v112, v112
  v_rcp_f32 v113, v113
  v_rcp_f32 v114, v114
  s_waitcnt lgkmcnt(4)
  v_mfma_f32_32x32x16_bf16 v[64:79], v[88:91], v[216:219], v[64:79]
  ds_read_b64_tr_b16 v[84:85], v10 offset:47104
  ds_read_b64_tr_b16 v[86:87], v13 offset:47104
  v_rcp_f32 v115, v115
  v_mul_f32 v112, v112, v56
  v_mul_f32 v113, v113, v57
  v_mul_f32 v114, v114, v58
  s_waitcnt lgkmcnt(4)
  v_mfma_f32_32x32x16_bf16 v[64:79], v[92:95], v[220:223], v[64:79]
  ds_read_b64_tr_b16 v[88:89], v10 offset:49152
  ds_read_b64_tr_b16 v[90:91], v13 offset:49152
  v_mul_f32 v115, v115, v59
  v_cvt_pk_bf16_f32 v100, v112, v113
  v_cvt_pk_bf16_f32 v101, v114, v115
  v_fmac_f32 v60, v106, v122
  v_fmac_f32 v61, v107, v122
  s_waitcnt lgkmcnt(4)
  v_mfma_f32_32x32x16_bf16 v[64:79], v[80:83], v[224:227], v[64:79]
  ds_read_b64_tr_b16 v[92:93], v10 offset:51200
  ds_read_b64_tr_b16 v[94:95], v13 offset:51200
  v_fmac_f32 v62, v108, v122
  v_fmac_f32 v63, v109, v122
  v_mul_f32 v112, v60, v60
  v_mul_f32 v113, v61, v61
  v_mul_f32 v114, v62, v62
  v_mul_f32 v115, v63, v63
  s_waitcnt lgkmcnt(4)
  v_mfma_f32_32x32x16_bf16 v[64:79], v[84:87], v[228:231], v[64:79]
  ds_read_b64_tr_b16 v[80:81], v11 offset:0
  ds_read_b64_tr_b16 v[82:83], v14 offset:0
  v_fma_f32 v112, v112, v124, v123
  v_fma_f32 v113, v113, v124, v123
  v_fma_f32 v114, v114, v124, v123
  v_fma_f32 v115, v115, v124, v123
  v_mul_f32 v112, v112, v60
  s_waitcnt lgkmcnt(4)
  v_mfma_f32_32x32x16_bf16 v[64:79], v[88:91], v[232:235], v[64:79]
  ds_read_b64_tr_b16 v[84:85], v11 offset:2048
  ds_read_b64_tr_b16 v[86:87], v14 offset:2048
  v_mul_f32 v113, v113, v61
  v_mul_f32 v114, v114, v62
  v_mul_f32 v115, v115, v63
  v_exp_f32 v112, v112
  s_waitcnt lgkmcnt(4)
  v_mfma_f32_32x32x16_bf16 v[64:79], v[92:95], v[236:239], v[64:79]
  ds_read_b64_tr_b16 v[88:89], v10 offset:53248
  ds_read_b64_tr_b16 v[90:91], v13 offset:53248
  v_exp_f32 v113, v113
  v_exp_f32 v114, v114
  v_exp_f32 v115, v115
  s_waitcnt lgkmcnt(4)
  v_mfma_f32_32x32x16_bf16 v[64:79], v[80:83], v[240:243], v[64:79]
  ds_read_b64_tr_b16 v[92:93], v10 offset:55296
  ds_read_b64_tr_b16 v[94:95], v13 offset:55296
  v_fma_f32 v112, v112, v125, v125
  v_fma_f32 v113, v113, v125, v125
  v_fma_f32 v114, v114, v125, v125
  v_fma_f32 v115, v115, v125, v125
  v_rcp_f32 v112, v112
  s_waitcnt lgkmcnt(4)
  v_mfma_f32_32x32x16_bf16 v[64:79], v[84:87], v[244:247], v[64:79]
  v_rcp_f32 v113, v113
  v_rcp_f32 v114, v114
  v_rcp_f32 v115, v115
  s_waitcnt lgkmcnt(2)
  v_mfma_f32_32x32x16_bf16 v[64:79], v[88:91], v[248:251], v[64:79]
  v_mul_f32 v112, v112, v60
  v_mul_f32 v113, v113, v61
  v_mul_f32 v114, v114, v62
  v_mul_f32_e64 v115, v115, v63
  v_cvt_pk_bf16_f32 v102, v112, v113
  s_waitcnt lgkmcnt(0)
  v_mfma_f32_32x32x16_bf16 v[64:79], v[92:95], v[252:255], v[64:79]
  v_cvt_pk_bf16_f32 v103, v114, v115
  s_add_u32 s70, s67, 0
  s_sub_u32 s54, s70, s83
  v_add_u32 v31, s54, v16
  buffer_store_dwordx4 v[96:99], v16, s[4:7], s70 offen sc1
  buffer_store_dwordx4 v[100:103], v16, s[4:7], s70 offen offset:2048 sc1
  ds_write_b128 v31, v[96:99] offset:0
  ds_write_b128 v31, v[100:103] offset:2048
  ds_read_b128 v[116:119], v111 offset:1280
  ds_read_b128 v[106:109], v111 offset:1312
  s_barrier
  s_nop 0
  ds_read_b64_tr_b16 v[80:81], v10 offset:57344
  ds_read_b64_tr_b16 v[82:83], v13 offset:57344
  ds_read_b64_tr_b16 v[84:85], v10 offset:59392
  ds_read_b64_tr_b16 v[86:87], v13 offset:59392
  ds_read_b64_tr_b16 v[88:89], v10 offset:61440
  ds_read_b64_tr_b16 v[90:91], v13 offset:61440
  s_waitcnt lgkmcnt(4)
  v_mfma_f32_32x32x16_bf16 v[48:63], v[80:83], v[128:131], 0
  ds_read_b64_tr_b16 v[92:93], v10 offset:63488
  ds_read_b64_tr_b16 v[94:95], v13 offset:63488
  v_fmac_f32 v64, v116, v122
  v_fmac_f32 v65, v117, v122
  v_fmac_f32 v66, v118, v122
  v_fmac_f32 v67, v119, v122
  s_waitcnt lgkmcnt(4)
  v_mfma_f32_32x32x16_bf16 v[48:63], v[84:87], v[132:135], v[48:63]
  ds_read_b64_tr_b16 v[80:81], v11 offset:8192
  ds_read_b64_tr_b16 v[82:83], v14 offset:8192
  ds_read_b128 v[116:119], v111 offset:1344
  v_mul_f32 v112, v64, v64
  v_mul_f32 v113, v65, v65
  v_mul_f32 v114, v66, v66
  v_mul_f32 v115, v67, v67
  v_fma_f32 v112, v112, v124, v123
  v_fma_f32 v113, v113, v124, v123
  s_waitcnt lgkmcnt(5)
  v_mfma_f32_32x32x16_bf16 v[48:63], v[88:91], v[136:139], v[48:63]
  ds_read_b64_tr_b16 v[84:85], v11 offset:10240
  ds_read_b64_tr_b16 v[86:87], v14 offset:10240
  v_fma_f32 v114, v114, v124, v123
  v_fma_f32 v115, v115, v124, v123
  v_mul_f32 v112, v112, v64
  v_mul_f32 v113, v113, v65
  v_mul_f32 v114, v114, v66
  s_waitcnt lgkmcnt(5)
  v_mfma_f32_32x32x16_bf16 v[48:63], v[92:95], v[140:143], v[48:63]
  ds_read_b64_tr_b16 v[88:89], v11 offset:12288
  ds_read_b64_tr_b16 v[90:91], v14 offset:12288
  v_mul_f32 v115, v115, v67
  v_exp_f32 v112, v112
  v_exp_f32 v113, v113
  s_waitcnt lgkmcnt(5)
  v_mfma_f32_32x32x16_bf16 v[48:63], v[80:83], v[144:147], v[48:63]
  ds_read_b64_tr_b16 v[92:93], v11 offset:14336
  ds_read_b64_tr_b16 v[94:95], v14 offset:14336
  v_exp_f32 v114, v114
  v_exp_f32_e64 v115, v115
  v_fma_f32 v112, v112, v125, v125
  v_fma_f32 v113, v113, v125, v125
  s_waitcnt lgkmcnt(4)
  v_mfma_f32_32x32x16_bf16 v[48:63], v[84:87], v[148:151], v[48:63]
  s_barrier
  ds_read_b64_tr_b16 v[80:81], v11 offset:16384
  ds_read_b64_tr_b16 v[82:83], v14 offset:16384
  v_fma_f32 v114, v114, v125, v125
  v_fma_f32 v115, v115, v125, v125
  v_rcp_f32 v112, v112
  v_rcp_f32 v113, v113
  s_waitcnt lgkmcnt(4)
  v_mfma_f32_32x32x16_bf16 v[48:63], v[88:91], v[152:155], v[48:63]
  ds_read_b64_tr_b16 v[84:85], v11 offset:18432
  ds_read_b64_tr_b16 v[86:87], v14 offset:18432
  v_rcp_f32 v114, v114
  v_rcp_f32 v115, v115
  v_mul_f32 v112, v112, v64
  s_waitcnt lgkmcnt(4)
  v_mfma_f32_32x32x16_bf16 v[48:63], v[92:95], v[156:159], v[48:63]
  ds_read_b64_tr_b16 v[88:89], v11 offset:20480
  ds_read_b64_tr_b16 v[90:91], v14 offset:20480
  v_mul_f32 v113, v113, v65
  v_mul_f32 v114, v114, v66
  v_mul_f32 v115, v115, v67
  v_cvt_pk_bf16_f32 v96, v112, v113
  v_cvt_pk_bf16_f32 v97, v114, v115
  v_fmac_f32 v68, v106, v122
  s_waitcnt lgkmcnt(4)
  v_mfma_f32_32x32x16_bf16 v[48:63], v[80:83], v[160:163], v[48:63]
  ds_read_b64_tr_b16 v[92:93], v11 offset:22528
  ds_read_b64_tr_b16 v[94:95], v14 offset:22528
  v_fmac_f32 v69, v107, v122
  v_fmac_f32 v70, v108, v122
  v_fmac_f32 v71, v109, v122
  s_waitcnt lgkmcnt(4)
  v_mfma_f32_32x32x16_bf16 v[48:63], v[84:87], v[164:167], v[48:63]
  ds_read_b64_tr_b16 v[80:81], v11 offset:24576
  ds_read_b64_tr_b16 v[82:83], v14 offset:24576
  ds_read_b128 v[106:109], v111 offset:1376
  v_mul_f32 v112, v68, v68
  v_mul_f32 v113, v69, v69
  v_mul_f32 v114, v70, v70
  v_mul_f32 v115, v71, v71
  v_fma_f32 v112, v112, v124, v123
  v_fma_f32 v113, v113, v124, v123
  s_waitcnt lgkmcnt(5)
  v_mfma_f32_32x32x16_bf16 v[48:63], v[88:91], v[168:171], v[48:63]
  ds_read_b64_tr_b16 v[84:85], v11 offset:26624
  ds_read_b64_tr_b16 v[86:87], v14 offset:26624
  v_fma_f32 v114, v114, v124, v123
  v_fma_f32 v115, v115, v124, v123
  v_mul_f32 v112, v112, v68
  v_mul_f32 v113, v113, v69
  v_mul_f32 v114, v114, v70
  v_mul_f32 v115, v115, v71
  s_waitcnt lgkmcnt(5)
  v_mfma_f32_32x32x16_bf16 v[48:63], v[92:95], v[172:175], v[48:63]
  ds_read_b64_tr_b16 v[88:89], v11 offset:28672
  ds_read_b64_tr_b16 v[90:91], v14 offset:28672
  v_exp_f32 v112, v112
  v_exp_f32 v113, v113
  v_exp_f32 v114, v114
  s_waitcnt lgkmcnt(5)
  v_mfma_f32_32x32x16_bf16 v[48:63], v[80:83], v[176:179], v[48:63]
  ds_read_b64_tr_b16 v[92:93], v11 offset:30720
  ds_read_b64_tr_b16 v[94:95], v14 offset:30720
  v_exp_f32_e64 v115, v115
  v_fma_f32 v112, v112, v125, v125
  v_fma_f32 v113, v113, v125, v125
  v_fma_f32 v114, v114, v125, v125
  s_waitcnt lgkmcnt(4)
  v_mfma_f32_32x32x16_bf16 v[48:63], v[84:87], v[180:183], v[48:63]
  s_barrier
  s_mul_i32 s53, s61, 4096
  s_add_u32 s53, s53, 40960
  ds_read_b64_tr_b16 v[80:81], v11 offset:32768
  ds_read_b64_tr_b16 v[82:83], v14 offset:32768
  v_fma_f32 v115, v115, v125, v125
  v_rcp_f32 v112, v112
  v_rcp_f32 v113, v113
  s_waitcnt lgkmcnt(4)
  v_mfma_f32_32x32x16_bf16 v[48:63], v[88:91], v[184:187], v[48:63]
  ds_read_b64_tr_b16 v[84:85], v11 offset:34816
  ds_read_b64_tr_b16 v[86:87], v14 offset:34816
  v_rcp_f32 v114, v114
  v_rcp_f32 v115, v115
  v_mul_f32 v112, v112, v68
  v_mul_f32 v113, v113, v69
  s_waitcnt lgkmcnt(4)
  v_mfma_f32_32x32x16_bf16 v[48:63], v[92:95], v[188:191], v[48:63]
  ds_read_b64_tr_b16 v[88:89], v11 offset:36864
  ds_read_b64_tr_b16 v[90:91], v14 offset:36864
  v_mul_f32 v114, v114, v70
  v_mul_f32 v115, v115, v71
  v_cvt_pk_bf16_f32 v98, v112, v113
  v_cvt_pk_bf16_f32 v99, v114, v115
  v_fmac_f32 v72, v116, v122
  s_waitcnt lgkmcnt(4)
  v_mfma_f32_32x32x16_bf16 v[48:63], v[80:83], v[192:195], v[48:63]
  ds_read_b64_tr_b16 v[92:93], v11 offset:38912
  ds_read_b64_tr_b16 v[94:95], v14 offset:38912
  v_fmac_f32 v73, v117, v122
  v_fmac_f32 v74, v118, v122
  v_fmac_f32 v75, v119, v122
  v_mul_f32 v112, v72, v72
  v_mul_f32 v113, v73, v73
  s_waitcnt lgkmcnt(4)
  v_mfma_f32_32x32x16_bf16 v[48:63], v[84:87], v[196:199], v[48:63]
  ds_read_b64_tr_b16 v[80:81], v11 offset:40960
  ds_read_b64_tr_b16 v[82:83], v14 offset:40960
  v_mul_f32 v114, v74, v74
  v_mul_f32 v115, v75, v75
  v_fma_f32 v112, v112, v124, v123
  v_fma_f32 v113, v113, v124, v123
  v_fma_f32 v114, v114, v124, v123
  v_fma_f32 v115, v115, v124, v123
  s_waitcnt lgkmcnt(4)
  v_mfma_f32_32x32x16_bf16 v[48:63], v[88:91], v[200:203], v[48:63]
  ds_read_b64_tr_b16 v[84:85], v11 offset:43008
  ds_read_b64_tr_b16 v[86:87], v14 offset:43008
  v_mul_f32 v112, v112, v72
  v_mul_f32 v113, v113, v73
  v_mul_f32 v114, v114, v74
  v_mul_f32 v115, v115, v75
  v_exp_f32 v112, v112
PAD_7:
  s_cbranch_execz L_TRAMP
  s_nop 0
  s_waitcnt lgkmcnt(4)
  v_mfma_f32_32x32x16_bf16 v[48:63], v[92:95], v[204:207], v[48:63]
  ds_read_b64_tr_b16 v[88:89], v11 offset:4096
  ds_read_b64_tr_b16 v[90:91], v14 offset:4096
  v_exp_f32 v113, v113
  v_exp_f32 v114, v114
  s_waitcnt lgkmcnt(4)
  v_mfma_f32_32x32x16_bf16 v[48:63], v[80:83], v[208:211], v[48:63]
  ds_read_b64_tr_b16 v[92:93], v11 offset:6144
  ds_read_b64_tr_b16 v[94:95], v14 offset:6144
  v_exp_f32_e64 v115, v115
  v_fma_f32 v112, v112, v125, v125
  v_fma_f32 v113, v113, v125, v125
  v_fma_f32 v114, v114, v125, v125
  v_fma_f32 v115, v115, v125, v125
  v_lshlrev_b32 v110, 4, v1
  v_add_u32 v110, s53, v110
  s_waitcnt lgkmcnt(4)
  v_mfma_f32_32x32x16_bf16 v[48:63], v[84:87], v[212:215], v[48:63]
  s_barrier
  ds_read_b64_tr_b16 v[80:81], v11 offset:45056
  ds_read_b64_tr_b16 v[82:83], v14 offset:45056
  v_rcp_f32 v112, v112
  v_rcp_f32 v113, v113
  v_rcp_f32 v114, v114
  s_waitcnt lgkmcnt(4)
  v_mfma_f32_32x32x16_bf16 v[48:63], v[88:91], v[216:219], v[48:63]
  ds_read_b64_tr_b16 v[84:85], v11 offset:47104
  ds_read_b64_tr_b16 v[86:87], v14 offset:47104
  v_rcp_f32 v115, v115
  v_mul_f32 v112, v112, v72
  v_mul_f32 v113, v113, v73
  v_mul_f32 v114, v114, v74
  s_waitcnt lgkmcnt(4)
  v_mfma_f32_32x32x16_bf16 v[48:63], v[92:95], v[220:223], v[48:63]
  ds_read_b64_tr_b16 v[88:89], v11 offset:49152
  ds_read_b64_tr_b16 v[90:91], v14 offset:49152
  v_mul_f32 v115, v115, v75
  v_cvt_pk_bf16_f32 v100, v112, v113
  v_cvt_pk_bf16_f32 v101, v114, v115
  v_fmac_f32 v76, v106, v122
  v_fmac_f32 v77, v107, v122
  v_fmac_f32 v78, v108, v122
  s_waitcnt lgkmcnt(4)
  v_mfma_f32_32x32x16_bf16 v[48:63], v[80:83], v[224:227], v[48:63]
  ds_read_b64_tr_b16 v[92:93], v11 offset:51200
  ds_read_b64_tr_b16 v[94:95], v14 offset:51200
  v_fmac_f32 v79, v109, v122
  v_mul_f32 v112, v76, v76
  v_mul_f32 v113, v77, v77
  v_mul_f32 v114, v78, v78
  v_mul_f32 v115, v79, v79
  s_waitcnt lgkmcnt(4)
  v_mfma_f32_32x32x16_bf16 v[48:63], v[84:87], v[228:231], v[48:63]
  ds_read_b64_tr_b16 v[80:81], v11 offset:53248
  ds_read_b64_tr_b16 v[82:83], v14 offset:53248
  v_fma_f32 v112, v112, v124, v123
  v_fma_f32 v113, v113, v124, v123
  v_fma_f32 v114, v114, v124, v123
  v_fma_f32 v115, v115, v124, v123
  v_mul_f32 v112, v112, v76
  s_waitcnt lgkmcnt(4)
  v_mfma_f32_32x32x16_bf16 v[48:63], v[88:91], v[232:235], v[48:63]
  ds_read_b64_tr_b16 v[84:85], v11 offset:55296
  ds_read_b64_tr_b16 v[86:87], v14 offset:55296
  v_mul_f32 v113, v113, v77
  v_mul_f32 v114, v114, v78
  v_mul_f32 v115, v115, v79
  v_exp_f32 v112, v112
  s_waitcnt lgkmcnt(4)
  v_mfma_f32_32x32x16_bf16 v[48:63], v[92:95], v[236:239], v[48:63]
  ds_read_b64_tr_b16 v[88:89], v10 offset:28672
  ds_read_b64_tr_b16 v[90:91], v13 offset:28672
  v_exp_f32 v113, v113
  v_exp_f32 v114, v114
  v_exp_f32 v115, v115
  s_waitcnt lgkmcnt(4)
  v_mfma_f32_32x32x16_bf16 v[48:63], v[80:83], v[240:243], v[48:63]
  ds_read_b64_tr_b16 v[92:93], v10 offset:30720
  ds_read_b64_tr_b16 v[94:95], v13 offset:30720
  v_fma_f32 v112, v112, v125, v125
  v_fma_f32 v113, v113, v125, v125
  v_fma_f32 v114, v114, v125, v125
  v_fma_f32 v115, v115, v125, v125
  v_rcp_f32 v112, v112
  s_waitcnt lgkmcnt(4)
  v_mfma_f32_32x32x16_bf16 v[48:63], v[84:87], v[244:247], v[48:63]
  v_rcp_f32 v113, v113
  v_rcp_f32 v114, v114
  v_rcp_f32 v115, v115
  s_waitcnt lgkmcnt(2)
  v_mfma_f32_32x32x16_bf16 v[48:63], v[88:91], v[248:251], v[48:63]
  v_mul_f32 v112, v112, v76
  v_mul_f32 v113, v113, v77
  v_mul_f32 v114, v114, v78
  v_mul_f32_e64 v115, v115, v79
  v_cvt_pk_bf16_f32 v102, v112, v113
  s_waitcnt lgkmcnt(0)
  v_mfma_f32_32x32x16_bf16 v[48:63], v[92:95], v[252:255], v[48:63]
  v_cvt_pk_bf16_f32 v103, v114, v115
  s_add_u32 s70, s67, 8192
  s_sub_u32 s54, s70, s83
  v_add_u32_e64 v31, s54, v16
  buffer_store_dwordx4 v[96:99], v16, s[4:7], s70 offen sc1
  buffer_store_dwordx4 v[100:103], v16, s[4:7], s70 offen offset:2048 sc1
  ds_write_b128 v31, v[96:99] offset:0
  ds_write_b128 v31, v[100:103] offset:2048
  ds_read_b128 v[116:119], v111 offset:1536
  ds_read_b128 v[106:109], v111 offset:1568
  s_barrier
  s_cmp_lg_u32 s64, 0
  s_nop 0
  s_cbranch_scc1 CV1_10
  ds_read_b64_tr_b16 v[80:81], v104 offset:57344
  ds_read_b64_tr_b16 v[82:83], v105 offset:57344
  ds_read_b64_tr_b16 v[84:85], v104 offset:58368
  ds_read_b64_tr_b16 v[86:87], v105 offset:58368
  ds_read_b64_tr_b16 v[88:89], v104 offset:59392
  ds_read_b64_tr_b16 v[90:91], v105 offset:59392
  s_waitcnt lgkmcnt(4)
  v_mfma_f32_32x32x16_bf16 v[64:79], v[80:83], v[128:131], 0
  ds_read_b64_tr_b16 v[92:93], v104 offset:60416
  ds_read_b64_tr_b16 v[94:95], v105 offset:60416
  v_fmac_f32 v48, v116, v122
  v_fmac_f32 v49, v117, v122
  v_fmac_f32 v50, v118, v122
  v_fmac_f32 v51, v119, v122
  s_waitcnt lgkmcnt(4)
  v_mfma_f32_32x32x16_bf16 v[64:79], v[84:87], v[132:135], v[64:79]
  ds_read_b64_tr_b16 v[80:81], v104 offset:61440
  ds_read_b64_tr_b16 v[82:83], v105 offset:61440
  ds_read_b128 v[116:119], v111 offset:1600
  v_mul_f32 v112, v48, v48
  v_mul_f32 v113, v49, v49
  v_mul_f32 v114, v50, v50
  v_mul_f32 v115, v51, v51
  v_fma_f32 v112, v112, v124, v123
  v_fma_f32 v113, v113, v124, v123
  v_fma_f32 v114, v114, v124, v123
  v_fma_f32 v115, v115, v124, v123
  v_mul_f32 v112, v112, v48
  v_mul_f32 v113, v113, v49
  v_mul_f32 v114, v114, v50
  v_mul_f32 v115, v115, v51
  v_exp_f32 v112, v112
  v_exp_f32 v113, v113
  s_waitcnt lgkmcnt(5)
  v_mfma_f32_32x32x16_bf16 v[64:79], v[88:91], v[136:139], v[64:79]
  ds_read_b64_tr_b16 v[84:85], v104 offset:62464
  ds_read_b64_tr_b16 v[86:87], v105 offset:62464
  v_exp_f32 v114, v114
  v_exp_f32_e64 v115, v115
  v_fma_f32 v112, v112, v125, v125
  v_fma_f32 v113, v113, v125, v125
  v_fma_f32 v114, v114, v125, v125
  v_fma_f32 v115, v115, v125, v125
  v_rcp_f32 v112, v112
  v_rcp_f32 v113, v113
  s_waitcnt lgkmcnt(5)
  v_mfma_f32_32x32x16_bf16 v[64:79], v[92:95], v[140:143], v[64:79]
  ds_read_b64_tr_b16 v[88:89], v104 offset:63488
  ds_read_b64_tr_b16 v[90:91], v105 offset:63488
  v_rcp_f32 v114, v114
  v_rcp_f32 v115, v115
  v_mul_f32 v112, v112, v48
  v_mul_f32 v113, v113, v49
  v_mul_f32 v114, v114, v50
  v_mul_f32_e64 v115, v115, v51
  v_cvt_pk_bf16_f32 v96, v112, v113
  v_cvt_pk_bf16_f32 v97, v114, v115
  v_fmac_f32 v52, v106, v122
  s_waitcnt lgkmcnt(5)
  v_mfma_f32_32x32x16_bf16 v[64:79], v[80:83], v[144:147], v[64:79]
  ds_read_b64_tr_b16 v[92:93], v104 offset:64512
  ds_read_b64_tr_b16 v[94:95], v105 offset:64512
  v_fmac_f32 v53, v107, v122
  v_fmac_f32 v54, v108, v122
  v_fmac_f32 v55, v109, v122
  s_waitcnt lgkmcnt(4)
  v_mfma_f32_32x32x16_bf16 v[64:79], v[84:87], v[148:151], v[64:79]
  ds_read_b64_tr_b16 v[80:81], v104 offset:0
  ds_read_b64_tr_b16 v[82:83], v105 offset:0
  ds_read_b128 v[106:109], v111 offset:1632
  v_mul_f32 v112, v52, v52
  v_mul_f32 v113, v53, v53
  v_mul_f32 v114, v54, v54
  v_mul_f32 v115, v55, v55
  v_fma_f32 v112, v112, v124, v123
  v_fma_f32 v113, v113, v124, v123
  v_fma_f32 v114, v114, v124, v123
  v_fma_f32 v115, v115, v124, v123
  v_mul_f32 v112, v112, v52
  v_mul_f32 v113, v113, v53
  v_mul_f32 v114, v114, v54
  v_mul_f32 v115, v115, v55
  v_exp_f32 v112, v112
  v_exp_f32 v113, v113
  v_exp_f32 v114, v114
  s_waitcnt lgkmcnt(5)
  v_mfma_f32_32x32x16_bf16 v[64:79], v[88:91], v[152:155], v[64:79]
  ds_read_b64_tr_b16 v[84:85], v104 offset:1024
  ds_read_b64_tr_b16 v[86:87], v105 offset:1024
  v_exp_f32_e64 v115, v115
  v_fma_f32 v112, v112, v125, v125
  v_fma_f32 v113, v113, v125, v125
  v_fma_f32 v114, v114, v125, v125
  v_fma_f32 v115, v115, v125, v125
  v_rcp_f32 v112, v112
  v_rcp_f32 v113, v113
  s_waitcnt lgkmcnt(5)
  v_mfma_f32_32x32x16_bf16 v[64:79], v[92:95], v[156:159], v[64:79]
  ds_read_b64_tr_b16 v[88:89], v104 offset:2048
  ds_read_b64_tr_b16 v[90:91], v105 offset:2048
  v_rcp_f32 v114, v114
  v_rcp_f32 v115, v115
  v_mul_f32 v112, v112, v52
  v_mul_f32 v113, v113, v53
  v_mul_f32 v114, v114, v54
  v_mul_f32_e64 v115, v115, v55
  v_cvt_pk_bf16_f32 v98, v112, v113
  v_cvt_pk_bf16_f32 v99, v114, v115
  v_fmac_f32 v56, v116, v122
  s_waitcnt lgkmcnt(5)
  v_mfma_f32_32x32x16_bf16 v[64:79], v[80:83], v[160:163], v[64:79]
  ds_read_b64_tr_b16 v[92:93], v104 offset:3072
  ds_read_b64_tr_b16 v[94:95], v105 offset:3072
  v_fmac_f32 v57, v117, v122
  v_fmac_f32 v58, v118, v122
  v_fmac_f32 v59, v119, v122
  v_mul_f32 v112, v56, v56
  v_mul_f32 v113, v57, v57
  v_mul_f32 v114, v58, v58
  v_mul_f32_e64 v115, v59, v59
  v_fma_f32 v112, v112, v124, v123
  v_fma_f32 v113, v113, v124, v123
  v_fma_f32 v114, v114, v124, v123
  v_fma_f32 v115, v115, v124, v123
  s_waitcnt lgkmcnt(4)
  v_mfma_f32_32x32x16_bf16 v[64:79], v[84:87], v[164:167], v[64:79]
  ds_read_b64_tr_b16 v[80:81], v104 offset:8192
  ds_read_b64_tr_b16 v[82:83], v105 offset:8192
  v_mul_f32 v112, v112, v56
  v_mul_f32 v113, v113, v57
  v_mul_f32 v114, v114, v58
  v_mul_f32 v115, v115, v59
  v_exp_f32 v112, v112
  v_exp_f32 v113, v113
  v_exp_f32 v114, v114
  s_waitcnt lgkmcnt(4)
  v_mfma_f32_32x32x16_bf16 v[64:79], v[88:91], v[168:171], v[64:79]
  ds_read_b64_tr_b16 v[84:85], v104 offset:9216
  ds_read_b64_tr_b16 v[86:87], v105 offset:9216
  v_exp_f32 v115, v115
  v_fma_f32 v112, v112, v125, v125
  v_fma_f32 v113, v113, v125, v125
  v_fma_f32 v114, v114, v125, v125
  v_fma_f32 v115, v115, v125, v125
  v_rcp_f32 v112, v112
  v_rcp_f32 v113, v113
  v_rcp_f32 v114, v114
  s_waitcnt lgkmcnt(4)
  v_mfma_f32_32x32x16_bf16 v[64:79], v[92:95], v[172:175], v[64:79]
  ds_read_b64_tr_b16 v[88:89], v104 offset:10240
  ds_read_b64_tr_b16 v[90:91], v105 offset:10240
  v_rcp_f32 v115, v115
  v_mul_f32 v112, v112, v56
  v_mul_f32 v113, v113, v57
  v_mul_f32 v114, v114, v58
  v_mul_f32_e64 v115, v115, v59
  v_cvt_pk_bf16_f32 v100, v112, v113
  v_cvt_pk_bf16_f32 v101, v114, v115
  v_fmac_f32 v60, v106, v122
  v_fmac_f32 v61, v107, v122
  v_fmac_f32 v62, v108, v122
  s_waitcnt lgkmcnt(4)
  v_mfma_f32_32x32x16_bf16 v[64:79], v[80:83], v[176:179], v[64:79]
  ds_read_b64_tr_b16 v[92:93], v104 offset:11264
  ds_read_b64_tr_b16 v[94:95], v105 offset:11264
  v_fmac_f32 v63, v109, v122
  v_mul_f32 v112, v60, v60
  v_mul_f32 v113, v61, v61
  v_mul_f32 v114, v62, v62
  v_mul_f32_e64 v115, v63, v63
  v_fma_f32 v112, v112, v124, v123
  v_fma_f32 v113, v113, v124, v123
  v_fma_f32 v114, v114, v124, v123
  v_fma_f32 v115, v115, v124, v123
  v_mul_f32 v112, v112, v60
  s_waitcnt lgkmcnt(4)
  v_mfma_f32_32x32x16_bf16 v[64:79], v[84:87], v[180:183], v[64:79]
  v_mul_f32 v113, v113, v61
  v_mul_f32 v114, v114, v62
  v_mul_f32 v115, v115, v63
  v_exp_f32 v112, v112
  v_exp_f32 v113, v113
  v_exp_f32 v114, v114
  v_exp_f32 v115, v115
  s_waitcnt lgkmcnt(2)
  v_mfma_f32_32x32x16_bf16 v[64:79], v[88:91], v[184:187], v[64:79]
  v_fma_f32 v112, v112, v125, v125
  v_fma_f32 v113, v113, v125, v125
  v_fma_f32 v114, v114, v125, v125
  v_fma_f32 v115, v115, v125, v125
  v_rcp_f32 v112, v112
  v_rcp_f32 v113, v113
  v_rcp_f32 v114, v114
  v_rcp_f32 v115, v115
  s_waitcnt lgkmcnt(0)
  v_mfma_f32_32x32x16_bf16 v[64:79], v[92:95], v[188:191], v[64:79]
  v_mul_f32 v112, v112, v60
  v_mul_f32 v113, v113, v61
  v_mul_f32 v114, v114, v62
  v_mul_f32_e64 v115, v115, v63
  v_cvt_pk_bf16_f32 v102, v112, v113
  v_cvt_pk_bf16_f32 v103, v114, v115
  s_add_u32 s70, s67, 16384
  s_sub_u32 s54, s70, s83
  v_add_u32 v31, s54, v16
  buffer_store_dwordx4 v[96:99], v16, s[4:7], s70 offen sc1
  buffer_store_dwordx4 v[100:103], v16, s[4:7], s70 offen offset:2048 sc1
  ds_write_b128 v31, v[96:99] offset:0
  ds_write_b128 v31, v[100:103] offset:2048
  ds_write_b128 v110, v[72:75] offset:0
  ds_write_b128 v110, v[76:79] offset:1024
  v_xor_b32 v110, 2048, v110
  s_lshl_b32 s53, s56, 1
  s_sub_u32 s53, s53, 0
  v_add_u32 v111, s53, v27
  s_sub_u32 s70, s68, 0
  s_waitcnt lgkmcnt(0)
  s_branch CVE_11
CV1_10:
PAD_8:
  s_cbranch_execz L_TRAMP
  s_nop 0
  ds_read_b64_tr_b16 v[80:81], v104 offset:12288
  ds_read_b64_tr_b16 v[82:83], v105 offset:12288
  ds_read_b64_tr_b16 v[84:85], v104 offset:13312
  ds_read_b64_tr_b16 v[86:87], v105 offset:13312
  ds_read_b64_tr_b16 v[88:89], v104 offset:14336
  ds_read_b64_tr_b16 v[90:91], v105 offset:14336
  s_waitcnt lgkmcnt(4)
  v_mfma_f32_32x32x16_bf16 v[64:79], v[80:83], v[192:195], 0
  ds_read_b64_tr_b16 v[92:93], v104 offset:15360
  ds_read_b64_tr_b16 v[94:95], v105 offset:15360
  v_fmac_f32 v48, v116, v122
  v_fmac_f32 v49, v117, v122
  v_fmac_f32 v50, v118, v122
  v_fmac_f32 v51, v119, v122
  s_waitcnt lgkmcnt(4)
  v_mfma_f32_32x32x16_bf16 v[64:79], v[84:87], v[196:199], v[64:79]
  ds_read_b64_tr_b16 v[80:81], v104 offset:16384
  ds_read_b64_tr_b16 v[82:83], v105 offset:16384
  ds_read_b128 v[116:119], v111 offset:1600
  v_mul_f32 v112, v48, v48
  v_mul_f32 v113, v49, v49
  v_mul_f32 v114, v50, v50
  v_mul_f32 v115, v51, v51
  v_fma_f32 v112, v112, v124, v123
  v_fma_f32 v113, v113, v124, v123
  v_fma_f32 v114, v114, v124, v123
  v_fma_f32 v115, v115, v124, v123
  v_mul_f32 v112, v112, v48
  v_mul_f32 v113, v113, v49
  v_mul_f32 v114, v114, v50
  v_mul_f32 v115, v115, v51
  v_exp_f32 v112, v112
  v_exp_f32 v113, v113
  s_waitcnt lgkmcnt(5)
  v_mfma_f32_32x32x16_bf16 v[64:79], v[88:91], v[200:203], v[64:79]
  ds_read_b64_tr_b16 v[84:85], v104 offset:17408
  ds_read_b64_tr_b16 v[86:87], v105 offset:17408
  v_exp_f32 v114, v114
  v_exp_f32_e64 v115, v115
  v_fma_f32 v112, v112, v125, v125
  v_fma_f32 v113, v113, v125, v125
  v_fma_f32 v114, v114, v125, v125
  v_fma_f32 v115, v115, v125, v125
  v_rcp_f32 v112, v112
  v_rcp_f32 v113, v113
  s_waitcnt lgkmcnt(5)
  v_mfma_f32_32x32x16_bf16 v[64:79], v[92:95], v[204:207], v[64:79]
  ds_read_b64_tr_b16 v[88:89], v104 offset:18432
  ds_read_b64_tr_b16 v[90:91], v105 offset:18432
  v_rcp_f32 v114, v114
  v_rcp_f32 v115, v115
  v_mul_f32 v112, v112, v48
  v_mul_f32 v113, v113, v49
  v_mul_f32 v114, v114, v50
  v_mul_f32_e64 v115, v115, v51
  v_cvt_pk_bf16_f32 v96, v112, v113
  v_cvt_pk_bf16_f32 v97, v114, v115
  v_fmac_f32 v52, v106, v122
  s_waitcnt lgkmcnt(5)
  v_mfma_f32_32x32x16_bf16 v[64:79], v[80:83], v[208:211], v[64:79]
  ds_read_b64_tr_b16 v[92:93], v104 offset:19456
  ds_read_b64_tr_b16 v[94:95], v105 offset:19456
  v_fmac_f32 v53, v107, v122
  v_fmac_f32 v54, v108, v122
  v_fmac_f32 v55, v109, v122
  s_waitcnt lgkmcnt(4)
  v_mfma_f32_32x32x16_bf16 v[64:79], v[84:87], v[212:215], v[64:79]
  ds_read_b64_tr_b16 v[80:81], v104 offset:20480
  ds_read_b64_tr_b16 v[82:83], v105 offset:20480
  ds_read_b128 v[106:109], v111 offset:1632
  v_mul_f32 v112, v52, v52
  v_mul_f32 v113, v53, v53
  v_mul_f32 v114, v54, v54
  v_mul_f32 v115, v55, v55
  v_fma_f32 v112, v112, v124, v123
  v_fma_f32 v113, v113, v124, v123
  v_fma_f32 v114, v114, v124, v123
  v_fma_f32 v115, v115, v124, v123
  v_mul_f32 v112, v112, v52
  v_mul_f32 v113, v113, v53
  v_mul_f32 v114, v114, v54
  v_mul_f32 v115, v115, v55
  v_exp_f32 v112, v112
  v_exp_f32 v113, v113
  v_exp_f32 v114, v114
  s_waitcnt lgkmcnt(5)
  v_mfma_f32_32x32x16_bf16 v[64:79], v[88:91], v[216:219], v[64:79]
  ds_read_b64_tr_b16 v[84:85], v104 offset:21504
  ds_read_b64_tr_b16 v[86:87], v105 offset:21504
  v_exp_f32_e64 v115, v115
  v_fma_f32 v112, v112, v125, v125
  v_fma_f32 v113, v113, v125, v125
  v_fma_f32 v114, v114, v125, v125
  v_fma_f32 v115, v115, v125, v125
  v_rcp_f32 v112, v112
  v_rcp_f32 v113, v113
  s_waitcnt lgkmcnt(5)
  v_mfma_f32_32x32x16_bf16 v[64:79], v[92:95], v[220:223], v[64:79]
  ds_read_b64_tr_b16 v[88:89], v104 offset:22528
  ds_read_b64_tr_b16 v[90:91], v105 offset:22528
  v_rcp_f32 v114, v114
  v_rcp_f32 v115, v115
  v_mul_f32 v112, v112, v52
  v_mul_f32 v113, v113, v53
  v_mul_f32 v114, v114, v54
  v_mul_f32_e64 v115, v115, v55
  v_cvt_pk_bf16_f32 v98, v112, v113
  v_cvt_pk_bf16_f32 v99, v114, v115
  v_fmac_f32 v56, v116, v122
  s_waitcnt lgkmcnt(5)
  v_mfma_f32_32x32x16_bf16 v[64:79], v[80:83], v[224:227], v[64:79]
  ds_read_b64_tr_b16 v[92:93], v104 offset:23552
  ds_read_b64_tr_b16 v[94:95], v105 offset:23552
  v_fmac_f32 v57, v117, v122
  v_fmac_f32 v58, v118, v122
  v_fmac_f32 v59, v119, v122
  v_mul_f32 v112, v56, v56
  v_mul_f32 v113, v57, v57
  v_mul_f32 v114, v58, v58
  v_mul_f32_e64 v115, v59, v59
  v_fma_f32 v112, v112, v124, v123
  v_fma_f32 v113, v113, v124, v123
  v_fma_f32 v114, v114, v124, v123
  v_fma_f32 v115, v115, v124, v123
  s_waitcnt lgkmcnt(4)
  v_mfma_f32_32x32x16_bf16 v[64:79], v[84:87], v[228:231], v[64:79]
  ds_read_b64_tr_b16 v[80:81], v104 offset:24576
  ds_read_b64_tr_b16 v[82:83], v105 offset:24576
  v_mul_f32 v112, v112, v56
  v_mul_f32 v113, v113, v57
  v_mul_f32 v114, v114, v58
  v_mul_f32 v115, v115, v59
  v_exp_f32 v112, v112
  v_exp_f32 v113, v113
  v_exp_f32 v114, v114
  s_waitcnt lgkmcnt(4)
  v_mfma_f32_32x32x16_bf16 v[64:79], v[88:91], v[232:235], v[64:79]
  ds_read_b64_tr_b16 v[84:85], v104 offset:25600
  ds_read_b64_tr_b16 v[86:87], v105 offset:25600
  v_exp_f32 v115, v115
  v_fma_f32 v112, v112, v125, v125
  v_fma_f32 v113, v113, v125, v125
  v_fma_f32 v114, v114, v125, v125
  v_fma_f32 v115, v115, v125, v125
  v_rcp_f32 v112, v112
  v_rcp_f32 v113, v113
  v_rcp_f32 v114, v114
  s_waitcnt lgkmcnt(4)
  v_mfma_f32_32x32x16_bf16 v[64:79], v[92:95], v[236:239], v[64:79]
  ds_read_b64_tr_b16 v[88:89], v104 offset:26624
  ds_read_b64_tr_b16 v[90:91], v105 offset:26624
  v_rcp_f32 v115, v115
  v_mul_f32 v112, v112, v56
  v_mul_f32 v113, v113, v57
  v_mul_f32 v114, v114, v58
  v_mul_f32_e64 v115, v115, v59
  v_cvt_pk_bf16_f32 v100, v112, v113
  v_cvt_pk_bf16_f32 v101, v114, v115
  v_fmac_f32 v60, v106, v122
  v_fmac_f32 v61, v107, v122
  v_fmac_f32 v62, v108, v122
  s_waitcnt lgkmcnt(4)
  v_mfma_f32_32x32x16_bf16 v[64:79], v[80:83], v[240:243], v[64:79]
  ds_read_b64_tr_b16 v[92:93], v104 offset:27648
  ds_read_b64_tr_b16 v[94:95], v105 offset:27648
  v_fmac_f32 v63, v109, v122
  v_mul_f32 v112, v60, v60
  v_mul_f32 v113, v61, v61
  v_mul_f32 v114, v62, v62
  v_mul_f32_e64 v115, v63, v63
  v_fma_f32 v112, v112, v124, v123
  v_fma_f32 v113, v113, v124, v123
  v_fma_f32 v114, v114, v124, v123
  v_fma_f32 v115, v115, v124, v123
  v_mul_f32 v112, v112, v60
  s_waitcnt lgkmcnt(4)
  v_mfma_f32_32x32x16_bf16 v[64:79], v[84:87], v[244:247], v[64:79]
  v_mul_f32 v113, v113, v61
  v_mul_f32 v114, v114, v62
  v_mul_f32 v115, v115, v63
  v_exp_f32 v112, v112
  v_exp_f32 v113, v113
  v_exp_f32 v114, v114
  v_exp_f32 v115, v115
  s_waitcnt lgkmcnt(2)
  v_mfma_f32_32x32x16_bf16 v[64:79], v[88:91], v[248:251], v[64:79]
  v_fma_f32 v112, v112, v125, v125
  v_fma_f32 v113, v113, v125, v125
  v_fma_f32 v114, v114, v125, v125
  v_fma_f32 v115, v115, v125, v125
  v_rcp_f32 v112, v112
  v_rcp_f32 v113, v113
  v_rcp_f32 v114, v114
  v_rcp_f32 v115, v115
  s_waitcnt lgkmcnt(0)
  v_mfma_f32_32x32x16_bf16 v[64:79], v[92:95], v[252:255], v[64:79]
  v_mul_f32 v112, v112, v60
  v_mul_f32 v113, v113, v61
  v_mul_f32 v114, v114, v62
  v_mul_f32_e64 v115, v115, v63
  v_cvt_pk_bf16_f32 v102, v112, v113
  v_cvt_pk_bf16_f32 v103, v114, v115
  s_add_u32 s70, s67, 16384
  s_sub_u32 s54, s70, s83
  v_add_u32 v31, s54, v16
  buffer_store_dwordx4 v[96:99], v16, s[4:7], s70 offen sc1
  buffer_store_dwordx4 v[100:103], v16, s[4:7], s70 offen offset:2048 sc1
  ds_write_b128 v31, v[96:99] offset:0
  ds_write_b128 v31, v[100:103] offset:2048
  ds_write_b128 v110, v[64:67] offset:2048
  ds_write_b128 v110, v[68:71] offset:3072
  v_mov_b32 v64, v72
  v_mov_b32 v65, v73
  v_mov_b32 v66, v74
  v_mov_b32 v67, v75
  v_mov_b32 v68, v76
  v_mov_b32 v69, v77
  v_mov_b32 v70, v78
  v_mov_b32 v71, v79
  v_xor_b32 v110, 0, v110
  s_lshl_b32 s53, s56, 1
  s_sub_u32 s53, s53, 64
  v_add_u32 v111, s53, v27
  s_sub_u32 s70, s68, 2048
  s_waitcnt lgkmcnt(0)
CVE_11:
  s_barrier
  ds_read_b128 v[72:75], v110
  ds_read_b128 v[76:79], v110 offset:1024
  ds_read_b128 v[116:119], v111 offset:1024
  ds_read_b128 v[106:109], v111 offset:1056
  s_waitcnt lgkmcnt(3)
  v_pk_add_f32 v[64:65], v[64:65], v[72:73]
  v_pk_add_f32 v[66:67], v[66:67], v[74:75]
  s_waitcnt lgkmcnt(2)
  v_pk_add_f32 v[68:69], v[68:69], v[76:77]
  v_pk_add_f32 v[70:71], v[70:71], v[78:79]
  s_waitcnt lgkmcnt(1)
  s_nop 0
  v_pk_fma_f32 v[64:65], v[116:117], v[122:123], v[64:65] op_sel:[0,0,0] op_sel_hi:[1,0,1]
  v_pk_fma_f32 v[66:67], v[118:119], v[122:123], v[66:67] op_sel:[0,0,0] op_sel_hi:[1,0,1]
  v_pk_mul_f32 v[112:113], v[64:65], v[64:65] op_sel:[0,0] op_sel_hi:[1,1]
  v_pk_mul_f32 v[114:115], v[66:67], v[66:67] op_sel:[0,0] op_sel_hi:[1,1]
  v_pk_fma_f32 v[112:113], v[112:113], v[124:125], v[122:123] op_sel:[0,0,1] op_sel_hi:[1,0,1]
  v_pk_fma_f32 v[114:115], v[114:115], v[124:125], v[122:123] op_sel:[0,0,1] op_sel_hi:[1,0,1]
  v_pk_mul_f32 v[112:113], v[112:113], v[64:65] op_sel:[0,0] op_sel_hi:[1,1]
  v_pk_mul_f32 v[114:115], v[114:115], v[66:67] op_sel:[0,0] op_sel_hi:[1,1]
  v_exp_f32 v112, v112
  v_exp_f32 v113, v113
  v_exp_f32 v114, v114
  v_exp_f32 v115, v115
  v_pk_fma_f32 v[112:113], v[112:113], v[124:125], v[124:125] op_sel:[0,1,1] op_sel_hi:[1,1,1]
  v_pk_fma_f32 v[114:115], v[114:115], v[124:125], v[124:125] op_sel:[0,1,1] op_sel_hi:[1,1,1]
  v_rcp_f32 v112, v112
  v_rcp_f32 v113, v113
  v_rcp_f32 v114, v114
  v_rcp_f32 v115, v115
  v_pk_mul_f32 v[112:113], v[112:113], v[64:65] op_sel:[0,0] op_sel_hi:[1,1]
  v_pk_mul_f32 v[114:115], v[114:115], v[66:67] op_sel:[0,0] op_sel_hi:[1,1]
  v_cvt_pk_bf16_f32 v96, v112, v113
  v_cvt_pk_bf16_f32 v97, v114, v115
  s_waitcnt lgkmcnt(0)
  s_nop 0
  v_pk_fma_f32 v[68:69], v[106:107], v[122:123], v[68:69] op_sel:[0,0,0] op_sel_hi:[1,0,1]
  v_pk_fma_f32 v[70:71], v[108:109], v[122:123], v[70:71] op_sel:[0,0,0] op_sel_hi:[1,0,1]
  v_pk_mul_f32 v[112:113], v[68:69], v[68:69] op_sel:[0,0] op_sel_hi:[1,1]
  v_pk_mul_f32 v[114:115], v[70:71], v[70:71] op_sel:[0,0] op_sel_hi:[1,1]
  v_pk_fma_f32 v[112:113], v[112:113], v[124:125], v[122:123] op_sel:[0,0,1] op_sel_hi:[1,0,1]
  v_pk_fma_f32 v[114:115], v[114:115], v[124:125], v[122:123] op_sel:[0,0,1] op_sel_hi:[1,0,1]
  v_pk_mul_f32 v[112:113], v[112:113], v[68:69] op_sel:[0,0] op_sel_hi:[1,1]
  v_pk_mul_f32 v[114:115], v[114:115], v[70:71] op_sel:[0,0] op_sel_hi:[1,1]
  v_exp_f32 v112, v112
  v_exp_f32 v113, v113
  v_exp_f32 v114, v114
  v_exp_f32 v115, v115
  v_pk_fma_f32 v[112:113], v[112:113], v[124:125], v[124:125] op_sel:[0,1,1] op_sel_hi:[1,1,1]
  v_pk_fma_f32 v[114:115], v[114:115], v[124:125], v[124:125] op_sel:[0,1,1] op_sel_hi:[1,1,1]
  v_rcp_f32 v112, v112
  v_rcp_f32 v113, v113
  v_rcp_f32 v114, v114
  v_rcp_f32 v115, v115
  v_pk_mul_f32 v[112:113], v[112:113], v[68:69] op_sel:[0,0] op_sel_hi:[1,1]
  v_pk_mul_f32 v[114:115], v[114:115], v[70:71] op_sel:[0,0] op_sel_hi:[1,1]
  v_cvt_pk_bf16_f32 v98, v112, v113
  v_cvt_pk_bf16_f32 v99, v114, v115
  buffer_store_dwordx4 v[96:99], v16, s[4:7], s70 offen sc1
  s_barrier
  s_nop 0
  ds_read_b64_tr_b16 v[128:129], v10 offset:32768
  ds_read_b64_tr_b16 v[130:131], v13 offset:32768
  ds_read_b64_tr_b16 v[132:133], v10 offset:34816
  ds_read_b64_tr_b16 v[134:135], v13 offset:34816
  ds_read_b64_tr_b16 v[136:137], v10 offset:36864
  ds_read_b64_tr_b16 v[138:139], v13 offset:36864
  ds_read_b64_tr_b16 v[140:141], v10 offset:38912
  ds_read_b64_tr_b16 v[142:143], v13 offset:38912
  ds_read_b64_tr_b16 v[144:145], v10 offset:49152
  ds_read_b64_tr_b16 v[146:147], v13 offset:49152
  ds_read_b64_tr_b16 v[148:149], v10 offset:51200
  ds_read_b64_tr_b16 v[150:151], v13 offset:51200
  ds_read_b64_tr_b16 v[152:153], v10 offset:53248
  ds_read_b64_tr_b16 v[154:155], v13 offset:53248
  ds_read_b64_tr_b16 v[156:157], v10 offset:55296
  ds_read_b64_tr_b16 v[158:159], v13 offset:55296
  ds_read_b64_tr_b16 v[160:161], v10 offset:57344
  ds_read_b64_tr_b16 v[162:163], v13 offset:57344
  ds_read_b64_tr_b16 v[164:165], v10 offset:59392
  ds_read_b64_tr_b16 v[166:167], v13 offset:59392
  ds_read_b64_tr_b16 v[168:169], v10 offset:61440
  ds_read_b64_tr_b16 v[170:171], v13 offset:61440
  ds_read_b64_tr_b16 v[172:173], v10 offset:63488
  ds_read_b64_tr_b16 v[174:175], v13 offset:63488
  ds_read_b64_tr_b16 v[176:177], v11 offset:28672
  ds_read_b64_tr_b16 v[178:179], v14 offset:28672
  ds_read_b64_tr_b16 v[180:181], v11 offset:30720
  ds_read_b64_tr_b16 v[182:183], v14 offset:30720
  ds_read_b64_tr_b16 v[184:185], v11 offset:32768
  ds_read_b64_tr_b16 v[186:187], v14 offset:32768
  ds_read_b64_tr_b16 v[188:189], v11 offset:34816
  ds_read_b64_tr_b16 v[190:191], v14 offset:34816
  ds_read_b64_tr_b16 v[192:193], v11 offset:36864
  ds_read_b64_tr_b16 v[194:195], v14 offset:36864
  ds_read_b64_tr_b16 v[196:197], v11 offset:38912
  ds_read_b64_tr_b16 v[198:199], v14 offset:38912
  ds_read_b64_tr_b16 v[200:201], v11 offset:40960
  ds_read_b64_tr_b16 v[202:203], v14 offset:40960
  ds_read_b64_tr_b16 v[204:205], v11 offset:43008
  ds_read_b64_tr_b16 v[206:207], v14 offset:43008
  s_waitcnt vmcnt(0)
  s_barrier
  s_sub_u32 s54, s70, s83
  v_add_u32 v31, s54, v16
  ds_write_b128 v31, v[96:99] offset:0
  ds_read_b64_tr_b16 v[208:209], v10 offset:28672
  ds_read_b64_tr_b16 v[210:211], v13 offset:28672
  ds_read_b64_tr_b16 v[212:213], v10 offset:30720
  ds_read_b64_tr_b16 v[214:215], v13 offset:30720
PAD_9:
  s_cbranch_execz L_TRAMP
  s_nop 0
  ds_read_b64_tr_b16 v[216:217], v11 offset:4096
  ds_read_b64_tr_b16 v[218:219], v14 offset:4096
  ds_read_b64_tr_b16 v[220:221], v11 offset:6144
  ds_read_b64_tr_b16 v[222:223], v14 offset:6144
  ds_read_b64_tr_b16 v[224:225], v11 offset:45056
  ds_read_b64_tr_b16 v[226:227], v14 offset:45056
  ds_read_b64_tr_b16 v[228:229], v11 offset:47104
  ds_read_b64_tr_b16 v[230:231], v14 offset:47104
  ds_read_b64_tr_b16 v[232:233], v11 offset:49152
  ds_read_b64_tr_b16 v[234:235], v14 offset:49152
  ds_read_b64_tr_b16 v[236:237], v11 offset:51200
  ds_read_b64_tr_b16 v[238:239], v14 offset:51200
  ds_read_b64_tr_b16 v[240:241], v11 offset:53248
  ds_read_b64_tr_b16 v[242:243], v14 offset:53248
  ds_read_b64_tr_b16 v[244:245], v11 offset:55296
  ds_read_b64_tr_b16 v[246:247], v14 offset:55296
  ds_read_b64_tr_b16 v[248:249], v12 offset:0
  ds_read_b64_tr_b16 v[250:251], v15 offset:0
  ds_read_b64_tr_b16 v[252:253], v12 offset:2048
  ds_read_b64_tr_b16 v[254:255], v15 offset:2048
  s_waitcnt lgkmcnt(0)
  s_barrier
  v_and_b32_e64 v29, 31, v1
  v_lshl_add_u32 v29, s61, 5, v29
  v_lshrrev_b32 v30, 5, v1
  v_subrev_u32 v31, 48, v29
  v_cmp_gt_u32 s[62:63], 16, v31
  v_lshlrev_b32_e64 v31, 4, v31
  v_lshl_add_u32 v31, v30, 8, v31
  s_lshl_b32 s53, s45, 1
  s_add_u32 s53, s53, s64
  s_lshl_b32 s53, s53, 10
  s_add_u32 s54, s46, 1
  s_mul_i32 s54, s54, 18432
  s_add_u32 s53, s53, s54
  s_add_u32 s53, s53, 262144
  s_cmp_eq_u32 s46, 31
  s_cselect_b32 s53, 2130706432, s53
  v_add_u32_e64 v31, s53, v31
  v_mov_b32 v48, 2130706432
  v_cndmask_b32 v48, v48, v31, s[62:63]
  v_and_b32_e64 v29, 31, v1
  v_lshl_add_u32 v29, s61, 5, v29
  v_subrev_u32_e64 v29, 48, v29
  v_cmp_gt_u32 s[62:63], 16, v29
  v_lshlrev_b32 v29, 2, v29
  v_lshrrev_b32 v30, 5, v1
  v_lshl_add_u32 v29, v30, 6, v29
  s_lshl_b32 s53, s45, 1
  s_add_u32 s53, s53, s64
  s_lshl_b32 s53, s53, 7
  s_add_u32 s54, s46, 1
  s_mul_i32 s54, s54, 18432
  s_add_u32 s53, s53, s54
  s_add_u32 s53, s53, 278528
  s_cmp_eq_u32 s46, 31
  s_cselect_b32 s53, 2130706432, s53
  v_add_u32_e64 v29, s53, v29
  v_mov_b32 v49, 2130706432
  v_cndmask_b32 v49, v49, v29, s[62:63]
  s_barrier
  s_nop 0
  ds_read_b64_tr_b16 v[80:81], v12 offset:4096
  ds_read_b64_tr_b16 v[82:83], v15 offset:4096
  ds_read_b128 v[96:99], v7 offset:0
  ds_read_b64_tr_b16 v[84:85], v12 offset:6144
  ds_read_b64_tr_b16 v[86:87], v15 offset:6144
  ds_read_b128 v[100:103], v7 offset:2048
  ds_read_b64_tr_b16 v[88:89], v12 offset:8192
  ds_read_b64_tr_b16 v[90:91], v15 offset:8192
  ds_read_b128 v[104:107], v7 offset:4096
  s_waitcnt lgkmcnt(6)
  v_mfma_f32_32x32x16_bf16 v[32:47], v[80:83], v[96:99], v[32:47]
  ds_read_b64_tr_b16 v[92:93], v12 offset:10240
  ds_read_b64_tr_b16 v[94:95], v15 offset:10240
  ds_read_b128 v[108:111], v7 offset:6144
  s_waitcnt lgkmcnt(6)
  v_mfma_f32_32x32x16_bf16 v[32:47], v[84:87], v[100:103], v[32:47]
  s_barrier
  ds_read_b64_tr_b16 v[80:81], v12 offset:12288
  ds_read_b64_tr_b16 v[82:83], v15 offset:12288
  ds_read_b128 v[96:99], v7 offset:8192
  s_waitcnt lgkmcnt(6)
  v_mfma_f32_32x32x16_bf16 v[32:47], v[88:91], v[104:107], v[32:47]
  ds_read_b64_tr_b16 v[84:85], v12 offset:14336
  ds_read_b64_tr_b16 v[86:87], v15 offset:14336
  ds_read_b128 v[100:103], v7 offset:10240
  s_waitcnt lgkmcnt(6)
  v_mfma_f32_32x32x16_bf16 v[32:47], v[92:95], v[108:111], v[32:47]
  ds_read_b64_tr_b16 v[88:89], v12 offset:16384
  ds_read_b64_tr_b16 v[90:91], v15 offset:16384
  ds_read_b128 v[104:107], v7 offset:12288
  s_waitcnt lgkmcnt(6)
  v_mfma_f32_32x32x16_bf16 v[32:47], v[80:83], v[96:99], v[32:47]
  ds_read_b64_tr_b16 v[92:93], v12 offset:18432
  ds_read_b64_tr_b16 v[94:95], v15 offset:18432
  ds_read_b128 v[108:111], v7 offset:14336
  s_waitcnt lgkmcnt(6)
  v_mfma_f32_32x32x16_bf16 v[32:47], v[84:87], v[100:103], v[32:47]
  s_barrier
  ds_read_b64_tr_b16 v[80:81], v12 offset:20480
  ds_read_b64_tr_b16 v[82:83], v15 offset:20480
  ds_read_b128 v[96:99], v7 offset:16384
  s_waitcnt lgkmcnt(6)
  v_mfma_f32_32x32x16_bf16 v[32:47], v[88:91], v[104:107], v[32:47]
  ds_read_b64_tr_b16 v[84:85], v12 offset:22528
  ds_read_b64_tr_b16 v[86:87], v15 offset:22528
  ds_read_b128 v[100:103], v7 offset:18432
  s_waitcnt lgkmcnt(6)
  v_mfma_f32_32x32x16_bf16 v[32:47], v[92:95], v[108:111], v[32:47]
  ds_read_b64_tr_b16 v[88:89], v12 offset:24576
  ds_read_b64_tr_b16 v[90:91], v15 offset:24576
  ds_read_b128 v[104:107], v7 offset:20480
  s_waitcnt lgkmcnt(6)
  v_mfma_f32_32x32x16_bf16 v[32:47], v[80:83], v[96:99], v[32:47]
  ds_read_b64_tr_b16 v[92:93], v12 offset:26624
  ds_read_b64_tr_b16 v[94:95], v15 offset:26624
  ds_read_b128 v[108:111], v7 offset:22528
  s_waitcnt lgkmcnt(6)
  v_mfma_f32_32x32x16_bf16 v[32:47], v[84:87], v[100:103], v[32:47]
  ds_read_b64_tr_b16 v[80:81], v11 offset:0
  ds_read_b64_tr_b16 v[82:83], v14 offset:0
  ds_read_b128 v[96:99], v7 offset:24576
  s_waitcnt lgkmcnt(6)
  v_mfma_f32_32x32x16_bf16 v[32:47], v[88:91], v[104:107], v[32:47]
  ds_read_b64_tr_b16 v[84:85], v11 offset:2048
  ds_read_b64_tr_b16 v[86:87], v14 offset:2048
  ds_read_b128 v[100:103], v7 offset:26624
  s_waitcnt lgkmcnt(6)
  v_mfma_f32_32x32x16_bf16 v[32:47], v[92:95], v[108:111], v[32:47]
  ds_read_b64_tr_b16 v[88:89], v11 offset:8192
  ds_read_b64_tr_b16 v[90:91], v14 offset:8192
  ds_read_b128 v[104:107], v7 offset:28672
  s_waitcnt lgkmcnt(6)
  v_mfma_f32_32x32x16_bf16 v[32:47], v[80:83], v[96:99], v[32:47]
  ds_read_b64_tr_b16 v[92:93], v11 offset:10240
  ds_read_b64_tr_b16 v[94:95], v14 offset:10240
  ds_read_b128 v[108:111], v7 offset:30720
  s_waitcnt lgkmcnt(6)
  v_mfma_f32_32x32x16_bf16 v[32:47], v[84:87], v[100:103], v[32:47]
  s_barrier
  ds_read_b64_tr_b16 v[80:81], v11 offset:12288
  ds_read_b64_tr_b16 v[82:83], v14 offset:12288
  ds_read_b128 v[96:99], v7 offset:32768
  s_waitcnt lgkmcnt(6)
  v_mfma_f32_32x32x16_bf16 v[32:47], v[88:91], v[104:107], v[32:47]
  ds_read_b64_tr_b16 v[84:85], v11 offset:14336
  ds_read_b64_tr_b16 v[86:87], v14 offset:14336
  ds_read_b128 v[100:103], v7 offset:34816
  s_waitcnt lgkmcnt(6)
  v_mfma_f32_32x32x16_bf16 v[32:47], v[92:95], v[108:111], v[32:47]
  ds_read_b64_tr_b16 v[88:89], v11 offset:16384
  ds_read_b64_tr_b16 v[90:91], v14 offset:16384
  ds_read_b128 v[104:107], v7 offset:36864
  s_waitcnt lgkmcnt(6)
  v_mfma_f32_32x32x16_bf16 v[32:47], v[80:83], v[96:99], v[32:47]
  ds_read_b64_tr_b16 v[92:93], v11 offset:18432
  ds_read_b64_tr_b16 v[94:95], v14 offset:18432
  ds_read_b128 v[108:111], v7 offset:38912
  s_waitcnt lgkmcnt(6)
  v_mfma_f32_32x32x16_bf16 v[32:47], v[84:87], v[100:103], v[32:47]
  ds_read_b64_tr_b16 v[80:81], v11 offset:20480
  ds_read_b64_tr_b16 v[82:83], v14 offset:20480
  ds_read_b128 v[96:99], v7 offset:49152
  s_waitcnt lgkmcnt(6)
  v_mfma_f32_32x32x16_bf16 v[32:47], v[88:91], v[104:107], v[32:47]
  ds_read_b64_tr_b16 v[84:85], v11 offset:22528
  ds_read_b64_tr_b16 v[86:87], v14 offset:22528
  ds_read_b128 v[100:103], v7 offset:51200
  s_waitcnt lgkmcnt(6)
  v_mfma_f32_32x32x16_bf16 v[32:47], v[92:95], v[108:111], v[32:47]
  ds_read_b64_tr_b16 v[88:89], v11 offset:24576
  ds_read_b64_tr_b16 v[90:91], v14 offset:24576
  ds_read_b128 v[104:107], v7 offset:53248
  s_waitcnt lgkmcnt(6)
  v_mfma_f32_32x32x16_bf16 v[32:47], v[80:83], v[96:99], v[32:47]
  ds_read_b64_tr_b16 v[92:93], v11 offset:26624
  ds_read_b64_tr_b16 v[94:95], v14 offset:26624
  ds_read_b128 v[108:111], v7 offset:55296
  s_waitcnt lgkmcnt(6)
  v_mfma_f32_32x32x16_bf16 v[32:47], v[84:87], v[100:103], v[32:47]
  s_barrier
  ds_read_b64_tr_b16 v[80:81], v11 offset:57344
  ds_read_b64_tr_b16 v[82:83], v14 offset:57344
  ds_read_b128 v[96:99], v7 offset:57344
  s_waitcnt lgkmcnt(6)
  v_mfma_f32_32x32x16_bf16 v[32:47], v[88:91], v[104:107], v[32:47]
  ds_read_b64_tr_b16 v[84:85], v11 offset:59392
  ds_read_b64_tr_b16 v[86:87], v14 offset:59392
  ds_read_b128 v[100:103], v7 offset:59392
  s_waitcnt lgkmcnt(6)
  v_mfma_f32_32x32x16_bf16 v[32:47], v[92:95], v[108:111], v[32:47]
  ds_read_b64_tr_b16 v[88:89], v11 offset:61440
  ds_read_b64_tr_b16 v[90:91], v14 offset:61440
  ds_read_b128 v[104:107], v7 offset:61440
  s_waitcnt lgkmcnt(6)
  v_mfma_f32_32x32x16_bf16 v[32:47], v[80:83], v[96:99], v[32:47]
  ds_read_b64_tr_b16 v[92:93], v11 offset:63488
  ds_read_b64_tr_b16 v[94:95], v14 offset:63488
  ds_read_b128 v[108:111], v7 offset:63488
  s_waitcnt lgkmcnt(6)
  v_mfma_f32_32x32x16_bf16 v[32:47], v[84:87], v[100:103], v[32:47]
  ds_read_b64_tr_b16 v[80:81], v10 offset:40960
  ds_read_b64_tr_b16 v[82:83], v13 offset:40960
  ds_read_b128 v[96:99], v8 offset:4096
  s_waitcnt lgkmcnt(6)
  v_mfma_f32_32x32x16_bf16 v[32:47], v[88:91], v[104:107], v[32:47]
  ds_read_b64_tr_b16 v[84:85], v10 offset:43008
  ds_read_b64_tr_b16 v[86:87], v13 offset:43008
  ds_read_b128 v[100:103], v8 offset:6144
  s_waitcnt lgkmcnt(6)
  v_mfma_f32_32x32x16_bf16 v[32:47], v[92:95], v[108:111], v[32:47]
  ds_read_b64_tr_b16 v[88:89], v10 offset:45056
  ds_read_b64_tr_b16 v[90:91], v13 offset:45056
  ds_read_b128 v[104:107], v7 offset:0
  s_waitcnt lgkmcnt(6)
  v_mfma_f32_32x32x16_bf16 v[32:47], v[80:83], v[96:99], v[32:47]
  ds_read_b64_tr_b16 v[92:93], v10 offset:47104
  ds_read_b64_tr_b16 v[94:95], v13 offset:47104
  ds_read_b128 v[108:111], v7 offset:2048
  s_waitcnt lgkmcnt(6)
  v_mfma_f32_32x32x16_bf16 v[32:47], v[84:87], v[100:103], v[32:47]
  s_barrier
  ds_read_b64_tr_b16 v[80:81], v10 offset:4096
  ds_read_b64_tr_b16 v[82:83], v13 offset:4096
  ds_read_b128 v[96:99], v8 offset:28672
  s_waitcnt lgkmcnt(6)
  v_mfma_f32_32x32x16_bf16 v[32:47], v[88:91], v[104:107], v[32:47]
  ds_read_b64_tr_b16 v[84:85], v10 offset:6144
  ds_read_b64_tr_b16 v[86:87], v13 offset:6144
  ds_read_b128 v[100:103], v8 offset:30720
  s_waitcnt lgkmcnt(6)
  v_mfma_f32_32x32x16_bf16 v[32:47], v[92:95], v[108:111], v[32:47]
  ds_read_b64_tr_b16 v[88:89], v11 offset:32768
  ds_read_b64_tr_b16 v[90:91], v14 offset:32768
  ds_read_b128 v[104:107], v7 offset:8192
  s_waitcnt lgkmcnt(6)
  v_mfma_f32_32x32x16_bf16 v[32:47], v[80:83], v[96:99], v[32:47]
  ds_read_b64_tr_b16 v[92:93], v11 offset:34816
  ds_read_b64_tr_b16 v[94:95], v14 offset:34816
  ds_read_b128 v[108:111], v7 offset:10240
  s_waitcnt lgkmcnt(6)
  v_mfma_f32_32x32x16_bf16 v[32:47], v[84:87], v[100:103], v[32:47]
  ds_read_b64_tr_b16 v[80:81], v11 offset:40960
  ds_read_b64_tr_b16 v[82:83], v14 offset:40960
  ds_read_b128 v[96:99], v8 offset:36864
  s_waitcnt lgkmcnt(6)
  v_mfma_f32_32x32x16_bf16 v[32:47], v[88:91], v[104:107], v[32:47]
  ds_read_b64_tr_b16 v[84:85], v11 offset:43008
  ds_read_b64_tr_b16 v[86:87], v14 offset:43008
  ds_read_b128 v[100:103], v8 offset:38912
  s_waitcnt lgkmcnt(6)
  v_mfma_f32_32x32x16_bf16 v[32:47], v[92:95], v[108:111], v[32:47]
  ds_read_b64_tr_b16 v[88:89], v10 offset:16384
  ds_read_b64_tr_b16 v[90:91], v13 offset:16384
  ds_read_b128 v[104:107], v7 offset:12288
  s_waitcnt lgkmcnt(6)
  v_mfma_f32_32x32x16_bf16 v[32:47], v[80:83], v[96:99], v[32:47]
  ds_read_b64_tr_b16 v[92:93], v10 offset:18432
  ds_read_b64_tr_b16 v[94:95], v13 offset:18432
  ds_read_b128 v[108:111], v7 offset:14336
  s_waitcnt lgkmcnt(6)
  v_mfma_f32_32x32x16_bf16 v[32:47], v[84:87], v[100:103], v[32:47]
  s_barrier
  ds_read_b64_tr_b16 v[80:81], v10 offset:24576
  ds_read_b64_tr_b16 v[82:83], v13 offset:24576
  ds_read_b128 v[96:99], v7 offset:20480
  s_waitcnt lgkmcnt(6)
  v_mfma_f32_32x32x16_bf16 v[32:47], v[88:91], v[104:107], v[32:47]
  ds_read_b64_tr_b16 v[84:85], v10 offset:26624
  ds_read_b64_tr_b16 v[86:87], v13 offset:26624
  ds_read_b128 v[100:103], v7 offset:22528
  s_waitcnt lgkmcnt(6)
  v_mfma_f32_32x32x16_bf16 v[32:47], v[92:95], v[108:111], v[32:47]
  ds_read_b64_tr_b16 v[88:89], v10 offset:32768
  ds_read_b64_tr_b16 v[90:91], v13 offset:32768
  ds_read_b128 v[104:107], v7 offset:28672
  s_waitcnt lgkmcnt(6)
  v_mfma_f32_32x32x16_bf16 v[32:47], v[80:83], v[96:99], v[32:47]
  ds_read_b64_tr_b16 v[92:93], v10 offset:34816
  ds_read_b64_tr_b16 v[94:95], v13 offset:34816
  ds_read_b128 v[108:111], v7 offset:30720
  s_waitcnt lgkmcnt(6)
  v_mfma_f32_32x32x16_bf16 v[32:47], v[84:87], v[100:103], v[32:47]
  ds_read_b64_tr_b16 v[80:81], v10 offset:49152
  ds_read_b64_tr_b16 v[82:83], v13 offset:49152
  ds_read_b128 v[96:99], v7 offset:36864
  s_waitcnt lgkmcnt(6)
  v_mfma_f32_32x32x16_bf16 v[32:47], v[88:91], v[104:107], v[32:47]
  ds_read_b64_tr_b16 v[84:85], v10 offset:51200
  ds_read_b64_tr_b16 v[86:87], v13 offset:51200
  ds_read_b128 v[100:103], v7 offset:38912
  s_waitcnt lgkmcnt(6)
  v_mfma_f32_32x32x16_bf16 v[32:47], v[92:95], v[108:111], v[32:47]
  ds_read_b64_tr_b16 v[88:89], v11 offset:8192
  ds_read_b64_tr_b16 v[90:91], v14 offset:8192
  ds_read_b128 v[104:107], v8 offset:0
  s_waitcnt lgkmcnt(6)
  v_mfma_f32_32x32x16_bf16 v[32:47], v[80:83], v[96:99], v[32:47]
  ds_read_b64_tr_b16 v[92:93], v11 offset:10240
  ds_read_b64_tr_b16 v[94:95], v14 offset:10240
  ds_read_b128 v[108:111], v8 offset:2048
  s_waitcnt lgkmcnt(6)
  v_mfma_f32_32x32x16_bf16 v[32:47], v[84:87], v[100:103], v[32:47]
  s_barrier
  ds_read_b64_tr_b16 v[80:81], v10 offset:53248
  ds_read_b64_tr_b16 v[82:83], v13 offset:53248
  ds_read_b128 v[96:99], v7 offset:40960
  s_waitcnt lgkmcnt(6)
  v_mfma_f32_32x32x16_bf16 v[32:47], v[88:91], v[104:107], v[32:47]
  ds_read_b64_tr_b16 v[84:85], v10 offset:55296
  ds_read_b64_tr_b16 v[86:87], v13 offset:55296
  ds_read_b128 v[100:103], v7 offset:43008
  s_waitcnt lgkmcnt(6)
  v_mfma_f32_32x32x16_bf16 v[32:47], v[92:95], v[108:111], v[32:47]
  ds_read_b64_tr_b16 v[88:89], v10 offset:61440
  ds_read_b64_tr_b16 v[90:91], v13 offset:61440
  ds_read_b128 v[104:107], v7 offset:57344
  s_waitcnt lgkmcnt(6)
  v_mfma_f32_32x32x16_bf16 v[32:47], v[80:83], v[96:99], v[32:47]
  ds_read_b64_tr_b16 v[92:93], v10 offset:63488
  ds_read_b64_tr_b16 v[94:95], v13 offset:63488
  ds_read_b128 v[108:111], v7 offset:59392
  s_waitcnt lgkmcnt(6)
  v_mfma_f32_32x32x16_bf16 v[32:47], v[84:87], v[100:103], v[32:47]
  ds_read_b64_tr_b16 v[80:81], v11 offset:12288
  ds_read_b64_tr_b16 v[82:83], v14 offset:12288
  ds_read_b128 v[96:99], v8 offset:4096
  s_waitcnt lgkmcnt(6)
  v_mfma_f32_32x32x16_bf16 v[32:47], v[88:91], v[104:107], v[32:47]
  ds_read_b64_tr_b16 v[84:85], v11 offset:14336
  ds_read_b64_tr_b16 v[86:87], v14 offset:14336
  ds_read_b128 v[100:103], v8 offset:6144
  s_waitcnt lgkmcnt(6)
  v_mfma_f32_32x32x16_bf16 v[32:47], v[92:95], v[108:111], v[32:47]
  ds_read_b64_tr_b16 v[88:89], v11 offset:20480
  ds_read_b64_tr_b16 v[90:91], v14 offset:20480
  ds_read_b128 v[104:107], v8 offset:16384
  s_waitcnt lgkmcnt(6)
  v_mfma_f32_32x32x16_bf16 v[32:47], v[80:83], v[96:99], v[32:47]
  ds_read_b64_tr_b16 v[92:93], v11 offset:22528
  ds_read_b64_tr_b16 v[94:95], v14 offset:22528
  ds_read_b128 v[108:111], v8 offset:18432
  s_waitcnt lgkmcnt(6)
  v_mfma_f32_32x32x16_bf16 v[32:47], v[84:87], v[100:103], v[32:47]
  s_barrier
  ds_read_b64_tr_b16 v[80:81], v10 offset:4096
  ds_read_b64_tr_b16 v[82:83], v13 offset:4096
  ds_read_b128 v[96:99], v7 offset:0
  s_waitcnt lgkmcnt(6)
  v_mfma_f32_32x32x16_bf16 v[32:47], v[88:91], v[104:107], v[32:47]
  ds_read_b64_tr_b16 v[84:85], v10 offset:6144
  ds_read_b64_tr_b16 v[86:87], v13 offset:6144
  ds_read_b128 v[100:103], v7 offset:2048
  s_waitcnt lgkmcnt(6)
  v_mfma_f32_32x32x16_bf16 v[32:47], v[92:95], v[108:111], v[32:47]
  ds_read_b64_tr_b16 v[88:89], v10 offset:45056
  ds_read_b64_tr_b16 v[90:91], v13 offset:45056
  ds_read_b128 v[104:107], v7 offset:8192
  s_waitcnt lgkmcnt(6)
  v_mfma_f32_32x32x16_bf16 v[32:47], v[80:83], v[96:99], v[32:47]
  ds_read_b64_tr_b16 v[92:93], v10 offset:47104
  ds_read_b64_tr_b16 v[94:95], v13 offset:47104
  ds_read_b128 v[108:111], v7 offset:10240
  s_waitcnt lgkmcnt(6)
  v_mfma_f32_32x32x16_bf16 v[32:47], v[84:87], v[100:103], v[32:47]
  ds_read_b64_tr_b16 v[80:81], v11 offset:28672
  ds_read_b64_tr_b16 v[82:83], v14 offset:28672
  ds_read_b128 v[96:99], v8 offset:24576
  s_waitcnt lgkmcnt(6)
  v_mfma_f32_32x32x16_bf16 v[32:47], v[88:91], v[104:107], v[32:47]
  ds_read_b64_tr_b16 v[84:85], v11 offset:30720
  ds_read_b64_tr_b16 v[86:87], v14 offset:30720
  ds_read_b128 v[100:103], v8 offset:26624
  s_waitcnt lgkmcnt(6)
  v_mfma_f32_32x32x16_bf16 v[32:47], v[92:95], v[108:111], v[32:47]
  ds_read_b64_tr_b16 v[88:89], v11 offset:36864
  ds_read_b64_tr_b16 v[90:91], v14 offset:36864
  ds_read_b128 v[104:107], v8 offset:32768
  s_waitcnt lgkmcnt(6)
  v_mfma_f32_32x32x16_bf16 v[32:47], v[80:83], v[96:99], v[32:47]
  ds_read_b64_tr_b16 v[92:93], v11 offset:38912
  ds_read_b64_tr_b16 v[94:95], v14 offset:38912
  ds_read_b128 v[108:111], v8 offset:34816
  s_waitcnt lgkmcnt(6)
  v_mfma_f32_32x32x16_bf16 v[32:47], v[84:87], v[100:103], v[32:47]
  s_barrier
  ds_read_b64_tr_b16 v[80:81], v10 offset:16384
  ds_read_b64_tr_b16 v[82:83], v13 offset:16384
  ds_read_b128 v[96:99], v7 offset:12288
  s_waitcnt lgkmcnt(6)
  v_mfma_f32_32x32x16_bf16 v[32:47], v[88:91], v[104:107], v[32:47]
  ds_read_b64_tr_b16 v[84:85], v10 offset:18432
  ds_read_b64_tr_b16 v[86:87], v13 offset:18432
  ds_read_b128 v[100:103], v7 offset:14336
  s_waitcnt lgkmcnt(6)
  v_mfma_f32_32x32x16_bf16 v[32:47], v[92:95], v[108:111], v[32:47]
  ds_read_b64_tr_b16 v[88:89], v10 offset:24576
  ds_read_b64_tr_b16 v[90:91], v13 offset:24576
  ds_read_b128 v[104:107], v7 offset:20480
  s_waitcnt lgkmcnt(6)
  v_mfma_f32_32x32x16_bf16 v[32:47], v[80:83], v[96:99], v[32:47]
  ds_read_b64_tr_b16 v[92:93], v10 offset:26624
  ds_read_b64_tr_b16 v[94:95], v13 offset:26624
  ds_read_b128 v[108:111], v7 offset:22528
  s_waitcnt lgkmcnt(6)
  v_mfma_f32_32x32x16_bf16 v[32:47], v[84:87], v[100:103], v[32:47]
  ds_read_b64_tr_b16 v[80:81], v10 offset:32768
  ds_read_b64_tr_b16 v[82:83], v13 offset:32768
  ds_read_b128 v[96:99], v7 offset:28672
  s_waitcnt lgkmcnt(6)
  v_mfma_f32_32x32x16_bf16 v[32:47], v[88:91], v[104:107], v[32:47]
  ds_read_b64_tr_b16 v[84:85], v10 offset:34816
  ds_read_b64_tr_b16 v[86:87], v13 offset:34816
  ds_read_b128 v[100:103], v7 offset:30720
  s_waitcnt lgkmcnt(6)
  v_mfma_f32_32x32x16_bf16 v[32:47], v[92:95], v[108:111], v[32:47]
  ds_read_b64_tr_b16 v[88:89], v10 offset:49152
  ds_read_b64_tr_b16 v[90:91], v13 offset:49152
  ds_read_b128 v[104:107], v7 offset:36864
  s_waitcnt lgkmcnt(6)
  v_mfma_f32_32x32x16_bf16 v[32:47], v[80:83], v[96:99], v[32:47]
  ds_read_b64_tr_b16 v[92:93], v10 offset:51200
  ds_read_b64_tr_b16 v[94:95], v13 offset:51200
  ds_read_b128 v[108:111], v7 offset:38912
  s_waitcnt lgkmcnt(6)
  v_mfma_f32_32x32x16_bf16 v[32:47], v[84:87], v[100:103], v[32:47]
  s_barrier
  ds_read_b64_tr_b16 v[80:81], v10 offset:53248
  ds_read_b64_tr_b16 v[82:83], v13 offset:53248
  ds_read_b128 v[96:99], v7 offset:40960
  s_waitcnt lgkmcnt(6)
  v_mfma_f32_32x32x16_bf16 v[32:47], v[88:91], v[104:107], v[32:47]
  ds_read_b64_tr_b16 v[84:85], v10 offset:55296
  ds_read_b64_tr_b16 v[86:87], v13 offset:55296
  ds_read_b128 v[100:103], v7 offset:43008
  s_waitcnt lgkmcnt(6)
  v_mfma_f32_32x32x16_bf16 v[32:47], v[92:95], v[108:111], v[32:47]
  ds_read_b64_tr_b16 v[88:89], v10 offset:61440
  ds_read_b64_tr_b16 v[90:91], v13 offset:61440
  ds_read_b128 v[104:107], v7 offset:57344
  s_waitcnt lgkmcnt(6)
  v_mfma_f32_32x32x16_bf16 v[32:47], v[80:83], v[96:99], v[32:47]
  ds_read_b64_tr_b16 v[92:93], v10 offset:63488
  ds_read_b64_tr_b16 v[94:95], v13 offset:63488
  ds_read_b128 v[108:111], v7 offset:59392
  s_waitcnt lgkmcnt(6)
  v_mfma_f32_32x32x16_bf16 v[32:47], v[84:87], v[100:103], v[32:47]
  ds_read_b64_tr_b16 v[80:81], v11 offset:4096
  ds_read_b64_tr_b16 v[82:83], v14 offset:4096
  ds_read_b128 v[96:99], v8 offset:0
  s_waitcnt lgkmcnt(6)
  v_mfma_f32_32x32x16_bf16 v[32:47], v[88:91], v[104:107], v[32:47]
  ds_read_b64_tr_b16 v[84:85], v11 offset:6144
  ds_read_b64_tr_b16 v[86:87], v14 offset:6144
  ds_read_b128 v[100:103], v8 offset:2048
  s_waitcnt lgkmcnt(6)
  v_mfma_f32_32x32x16_bf16 v[32:47], v[92:95], v[108:111], v[32:47]
  ds_read_b64_tr_b16 v[88:89], v11 offset:12288
  ds_read_b64_tr_b16 v[90:91], v14 offset:12288
  ds_read_b128 v[104:107], v8 offset:8192
  s_waitcnt lgkmcnt(6)
  v_mfma_f32_32x32x16_bf16 v[32:47], v[80:83], v[96:99], v[32:47]
  ds_read_b64_tr_b16 v[92:93], v11 offset:14336
  ds_read_b64_tr_b16 v[94:95], v14 offset:14336
  ds_read_b128 v[108:111], v8 offset:10240
  s_waitcnt lgkmcnt(6)
  v_mfma_f32_32x32x16_bf16 v[32:47], v[84:87], v[100:103], v[32:47]
  s_barrier
  ds_read_b128 v[96:99], v7 offset:0
  s_waitcnt lgkmcnt(4)
  v_mfma_f32_32x32x16_bf16 v[32:47], v[88:91], v[104:107], v[32:47]
  ds_read_b128 v[100:103], v7 offset:2048
  s_waitcnt lgkmcnt(2)
  v_mfma_f32_32x32x16_bf16 v[32:47], v[92:95], v[108:111], v[32:47]
  ds_read_b128 v[104:107], v7 offset:4096
  s_waitcnt lgkmcnt(2)
  v_mfma_f32_32x32x16_bf16 v[32:47], v[128:131], v[96:99], v[32:47]
  ds_read_b128 v[108:111], v7 offset:6144
  s_waitcnt lgkmcnt(2)
  v_mfma_f32_32x32x16_bf16 v[32:47], v[132:135], v[100:103], v[32:47]
  ds_read_b128 v[96:99], v7 offset:8192
  s_waitcnt lgkmcnt(2)
  v_mfma_f32_32x32x16_bf16 v[32:47], v[136:139], v[104:107], v[32:47]
  ds_read_b128 v[100:103], v7 offset:10240
  s_waitcnt lgkmcnt(2)
  v_mfma_f32_32x32x16_bf16 v[32:47], v[140:143], v[108:111], v[32:47]
  ds_read_b128 v[104:107], v7 offset:45056
  s_waitcnt lgkmcnt(2)
  v_mfma_f32_32x32x16_bf16 v[32:47], v[144:147], v[96:99], v[32:47]
  ds_read_b128 v[108:111], v7 offset:47104
  s_waitcnt lgkmcnt(2)
  v_mfma_f32_32x32x16_bf16 v[32:47], v[148:151], v[100:103], v[32:47]
  s_barrier
  ds_read_b128 v[96:99], v7 offset:12288
  s_waitcnt lgkmcnt(2)
  v_mfma_f32_32x32x16_bf16 v[32:47], v[152:155], v[104:107], v[32:47]
  ds_read_b128 v[100:103], v7 offset:14336
  s_waitcnt lgkmcnt(2)
  v_mfma_f32_32x32x16_bf16 v[32:47], v[156:159], v[108:111], v[32:47]
  ds_read_b128 v[104:107], v7 offset:16384
  s_waitcnt lgkmcnt(2)
  v_mfma_f32_32x32x16_bf16 v[32:47], v[160:163], v[96:99], v[32:47]
  ds_read_b128 v[108:111], v7 offset:18432
  s_waitcnt lgkmcnt(2)
  v_mfma_f32_32x32x16_bf16 v[32:47], v[164:167], v[100:103], v[32:47]
  ds_read_b128 v[96:99], v7 offset:20480
  s_waitcnt lgkmcnt(2)
  v_mfma_f32_32x32x16_bf16 v[32:47], v[168:171], v[104:107], v[32:47]
  ds_read_b128 v[100:103], v7 offset:22528
  s_waitcnt lgkmcnt(2)
  v_mfma_f32_32x32x16_bf16 v[32:47], v[172:175], v[108:111], v[32:47]
  ds_read_b128 v[104:107], v7 offset:24576
  s_waitcnt lgkmcnt(2)
  v_mfma_f32_32x32x16_bf16 v[32:47], v[176:179], v[96:99], v[32:47]
  ds_read_b128 v[108:111], v7 offset:26624
  s_waitcnt lgkmcnt(2)
  v_mfma_f32_32x32x16_bf16 v[32:47], v[180:183], v[100:103], v[32:47]
  s_barrier
  ds_read_b128 v[96:99], v7 offset:28672
  s_waitcnt lgkmcnt(2)
  v_mfma_f32_32x32x16_bf16 v[32:47], v[184:187], v[104:107], v[32:47]
  ds_read_b128 v[100:103], v7 offset:30720
  s_waitcnt lgkmcnt(2)
  v_mfma_f32_32x32x16_bf16 v[32:47], v[188:191], v[108:111], v[32:47]
  ds_read_b128 v[104:107], v7 offset:32768
  s_waitcnt lgkmcnt(2)
  v_mfma_f32_32x32x16_bf16 v[32:47], v[192:195], v[96:99], v[32:47]
  ds_read_b128 v[108:111], v7 offset:34816
  s_waitcnt lgkmcnt(2)
  v_mfma_f32_32x32x16_bf16 v[32:47], v[196:199], v[100:103], v[32:47]
  ds_read_b128 v[96:99], v7 offset:36864
  s_waitcnt lgkmcnt(2)
  v_mfma_f32_32x32x16_bf16 v[32:47], v[200:203], v[104:107], v[32:47]
  ds_read_b128 v[100:103], v7 offset:38912
  s_waitcnt lgkmcnt(2)
  v_mfma_f32_32x32x16_bf16 v[32:47], v[204:207], v[108:111], v[32:47]
  ds_read_b128 v[104:107], v7 offset:40960
  s_waitcnt lgkmcnt(2)
  v_mfma_f32_32x32x16_bf16 v[32:47], v[208:211], v[96:99], v[32:47]
  ds_read_b128 v[108:111], v7 offset:43008
  s_waitcnt lgkmcnt(2)
  v_mfma_f32_32x32x16_bf16 v[32:47], v[212:215], v[100:103], v[32:47]
  s_barrier
  ds_read_b128 v[96:99], v7 offset:49152
  s_waitcnt lgkmcnt(2)
  v_mfma_f32_32x32x16_bf16 v[32:47], v[216:219], v[104:107], v[32:47]
  ds_read_b128 v[100:103], v7 offset:51200
  s_waitcnt lgkmcnt(2)
  v_mfma_f32_32x32x16_bf16 v[32:47], v[220:223], v[108:111], v[32:47]
  ds_read_b128 v[104:107], v7 offset:53248
  s_waitcnt lgkmcnt(2)
  v_mfma_f32_32x32x16_bf16 v[32:47], v[224:227], v[96:99], v[32:47]
  ds_read_b128 v[108:111], v7 offset:55296
  s_waitcnt lgkmcnt(2)
  v_mfma_f32_32x32x16_bf16 v[32:47], v[228:231], v[100:103], v[32:47]
  s_barrier
  ds_read_b128 v[96:99], v7 offset:0
  s_waitcnt lgkmcnt(2)
  v_mfma_f32_32x32x16_bf16 v[32:47], v[232:235], v[104:107], v[32:47]
  ds_read_b128 v[100:103], v7 offset:2048
  s_waitcnt lgkmcnt(2)
  v_mfma_f32_32x32x16_bf16 v[32:47], v[236:239], v[108:111], v[32:47]
  ds_read_b128 v[104:107], v7 offset:4096
  s_waitcnt lgkmcnt(2)
  v_mfma_f32_32x32x16_bf16 v[32:47], v[240:243], v[96:99], v[32:47]
  ds_read_b128 v[108:111], v7 offset:6144
  s_waitcnt lgkmcnt(2)
  v_mfma_f32_32x32x16_bf16 v[32:47], v[244:247], v[100:103], v[32:47]
  s_waitcnt lgkmcnt(1)
  v_mfma_f32_32x32x16_bf16 v[32:47], v[248:251], v[104:107], v[32:47]
  s_waitcnt lgkmcnt(0)
  v_mfma_f32_32x32x16_bf16 v[32:47], v[252:255], v[108:111], v[32:47]
  s_nop 11
  v_cvt_pk_bf16_f32 v96, v32, v33
  v_cvt_pk_bf16_f32 v97, v34, v35
  v_cvt_pk_bf16_f32 v98, v36, v37
  v_cvt_pk_bf16_f32 v99, v38, v39
  v_cvt_pk_bf16_f32 v100, v40, v41
  v_cvt_pk_bf16_f32 v101, v42, v43
  v_cvt_pk_bf16_f32 v102, v44, v45
  v_cvt_pk_bf16_f32 v103, v46, v47
  buffer_store_dwordx4 v[96:99], v16, s[4:7], s66 offen
  buffer_store_dwordx4 v[100:103], v16, s[4:7], s66 offen offset:2048
  v_pk_add_f32 v[112:113], v[32:33], v[34:35]
PAD_10:
  s_cbranch_execz L_TRAMP
  s_nop 0
  v_pk_add_f32 v[114:115], v[36:37], v[38:39]
  v_pk_add_f32 v[116:117], v[40:41], v[42:43]
  v_pk_add_f32 v[118:119], v[44:45], v[46:47]
  v_pk_mul_f32 v[120:121], v[32:33], v[32:33]
  v_pk_fma_f32 v[120:121], v[34:35], v[34:35], v[120:121]
  v_pk_fma_f32 v[120:121], v[36:37], v[36:37], v[120:121]
  v_pk_fma_f32 v[120:121], v[38:39], v[38:39], v[120:121]
  v_pk_fma_f32 v[120:121], v[40:41], v[40:41], v[120:121]
  v_pk_fma_f32 v[120:121], v[42:43], v[42:43], v[120:121]
  v_pk_fma_f32 v[120:121], v[44:45], v[44:45], v[120:121]
  v_pk_fma_f32 v[120:121], v[46:47], v[46:47], v[120:121]
  v_pk_add_f32 v[112:113], v[112:113], v[114:115]
  v_pk_add_f32 v[116:117], v[116:117], v[118:119]
  v_add_f32_e64 v120, v120, v121
  v_pk_add_f32 v[112:113], v[112:113], v[116:117]
  v_add_f32 v112, v112, v113
  s_nop 1
  v_permlane32_swap_b32 v112, v120
  v_add_f32 v112, v112, v120
  buffer_store_dword v112, v28, s[4:7], s81 offen
  s_barrier
  s_waitcnt vmcnt(0)
  s_barrier
  s_nop 0
  buffer_store_dwordx4 v[96:99], v48, s[4:7], 0 offen sc1
  buffer_store_dwordx4 v[100:103], v48, s[4:7], 0 offen offset:512 sc1
  buffer_store_dword v112, v49, s[4:7], 0 offen sc1
  ds_write_b128 v16, v[96:99] offset:0
  ds_write_b128 v16, v[100:103] offset:2048
  v_bfe_u32 v29, v1, 4, 1
  v_bfe_u32 v30, v1, 2, 2
  v_lshl_add_u32 v17, v29, 2, v30
  v_lshrrev_b32_e64 v31, 5, v1
  v_lshl_add_u32 v17, v31, 4, v17
  v_lshlrev_b32 v17, 7, v17
  v_and_b32 v30, 2, v30
  v_or_b32 v29, v29, v30
  v_xor_b32 v29, s44, v29
  v_lshl_add_u32 v17, v29, 5, v17
  v_and_b32_e64 v30, 3, v1
  v_lshl_add_u32 v17, v30, 3, v17
  v_add_u32 v18, 0x20000, v17
  v_add_u32 v17, 0x10000, v17
  v_bfe_u32 v29, v1, 4, 1
  v_bfe_u32 v30, v1, 2, 2
  v_lshl_add_u32 v22, v29, 2, v30
  v_add_u32 v22, 8, v22
  v_lshrrev_b32 v31, 5, v1
  v_lshl_add_u32 v22, v31, 4, v22
  v_lshlrev_b32 v22, 7, v22
  v_and_b32 v30, 2, v30
  v_xor_b32 v29, 1, v29
  v_or_b32 v29, v29, v30
  v_xor_b32_e64 v29, s44, v29
  v_lshl_add_u32 v22, v29, 5, v22
  v_and_b32_e64 v30, 3, v1
  v_lshl_add_u32 v22, v30, 3, v22
  v_add_u32 v23, 0x20000, v22
  v_add_u32 v22, 0x10000, v22
  v_mov_b32 v31, 0x0c0c0c0c
  v_mov_b32 v29, 0xc0c0100
  v_mov_b32 v30, 0x1000c0c
  v_cndmask_b32 v29, v29, v30, s[84:85]
  v_cndmask_b32 v92, v31, v29, s[86:87]
  v_cndmask_b32 v94, v29, v31, s[86:87]
  v_mov_b32 v29, 0xc0c0302
  v_mov_b32 v30, 0x3020c0c
  v_cndmask_b32 v29, v29, v30, s[84:85]
  v_cndmask_b32 v93, v31, v29, s[88:89]
  v_cndmask_b32 v95, v29, v31, s[88:89]
  v_and_b32 v122, 15, v1
  v_lshlrev_b32 v122, 2, v122
  v_add_u32 v122, 159744, v122
  v_and_b32_e64 v31, 48, v1
  v_add_u32 v120, 159744, v31
  s_lshl_b32 s53, s44, 6
  s_add_u32 s53, s53, 2048
  v_add_u32 v126, s53, v120
  v_add_u32_e64 v127, s53, v122
  v_bfe_u32 v29, v1, 4, 1
  v_lshrrev_b32_e64 v30, 5, v1
  v_lshl_add_u32 v31, v29, 1, v30
  v_lshl_add_u32 v123, v31, 6, v122
  v_and_b32 v31, 15, v1
  v_lshlrev_b32 v31, 4, v31
  v_lshl_add_u32 v31, v29, 10, v31
  v_lshl_add_u32 v31, v30, 8, v31
  s_lshl_b32 s53, s44, 11
  v_add_u32 v121, s53, v31
  v_and_b32 v29, 15, v1
  v_lshlrev_b32 v7, 4, v29
  v_lshrrev_b32_e64 v30, 4, v1
  v_lshl_add_u32 v7, v30, 10, v7
  s_waitcnt lgkmcnt(0)
  s_barrier
  s_barrier
  s_nop 0
  ds_read_b64_tr_b16 v[216:217], v17 offset:16384
  ds_read_b64_tr_b16 v[218:219], v22 offset:16384
  ds_read_b128 v[184:187], v7 offset:0
  ds_read_b64_tr_b16 v[220:221], v17 offset:20480
  ds_read_b64_tr_b16 v[222:223], v22 offset:20480
  ds_read_b64_tr_b16 v[224:225], v17 offset:24576
  ds_read_b64_tr_b16 v[226:227], v22 offset:24576
  ds_read_b128 v[188:191], v7 offset:256
  ds_read_b128 v[192:195], v7 offset:512
  ds_read_b128 v[196:199], v7 offset:768
  s_waitcnt lgkmcnt(7)
  v_mfma_f32_16x16x32_bf16 v[128:131], v[216:219], v[184:187], 0
  s_waitcnt lgkmcnt(5)
  v_mfma_f32_16x16x32_bf16 v[148:151], v[220:223], v[184:187], 0
  ds_read_b64_tr_b16 v[228:229], v17 offset:28672
  s_waitcnt lgkmcnt(4)
  v_mfma_f32_16x16x32_bf16 v[168:171], v[184:187], v[224:227], 0
  ds_read_b64_tr_b16 v[230:231], v22 offset:28672
  s_waitcnt lgkmcnt(4)
  v_mfma_f32_16x16x32_bf16 v[132:135], v[216:219], v[188:191], 0
  ds_read_b128 v[200:203], v7 offset:4096
  v_mfma_f32_16x16x32_bf16 v[152:155], v[220:223], v[188:191], 0
  ds_read_b64_tr_b16 v[232:233], v17 offset:32768
  v_mfma_f32_16x16x32_bf16 v[172:175], v[188:191], v[224:227], 0
  ds_read_b64_tr_b16 v[234:235], v22 offset:32768
  s_waitcnt lgkmcnt(6)
  v_mfma_f32_16x16x32_bf16 v[136:139], v[216:219], v[192:195], 0
  ds_read_b64_tr_b16 v[236:237], v17 offset:0
  v_mfma_f32_16x16x32_bf16 v[156:159], v[220:223], v[192:195], 0
  ds_read_b64_tr_b16 v[238:239], v22 offset:0
  v_mfma_f32_16x16x32_bf16 v[176:179], v[192:195], v[224:227], 0
  ds_read_b128 v[204:207], v7 offset:4352
  s_waitcnt lgkmcnt(8)
  v_mfma_f32_16x16x32_bf16 v[140:143], v[216:219], v[196:199], 0
  ds_read_b128 v[208:211], v7 offset:4608
  v_mfma_f32_16x16x32_bf16 v[160:163], v[220:223], v[196:199], 0
  ds_read_b128 v[212:215], v7 offset:4864
  v_mfma_f32_16x16x32_bf16 v[180:183], v[196:199], v[224:227], 0
  s_waitcnt lgkmcnt(7)
  v_mfma_f32_16x16x32_bf16 v[128:131], v[228:231], v[200:203], v[128:131]
  s_waitcnt vmcnt(0)
  s_barrier
  s_waitcnt lgkmcnt(5)
  v_mfma_f32_16x16x32_bf16 v[148:151], v[232:235], v[200:203], v[148:151]
  ds_read_b64_tr_b16 v[216:217], v17 offset:4096
  s_waitcnt lgkmcnt(4)
  v_mfma_f32_16x16x32_bf16 v[168:171], v[200:203], v[236:239], v[168:171]
  ds_read_b64_tr_b16 v[218:219], v22 offset:4096
  s_waitcnt lgkmcnt(4)
  v_mfma_f32_16x16x32_bf16 v[132:135], v[228:231], v[204:207], v[132:135]
  ds_read_b128 v[184:187], v7 offset:8192
  v_mfma_f32_16x16x32_bf16 v[152:155], v[232:235], v[204:207], v[152:155]
  ds_read_b64_tr_b16 v[220:221], v17 offset:8192
  v_mfma_f32_16x16x32_bf16 v[172:175], v[204:207], v[236:239], v[172:175]
  ds_read_b64_tr_b16 v[222:223], v22 offset:8192
  s_waitcnt lgkmcnt(6)
  v_mfma_f32_16x16x32_bf16 v[136:139], v[228:231], v[208:211], v[136:139]
  ds_read_b64_tr_b16 v[224:225], v17 offset:12288
  v_mfma_f32_16x16x32_bf16 v[156:159], v[232:235], v[208:211], v[156:159]
  ds_read_b64_tr_b16 v[226:227], v22 offset:12288
  v_mfma_f32_16x16x32_bf16 v[176:179], v[208:211], v[236:239], v[176:179]
  ds_read_b128 v[188:191], v7 offset:8448
  s_waitcnt lgkmcnt(8)
  v_mfma_f32_16x16x32_bf16 v[140:143], v[228:231], v[212:215], v[140:143]
  ds_read_b128 v[192:195], v7 offset:8704
  v_mfma_f32_16x16x32_bf16 v[160:163], v[232:235], v[212:215], v[160:163]
  ds_read_b128 v[196:199], v7 offset:8960
  v_mfma_f32_16x16x32_bf16 v[180:183], v[212:215], v[236:239], v[180:183]
  s_waitcnt lgkmcnt(7)
  v_mfma_f32_16x16x32_bf16 v[128:131], v[216:219], v[184:187], v[128:131]
  s_waitcnt lgkmcnt(5)
  v_mfma_f32_16x16x32_bf16 v[148:151], v[220:223], v[184:187], v[148:151]
  ds_read_b64_tr_b16 v[228:229], v17 offset:36864
  s_waitcnt lgkmcnt(4)
  v_mfma_f32_16x16x32_bf16 v[168:171], v[184:187], v[224:227], v[168:171]
  ds_read_b64_tr_b16 v[230:231], v22 offset:36864
  s_waitcnt lgkmcnt(4)
  v_mfma_f32_16x16x32_bf16 v[132:135], v[216:219], v[188:191], v[132:135]
  ds_read_b128 v[200:203], v7 offset:12288
  v_mfma_f32_16x16x32_bf16 v[152:155], v[220:223], v[188:191], v[152:155]
  ds_read_b64_tr_b16 v[232:233], v17 offset:40960
  v_mfma_f32_16x16x32_bf16 v[172:175], v[188:191], v[224:227], v[172:175]
  ds_read_b64_tr_b16 v[234:235], v22 offset:40960
  s_waitcnt lgkmcnt(6)
  v_mfma_f32_16x16x32_bf16 v[136:139], v[216:219], v[192:195], v[136:139]
  ds_read_b64_tr_b16 v[236:237], v17 offset:45056
  v_mfma_f32_16x16x32_bf16 v[156:159], v[220:223], v[192:195], v[156:159]
  ds_read_b64_tr_b16 v[238:239], v22 offset:45056
  v_mfma_f32_16x16x32_bf16 v[176:179], v[192:195], v[224:227], v[176:179]
  ds_read_b128 v[204:207], v7 offset:12544
  s_waitcnt lgkmcnt(8)
  v_mfma_f32_16x16x32_bf16 v[140:143], v[216:219], v[196:199], v[140:143]
  ds_read_b128 v[208:211], v7 offset:12800
  v_mfma_f32_16x16x32_bf16 v[160:163], v[220:223], v[196:199], v[160:163]
  ds_read_b128 v[212:215], v7 offset:13056
  v_mfma_f32_16x16x32_bf16 v[180:183], v[196:199], v[224:227], v[180:183]
  s_waitcnt lgkmcnt(7)
  v_mfma_f32_16x16x32_bf16 v[128:131], v[228:231], v[200:203], v[128:131]
  s_barrier
  s_waitcnt lgkmcnt(5)
  v_mfma_f32_16x16x32_bf16 v[148:151], v[232:235], v[200:203], v[148:151]
  ds_read_b64_tr_b16 v[216:217], v17 offset:49152
  s_waitcnt lgkmcnt(4)
  v_mfma_f32_16x16x32_bf16 v[168:171], v[200:203], v[236:239], v[168:171]
  ds_read_b64_tr_b16 v[218:219], v22 offset:49152
  s_waitcnt lgkmcnt(4)
  v_mfma_f32_16x16x32_bf16 v[132:135], v[228:231], v[204:207], v[132:135]
  ds_read_b128 v[184:187], v7 offset:16384
  v_mfma_f32_16x16x32_bf16 v[152:155], v[232:235], v[204:207], v[152:155]
  ds_read_b64_tr_b16 v[220:221], v17 offset:53248
  v_mfma_f32_16x16x32_bf16 v[172:175], v[204:207], v[236:239], v[172:175]
  ds_read_b64_tr_b16 v[222:223], v22 offset:53248
  s_waitcnt lgkmcnt(6)
  v_mfma_f32_16x16x32_bf16 v[136:139], v[228:231], v[208:211], v[136:139]
  ds_read_b64_tr_b16 v[224:225], v17 offset:57344
  v_mfma_f32_16x16x32_bf16 v[156:159], v[232:235], v[208:211], v[156:159]
  ds_read_b64_tr_b16 v[226:227], v22 offset:57344
  v_mfma_f32_16x16x32_bf16 v[176:179], v[208:211], v[236:239], v[176:179]
  ds_read_b128 v[188:191], v7 offset:16640
  s_waitcnt lgkmcnt(8)
  v_mfma_f32_16x16x32_bf16 v[140:143], v[228:231], v[212:215], v[140:143]
  ds_read_b128 v[192:195], v7 offset:16896
  v_mfma_f32_16x16x32_bf16 v[160:163], v[232:235], v[212:215], v[160:163]
  ds_read_b128 v[196:199], v7 offset:17152
  v_mfma_f32_16x16x32_bf16 v[180:183], v[212:215], v[236:239], v[180:183]
  s_waitcnt lgkmcnt(7)
  v_mfma_f32_16x16x32_bf16 v[128:131], v[216:219], v[184:187], v[128:131]
  s_waitcnt lgkmcnt(5)
  v_mfma_f32_16x16x32_bf16 v[148:151], v[220:223], v[184:187], v[148:151]
  ds_read_b64_tr_b16 v[228:229], v17 offset:61440
  s_waitcnt lgkmcnt(4)
  v_mfma_f32_16x16x32_bf16 v[168:171], v[184:187], v[224:227], v[168:171]
  ds_read_b64_tr_b16 v[230:231], v22 offset:61440
  s_waitcnt lgkmcnt(4)
  v_mfma_f32_16x16x32_bf16 v[132:135], v[216:219], v[188:191], v[132:135]
  ds_read_b128 v[200:203], v7 offset:20480
  v_mfma_f32_16x16x32_bf16 v[152:155], v[220:223], v[188:191], v[152:155]
  ds_read_b64_tr_b16 v[232:233], v18 offset:0
  v_mfma_f32_16x16x32_bf16 v[172:175], v[188:191], v[224:227], v[172:175]
  ds_read_b64_tr_b16 v[234:235], v23 offset:0
  s_waitcnt lgkmcnt(6)
  v_mfma_f32_16x16x32_bf16 v[136:139], v[216:219], v[192:195], v[136:139]
  ds_read_b64_tr_b16 v[236:237], v18 offset:4096
  v_mfma_f32_16x16x32_bf16 v[156:159], v[220:223], v[192:195], v[156:159]
  ds_read_b64_tr_b16 v[238:239], v23 offset:4096
  v_mfma_f32_16x16x32_bf16 v[176:179], v[192:195], v[224:227], v[176:179]
  ds_read_b128 v[204:207], v7 offset:20736
  s_waitcnt lgkmcnt(8)
  v_mfma_f32_16x16x32_bf16 v[140:143], v[216:219], v[196:199], v[140:143]
  ds_read_b128 v[208:211], v7 offset:20992
  v_mfma_f32_16x16x32_bf16 v[160:163], v[220:223], v[196:199], v[160:163]
  ds_read_b128 v[212:215], v7 offset:21248
  v_mfma_f32_16x16x32_bf16 v[180:183], v[196:199], v[224:227], v[180:183]
  s_waitcnt lgkmcnt(7)
  v_mfma_f32_16x16x32_bf16 v[128:131], v[228:231], v[200:203], v[128:131]
  s_barrier
  s_waitcnt lgkmcnt(5)
  v_mfma_f32_16x16x32_bf16 v[148:151], v[232:235], v[200:203], v[148:151]
  ds_read_b64_tr_b16 v[216:217], v18 offset:8192
  s_waitcnt lgkmcnt(4)
  v_mfma_f32_16x16x32_bf16 v[168:171], v[200:203], v[236:239], v[168:171]
  ds_read_b64_tr_b16 v[218:219], v23 offset:8192
  s_waitcnt lgkmcnt(4)
  v_mfma_f32_16x16x32_bf16 v[132:135], v[228:231], v[204:207], v[132:135]
  ds_read_b128 v[184:187], v7 offset:24576
  v_mfma_f32_16x16x32_bf16 v[152:155], v[232:235], v[204:207], v[152:155]
  ds_read_b64_tr_b16 v[220:221], v18 offset:12288
  v_mfma_f32_16x16x32_bf16 v[172:175], v[204:207], v[236:239], v[172:175]
  ds_read_b64_tr_b16 v[222:223], v23 offset:12288
  s_waitcnt lgkmcnt(6)
  v_mfma_f32_16x16x32_bf16 v[136:139], v[228:231], v[208:211], v[136:139]
  ds_read_b64_tr_b16 v[224:225], v18 offset:16384
  v_mfma_f32_16x16x32_bf16 v[156:159], v[232:235], v[208:211], v[156:159]
  ds_read_b64_tr_b16 v[226:227], v23 offset:16384
  v_mfma_f32_16x16x32_bf16 v[176:179], v[208:211], v[236:239], v[176:179]
  ds_read_b128 v[188:191], v7 offset:24832
  s_waitcnt lgkmcnt(8)
  v_mfma_f32_16x16x32_bf16 v[140:143], v[228:231], v[212:215], v[140:143]
  ds_read_b128 v[192:195], v7 offset:25088
  v_mfma_f32_16x16x32_bf16 v[160:163], v[232:235], v[212:215], v[160:163]
  ds_read_b128 v[196:199], v7 offset:25344
  v_mfma_f32_16x16x32_bf16 v[180:183], v[212:215], v[236:239], v[180:183]
  s_waitcnt lgkmcnt(7)
  v_mfma_f32_16x16x32_bf16 v[128:131], v[216:219], v[184:187], v[128:131]
  s_waitcnt lgkmcnt(5)
  v_mfma_f32_16x16x32_bf16 v[148:151], v[220:223], v[184:187], v[148:151]
  ds_read_b64_tr_b16 v[228:229], v18 offset:20480
  s_waitcnt lgkmcnt(4)
  v_mfma_f32_16x16x32_bf16 v[168:171], v[184:187], v[224:227], v[168:171]
  ds_read_b64_tr_b16 v[230:231], v23 offset:20480
  s_waitcnt lgkmcnt(4)
  v_mfma_f32_16x16x32_bf16 v[132:135], v[216:219], v[188:191], v[132:135]
  ds_read_b128 v[200:203], v7 offset:28672
  v_mfma_f32_16x16x32_bf16 v[152:155], v[220:223], v[188:191], v[152:155]
  ds_read_b64_tr_b16 v[232:233], v18 offset:24576
  v_mfma_f32_16x16x32_bf16 v[172:175], v[188:191], v[224:227], v[172:175]
  ds_read_b64_tr_b16 v[234:235], v23 offset:24576
  s_waitcnt lgkmcnt(6)
  v_mfma_f32_16x16x32_bf16 v[136:139], v[216:219], v[192:195], v[136:139]
  ds_read_b64_tr_b16 v[236:237], v17 offset:24576
  v_mfma_f32_16x16x32_bf16 v[156:159], v[220:223], v[192:195], v[156:159]
  ds_read_b64_tr_b16 v[238:239], v22 offset:24576
  v_mfma_f32_16x16x32_bf16 v[176:179], v[192:195], v[224:227], v[176:179]
  ds_read_b128 v[204:207], v7 offset:28928
  s_waitcnt lgkmcnt(8)
  v_mfma_f32_16x16x32_bf16 v[140:143], v[216:219], v[196:199], v[140:143]
  ds_read_b128 v[208:211], v7 offset:29184
  v_mfma_f32_16x16x32_bf16 v[160:163], v[220:223], v[196:199], v[160:163]
  ds_read_b128 v[212:215], v7 offset:29440
  v_mfma_f32_16x16x32_bf16 v[180:183], v[196:199], v[224:227], v[180:183]
  s_waitcnt lgkmcnt(7)
  v_mfma_f32_16x16x32_bf16 v[128:131], v[228:231], v[200:203], v[128:131]
  s_barrier
  s_waitcnt lgkmcnt(5)
  v_mfma_f32_16x16x32_bf16 v[148:151], v[232:235], v[200:203], v[148:151]
  ds_read_b64_tr_b16 v[216:217], v17 offset:28672
  s_waitcnt lgkmcnt(4)
  v_mfma_f32_16x16x32_bf16 v[168:171], v[200:203], v[236:239], v[168:171]
  ds_read_b64_tr_b16 v[218:219], v22 offset:28672
  s_waitcnt lgkmcnt(4)
  v_mfma_f32_16x16x32_bf16 v[132:135], v[228:231], v[204:207], v[132:135]
  ds_read_b128 v[184:187], v7 offset:32768
  v_mfma_f32_16x16x32_bf16 v[152:155], v[232:235], v[204:207], v[152:155]
  ds_read_b64_tr_b16 v[220:221], v17 offset:0
  v_mfma_f32_16x16x32_bf16 v[172:175], v[204:207], v[236:239], v[172:175]
  ds_read_b64_tr_b16 v[222:223], v22 offset:0
  s_waitcnt lgkmcnt(6)
  v_mfma_f32_16x16x32_bf16 v[136:139], v[228:231], v[208:211], v[136:139]
  ds_read_b64_tr_b16 v[224:225], v17 offset:4096
  v_mfma_f32_16x16x32_bf16 v[156:159], v[232:235], v[208:211], v[156:159]
  ds_read_b64_tr_b16 v[226:227], v22 offset:4096
  v_mfma_f32_16x16x32_bf16 v[176:179], v[208:211], v[236:239], v[176:179]
  ds_read_b128 v[188:191], v7 offset:33024
  s_waitcnt lgkmcnt(8)
  v_mfma_f32_16x16x32_bf16 v[140:143], v[228:231], v[212:215], v[140:143]
  ds_read_b128 v[192:195], v7 offset:33280
  v_mfma_f32_16x16x32_bf16 v[160:163], v[232:235], v[212:215], v[160:163]
  ds_read_b128 v[196:199], v7 offset:33536
  v_mfma_f32_16x16x32_bf16 v[180:183], v[212:215], v[236:239], v[180:183]
  s_waitcnt lgkmcnt(7)
  v_mfma_f32_16x16x32_bf16 v[128:131], v[216:219], v[184:187], v[128:131]
  s_waitcnt lgkmcnt(5)
  v_mfma_f32_16x16x32_bf16 v[148:151], v[220:223], v[184:187], v[148:151]
  ds_read_b64_tr_b16 v[228:229], v17 offset:8192
  s_waitcnt lgkmcnt(4)
  v_mfma_f32_16x16x32_bf16 v[168:171], v[184:187], v[224:227], v[168:171]
  ds_read_b64_tr_b16 v[230:231], v22 offset:8192
  s_waitcnt lgkmcnt(4)
  v_mfma_f32_16x16x32_bf16 v[132:135], v[216:219], v[188:191], v[132:135]
  ds_read_b128 v[200:203], v7 offset:36864
  v_mfma_f32_16x16x32_bf16 v[152:155], v[220:223], v[188:191], v[152:155]
  ds_read_b64_tr_b16 v[232:233], v17 offset:12288
  v_mfma_f32_16x16x32_bf16 v[172:175], v[188:191], v[224:227], v[172:175]
  ds_read_b64_tr_b16 v[234:235], v22 offset:12288
  s_waitcnt lgkmcnt(6)
  v_mfma_f32_16x16x32_bf16 v[136:139], v[216:219], v[192:195], v[136:139]
  ds_read_b64_tr_b16 v[236:237], v17 offset:32768
  v_mfma_f32_16x16x32_bf16 v[156:159], v[220:223], v[192:195], v[156:159]
  ds_read_b64_tr_b16 v[238:239], v22 offset:32768
  v_mfma_f32_16x16x32_bf16 v[176:179], v[192:195], v[224:227], v[176:179]
  ds_read_b128 v[204:207], v7 offset:37120
  s_waitcnt lgkmcnt(8)
  v_mfma_f32_16x16x32_bf16 v[140:143], v[216:219], v[196:199], v[140:143]
  ds_read_b128 v[208:211], v7 offset:37376
  v_mfma_f32_16x16x32_bf16 v[160:163], v[220:223], v[196:199], v[160:163]
  ds_read_b128 v[212:215], v7 offset:37632
  v_mfma_f32_16x16x32_bf16 v[180:183], v[196:199], v[224:227], v[180:183]
  s_waitcnt lgkmcnt(7)
  v_mfma_f32_16x16x32_bf16 v[128:131], v[228:231], v[200:203], v[128:131]
  s_barrier
  s_waitcnt lgkmcnt(5)
  v_mfma_f32_16x16x32_bf16 v[148:151], v[232:235], v[200:203], v[148:151]
  ds_read_b64_tr_b16 v[216:217], v17 offset:36864
  s_waitcnt lgkmcnt(4)
  v_mfma_f32_16x16x32_bf16 v[168:171], v[200:203], v[236:239], v[168:171]
  ds_read_b64_tr_b16 v[218:219], v22 offset:36864
  s_waitcnt lgkmcnt(4)
  v_mfma_f32_16x16x32_bf16 v[132:135], v[228:231], v[204:207], v[132:135]
  ds_read_b128 v[184:187], v7 offset:40960
  v_mfma_f32_16x16x32_bf16 v[152:155], v[232:235], v[204:207], v[152:155]
  ds_read_b64_tr_b16 v[220:221], v17 offset:40960
  v_mfma_f32_16x16x32_bf16 v[172:175], v[204:207], v[236:239], v[172:175]
  ds_read_b64_tr_b16 v[222:223], v22 offset:40960
  s_waitcnt lgkmcnt(6)
  v_mfma_f32_16x16x32_bf16 v[136:139], v[228:231], v[208:211], v[136:139]
  ds_read_b64_tr_b16 v[224:225], v17 offset:45056
  v_mfma_f32_16x16x32_bf16 v[156:159], v[232:235], v[208:211], v[156:159]
  ds_read_b64_tr_b16 v[226:227], v22 offset:45056
  v_mfma_f32_16x16x32_bf16 v[176:179], v[208:211], v[236:239], v[176:179]
  ds_read_b128 v[188:191], v7 offset:41216
  s_waitcnt lgkmcnt(8)
  v_mfma_f32_16x16x32_bf16 v[140:143], v[228:231], v[212:215], v[140:143]
  ds_read_b128 v[192:195], v7 offset:41472
  v_mfma_f32_16x16x32_bf16 v[160:163], v[232:235], v[212:215], v[160:163]
  ds_read_b128 v[196:199], v7 offset:41728
  v_mfma_f32_16x16x32_bf16 v[180:183], v[212:215], v[236:239], v[180:183]
  s_waitcnt lgkmcnt(7)
  v_mfma_f32_16x16x32_bf16 v[128:131], v[216:219], v[184:187], v[128:131]
  s_waitcnt lgkmcnt(5)
  v_mfma_f32_16x16x32_bf16 v[148:151], v[220:223], v[184:187], v[148:151]
  ds_read_b64_tr_b16 v[228:229], v17 offset:49152
  s_waitcnt lgkmcnt(4)
  v_mfma_f32_16x16x32_bf16 v[168:171], v[184:187], v[224:227], v[168:171]
  ds_read_b64_tr_b16 v[230:231], v22 offset:49152
  s_waitcnt lgkmcnt(4)
  v_mfma_f32_16x16x32_bf16 v[132:135], v[216:219], v[188:191], v[132:135]
  ds_read_b128 v[200:203], v7 offset:45056
  v_mfma_f32_16x16x32_bf16 v[152:155], v[220:223], v[188:191], v[152:155]
  ds_read_b64_tr_b16 v[232:233], v17 offset:53248
  v_mfma_f32_16x16x32_bf16 v[172:175], v[188:191], v[224:227], v[172:175]
  ds_read_b64_tr_b16 v[234:235], v22 offset:53248
  s_waitcnt lgkmcnt(6)
  v_mfma_f32_16x16x32_bf16 v[136:139], v[216:219], v[192:195], v[136:139]
  ds_read_b64_tr_b16 v[236:237], v17 offset:57344
  v_mfma_f32_16x16x32_bf16 v[156:159], v[220:223], v[192:195], v[156:159]
  ds_read_b64_tr_b16 v[238:239], v22 offset:57344
  v_mfma_f32_16x16x32_bf16 v[176:179], v[192:195], v[224:227], v[176:179]
  ds_read_b128 v[204:207], v7 offset:45312
  s_waitcnt lgkmcnt(8)
  v_mfma_f32_16x16x32_bf16 v[140:143], v[216:219], v[196:199], v[140:143]
  ds_read_b128 v[208:211], v7 offset:45568
  v_mfma_f32_16x16x32_bf16 v[160:163], v[220:223], v[196:199], v[160:163]
  ds_read_b128 v[212:215], v7 offset:45824
  v_mfma_f32_16x16x32_bf16 v[180:183], v[196:199], v[224:227], v[180:183]
  s_waitcnt lgkmcnt(7)
  v_mfma_f32_16x16x32_bf16 v[128:131], v[228:231], v[200:203], v[128:131]
  s_barrier
  s_waitcnt lgkmcnt(5)
  v_mfma_f32_16x16x32_bf16 v[148:151], v[232:235], v[200:203], v[148:151]
  ds_read_b64_tr_b16 v[216:217], v17 offset:61440
  s_waitcnt lgkmcnt(4)
  v_mfma_f32_16x16x32_bf16 v[168:171], v[200:203], v[236:239], v[168:171]
  ds_read_b64_tr_b16 v[218:219], v22 offset:61440
  s_waitcnt lgkmcnt(4)
  v_mfma_f32_16x16x32_bf16 v[132:135], v[228:231], v[204:207], v[132:135]
  ds_read_b128 v[184:187], v7 offset:49152
  v_mfma_f32_16x16x32_bf16 v[152:155], v[232:235], v[204:207], v[152:155]
  ds_read_b64_tr_b16 v[220:221], v18 offset:0
  v_mfma_f32_16x16x32_bf16 v[172:175], v[204:207], v[236:239], v[172:175]
  ds_read_b64_tr_b16 v[222:223], v23 offset:0
  s_waitcnt lgkmcnt(6)
  v_mfma_f32_16x16x32_bf16 v[136:139], v[228:231], v[208:211], v[136:139]
  ds_read_b64_tr_b16 v[224:225], v18 offset:4096
  v_mfma_f32_16x16x32_bf16 v[156:159], v[232:235], v[208:211], v[156:159]
  ds_read_b64_tr_b16 v[226:227], v23 offset:4096
  v_mfma_f32_16x16x32_bf16 v[176:179], v[208:211], v[236:239], v[176:179]
  ds_read_b128 v[188:191], v7 offset:49408
  s_waitcnt lgkmcnt(8)
  v_mfma_f32_16x16x32_bf16 v[140:143], v[228:231], v[212:215], v[140:143]
  ds_read_b128 v[192:195], v7 offset:49664
  v_mfma_f32_16x16x32_bf16 v[160:163], v[232:235], v[212:215], v[160:163]
  ds_read_b128 v[196:199], v7 offset:49920
  v_mfma_f32_16x16x32_bf16 v[180:183], v[212:215], v[236:239], v[180:183]
  s_waitcnt lgkmcnt(7)
  v_mfma_f32_16x16x32_bf16 v[128:131], v[216:219], v[184:187], v[128:131]
  s_waitcnt lgkmcnt(5)
  v_mfma_f32_16x16x32_bf16 v[148:151], v[220:223], v[184:187], v[148:151]
  ds_read_b64_tr_b16 v[228:229], v18 offset:8192
  s_waitcnt lgkmcnt(4)
  v_mfma_f32_16x16x32_bf16 v[168:171], v[184:187], v[224:227], v[168:171]
  ds_read_b64_tr_b16 v[230:231], v23 offset:8192
  s_waitcnt lgkmcnt(4)
  v_mfma_f32_16x16x32_bf16 v[132:135], v[216:219], v[188:191], v[132:135]
  ds_read_b128 v[200:203], v7 offset:53248
  v_mfma_f32_16x16x32_bf16 v[152:155], v[220:223], v[188:191], v[152:155]
  ds_read_b64_tr_b16 v[232:233], v18 offset:12288
  v_mfma_f32_16x16x32_bf16 v[172:175], v[188:191], v[224:227], v[172:175]
  ds_read_b64_tr_b16 v[234:235], v23 offset:12288
  s_waitcnt lgkmcnt(6)
  v_mfma_f32_16x16x32_bf16 v[136:139], v[216:219], v[192:195], v[136:139]
  ds_read_b64_tr_b16 v[236:237], v18 offset:16384
  v_mfma_f32_16x16x32_bf16 v[156:159], v[220:223], v[192:195], v[156:159]
  ds_read_b64_tr_b16 v[238:239], v23 offset:16384
  v_mfma_f32_16x16x32_bf16 v[176:179], v[192:195], v[224:227], v[176:179]
  ds_read_b128 v[204:207], v7 offset:53504
  s_waitcnt lgkmcnt(8)
  v_mfma_f32_16x16x32_bf16 v[140:143], v[216:219], v[196:199], v[140:143]
  ds_read_b128 v[208:211], v7 offset:53760
  v_mfma_f32_16x16x32_bf16 v[160:163], v[220:223], v[196:199], v[160:163]
  ds_read_b128 v[212:215], v7 offset:54016
  v_mfma_f32_16x16x32_bf16 v[180:183], v[196:199], v[224:227], v[180:183]
  s_waitcnt lgkmcnt(7)
  v_mfma_f32_16x16x32_bf16 v[128:131], v[228:231], v[200:203], v[128:131]
  s_barrier
  s_waitcnt lgkmcnt(5)
  v_mfma_f32_16x16x32_bf16 v[148:151], v[232:235], v[200:203], v[148:151]
  ds_read_b64_tr_b16 v[216:217], v18 offset:20480
  s_waitcnt lgkmcnt(4)
  v_mfma_f32_16x16x32_bf16 v[168:171], v[200:203], v[236:239], v[168:171]
  ds_read_b64_tr_b16 v[218:219], v23 offset:20480
  s_waitcnt lgkmcnt(4)
  v_mfma_f32_16x16x32_bf16 v[132:135], v[228:231], v[204:207], v[132:135]
  ds_read_b128 v[184:187], v7 offset:57344
  v_mfma_f32_16x16x32_bf16 v[152:155], v[232:235], v[204:207], v[152:155]
  ds_read_b64_tr_b16 v[220:221], v17 offset:0
  v_mfma_f32_16x16x32_bf16 v[172:175], v[204:207], v[236:239], v[172:175]
  ds_read_b64_tr_b16 v[222:223], v22 offset:0
  s_waitcnt lgkmcnt(6)
  v_mfma_f32_16x16x32_bf16 v[136:139], v[228:231], v[208:211], v[136:139]
  ds_read_b64_tr_b16 v[224:225], v17 offset:4096
  v_mfma_f32_16x16x32_bf16 v[156:159], v[232:235], v[208:211], v[156:159]
  ds_read_b64_tr_b16 v[226:227], v22 offset:4096
  v_mfma_f32_16x16x32_bf16 v[176:179], v[208:211], v[236:239], v[176:179]
  ds_read_b128 v[188:191], v7 offset:57600
  s_waitcnt lgkmcnt(8)
  v_mfma_f32_16x16x32_bf16 v[140:143], v[228:231], v[212:215], v[140:143]
  ds_read_b128 v[192:195], v7 offset:57856
  v_mfma_f32_16x16x32_bf16 v[160:163], v[232:235], v[212:215], v[160:163]
  ds_read_b128 v[196:199], v7 offset:58112
  v_mfma_f32_16x16x32_bf16 v[180:183], v[212:215], v[236:239], v[180:183]
  s_waitcnt lgkmcnt(7)
  v_mfma_f32_16x16x32_bf16 v[128:131], v[216:219], v[184:187], v[128:131]
  s_waitcnt lgkmcnt(5)
  v_mfma_f32_16x16x32_bf16 v[148:151], v[220:223], v[184:187], v[148:151]
  ds_read_b64_tr_b16 v[228:229], v17 offset:8192
  s_waitcnt lgkmcnt(4)
  v_mfma_f32_16x16x32_bf16 v[168:171], v[184:187], v[224:227], v[168:171]
  ds_read_b64_tr_b16 v[230:231], v22 offset:8192
  s_waitcnt lgkmcnt(4)
  v_mfma_f32_16x16x32_bf16 v[132:135], v[216:219], v[188:191], v[132:135]
  ds_read_b128 v[200:203], v7 offset:61440
  v_mfma_f32_16x16x32_bf16 v[152:155], v[220:223], v[188:191], v[152:155]
  ds_read_b64_tr_b16 v[232:233], v17 offset:24576
  v_mfma_f32_16x16x32_bf16 v[172:175], v[188:191], v[224:227], v[172:175]
  ds_read_b64_tr_b16 v[234:235], v22 offset:24576
  s_waitcnt lgkmcnt(6)
  v_mfma_f32_16x16x32_bf16 v[136:139], v[216:219], v[192:195], v[136:139]
  ds_read_b64_tr_b16 v[236:237], v17 offset:28672
  v_mfma_f32_16x16x32_bf16 v[156:159], v[220:223], v[192:195], v[156:159]
  ds_read_b64_tr_b16 v[238:239], v22 offset:28672
  v_mfma_f32_16x16x32_bf16 v[176:179], v[192:195], v[224:227], v[176:179]
  ds_read_b128 v[204:207], v7 offset:61696
  s_waitcnt lgkmcnt(8)
  v_mfma_f32_16x16x32_bf16 v[140:143], v[216:219], v[196:199], v[140:143]
  ds_read_b128 v[208:211], v7 offset:61952
  v_mfma_f32_16x16x32_bf16 v[160:163], v[220:223], v[196:199], v[160:163]
  ds_read_b128 v[212:215], v7 offset:62208
  v_mfma_f32_16x16x32_bf16 v[180:183], v[196:199], v[224:227], v[180:183]
  s_waitcnt lgkmcnt(7)
  v_mfma_f32_16x16x32_bf16 v[128:131], v[228:231], v[200:203], v[128:131]
  s_waitcnt lgkmcnt(5)
  v_mfma_f32_16x16x32_bf16 v[148:151], v[232:235], v[200:203], v[148:151]
  s_waitcnt lgkmcnt(3)
  v_mfma_f32_16x16x32_bf16 v[168:171], v[200:203], v[236:239], v[168:171]
  s_waitcnt lgkmcnt(2)
  v_mfma_f32_16x16x32_bf16 v[132:135], v[228:231], v[204:207], v[132:135]
  v_mfma_f32_16x16x32_bf16 v[152:155], v[232:235], v[204:207], v[152:155]
  v_mfma_f32_16x16x32_bf16 v[172:175], v[204:207], v[236:239], v[172:175]
  s_waitcnt lgkmcnt(1)
  v_mfma_f32_16x16x32_bf16 v[136:139], v[228:231], v[208:211], v[136:139]
  v_mfma_f32_16x16x32_bf16 v[156:159], v[232:235], v[208:211], v[156:159]
  v_mfma_f32_16x16x32_bf16 v[176:179], v[208:211], v[236:239], v[176:179]
  s_waitcnt lgkmcnt(0)
  v_mfma_f32_16x16x32_bf16 v[140:143], v[228:231], v[212:215], v[140:143]
  v_mfma_f32_16x16x32_bf16 v[160:163], v[232:235], v[212:215], v[160:163]
  v_mfma_f32_16x16x32_bf16 v[180:183], v[212:215], v[236:239], v[180:183]
  s_barrier
  s_nop 0
  ds_read_b128 v[80:83], v126 offset:0
  ds_read_b128 v[84:87], v126 offset:256
  ds_read2_b32 v[66:67], v122 offset0:16 offset1:144
  ds_read2_b32 v[68:69], v122 offset0:32 offset1:160
  ds_read2_b32 v[70:71], v122 offset0:48 offset1:176
  ds_read2_b32 v[72:73], v122 offset0:64 offset1:192
  ds_read_b32 v88, v127 offset:512
  ds_read_b128 v[188:191], v120 offset:576
  ds_read_b128 v[208:211], v120 offset:64
  ds_read_b128 v[192:195], v120 offset:640
  ds_read_b128 v[212:215], v120 offset:128
  ds_read_b128 v[196:199], v120 offset:704
  ds_read_b128 v[216:219], v120 offset:192
  ds_read_b128 v[200:203], v120 offset:768
  ds_read_b128 v[220:223], v120 offset:256
  ds_read_b32 v124, v123 offset:64
  v_lshlrev_b32_e64 v31, 4, v1
  s_add_u32 s53, s47, 77824
  v_add_u32 v31, s53, v31
  s_waitcnt lgkmcnt(13)
  v_fmac_f32 v148, v84, v67
  v_fmac_f32 v149, v85, v67
  v_fmac_f32 v150, v86, v67
  v_fmac_f32 v151, v87, v67
  v_fmac_f32 v128, v80, v67
  v_fmac_f32 v129, v81, v67
  v_fmac_f32 v130, v82, v67
  v_fmac_f32 v131, v83, v67
  v_mul_f32 v148, v148, v66
  v_mul_f32 v149, v149, v66
  v_mul_f32 v150, v150, v66
  v_mul_f32 v151, v151, v66
PAD_11:
  s_cbranch_execz L_TRAMP
  s_nop 0
  s_waitcnt lgkmcnt(12)
  v_fmac_f32 v152, v84, v69
  v_fmac_f32 v153, v85, v69
  v_fmac_f32 v154, v86, v69
  v_fmac_f32 v155, v87, v69
  v_fmac_f32 v132, v80, v69
  v_fmac_f32 v133, v81, v69
  v_fmac_f32 v134, v82, v69
  v_fmac_f32 v135, v83, v69
  v_mul_f32 v152, v152, v68
  v_mul_f32 v153, v153, v68
  v_mul_f32 v154, v154, v68
  v_mul_f32 v155, v155, v68
  s_waitcnt lgkmcnt(11)
  v_fmac_f32 v156, v84, v71
  v_fmac_f32 v157, v85, v71
  v_fmac_f32 v158, v86, v71
  v_fmac_f32 v159, v87, v71
  v_fmac_f32 v136, v80, v71
  v_fmac_f32 v137, v81, v71
  v_fmac_f32 v138, v82, v71
  v_fmac_f32 v139, v83, v71
  v_mul_f32 v156, v156, v70
  v_mul_f32 v157, v157, v70
  v_mul_f32 v158, v158, v70
  v_mul_f32 v159, v159, v70
  s_waitcnt lgkmcnt(10)
  v_fmac_f32 v160, v84, v73
  v_fmac_f32 v161, v85, v73
  v_fmac_f32 v162, v86, v73
  v_fmac_f32 v163, v87, v73
  v_fmac_f32 v140, v80, v73
  v_fmac_f32 v141, v81, v73
  v_fmac_f32 v142, v82, v73
  v_fmac_f32 v143, v83, v73
  v_mul_f32 v160, v160, v72
  v_mul_f32 v161, v161, v72
  v_mul_f32 v162, v162, v72
  v_mul_f32 v163, v163, v72
  s_waitcnt lgkmcnt(8)
  v_fmac_f32 v168, v188, v88
  v_fmac_f32 v169, v189, v88
  v_fmac_f32 v170, v190, v88
  v_fmac_f32 v171, v191, v88
  s_waitcnt lgkmcnt(6)
  v_fmac_f32 v172, v192, v88
  v_fmac_f32 v173, v193, v88
  v_fmac_f32 v174, v194, v88
  v_fmac_f32 v175, v195, v88
  s_waitcnt lgkmcnt(4)
  v_fmac_f32 v176, v196, v88
  v_fmac_f32 v177, v197, v88
  v_fmac_f32 v178, v198, v88
  v_fmac_f32 v179, v199, v88
  s_waitcnt lgkmcnt(2)
  v_fmac_f32 v180, v200, v88
  v_fmac_f32 v181, v201, v88
  v_fmac_f32 v182, v202, v88
  v_fmac_f32 v183, v203, v88
  v_mul_f32 v168, v168, v208
  v_mul_f32 v169, v169, v209
  v_mul_f32 v170, v170, v210
  v_mul_f32 v171, v171, v211
  v_mul_f32 v172, v172, v212
  v_mul_f32 v173, v173, v213
  v_mul_f32 v174, v174, v214
  v_mul_f32 v175, v175, v215
  v_mul_f32 v176, v176, v216
  v_mul_f32 v177, v177, v217
  v_mul_f32 v178, v178, v218
  v_mul_f32 v179, v179, v219
  s_waitcnt lgkmcnt(1)
  v_mul_f32 v180, v180, v220
  v_mul_f32 v181, v181, v221
  v_mul_f32 v182, v182, v222
  v_mul_f32 v183, v183, v223
  v_cvt_pk_bf16_f32 v148, v148, v149
  v_cvt_pk_bf16_f32 v149, v150, v151
  v_cvt_pk_bf16_f32 v132, v132, v133
  v_cvt_pk_bf16_f32 v133, v134, v135
  v_cvt_pk_bf16_f32 v152, v152, v153
  v_cvt_pk_bf16_f32 v153, v154, v155
  v_mfma_f32_16x16x16_bf16 v[236:239], v[148:149], v[132:133], 0
  v_cvt_pk_bf16_f32 v136, v136, v137
  v_cvt_pk_bf16_f32 v137, v138, v139
  v_mfma_f32_16x16x16_bf16 v[232:235], v[152:153], v[132:133], 0
  v_cvt_pk_bf16_f32 v156, v156, v157
  v_cvt_pk_bf16_f32 v157, v158, v159
  v_mfma_f32_16x16x16_bf16 v[244:247], v[152:153], v[136:137], 0
  v_cvt_pk_bf16_f32 v140, v140, v141
  v_cvt_pk_bf16_f32 v141, v142, v143
  v_mfma_f32_16x16x16_bf16 v[240:243], v[156:157], v[136:137], 0
  v_cvt_pk_bf16_f32 v160, v160, v161
  v_cvt_pk_bf16_f32 v161, v162, v163
  v_mfma_f32_16x16x16_bf16 v[252:255], v[156:157], v[140:141], 0
  v_cvt_pk_bf16_f32 v128, v128, v129
  v_cvt_pk_bf16_f32 v129, v130, v131
  v_mfma_f32_16x16x16_bf16 v[248:251], v[160:161], v[140:141], 0
  v_cvt_pk_bf16_f32 v168, v168, v169
  v_cvt_pk_bf16_f32 v169, v170, v171
  v_mfma_f32_16x16x16_bf16 v[224:227], v[148:149], v[128:129], 0
  v_cvt_pk_bf16_f32 v172, v172, v173
  v_cvt_pk_bf16_f32 v173, v174, v175
  v_cvt_pk_bf16_f32 v176, v176, v177
  v_cvt_pk_bf16_f32 v177, v178, v179
  v_cvt_pk_bf16_f32 v180, v180, v181
  v_cvt_pk_bf16_f32 v181, v182, v183
  v_cndmask_b32 v232, v232, v233, s[84:85]
  v_cndmask_b32 v236, v236, v237, s[84:85]
  v_cndmask_b32 v234, v234, v235, s[84:85]
  v_cndmask_b32 v238, v238, v239, s[84:85]
  v_cndmask_b32 v97, v236, v232, s[86:87]
  v_cndmask_b32 v101, v238, v234, s[88:89]
  v_cndmask_b32 v240, v240, v241, s[84:85]
  v_cndmask_b32 v244, v244, v245, s[84:85]
  v_cndmask_b32 v242, v242, v243, s[84:85]
  v_cndmask_b32 v246, v246, v247, s[84:85]
  v_cndmask_b32 v98, v244, v240, s[86:87]
  v_cndmask_b32 v102, v246, v242, s[88:89]
  s_barrier
  s_nop 0
  ds_read_b128 v[144:147], v31
  v_cndmask_b32 v248, v248, v249, s[84:85]
  v_cndmask_b32 v252, v252, v253, s[84:85]
  v_cndmask_b32 v250, v250, v251, s[84:85]
  v_cndmask_b32 v254, v254, v255, s[84:85]
  v_cndmask_b32 v99, v252, v248, s[86:87]
  v_cndmask_b32 v103, v254, v250, s[88:89]
  s_waitcnt lgkmcnt(1)
  v_mul_f32 v124, 0x3eb8aa3b, v124
  s_waitcnt lgkmcnt(0)
  v_mfma_f32_16x16x16_bf16 v[228:231], v[144:145], v[128:129], 0
  v_permlane32_swap_b32 v98, v99
  v_permlane32_swap_b32 v102, v103
  s_cmp_lg_u32 s46, 0
  s_cbranch_scc1 CSK_12
  s_nop 0
  s_nop 3
  v_mov_b32 v228, 0xf149f2ca
  v_mov_b32 v229, 0xf149f2ca
  v_mov_b32 v230, 0xf149f2ca
  v_mov_b32 v231, 0xf149f2ca
CSK_12:
  v_cndmask_b32 v224, v224, v225, s[84:85]
  s_nop 0
  s_nop 2
  v_cndmask_b32 v228, v228, v229, s[84:85]
  v_cndmask_b32 v226, v226, v227, s[84:85]
  v_cndmask_b32 v230, v230, v231, s[84:85]
  v_cndmask_b32 v96, v228, v224, s[86:87]
  v_cndmask_b32 v100, v230, v226, s[88:89]
  s_nop 0
  v_permlane32_swap_b32 v96, v97
  v_permlane32_swap_b32 v100, v101
  s_nop 0
  v_permlane16_swap_b32 v96, v98
  v_permlane16_swap_b32 v97, v99
  v_permlane16_swap_b32 v100, v102
  v_permlane16_swap_b32 v101, v103
  v_max3_f32 v29, v96, v98, v97
  v_max3_f32 v30, v99, v100, v102
  v_max3_f32 v29, v29, v101, v103
  v_max_f32_e64 v29, v29, v30
  v_mul_f32 v125, -v29, v124
  v_pk_fma_f32 v[96:97], v[96:97], v[124:125], v[124:125] op_sel:[0,0,1] op_sel_hi:[1,0,1]
  v_pk_fma_f32 v[98:99], v[98:99], v[124:125], v[124:125] op_sel:[0,0,1] op_sel_hi:[1,0,1]
  v_pk_fma_f32 v[100:101], v[100:101], v[124:125], v[124:125] op_sel:[0,0,1] op_sel_hi:[1,0,1]
  v_pk_fma_f32 v[102:103], v[102:103], v[124:125], v[124:125] op_sel:[0,0,1] op_sel_hi:[1,0,1]
  v_exp_f32 v96, v96
  v_exp_f32 v97, v97
  v_exp_f32 v98, v98
  v_exp_f32 v99, v99
  v_exp_f32 v100, v100
  v_exp_f32 v101, v101
  v_exp_f32 v102, v102
  v_exp_f32 v103, v103
  v_pk_add_f32 v[112:113], v[96:97], v[98:99]
  v_pk_add_f32 v[114:115], v[100:101], v[102:103]
  v_pk_add_f32 v[112:113], v[112:113], v[114:115]
  v_add_f32 v124, v112, v113
  v_rcp_f32 v124, v124
  s_nop 0
  s_nop 0
  v_pk_mul_f32 v[96:97], v[96:97], v[124:125] op_sel_hi:[1,0]
  v_pk_mul_f32 v[98:99], v[98:99], v[124:125] op_sel_hi:[1,0]
  v_pk_mul_f32 v[100:101], v[100:101], v[124:125] op_sel_hi:[1,0]
  v_pk_mul_f32 v[102:103], v[102:103], v[124:125] op_sel_hi:[1,0]
  v_cvt_pk_bf16_f32 v104, v96, v100
  v_cvt_pk_bf16_f32 v106, v98, v102
  v_cvt_pk_bf16_f32 v105, v97, v101
  v_cvt_pk_bf16_f32 v107, v99, v103
  v_permlane16_swap_b32 v104, v106
  s_nop 0
  v_permlane16_swap_b32 v105, v107
  s_nop 1
  v_permlane32_swap_b32 v104, v105
  v_permlane32_swap_b32 v106, v107
  v_perm_b32 v184, v104, v104, v92
  v_perm_b32 v185, v104, v104, v93
  v_perm_b32 v186, v104, v104, v94
  v_perm_b32 v187, v104, v104, v95
  v_perm_b32 v188, v105, v105, v92
  v_perm_b32 v189, v105, v105, v93
  v_perm_b32 v190, v105, v105, v94
  v_perm_b32 v191, v105, v105, v95
  v_mfma_f32_16x16x16_bf16 v[200:203], v[168:169], v[184:185], 0
  v_mfma_f32_16x16x16_bf16 v[200:203], v[146:147], v[186:187], v[200:203]
  v_perm_b32 v192, v106, v106, v92
  v_perm_b32 v193, v106, v106, v93
  v_perm_b32 v194, v106, v106, v94
  v_perm_b32 v195, v106, v106, v95
  v_mfma_f32_16x16x16_bf16 v[204:207], v[172:173], v[188:189], 0
  v_mfma_f32_16x16x16_bf16 v[204:207], v[168:169], v[190:191], v[204:207]
  v_perm_b32 v196, v107, v107, v92
  v_perm_b32 v197, v107, v107, v93
  v_perm_b32 v198, v107, v107, v94
  v_perm_b32 v199, v107, v107, v95
  v_mfma_f32_16x16x16_bf16 v[208:211], v[176:177], v[192:193], 0
  v_mfma_f32_16x16x16_bf16 v[208:211], v[172:173], v[194:195], v[208:211]
  v_mfma_f32_16x16x16_bf16 v[212:215], v[180:181], v[196:197], 0
  v_mfma_f32_16x16x16_bf16 v[212:215], v[176:177], v[198:199], v[212:215]
  v_cvt_pk_bf16_f32 v48, v200, v201
  v_cvt_pk_bf16_f32 v49, v202, v203
  v_cvt_pk_bf16_f32 v50, v204, v205
  v_cvt_pk_bf16_f32 v51, v206, v207
  s_nop 0
  v_permlane32_swap_b32 v48, v50
  v_permlane32_swap_b32_e64 v49, v51
  v_cvt_pk_bf16_f32 v52, v208, v209
  v_cvt_pk_bf16_f32 v53, v210, v211
  v_cvt_pk_bf16_f32 v54, v212, v213
  v_cvt_pk_bf16_f32 v55, v214, v215
  s_nop 0
  v_permlane32_swap_b32 v52, v54
  v_permlane32_swap_b32_e64 v53, v55
  buffer_store_dwordx4 v[48:51], v121, s[4:7], s65 offen offset:0
  buffer_store_dwordx4 v[52:55], v121, s[4:7], s65 offen offset:512
  s_barrier
  s_nop 0
  ds_read_b64_tr_b16 v[128:129], v10 offset:20480
  ds_read_b64_tr_b16 v[130:131], v13 offset:20480
  ds_read_b64_tr_b16 v[132:133], v10 offset:22528
  ds_read_b64_tr_b16 v[134:135], v13 offset:22528
  ds_read_b64_tr_b16 v[136:137], v10 offset:24576
  ds_read_b64_tr_b16 v[138:139], v13 offset:24576
  ds_read_b64_tr_b16 v[140:141], v10 offset:26624
  ds_read_b64_tr_b16 v[142:143], v13 offset:26624
  ds_read_b64_tr_b16 v[144:145], v10 offset:28672
  ds_read_b64_tr_b16 v[146:147], v13 offset:28672
  ds_read_b64_tr_b16 v[148:149], v10 offset:30720
  ds_read_b64_tr_b16 v[150:151], v13 offset:30720
  ds_read_b64_tr_b16 v[152:153], v10 offset:32768
  ds_read_b64_tr_b16 v[154:155], v13 offset:32768
  ds_read_b64_tr_b16 v[156:157], v10 offset:34816
  ds_read_b64_tr_b16 v[158:159], v13 offset:34816
  ds_read_b64_tr_b16 v[160:161], v12 offset:24576
  ds_read_b64_tr_b16 v[162:163], v15 offset:24576
  ds_read_b64_tr_b16 v[164:165], v12 offset:26624
  ds_read_b64_tr_b16 v[166:167], v15 offset:26624
  ds_read_b64_tr_b16 v[168:169], v10 offset:36864
  ds_read_b64_tr_b16 v[170:171], v13 offset:36864
  ds_read_b64_tr_b16 v[172:173], v10 offset:38912
  ds_read_b64_tr_b16 v[174:175], v13 offset:38912
  ds_read_b64_tr_b16 v[176:177], v10 offset:40960
  ds_read_b64_tr_b16 v[178:179], v13 offset:40960
  ds_read_b64_tr_b16 v[180:181], v10 offset:43008
  ds_read_b64_tr_b16 v[182:183], v13 offset:43008
  ds_read_b64_tr_b16 v[184:185], v10 offset:45056
  ds_read_b64_tr_b16 v[186:187], v13 offset:45056
  ds_read_b64_tr_b16 v[188:189], v10 offset:47104
  ds_read_b64_tr_b16 v[190:191], v13 offset:47104
  ds_read_b64_tr_b16 v[192:193], v10 offset:49152
  ds_read_b64_tr_b16 v[194:195], v13 offset:49152
  ds_read_b64_tr_b16 v[196:197], v10 offset:51200
  ds_read_b64_tr_b16 v[198:199], v13 offset:51200
  ds_read_b64_tr_b16 v[200:201], v11 offset:32768
  ds_read_b64_tr_b16 v[202:203], v14 offset:32768
  ds_read_b64_tr_b16 v[204:205], v11 offset:34816
  ds_read_b64_tr_b16 v[206:207], v14 offset:34816
  s_waitcnt vmcnt(0)
  s_barrier
  ds_write_b128 v121, v[48:51] offset:0
  ds_write_b128 v121, v[52:55] offset:512
  v_and_b32_e64 v29, 31, v1
  v_lshl_add_u32 v29, s61, 5, v29
  v_lshlrev_b32 v7, 4, v29
  v_lshrrev_b32 v30, 5, v1
  v_mul_u32_u24 v30, 1024, v30
  v_add_u32_e64 v7, v7, v30
  v_add_u32 v9, 0x20000, v7
  v_add_u32 v8, 0x10000, v7
  ds_read_b64_tr_b16 v[208:209], v11 offset:36864
  ds_read_b64_tr_b16 v[210:211], v14 offset:36864
  ds_read_b64_tr_b16 v[212:213], v11 offset:38912
  ds_read_b64_tr_b16 v[214:215], v14 offset:38912
  ds_read_b64_tr_b16 v[216:217], v11 offset:40960
  ds_read_b64_tr_b16 v[218:219], v14 offset:40960
  ds_read_b64_tr_b16 v[220:221], v11 offset:43008
  ds_read_b64_tr_b16 v[222:223], v14 offset:43008
  ds_read_b64_tr_b16 v[224:225], v11 offset:45056
  ds_read_b64_tr_b16 v[226:227], v14 offset:45056
  ds_read_b64_tr_b16 v[228:229], v11 offset:47104
  ds_read_b64_tr_b16 v[230:231], v14 offset:47104
  ds_read_b64_tr_b16 v[232:233], v11 offset:49152
  ds_read_b64_tr_b16 v[234:235], v14 offset:49152
  ds_read_b64_tr_b16 v[236:237], v11 offset:51200
  ds_read_b64_tr_b16 v[238:239], v14 offset:51200
  ds_read_b64_tr_b16 v[240:241], v11 offset:53248
  ds_read_b64_tr_b16 v[242:243], v14 offset:53248
  ds_read_b64_tr_b16 v[244:245], v11 offset:55296
  ds_read_b64_tr_b16 v[246:247], v14 offset:55296
  ds_read_b64_tr_b16 v[248:249], v11 offset:57344
  ds_read_b64_tr_b16 v[250:251], v14 offset:57344
  ds_read_b64_tr_b16 v[252:253], v11 offset:59392
  ds_read_b64_tr_b16 v[254:255], v14 offset:59392
  s_waitcnt lgkmcnt(0)
  s_barrier
  s_barrier
  ds_read_b128 v[96:99], v7 offset:0
  ds_read_b128 v[100:103], v7 offset:2048
  ds_read_b128 v[104:107], v7 offset:4096
  s_waitcnt lgkmcnt(2)
  v_mfma_f32_32x32x16_bf16 v[32:47], v[128:131], v[96:99], v[32:47]
  ds_read_b128 v[108:111], v7 offset:6144
  s_waitcnt lgkmcnt(2)
  v_mfma_f32_32x32x16_bf16 v[32:47], v[132:135], v[100:103], v[32:47]
  s_barrier
  ds_read_b128 v[96:99], v7 offset:8192
  s_waitcnt lgkmcnt(2)
  v_mfma_f32_32x32x16_bf16 v[32:47], v[136:139], v[104:107], v[32:47]
  ds_read_b128 v[100:103], v7 offset:10240
  s_waitcnt lgkmcnt(2)
  v_mfma_f32_32x32x16_bf16 v[32:47], v[140:143], v[108:111], v[32:47]
  ds_read_b128 v[104:107], v7 offset:12288
  s_waitcnt lgkmcnt(2)
  v_mfma_f32_32x32x16_bf16 v[32:47], v[144:147], v[96:99], v[32:47]
  ds_read_b128 v[108:111], v7 offset:14336
  s_waitcnt lgkmcnt(2)
  v_mfma_f32_32x32x16_bf16 v[32:47], v[148:151], v[100:103], v[32:47]
  s_barrier
  ds_read_b128 v[96:99], v7 offset:16384
  s_waitcnt lgkmcnt(2)
  v_mfma_f32_32x32x16_bf16 v[32:47], v[152:155], v[104:107], v[32:47]
  ds_read_b128 v[100:103], v7 offset:18432
  s_waitcnt lgkmcnt(2)
  v_mfma_f32_32x32x16_bf16 v[32:47], v[156:159], v[108:111], v[32:47]
  ds_read_b128 v[104:107], v7 offset:20480
  s_waitcnt lgkmcnt(2)
  v_mfma_f32_32x32x16_bf16 v[32:47], v[160:163], v[96:99], v[32:47]
  ds_read_b128 v[108:111], v7 offset:22528
  s_waitcnt lgkmcnt(2)
  v_mfma_f32_32x32x16_bf16 v[32:47], v[164:167], v[100:103], v[32:47]
  s_barrier
  ds_read_b128 v[96:99], v7 offset:24576
  s_waitcnt lgkmcnt(2)
  v_mfma_f32_32x32x16_bf16 v[32:47], v[168:171], v[104:107], v[32:47]
  ds_read_b128 v[100:103], v7 offset:26624
  s_waitcnt lgkmcnt(2)
  v_mfma_f32_32x32x16_bf16 v[32:47], v[172:175], v[108:111], v[32:47]
  ds_read_b128 v[104:107], v7 offset:28672
  s_waitcnt lgkmcnt(2)
  v_mfma_f32_32x32x16_bf16 v[32:47], v[176:179], v[96:99], v[32:47]
  ds_read_b128 v[108:111], v7 offset:30720
  s_waitcnt lgkmcnt(2)
  v_mfma_f32_32x32x16_bf16 v[32:47], v[180:183], v[100:103], v[32:47]
  s_barrier
  ds_read_b128 v[96:99], v7 offset:32768
  s_waitcnt lgkmcnt(2)
  v_mfma_f32_32x32x16_bf16 v[32:47], v[184:187], v[104:107], v[32:47]
  ds_read_b128 v[100:103], v7 offset:34816
  s_waitcnt lgkmcnt(2)
  v_mfma_f32_32x32x16_bf16 v[32:47], v[188:191], v[108:111], v[32:47]
  ds_read_b128 v[104:107], v7 offset:36864
  s_waitcnt lgkmcnt(2)
  v_mfma_f32_32x32x16_bf16 v[32:47], v[192:195], v[96:99], v[32:47]
  ds_read_b128 v[108:111], v7 offset:38912
  s_waitcnt lgkmcnt(2)
  v_mfma_f32_32x32x16_bf16 v[32:47], v[196:199], v[100:103], v[32:47]
  s_barrier
  ds_read_b128 v[96:99], v7 offset:40960
  s_waitcnt lgkmcnt(2)
  v_mfma_f32_32x32x16_bf16 v[32:47], v[200:203], v[104:107], v[32:47]
  ds_read_b128 v[100:103], v7 offset:43008
  s_waitcnt lgkmcnt(2)
  v_mfma_f32_32x32x16_bf16 v[32:47], v[204:207], v[108:111], v[32:47]
  ds_read_b128 v[104:107], v7 offset:45056
  s_waitcnt lgkmcnt(2)
  v_mfma_f32_32x32x16_bf16 v[32:47], v[208:211], v[96:99], v[32:47]
  ds_read_b128 v[108:111], v7 offset:47104
  s_waitcnt lgkmcnt(2)
  v_mfma_f32_32x32x16_bf16 v[32:47], v[212:215], v[100:103], v[32:47]
  s_barrier
  ds_read_b128 v[96:99], v7 offset:49152
  s_waitcnt lgkmcnt(2)
  v_mfma_f32_32x32x16_bf16 v[32:47], v[216:219], v[104:107], v[32:47]
  ds_read_b128 v[100:103], v7 offset:51200
  s_waitcnt lgkmcnt(2)
  v_mfma_f32_32x32x16_bf16 v[32:47], v[220:223], v[108:111], v[32:47]
  ds_read_b128 v[104:107], v7 offset:53248
  s_waitcnt lgkmcnt(2)
  v_mfma_f32_32x32x16_bf16 v[32:47], v[224:227], v[96:99], v[32:47]
  ds_read_b128 v[108:111], v7 offset:55296
  s_waitcnt lgkmcnt(2)
  v_mfma_f32_32x32x16_bf16 v[32:47], v[228:231], v[100:103], v[32:47]
  s_barrier
  ds_read_b128 v[96:99], v7 offset:57344
  s_waitcnt lgkmcnt(2)
  v_mfma_f32_32x32x16_bf16 v[32:47], v[232:235], v[104:107], v[32:47]
  ds_read_b128 v[100:103], v7 offset:59392
  s_waitcnt lgkmcnt(2)
  v_mfma_f32_32x32x16_bf16 v[32:47], v[236:239], v[108:111], v[32:47]
  ds_read_b128 v[104:107], v7 offset:61440
  s_waitcnt lgkmcnt(2)
  v_mfma_f32_32x32x16_bf16 v[32:47], v[240:243], v[96:99], v[32:47]
  ds_read_b128 v[108:111], v7 offset:63488
  s_waitcnt lgkmcnt(2)
  v_mfma_f32_32x32x16_bf16 v[32:47], v[244:247], v[100:103], v[32:47]
  s_waitcnt lgkmcnt(1)
  v_mfma_f32_32x32x16_bf16 v[32:47], v[248:251], v[104:107], v[32:47]
  s_waitcnt lgkmcnt(0)
  v_mfma_f32_32x32x16_bf16 v[32:47], v[252:255], v[108:111], v[32:47]
  s_nop 0
  s_nop 11
  v_cvt_pk_bf16_f32 v96, v32, v33
  v_cvt_pk_bf16_f32 v97, v34, v35
  v_cvt_pk_bf16_f32 v98, v36, v37
  v_cvt_pk_bf16_f32 v99, v38, v39
  v_cvt_pk_bf16_f32 v100, v40, v41
  v_cvt_pk_bf16_f32 v101, v42, v43
  v_cvt_pk_bf16_f32 v102, v44, v45
  v_cvt_pk_bf16_f32 v103, v46, v47
  buffer_store_dwordx4 v[96:99], v16, s[4:7], s66 offen
  buffer_store_dwordx4 v[100:103], v16, s[4:7], s66 offen offset:2048
  v_pk_add_f32 v[112:113], v[32:33], v[34:35]
  v_pk_add_f32 v[114:115], v[36:37], v[38:39]
  v_pk_add_f32 v[116:117], v[40:41], v[42:43]
  v_pk_add_f32 v[118:119], v[44:45], v[46:47]
  v_pk_mul_f32 v[120:121], v[32:33], v[32:33]
  v_pk_fma_f32 v[120:121], v[34:35], v[34:35], v[120:121]
  v_pk_fma_f32 v[120:121], v[36:37], v[36:37], v[120:121]
  v_pk_fma_f32 v[120:121], v[38:39], v[38:39], v[120:121]
  v_pk_fma_f32 v[120:121], v[40:41], v[40:41], v[120:121]
  v_pk_fma_f32 v[120:121], v[42:43], v[42:43], v[120:121]
  v_pk_fma_f32 v[120:121], v[44:45], v[44:45], v[120:121]
  v_pk_fma_f32 v[120:121], v[46:47], v[46:47], v[120:121]
  v_pk_add_f32 v[112:113], v[112:113], v[114:115]
  v_pk_add_f32 v[116:117], v[116:117], v[118:119]
  v_add_f32_e64 v120, v120, v121
  v_pk_add_f32 v[112:113], v[112:113], v[116:117]
  v_add_f32 v112, v112, v113
  s_nop 1
  v_permlane32_swap_b32 v112, v120
  v_add_f32 v112, v112, v120
  buffer_store_dword v112, v28, s[4:7], s81 offen
  s_barrier
  s_nop 0
  ds_read_b64_tr_b16 v[128:129], v11 offset:0
  ds_read_b64_tr_b16 v[130:131], v14 offset:0
  ds_read_b64_tr_b16 v[132:133], v11 offset:2048
  ds_read_b64_tr_b16 v[134:135], v14 offset:2048
  ds_read_b64_tr_b16 v[136:137], v11 offset:4096
  ds_read_b64_tr_b16 v[138:139], v14 offset:4096
  ds_read_b64_tr_b16 v[140:141], v11 offset:6144
  ds_read_b64_tr_b16 v[142:143], v14 offset:6144
  ds_read_b64_tr_b16 v[144:145], v11 offset:8192
  ds_read_b64_tr_b16 v[146:147], v14 offset:8192
  ds_read_b64_tr_b16 v[148:149], v11 offset:10240
  ds_read_b64_tr_b16 v[150:151], v14 offset:10240
  ds_read_b64_tr_b16 v[152:153], v11 offset:16384
  ds_read_b64_tr_b16 v[154:155], v14 offset:16384
  ds_read_b64_tr_b16 v[156:157], v11 offset:18432
  ds_read_b64_tr_b16 v[158:159], v14 offset:18432
  ds_read_b64_tr_b16 v[160:161], v11 offset:20480
  ds_read_b64_tr_b16 v[162:163], v14 offset:20480
  ds_read_b64_tr_b16 v[164:165], v11 offset:22528
  ds_read_b64_tr_b16 v[166:167], v14 offset:22528
  ds_read_b64_tr_b16 v[168:169], v11 offset:24576
  ds_read_b64_tr_b16 v[170:171], v14 offset:24576
  ds_read_b64_tr_b16 v[172:173], v11 offset:26624
  ds_read_b64_tr_b16 v[174:175], v14 offset:26624
  ds_read_b64_tr_b16 v[176:177], v11 offset:28672
  ds_read_b64_tr_b16 v[178:179], v14 offset:28672
  ds_read_b64_tr_b16 v[180:181], v11 offset:30720
  ds_read_b64_tr_b16 v[182:183], v14 offset:30720
  ds_read_b64_tr_b16 v[184:185], v11 offset:12288
  ds_read_b64_tr_b16 v[186:187], v14 offset:12288
  ds_read_b64_tr_b16 v[188:189], v11 offset:14336
  ds_read_b64_tr_b16 v[190:191], v14 offset:14336
  ds_read_b64_tr_b16 v[192:193], v11 offset:61440
  ds_read_b64_tr_b16 v[194:195], v14 offset:61440
  ds_read_b64_tr_b16 v[196:197], v11 offset:63488
  ds_read_b64_tr_b16 v[198:199], v14 offset:63488
  ds_read_b64_tr_b16 v[200:201], v12 offset:0
  ds_read_b64_tr_b16 v[202:203], v15 offset:0
  ds_read_b64_tr_b16 v[204:205], v12 offset:2048
  ds_read_b64_tr_b16 v[206:207], v15 offset:2048
  s_waitcnt vmcnt(0)
  s_barrier
  ds_write_b128 v16, v[96:99] offset:0
  ds_write_b128 v16, v[100:103] offset:2048
  ds_read_b64_tr_b16 v[208:209], v12 offset:4096
  ds_read_b64_tr_b16 v[210:211], v15 offset:4096
  ds_read_b64_tr_b16 v[212:213], v12 offset:6144
  ds_read_b64_tr_b16 v[214:215], v15 offset:6144
  ds_read_b64_tr_b16 v[216:217], v12 offset:8192
  ds_read_b64_tr_b16 v[218:219], v15 offset:8192
  ds_read_b64_tr_b16 v[220:221], v12 offset:10240
  ds_read_b64_tr_b16 v[222:223], v15 offset:10240
  ds_read_b64_tr_b16 v[224:225], v12 offset:12288
  ds_read_b64_tr_b16 v[226:227], v15 offset:12288
  ds_read_b64_tr_b16 v[228:229], v12 offset:14336
  ds_read_b64_tr_b16 v[230:231], v15 offset:14336
  ds_read_b64_tr_b16 v[232:233], v11 offset:32768
  ds_read_b64_tr_b16 v[234:235], v14 offset:32768
  ds_read_b64_tr_b16 v[236:237], v11 offset:34816
  ds_read_b64_tr_b16 v[238:239], v14 offset:34816
  ds_read_b64_tr_b16 v[240:241], v11 offset:36864
  ds_read_b64_tr_b16 v[242:243], v14 offset:36864
  ds_read_b64_tr_b16 v[244:245], v11 offset:38912
  ds_read_b64_tr_b16 v[246:247], v14 offset:38912
  ds_read_b64_tr_b16 v[248:249], v11 offset:40960
  ds_read_b64_tr_b16 v[250:251], v14 offset:40960
  ds_read_b64_tr_b16 v[252:253], v11 offset:43008
  ds_read_b64_tr_b16 v[254:255], v14 offset:43008
  s_waitcnt lgkmcnt(0)
  s_barrier
  s_barrier
  ds_read_b128 v[96:99], v7 offset:0
  ds_read_b128 v[100:103], v7 offset:2048
  ds_read_b128 v[104:107], v7 offset:4096
  s_waitcnt lgkmcnt(2)
  v_mfma_f32_32x32x16_bf16 v[48:63], v[128:131], v[96:99], 0
  ds_read_b128 v[108:111], v7 offset:6144
  s_waitcnt lgkmcnt(2)
  v_mfma_f32_32x32x16_bf16 v[48:63], v[132:135], v[100:103], v[48:63]
  s_barrier
  ds_read_b128 v[96:99], v7 offset:8192
  s_waitcnt lgkmcnt(2)
  v_mfma_f32_32x32x16_bf16 v[48:63], v[136:139], v[104:107], v[48:63]
  ds_read_b128 v[100:103], v7 offset:10240
  s_waitcnt lgkmcnt(2)
  v_mfma_f32_32x32x16_bf16 v[48:63], v[140:143], v[108:111], v[48:63]
  ds_read_b128 v[104:107], v7 offset:12288
  s_waitcnt lgkmcnt(2)
  v_mfma_f32_32x32x16_bf16 v[48:63], v[144:147], v[96:99], v[48:63]
  ds_read_b128 v[108:111], v7 offset:14336
  s_waitcnt lgkmcnt(2)
  v_mfma_f32_32x32x16_bf16 v[48:63], v[148:151], v[100:103], v[48:63]
  s_barrier
  ds_read_b128 v[96:99], v7 offset:16384
  s_mul_i32 s69, s61, 4096
  s_add_u32 s69, s69, 65536
  v_add_u32 v29, s69, v28
  s_waitcnt lgkmcnt(2)
  v_mfma_f32_32x32x16_bf16 v[48:63], v[152:155], v[104:107], v[48:63]
  ds_read_b128 v[100:103], v7 offset:18432
  ds_read2st64_b32 v[80:81], v29 offset0:0 offset1:1
  ds_read2st64_b32 v[82:83], v29 offset0:2 offset1:3
  ds_read2st64_b32 v[84:85], v29 offset0:4 offset1:5
  ds_read2st64_b32 v[86:87], v29 offset0:6 offset1:7
  ds_read2st64_b32 v[88:89], v29 offset0:8 offset1:9
  ds_read2st64_b32 v[90:91], v29 offset0:10 offset1:11
  s_waitcnt lgkmcnt(8)
  v_mfma_f32_32x32x16_bf16 v[48:63], v[156:159], v[108:111], v[48:63]
  ds_read_b128 v[104:107], v7 offset:20480
  ds_read2st64_b32 v[92:93], v29 offset0:12 offset1:13
  ds_read2st64_b32 v[94:95], v29 offset0:14 offset1:15
  s_waitcnt lgkmcnt(10)
  v_mfma_f32_32x32x16_bf16 v[48:63], v[160:163], v[96:99], v[48:63]
  ds_read_b128 v[108:111], v7 offset:22528
  s_waitcnt lgkmcnt(10)
  v_mfma_f32_32x32x16_bf16 v[48:63], v[164:167], v[100:103], v[48:63]
  s_barrier
  ds_read_b128 v[96:99], v7 offset:24576
  s_waitcnt lgkmcnt(4)
  v_mfma_f32_32x32x16_bf16 v[48:63], v[168:171], v[104:107], v[48:63]
  ds_read_b128 v[100:103], v7 offset:26624
  v_add_f32 v80, v80, v81
  v_add_f32 v82, v82, v83
  v_add_f32 v84, v84, v85
  s_waitcnt lgkmcnt(2)
  v_mfma_f32_32x32x16_bf16 v[48:63], v[172:175], v[108:111], v[48:63]
  ds_read_b128 v[104:107], v7 offset:28672
  v_add_f32 v86, v86, v87
  v_add_f32 v88, v88, v89
  s_waitcnt lgkmcnt(2)
  v_mfma_f32_32x32x16_bf16 v[48:63], v[176:179], v[96:99], v[48:63]
  ds_read_b128 v[108:111], v7 offset:30720
  v_add_f32 v90, v90, v91
  v_add_f32 v92, v92, v93
  s_waitcnt lgkmcnt(2)
  v_mfma_f32_32x32x16_bf16 v[48:63], v[180:183], v[100:103], v[48:63]
  s_barrier
  s_nop 0
  ds_read_b128 v[64:67], v27 offset:768
  ds_read_b128 v[68:71], v27 offset:800
  ds_read_b128 v[72:75], v27 offset:832
  ds_read_b128 v[76:79], v27 offset:864
  ds_read_b128 v[96:99], v7 offset:32768
  v_add_f32 v94, v94, v95
  v_add_f32 v80, v80, v82
  s_waitcnt lgkmcnt(6)
  v_mfma_f32_32x32x16_bf16 v[48:63], v[184:187], v[104:107], v[48:63]
  ds_read_b128 v[100:103], v7 offset:34816
  v_add_f32 v84, v84, v86
  v_add_f32 v88, v88, v90
  s_waitcnt lgkmcnt(6)
  v_mfma_f32_32x32x16_bf16 v[48:63], v[188:191], v[108:111], v[48:63]
  ds_read_b128 v[104:107], v7 offset:36864
  v_add_f32 v92, v92, v94
  v_add_f32 v80, v80, v84
  s_waitcnt lgkmcnt(2)
  v_mfma_f32_32x32x16_bf16 v[48:63], v[192:195], v[96:99], v[48:63]
  ds_read_b128 v[108:111], v7 offset:38912
  v_add_f32 v88, v88, v92
  v_add_f32 v80, v80, v88
  s_waitcnt lgkmcnt(2)
  v_mfma_f32_32x32x16_bf16 v[48:63], v[196:199], v[100:103], v[48:63]
  s_barrier
  ds_read_b128 v[96:99], v7 offset:40960
  v_mov_b32 v30, v80
  s_nop 1
  v_permlane32_swap_b32 v80, v30
PAD_12:
  s_cbranch_execz L_TRAMP
  s_nop 0
  s_waitcnt lgkmcnt(2)
  v_mfma_f32_32x32x16_bf16 v[48:63], v[200:203], v[104:107], v[48:63]
  ds_read_b128 v[100:103], v7 offset:43008
  v_mul_f32 v122, 0xbb000000, v80
  v_mul_f32 v30, 0x3b000000, v30
  s_waitcnt lgkmcnt(2)
  v_mfma_f32_32x32x16_bf16 v[48:63], v[204:207], v[108:111], v[48:63]
  ds_read_b128 v[104:107], v7 offset:45056
  v_fma_f32 v30, -v122, v122, v30
  v_max_f32 v30, 0, v30
  s_waitcnt lgkmcnt(2)
  v_mfma_f32_32x32x16_bf16 v[48:63], v[208:211], v[96:99], v[48:63]
  ds_read_b128 v[108:111], v7 offset:47104
  v_add_f32 v29, 0x3727c5ac, v30
  v_rsq_f32 v126, v29
  s_nop 0
  v_mul_f32 v30, v30, v126
  s_waitcnt lgkmcnt(2)
  v_mfma_f32_32x32x16_bf16 v[48:63], v[212:215], v[100:103], v[48:63]
  s_barrier
  ds_read_b128 v[96:99], v7 offset:49152
  v_mul_f32 v30, v30, v126
  v_add_f32 v30, 0x3727c5ac, v30
  s_waitcnt lgkmcnt(2)
  v_mfma_f32_32x32x16_bf16 v[48:63], v[216:219], v[104:107], v[48:63]
  ds_read_b128 v[100:103], v7 offset:51200
  v_rsq_f32 v30, v30
  v_mul_f32 v127, v122, v126
  s_waitcnt lgkmcnt(2)
  v_mfma_f32_32x32x16_bf16 v[48:63], v[220:223], v[108:111], v[48:63]
  ds_read_b128 v[104:107], v7 offset:53248
  v_mul_f32 v29, v30, v126
  v_rcp_f32 v125, v29
  s_waitcnt lgkmcnt(2)
  v_mfma_f32_32x32x16_bf16 v[48:63], v[224:227], v[96:99], v[48:63]
  ds_read_b128 v[108:111], v7 offset:55296
  v_mul_f32 v123, 0xc0135761, v29
  v_mul_f32 v30, v29, v29
  s_waitcnt lgkmcnt(2)
  v_mfma_f32_32x32x16_bf16 v[48:63], v[228:231], v[100:103], v[48:63]
  s_barrier
  ds_read_b128 v[96:99], v7 offset:57344
  v_mul_f32_e64 v30, v30, v29
  v_mul_f32 v124, 0xbdd2d3e8, v30
  s_waitcnt lgkmcnt(2)
  v_mfma_f32_32x32x16_bf16 v[48:63], v[232:235], v[104:107], v[48:63]
  ds_read_b128 v[100:103], v7 offset:59392
  s_waitcnt lgkmcnt(2)
  v_mfma_f32_32x32x16_bf16 v[48:63], v[236:239], v[108:111], v[48:63]
  ds_read_b128 v[104:107], v7 offset:61440
  s_waitcnt lgkmcnt(2)
  v_mfma_f32_32x32x16_bf16 v[48:63], v[240:243], v[96:99], v[48:63]
  ds_read_b128 v[108:111], v7 offset:63488
  s_waitcnt lgkmcnt(2)
  v_mfma_f32_32x32x16_bf16 v[48:63], v[244:247], v[100:103], v[48:63]
  s_waitcnt lgkmcnt(1)
  v_mfma_f32_32x32x16_bf16 v[48:63], v[248:251], v[104:107], v[48:63]
  s_waitcnt lgkmcnt(0)
  v_mfma_f32_32x32x16_bf16 v[48:63], v[252:255], v[108:111], v[48:63]
  s_nop 0
  s_nop 11
  v_pk_fma_f32 v[48:49], v[64:65], v[122:123], v[48:49] op_sel:[0,0,0] op_sel_hi:[1,0,1]
  v_pk_fma_f32 v[50:51], v[66:67], v[122:123], v[50:51] op_sel:[0,0,0] op_sel_hi:[1,0,1]
  v_pk_mul_f32 v[112:113], v[48:49], v[48:49] op_sel:[0,0] op_sel_hi:[1,1]
  v_pk_mul_f32 v[114:115], v[50:51], v[50:51] op_sel:[0,0] op_sel_hi:[1,1]
  v_pk_fma_f32 v[112:113], v[112:113], v[124:125], v[122:123] op_sel:[0,0,1] op_sel_hi:[1,0,1]
  v_pk_fma_f32 v[114:115], v[114:115], v[124:125], v[122:123] op_sel:[0,0,1] op_sel_hi:[1,0,1]
  v_pk_mul_f32 v[112:113], v[112:113], v[48:49] op_sel:[0,0] op_sel_hi:[1,1]
  v_pk_mul_f32 v[114:115], v[114:115], v[50:51] op_sel:[0,0] op_sel_hi:[1,1]
  v_exp_f32 v112, v112
  v_exp_f32 v113, v113
  v_exp_f32 v114, v114
  v_exp_f32 v115, v115
  v_pk_fma_f32 v[112:113], v[112:113], v[124:125], v[124:125] op_sel:[0,1,1] op_sel_hi:[1,1,1]
  v_pk_fma_f32 v[114:115], v[114:115], v[124:125], v[124:125] op_sel:[0,1,1] op_sel_hi:[1,1,1]
  v_rcp_f32 v112, v112
  v_rcp_f32 v113, v113
  v_rcp_f32 v114, v114
  v_rcp_f32 v115, v115
  v_pk_mul_f32 v[112:113], v[112:113], v[48:49] op_sel:[0,0] op_sel_hi:[1,1]
  v_pk_mul_f32 v[114:115], v[114:115], v[50:51] op_sel:[0,0] op_sel_hi:[1,1]
  v_cvt_pk_bf16_f32 v96, v112, v113
  v_cvt_pk_bf16_f32 v97, v114, v115
  v_pk_fma_f32 v[52:53], v[68:69], v[122:123], v[52:53] op_sel:[0,0,0] op_sel_hi:[1,0,1]
  v_pk_fma_f32 v[54:55], v[70:71], v[122:123], v[54:55] op_sel:[0,0,0] op_sel_hi:[1,0,1]
  v_pk_mul_f32 v[112:113], v[52:53], v[52:53] op_sel:[0,0] op_sel_hi:[1,1]
  v_pk_mul_f32 v[114:115], v[54:55], v[54:55] op_sel:[0,0] op_sel_hi:[1,1]
  v_pk_fma_f32 v[112:113], v[112:113], v[124:125], v[122:123] op_sel:[0,0,1] op_sel_hi:[1,0,1]
  v_pk_fma_f32 v[114:115], v[114:115], v[124:125], v[122:123] op_sel:[0,0,1] op_sel_hi:[1,0,1]
  v_pk_mul_f32 v[112:113], v[112:113], v[52:53] op_sel:[0,0] op_sel_hi:[1,1]
  v_pk_mul_f32 v[114:115], v[114:115], v[54:55] op_sel:[0,0] op_sel_hi:[1,1]
  v_exp_f32 v112, v112
  v_exp_f32 v113, v113
  v_exp_f32 v114, v114
  v_exp_f32 v115, v115
  v_pk_fma_f32 v[112:113], v[112:113], v[124:125], v[124:125] op_sel:[0,1,1] op_sel_hi:[1,1,1]
  v_pk_fma_f32 v[114:115], v[114:115], v[124:125], v[124:125] op_sel:[0,1,1] op_sel_hi:[1,1,1]
  v_rcp_f32 v112, v112
  v_rcp_f32 v113, v113
  v_rcp_f32 v114, v114
  v_rcp_f32 v115, v115
  v_pk_mul_f32 v[112:113], v[112:113], v[52:53] op_sel:[0,0] op_sel_hi:[1,1]
  v_pk_mul_f32 v[114:115], v[114:115], v[54:55] op_sel:[0,0] op_sel_hi:[1,1]
  v_cvt_pk_bf16_f32 v98, v112, v113
  v_cvt_pk_bf16_f32 v99, v114, v115
  v_pk_fma_f32 v[56:57], v[72:73], v[122:123], v[56:57] op_sel:[0,0,0] op_sel_hi:[1,0,1]
  v_pk_fma_f32 v[58:59], v[74:75], v[122:123], v[58:59] op_sel:[0,0,0] op_sel_hi:[1,0,1]
  v_pk_mul_f32 v[112:113], v[56:57], v[56:57] op_sel:[0,0] op_sel_hi:[1,1]
  v_pk_mul_f32 v[114:115], v[58:59], v[58:59] op_sel:[0,0] op_sel_hi:[1,1]
  v_pk_fma_f32 v[112:113], v[112:113], v[124:125], v[122:123] op_sel:[0,0,1] op_sel_hi:[1,0,1]
  v_pk_fma_f32 v[114:115], v[114:115], v[124:125], v[122:123] op_sel:[0,0,1] op_sel_hi:[1,0,1]
  v_pk_mul_f32 v[112:113], v[112:113], v[56:57] op_sel:[0,0] op_sel_hi:[1,1]
  v_pk_mul_f32 v[114:115], v[114:115], v[58:59] op_sel:[0,0] op_sel_hi:[1,1]
  v_exp_f32 v112, v112
  v_exp_f32 v113, v113
  v_exp_f32 v114, v114
  v_exp_f32 v115, v115
  v_pk_fma_f32 v[112:113], v[112:113], v[124:125], v[124:125] op_sel:[0,1,1] op_sel_hi:[1,1,1]
  v_pk_fma_f32 v[114:115], v[114:115], v[124:125], v[124:125] op_sel:[0,1,1] op_sel_hi:[1,1,1]
  v_rcp_f32 v112, v112
  v_rcp_f32 v113, v113
  v_rcp_f32 v114, v114
  v_rcp_f32 v115, v115
  v_pk_mul_f32 v[112:113], v[112:113], v[56:57] op_sel:[0,0] op_sel_hi:[1,1]
  v_pk_mul_f32 v[114:115], v[114:115], v[58:59] op_sel:[0,0] op_sel_hi:[1,1]
  v_cvt_pk_bf16_f32 v100, v112, v113
  v_cvt_pk_bf16_f32 v101, v114, v115
  v_pk_fma_f32 v[60:61], v[76:77], v[122:123], v[60:61] op_sel:[0,0,0] op_sel_hi:[1,0,1]
  v_pk_fma_f32 v[62:63], v[78:79], v[122:123], v[62:63] op_sel:[0,0,0] op_sel_hi:[1,0,1]
  v_pk_mul_f32 v[112:113], v[60:61], v[60:61] op_sel:[0,0] op_sel_hi:[1,1]
  v_pk_mul_f32 v[114:115], v[62:63], v[62:63] op_sel:[0,0] op_sel_hi:[1,1]
  v_pk_fma_f32 v[112:113], v[112:113], v[124:125], v[122:123] op_sel:[0,0,1] op_sel_hi:[1,0,1]
  v_pk_fma_f32 v[114:115], v[114:115], v[124:125], v[122:123] op_sel:[0,0,1] op_sel_hi:[1,0,1]
  v_pk_mul_f32 v[112:113], v[112:113], v[60:61] op_sel:[0,0] op_sel_hi:[1,1]
  v_pk_mul_f32 v[114:115], v[114:115], v[62:63] op_sel:[0,0] op_sel_hi:[1,1]
  v_exp_f32 v112, v112
  v_exp_f32 v113, v113
  v_exp_f32 v114, v114
  v_exp_f32 v115, v115
  v_pk_fma_f32 v[112:113], v[112:113], v[124:125], v[124:125] op_sel:[0,1,1] op_sel_hi:[1,1,1]
  v_pk_fma_f32 v[114:115], v[114:115], v[124:125], v[124:125] op_sel:[0,1,1] op_sel_hi:[1,1,1]
  v_rcp_f32 v112, v112
  v_rcp_f32 v113, v113
  v_rcp_f32 v114, v114
  v_rcp_f32 v115, v115
  v_pk_mul_f32 v[112:113], v[112:113], v[60:61] op_sel:[0,0] op_sel_hi:[1,1]
  v_pk_mul_f32 v[114:115], v[114:115], v[62:63] op_sel:[0,0] op_sel_hi:[1,1]
  v_cvt_pk_bf16_f32 v102, v112, v113
  v_cvt_pk_bf16_f32 v103, v114, v115
  buffer_store_dwordx4 v[96:99], v16, s[4:7], s65 offen
  buffer_store_dwordx4 v[100:103], v16, s[4:7], s65 offen offset:2048
  v_min_u32 v104, -2, v96
  v_min_u32 v105, -2, v97
  v_min_u32 v106, -2, v98
  v_min_u32 v107, -2, v99
  v_min_u32 v108, -2, v100
  v_min_u32 v109, -2, v101
  v_min_u32 v110, -2, v102
  v_min_u32 v111, -2, v103
  s_add_u32 s53, s72, 65536
  buffer_store_dwordx4 v[104:107], v20, s[4:7], s53 offen sc1
  buffer_store_dwordx4 v[108:111], v20, s[4:7], s53 offen offset:32 sc1
  s_barrier
  s_nop 0
  ds_read_b64_tr_b16 v[128:129], v11 offset:45056
  ds_read_b64_tr_b16 v[130:131], v14 offset:45056
  ds_read_b64_tr_b16 v[132:133], v11 offset:47104
  ds_read_b64_tr_b16 v[134:135], v14 offset:47104
  ds_read_b64_tr_b16 v[136:137], v11 offset:49152
  ds_read_b64_tr_b16 v[138:139], v14 offset:49152
  ds_read_b64_tr_b16 v[140:141], v11 offset:51200
  ds_read_b64_tr_b16 v[142:143], v14 offset:51200
  ds_read_b64_tr_b16 v[144:145], v11 offset:53248
  ds_read_b64_tr_b16 v[146:147], v14 offset:53248
  ds_read_b64_tr_b16 v[148:149], v11 offset:55296
  ds_read_b64_tr_b16 v[150:151], v14 offset:55296
  ds_read_b64_tr_b16 v[152:153], v11 offset:57344
  ds_read_b64_tr_b16 v[154:155], v14 offset:57344
  ds_read_b64_tr_b16 v[156:157], v11 offset:59392
  ds_read_b64_tr_b16 v[158:159], v14 offset:59392
  ds_read_b64_tr_b16 v[160:161], v12 offset:16384
  ds_read_b64_tr_b16 v[162:163], v15 offset:16384
  ds_read_b64_tr_b16 v[164:165], v12 offset:18432
  ds_read_b64_tr_b16 v[166:167], v15 offset:18432
  ds_read_b64_tr_b16 v[168:169], v12 offset:20480
  ds_read_b64_tr_b16 v[170:171], v15 offset:20480
  ds_read_b64_tr_b16 v[172:173], v12 offset:22528
  ds_read_b64_tr_b16 v[174:175], v15 offset:22528
  ds_read_b64_tr_b16 v[176:177], v12 offset:24576
  ds_read_b64_tr_b16 v[178:179], v15 offset:24576
  ds_read_b64_tr_b16 v[180:181], v12 offset:26624
  ds_read_b64_tr_b16 v[182:183], v15 offset:26624
  ds_read_b64_tr_b16 v[184:185], v11 offset:8192
  ds_read_b64_tr_b16 v[186:187], v14 offset:8192
  ds_read_b64_tr_b16 v[188:189], v11 offset:10240
  ds_read_b64_tr_b16 v[190:191], v14 offset:10240
  ds_read_b64_tr_b16 v[192:193], v11 offset:12288
  ds_read_b64_tr_b16 v[194:195], v14 offset:12288
  ds_read_b64_tr_b16 v[196:197], v11 offset:14336
  ds_read_b64_tr_b16 v[198:199], v14 offset:14336
  ds_read_b64_tr_b16 v[200:201], v11 offset:16384
  ds_read_b64_tr_b16 v[202:203], v14 offset:16384
  ds_read_b64_tr_b16 v[204:205], v11 offset:18432
  ds_read_b64_tr_b16 v[206:207], v14 offset:18432
  s_waitcnt vmcnt(2)
  s_barrier
  v_pk_fma_f32 v[64:65], v[32:33], v[126:127], v[126:127] op_sel:[0,0,1] op_sel_hi:[1,0,1]
  v_pk_fma_f32 v[66:67], v[34:35], v[126:127], v[126:127] op_sel:[0,0,1] op_sel_hi:[1,0,1]
  v_pk_fma_f32 v[68:69], v[36:37], v[126:127], v[126:127] op_sel:[0,0,1] op_sel_hi:[1,0,1]
  v_pk_fma_f32 v[70:71], v[38:39], v[126:127], v[126:127] op_sel:[0,0,1] op_sel_hi:[1,0,1]
  v_pk_fma_f32 v[72:73], v[40:41], v[126:127], v[126:127] op_sel:[0,0,1] op_sel_hi:[1,0,1]
  v_pk_fma_f32 v[74:75], v[42:43], v[126:127], v[126:127] op_sel:[0,0,1] op_sel_hi:[1,0,1]
  v_pk_fma_f32 v[76:77], v[44:45], v[126:127], v[126:127] op_sel:[0,0,1] op_sel_hi:[1,0,1]
  v_pk_fma_f32 v[78:79], v[46:47], v[126:127], v[126:127] op_sel:[0,0,1] op_sel_hi:[1,0,1]
  v_and_b32_e64 v29, 31, v1
  v_lshl_add_u32 v29, s61, 5, v29
  v_lshlrev_b32 v7, 4, v29
  v_lshrrev_b32 v30, 5, v1
  v_mul_u32_u24 v30, 1088, v30
  v_add_u32_e64 v7, v7, v30
  v_add_u32 v9, 0x20000, v7
  v_add_u32 v8, 0x10000, v7
  ds_read_b64_tr_b16 v[208:209], v11 offset:4096
  ds_read_b64_tr_b16 v[210:211], v14 offset:4096
  ds_read_b64_tr_b16 v[212:213], v11 offset:6144
  ds_read_b64_tr_b16 v[214:215], v14 offset:6144
  ds_read_b64_tr_b16 v[216:217], v11 offset:20480
  ds_read_b64_tr_b16 v[218:219], v14 offset:20480
  ds_read_b64_tr_b16 v[220:221], v11 offset:22528
  ds_read_b64_tr_b16 v[222:223], v14 offset:22528
  ds_read_b64_tr_b16 v[224:225], v11 offset:24576
  ds_read_b64_tr_b16 v[226:227], v14 offset:24576
  ds_read_b64_tr_b16 v[228:229], v11 offset:26624
  ds_read_b64_tr_b16 v[230:231], v14 offset:26624
  ds_read_b64_tr_b16 v[232:233], v11 offset:28672
  ds_read_b64_tr_b16 v[234:235], v14 offset:28672
  ds_read_b64_tr_b16 v[236:237], v11 offset:30720
  ds_read_b64_tr_b16 v[238:239], v14 offset:30720
  ds_read_b64_tr_b16 v[240:241], v11 offset:32768
  ds_read_b64_tr_b16 v[242:243], v14 offset:32768
  ds_read_b64_tr_b16 v[244:245], v11 offset:34816
  ds_read_b64_tr_b16 v[246:247], v14 offset:34816
  ds_read_b64_tr_b16 v[248:249], v11 offset:36864
  ds_read_b64_tr_b16 v[250:251], v14 offset:36864
  ds_read_b64_tr_b16 v[252:253], v11 offset:38912
  ds_read_b64_tr_b16 v[254:255], v14 offset:38912
  s_waitcnt lgkmcnt(0)
  s_barrier
  s_cmp_lg_u32 s61, 0
  s_cbranch_scc1 CV1_13
  s_barrier
  ds_read_b128 v[96:99], v7 offset:17456
  ds_read_b128 v[100:103], v7 offset:19632
  ds_read_b128 v[104:107], v7 offset:21808
  s_waitcnt lgkmcnt(2)
  v_mfma_f32_32x32x16_bf16 v[64:79], v[160:163], v[96:99], v[64:79]
  ds_read_b128 v[108:111], v7 offset:23984
  s_waitcnt lgkmcnt(2)
  v_mfma_f32_32x32x16_bf16 v[64:79], v[164:167], v[100:103], v[64:79]
  s_barrier
  ds_read_b128 v[96:99], v7 offset:26160
  s_waitcnt lgkmcnt(2)
  v_mfma_f32_32x32x16_bf16 v[64:79], v[168:171], v[104:107], v[64:79]
  ds_read_b128 v[100:103], v7 offset:28336
  s_waitcnt lgkmcnt(2)
  v_mfma_f32_32x32x16_bf16 v[64:79], v[172:175], v[108:111], v[64:79]
  ds_read_b128 v[104:107], v7 offset:30512
  s_waitcnt lgkmcnt(2)
  v_mfma_f32_32x32x16_bf16 v[64:79], v[176:179], v[96:99], v[64:79]
  ds_read_b128 v[108:111], v7 offset:32688
  s_waitcnt lgkmcnt(2)
  v_mfma_f32_32x32x16_bf16 v[64:79], v[180:183], v[100:103], v[64:79]
  s_barrier
  ds_read_b128 v[96:99], v7 offset:52288
  s_waitcnt lgkmcnt(2)
  v_mfma_f32_32x32x16_bf16 v[64:79], v[184:187], v[104:107], v[64:79]
  ds_read_b128 v[100:103], v7 offset:54464
  s_waitcnt lgkmcnt(2)
  v_mfma_f32_32x32x16_bf16 v[64:79], v[188:191], v[108:111], v[64:79]
  ds_read_b128 v[104:107], v7 offset:56640
  s_waitcnt lgkmcnt(2)
  v_mfma_f32_32x32x16_bf16 v[64:79], v[224:227], v[96:99], v[64:79]
  ds_read_b128 v[108:111], v7 offset:58816
  s_waitcnt lgkmcnt(2)
  v_mfma_f32_32x32x16_bf16 v[64:79], v[228:231], v[100:103], v[64:79]
  s_barrier
  ds_read_b128 v[96:99], v7 offset:60992
  s_waitcnt lgkmcnt(2)
  v_mfma_f32_32x32x16_bf16 v[64:79], v[232:235], v[104:107], v[64:79]
  ds_read_b128 v[100:103], v7 offset:63168
  s_waitcnt lgkmcnt(2)
  v_mfma_f32_32x32x16_bf16 v[64:79], v[236:239], v[108:111], v[64:79]
  ds_read_b128 v[104:107], v7 offset:65344
  s_waitcnt lgkmcnt(2)
  v_mfma_f32_32x32x16_bf16 v[64:79], v[240:243], v[96:99], v[64:79]
  ds_read_b128 v[108:111], v8 offset:1984
  s_waitcnt lgkmcnt(2)
  v_mfma_f32_32x32x16_bf16 v[64:79], v[244:247], v[100:103], v[64:79]
  s_barrier
  ds_read_b128 v[96:99], v7 offset:16
  s_waitcnt lgkmcnt(2)
  v_mfma_f32_32x32x16_bf16 v[64:79], v[248:251], v[104:107], v[64:79]
  ds_read_b128 v[100:103], v7 offset:2192
  s_waitcnt lgkmcnt(2)
  v_mfma_f32_32x32x16_bf16 v[64:79], v[252:255], v[108:111], v[64:79]
  ds_read_b128 v[104:107], v7 offset:4368
  s_waitcnt lgkmcnt(2)
  v_mfma_f32_32x32x16_bf16 v[64:79], v[128:131], v[96:99], v[64:79]
  ds_read_b128 v[108:111], v7 offset:6544
  s_waitcnt lgkmcnt(2)
  v_mfma_f32_32x32x16_bf16 v[64:79], v[132:135], v[100:103], v[64:79]
  ds_read_b128 v[96:99], v7 offset:8720
  s_waitcnt lgkmcnt(2)
  v_mfma_f32_32x32x16_bf16 v[64:79], v[136:139], v[104:107], v[64:79]
  ds_read_b128 v[100:103], v7 offset:10896
  s_waitcnt lgkmcnt(2)
  v_mfma_f32_32x32x16_bf16 v[64:79], v[140:143], v[108:111], v[64:79]
  ds_read_b128 v[104:107], v7 offset:13072
  s_waitcnt lgkmcnt(2)
  v_mfma_f32_32x32x16_bf16 v[64:79], v[144:147], v[96:99], v[64:79]
  ds_read_b128 v[108:111], v7 offset:15248
  s_waitcnt lgkmcnt(2)
  v_mfma_f32_32x32x16_bf16 v[64:79], v[148:151], v[100:103], v[64:79]
  s_barrier
  ds_read_b128 v[96:99], v7 offset:34816
  s_waitcnt lgkmcnt(2)
  v_mfma_f32_32x32x16_bf16 v[64:79], v[152:155], v[104:107], v[64:79]
  ds_read_b128 v[100:103], v7 offset:36992
  s_waitcnt lgkmcnt(2)
  v_mfma_f32_32x32x16_bf16 v[64:79], v[156:159], v[108:111], v[64:79]
  ds_read_b128 v[104:107], v7 offset:39168
  s_waitcnt lgkmcnt(2)
  v_mfma_f32_32x32x16_bf16 v[64:79], v[192:195], v[96:99], v[64:79]
  ds_read_b128 v[108:111], v7 offset:41344
  s_waitcnt lgkmcnt(2)
  v_mfma_f32_32x32x16_bf16 v[64:79], v[196:199], v[100:103], v[64:79]
  ds_read_b128 v[96:99], v7 offset:43520
  s_waitcnt lgkmcnt(2)
  v_mfma_f32_32x32x16_bf16 v[64:79], v[200:203], v[104:107], v[64:79]
  ds_read_b128 v[100:103], v7 offset:45696
  s_waitcnt lgkmcnt(2)
  v_mfma_f32_32x32x16_bf16 v[64:79], v[204:207], v[108:111], v[64:79]
  ds_read_b128 v[104:107], v7 offset:47872
  s_waitcnt lgkmcnt(2)
  v_mfma_f32_32x32x16_bf16 v[64:79], v[208:211], v[96:99], v[64:79]
  ds_read_b128 v[108:111], v7 offset:50048
  s_waitcnt lgkmcnt(2)
  v_mfma_f32_32x32x16_bf16 v[64:79], v[212:215], v[100:103], v[64:79]
  s_waitcnt lgkmcnt(1)
  v_mfma_f32_32x32x16_bf16 v[64:79], v[216:219], v[104:107], v[64:79]
  s_waitcnt lgkmcnt(0)
  v_mfma_f32_32x32x16_bf16 v[64:79], v[220:223], v[108:111], v[64:79]
  s_branch CVE_14
CV1_13:
PAD_13:
  s_cbranch_execz L_TRAMP
  s_nop 0
  s_barrier
  ds_read_b128 v[96:99], v7 offset:16
  ds_read_b128 v[100:103], v7 offset:2192
  ds_read_b128 v[104:107], v7 offset:4368
  s_waitcnt lgkmcnt(2)
  v_mfma_f32_32x32x16_bf16 v[64:79], v[128:131], v[96:99], v[64:79]
  ds_read_b128 v[108:111], v7 offset:6544
  s_waitcnt lgkmcnt(2)
  v_mfma_f32_32x32x16_bf16 v[64:79], v[132:135], v[100:103], v[64:79]
  s_barrier
  ds_read_b128 v[96:99], v7 offset:8720
  s_waitcnt lgkmcnt(2)
  v_mfma_f32_32x32x16_bf16 v[64:79], v[136:139], v[104:107], v[64:79]
  ds_read_b128 v[100:103], v7 offset:10896
  s_waitcnt lgkmcnt(2)
  v_mfma_f32_32x32x16_bf16 v[64:79], v[140:143], v[108:111], v[64:79]
  ds_read_b128 v[104:107], v7 offset:13072
  s_waitcnt lgkmcnt(2)
  v_mfma_f32_32x32x16_bf16 v[64:79], v[144:147], v[96:99], v[64:79]
  ds_read_b128 v[108:111], v7 offset:15248
  s_waitcnt lgkmcnt(2)
  v_mfma_f32_32x32x16_bf16 v[64:79], v[148:151], v[100:103], v[64:79]
  s_barrier
  ds_read_b128 v[96:99], v7 offset:34816
  s_waitcnt lgkmcnt(2)
  v_mfma_f32_32x32x16_bf16 v[64:79], v[152:155], v[104:107], v[64:79]
  ds_read_b128 v[100:103], v7 offset:36992
  s_waitcnt lgkmcnt(2)
  v_mfma_f32_32x32x16_bf16 v[64:79], v[156:159], v[108:111], v[64:79]
  ds_read_b128 v[104:107], v7 offset:39168
  s_waitcnt lgkmcnt(2)
  v_mfma_f32_32x32x16_bf16 v[64:79], v[192:195], v[96:99], v[64:79]
  ds_read_b128 v[108:111], v7 offset:41344
  s_waitcnt lgkmcnt(2)
  v_mfma_f32_32x32x16_bf16 v[64:79], v[196:199], v[100:103], v[64:79]
  s_barrier
  ds_read_b128 v[96:99], v7 offset:43520
  s_waitcnt lgkmcnt(2)
  v_mfma_f32_32x32x16_bf16 v[64:79], v[200:203], v[104:107], v[64:79]
  ds_read_b128 v[100:103], v7 offset:45696
  s_waitcnt lgkmcnt(2)
  v_mfma_f32_32x32x16_bf16 v[64:79], v[204:207], v[108:111], v[64:79]
  ds_read_b128 v[104:107], v7 offset:47872
  s_waitcnt lgkmcnt(2)
  v_mfma_f32_32x32x16_bf16 v[64:79], v[208:211], v[96:99], v[64:79]
  ds_read_b128 v[108:111], v7 offset:50048
  s_waitcnt lgkmcnt(2)
  v_mfma_f32_32x32x16_bf16 v[64:79], v[212:215], v[100:103], v[64:79]
  s_barrier
  ds_read_b128 v[96:99], v7 offset:17456
  s_waitcnt lgkmcnt(2)
  v_mfma_f32_32x32x16_bf16 v[64:79], v[216:219], v[104:107], v[64:79]
  ds_read_b128 v[100:103], v7 offset:19632
  s_waitcnt lgkmcnt(2)
  v_mfma_f32_32x32x16_bf16 v[64:79], v[220:223], v[108:111], v[64:79]
  ds_read_b128 v[104:107], v7 offset:21808
  s_waitcnt lgkmcnt(2)
  v_mfma_f32_32x32x16_bf16 v[64:79], v[160:163], v[96:99], v[64:79]
  ds_read_b128 v[108:111], v7 offset:23984
  s_waitcnt lgkmcnt(2)
  v_mfma_f32_32x32x16_bf16 v[64:79], v[164:167], v[100:103], v[64:79]
  ds_read_b128 v[96:99], v7 offset:26160
  s_waitcnt lgkmcnt(2)
  v_mfma_f32_32x32x16_bf16 v[64:79], v[168:171], v[104:107], v[64:79]
  ds_read_b128 v[100:103], v7 offset:28336
  s_waitcnt lgkmcnt(2)
  v_mfma_f32_32x32x16_bf16 v[64:79], v[172:175], v[108:111], v[64:79]
  ds_read_b128 v[104:107], v7 offset:30512
  s_waitcnt lgkmcnt(2)
  v_mfma_f32_32x32x16_bf16 v[64:79], v[176:179], v[96:99], v[64:79]
  ds_read_b128 v[108:111], v7 offset:32688
  s_waitcnt lgkmcnt(2)
  v_mfma_f32_32x32x16_bf16 v[64:79], v[180:183], v[100:103], v[64:79]
  s_barrier
  ds_read_b128 v[96:99], v7 offset:52288
  s_waitcnt lgkmcnt(2)
  v_mfma_f32_32x32x16_bf16 v[64:79], v[184:187], v[104:107], v[64:79]
  ds_read_b128 v[100:103], v7 offset:54464
  s_waitcnt lgkmcnt(2)
  v_mfma_f32_32x32x16_bf16 v[64:79], v[188:191], v[108:111], v[64:79]
  ds_read_b128 v[104:107], v7 offset:56640
  s_waitcnt lgkmcnt(2)
  v_mfma_f32_32x32x16_bf16 v[64:79], v[224:227], v[96:99], v[64:79]
  ds_read_b128 v[108:111], v7 offset:58816
  s_waitcnt lgkmcnt(2)
  v_mfma_f32_32x32x16_bf16 v[64:79], v[228:231], v[100:103], v[64:79]
  ds_read_b128 v[96:99], v7 offset:60992
  s_waitcnt lgkmcnt(2)
  v_mfma_f32_32x32x16_bf16 v[64:79], v[232:235], v[104:107], v[64:79]
  ds_read_b128 v[100:103], v7 offset:63168
  s_waitcnt lgkmcnt(2)
  v_mfma_f32_32x32x16_bf16 v[64:79], v[236:239], v[108:111], v[64:79]
  ds_read_b128 v[104:107], v7 offset:65344
  s_waitcnt lgkmcnt(2)
  v_mfma_f32_32x32x16_bf16 v[64:79], v[240:243], v[96:99], v[64:79]
  ds_read_b128 v[108:111], v8 offset:1984
  s_waitcnt lgkmcnt(2)
  v_mfma_f32_32x32x16_bf16 v[64:79], v[244:247], v[100:103], v[64:79]
  s_waitcnt lgkmcnt(1)
  v_mfma_f32_32x32x16_bf16 v[64:79], v[248:251], v[104:107], v[64:79]
  s_waitcnt lgkmcnt(0)
  v_mfma_f32_32x32x16_bf16 v[64:79], v[252:255], v[108:111], v[64:79]
CVE_14:
  s_nop 8
  s_nop 0
  s_nop 2
  v_cvt_pk_bf16_f32 v96, v64, v65
  v_cvt_pk_bf16_f32 v97, v66, v67
  v_cvt_pk_bf16_f32 v98, v68, v69
  v_cvt_pk_bf16_f32 v99, v70, v71
  v_cvt_pk_bf16_f32 v100, v72, v73
  v_cvt_pk_bf16_f32 v101, v74, v75
  v_cvt_pk_bf16_f32 v102, v76, v77
  v_cvt_pk_bf16_f32 v103, v78, v79
  buffer_store_dwordx4 v[96:99], v16, s[4:7], s66 offen
  buffer_store_dwordx4 v[100:103], v16, s[4:7], s66 offen offset:2048
  v_pk_add_f32 v[112:113], v[64:65], v[66:67]
  v_pk_add_f32 v[114:115], v[68:69], v[70:71]
  v_pk_add_f32 v[116:117], v[72:73], v[74:75]
  v_pk_add_f32 v[118:119], v[76:77], v[78:79]
  v_pk_mul_f32 v[120:121], v[64:65], v[64:65]
  v_pk_fma_f32 v[120:121], v[66:67], v[66:67], v[120:121]
  v_pk_fma_f32 v[120:121], v[68:69], v[68:69], v[120:121]
  v_pk_fma_f32 v[120:121], v[70:71], v[70:71], v[120:121]
  v_pk_fma_f32 v[120:121], v[72:73], v[72:73], v[120:121]
  v_pk_fma_f32 v[120:121], v[74:75], v[74:75], v[120:121]
  v_pk_fma_f32 v[120:121], v[76:77], v[76:77], v[120:121]
  v_pk_fma_f32 v[120:121], v[78:79], v[78:79], v[120:121]
  v_pk_add_f32 v[112:113], v[112:113], v[114:115]
  v_pk_add_f32 v[116:117], v[116:117], v[118:119]
  v_add_f32_e64 v120, v120, v121
  v_pk_add_f32 v[112:113], v[112:113], v[116:117]
  v_add_f32 v112, v112, v113
  s_nop 1
  v_permlane32_swap_b32 v112, v120
  v_add_f32 v112, v112, v120
  buffer_store_dword v112, v28, s[4:7], s81 offen
  s_barrier
  s_waitcnt vmcnt(0)
  s_barrier
  s_nop 0
  ds_write_b128 v16, v[96:99] offset:0
  ds_write_b128 v16, v[100:103] offset:2048
  v_pk_add_f32 v[32:33], v[32:33], v[64:65]
  v_pk_add_f32 v[34:35], v[34:35], v[66:67]
  v_pk_add_f32 v[36:37], v[36:37], v[68:69]
  v_pk_add_f32 v[38:39], v[38:39], v[70:71]
  v_pk_add_f32 v[40:41], v[40:41], v[72:73]
  v_pk_add_f32 v[42:43], v[42:43], v[74:75]
  v_pk_add_f32 v[44:45], v[44:45], v[76:77]
  v_pk_add_f32 v[46:47], v[46:47], v[78:79]
  v_and_b32_e64 v29, 31, v1
  v_lshl_add_u32 v29, s61, 5, v29
  v_lshlrev_b32 v7, 4, v29
  v_lshrrev_b32 v30, 5, v1
  v_mul_u32_u24 v30, 1024, v30
  v_add_u32_e64 v7, v7, v30
  v_add_u32 v9, 0x20000, v7
  v_add_u32 v8, 0x10000, v7
  s_waitcnt lgkmcnt(0)
  s_barrier
  s_lshl_b32 s53, s55, 1
  v_add_u32 v111, s53, v27
  v_lshrrev_b32_e64 v29, 5, v1
  v_bfe_u32 v30, v1, 2, 2
  v_lshl_add_u32 v104, v29, 2, v30
  v_lshlrev_b32_e64 v104, 6, v104
  v_bfe_u32 v29, v1, 4, 1
  v_lshl_add_u32 v104, v29, 5, v104
  v_and_b32_e64 v29, 3, v1
  v_lshl_add_u32 v104, v29, 3, v104
  v_add_u32 v104, 0x10000, v104
  v_lshrrev_b32_e64 v29, 5, v1
  v_bfe_u32 v30, v1, 2, 2
  v_lshl_add_u32 v105, v29, 2, v30
  v_add_u32 v105, 8, v105
  v_lshlrev_b32 v105, 6, v105
  v_bfe_u32 v29, v1, 4, 1
  v_lshl_add_u32 v105, v29, 5, v105
  v_and_b32_e64 v29, 3, v1
  v_lshl_add_u32 v105, v29, 3, v105
  v_add_u32 v105, 0x10000, v105
  s_barrier
  s_nop 0
  ds_read_b64_tr_b16 v[80:81], v11 offset:40960
  ds_read_b64_tr_b16 v[82:83], v14 offset:40960
  ds_read_b128 v[128:131], v7 offset:0
  ds_read_b64_tr_b16 v[84:85], v11 offset:43008
  ds_read_b64_tr_b16 v[86:87], v14 offset:43008
  ds_read_b128 v[132:135], v7 offset:2048
  ds_read_b64_tr_b16 v[88:89], v11 offset:61440
  ds_read_b64_tr_b16 v[90:91], v14 offset:61440
  ds_read_b128 v[136:139], v7 offset:4096
  s_waitcnt lgkmcnt(6)
  v_mfma_f32_32x32x16_bf16 v[48:63], v[80:83], v[128:131], 0
  ds_read_b64_tr_b16 v[92:93], v11 offset:63488
  ds_read_b64_tr_b16 v[94:95], v14 offset:63488
  ds_read_b128 v[140:143], v7 offset:6144
  s_waitcnt lgkmcnt(6)
  v_mfma_f32_32x32x16_bf16 v[48:63], v[84:87], v[132:135], v[48:63]
  s_barrier
  ds_read_b64_tr_b16 v[80:81], v12 offset:0
  ds_read_b64_tr_b16 v[82:83], v15 offset:0
  ds_read_b128 v[144:147], v7 offset:8192
  s_waitcnt lgkmcnt(6)
  v_mfma_f32_32x32x16_bf16 v[48:63], v[88:91], v[136:139], v[48:63]
  ds_read_b64_tr_b16 v[84:85], v12 offset:2048
  ds_read_b64_tr_b16 v[86:87], v15 offset:2048
  ds_read_b128 v[148:151], v7 offset:10240
  s_waitcnt lgkmcnt(6)
  v_mfma_f32_32x32x16_bf16 v[48:63], v[92:95], v[140:143], v[48:63]
  ds_read_b64_tr_b16 v[88:89], v12 offset:4096
  ds_read_b64_tr_b16 v[90:91], v15 offset:4096
  ds_read_b128 v[152:155], v7 offset:12288
  s_waitcnt lgkmcnt(6)
  v_mfma_f32_32x32x16_bf16 v[48:63], v[80:83], v[144:147], v[48:63]
  ds_read_b64_tr_b16 v[92:93], v12 offset:6144
  ds_read_b64_tr_b16 v[94:95], v15 offset:6144
  ds_read_b128 v[156:159], v7 offset:14336
  s_waitcnt lgkmcnt(6)
  v_mfma_f32_32x32x16_bf16 v[48:63], v[84:87], v[148:151], v[48:63]
  s_barrier
  ds_read_b64_tr_b16 v[80:81], v11 offset:4096
  ds_read_b64_tr_b16 v[82:83], v14 offset:4096
  ds_read_b128 v[160:163], v7 offset:16384
  s_mul_i32 s69, s61, 86016
  s_add_u32 s69, s69, 65536
  v_add_u32 v29, s69, v28
  s_waitcnt lgkmcnt(6)
  v_mfma_f32_32x32x16_bf16 v[48:63], v[88:91], v[152:155], v[48:63]
  ds_read_b64_tr_b16 v[84:85], v11 offset:6144
  ds_read_b64_tr_b16 v[86:87], v14 offset:6144
  ds_read_b128 v[164:167], v7 offset:18432
  ds_read2st64_b32 v[64:65], v29 offset0:0 offset1:1
  ds_read2st64_b32 v[66:67], v29 offset0:2 offset1:3
  ds_read2st64_b32 v[68:69], v29 offset0:4 offset1:5
  ds_read2st64_b32 v[70:71], v29 offset0:6 offset1:7
  s_waitcnt lgkmcnt(10)
  v_mfma_f32_32x32x16_bf16 v[48:63], v[92:95], v[156:159], v[48:63]
  ds_read_b64_tr_b16 v[88:89], v11 offset:8192
  ds_read_b64_tr_b16 v[90:91], v14 offset:8192
  ds_read_b128 v[168:171], v7 offset:20480
  ds_read2st64_b32 v[72:73], v29 offset0:8 offset1:9
  ds_read2st64_b32 v[74:75], v29 offset0:10 offset1:11
  s_waitcnt lgkmcnt(12)
  v_mfma_f32_32x32x16_bf16 v[48:63], v[80:83], v[160:163], v[48:63]
  ds_read_b64_tr_b16 v[92:93], v11 offset:10240
  ds_read_b64_tr_b16 v[94:95], v14 offset:10240
  ds_read_b128 v[172:175], v7 offset:22528
  ds_read2st64_b32 v[76:77], v29 offset0:12 offset1:13
  s_waitcnt lgkmcnt(13)
  v_mfma_f32_32x32x16_bf16 v[48:63], v[84:87], v[164:167], v[48:63]
  s_barrier
PAD_14:
  s_cbranch_execz L_TRAMP
  s_nop 0
  ds_read_b64_tr_b16 v[80:81], v11 offset:12288
  ds_read_b64_tr_b16 v[82:83], v14 offset:12288
  ds_read_b128 v[176:179], v7 offset:24576
  ds_read2st64_b32 v[78:79], v29 offset0:14 offset1:15
  s_waitcnt lgkmcnt(10)
  v_mfma_f32_32x32x16_bf16 v[48:63], v[88:91], v[168:171], v[48:63]
  ds_read_b64_tr_b16 v[84:85], v11 offset:14336
  ds_read_b64_tr_b16 v[86:87], v14 offset:14336
  ds_read_b128 v[180:183], v7 offset:26624
  s_waitcnt lgkmcnt(8)
  v_mfma_f32_32x32x16_bf16 v[48:63], v[92:95], v[172:175], v[48:63]
  ds_read_b64_tr_b16 v[88:89], v11 offset:16384
  ds_read_b64_tr_b16 v[90:91], v14 offset:16384
  ds_read_b128 v[184:187], v7 offset:28672
  s_waitcnt lgkmcnt(7)
  v_mfma_f32_32x32x16_bf16 v[48:63], v[80:83], v[176:179], v[48:63]
  ds_read_b64_tr_b16 v[92:93], v11 offset:18432
  ds_read_b64_tr_b16 v[94:95], v14 offset:18432
  ds_read_b128 v[188:191], v7 offset:30720
  v_add_f32 v64, v64, v65
  v_add_f32 v66, v66, v67
  s_waitcnt lgkmcnt(6)
  v_mfma_f32_32x32x16_bf16 v[48:63], v[84:87], v[180:183], v[48:63]
  s_barrier
  ds_read_b64_tr_b16 v[80:81], v11 offset:20480
  ds_read_b64_tr_b16 v[82:83], v14 offset:20480
  ds_read_b128 v[192:195], v7 offset:32768
  v_add_f32 v68, v68, v69
  s_waitcnt lgkmcnt(6)
  v_mfma_f32_32x32x16_bf16 v[48:63], v[88:91], v[184:187], v[48:63]
  ds_read_b64_tr_b16 v[84:85], v11 offset:22528
  ds_read_b64_tr_b16 v[86:87], v14 offset:22528
  ds_read_b128 v[196:199], v7 offset:34816
  v_add_f32 v70, v70, v71
  v_add_f32 v72, v72, v73
  s_waitcnt lgkmcnt(6)
  v_mfma_f32_32x32x16_bf16 v[48:63], v[92:95], v[188:191], v[48:63]
  ds_read_b64_tr_b16 v[88:89], v11 offset:24576
  ds_read_b64_tr_b16 v[90:91], v14 offset:24576
  ds_read_b128 v[200:203], v7 offset:36864
  v_add_f32 v74, v74, v75
  s_waitcnt lgkmcnt(6)
  v_mfma_f32_32x32x16_bf16 v[48:63], v[80:83], v[192:195], v[48:63]
  ds_read_b64_tr_b16 v[92:93], v11 offset:26624
  ds_read_b64_tr_b16 v[94:95], v14 offset:26624
  ds_read_b128 v[204:207], v7 offset:38912
  v_add_f32 v76, v76, v77
  v_add_f32 v78, v78, v79
  s_waitcnt lgkmcnt(6)
  v_mfma_f32_32x32x16_bf16 v[48:63], v[84:87], v[196:199], v[48:63]
  s_barrier
  ds_read_b64_tr_b16 v[80:81], v11 offset:28672
  ds_read_b64_tr_b16 v[82:83], v14 offset:28672
  ds_read_b128 v[208:211], v7 offset:40960
  v_add_f32 v64, v64, v66
  s_waitcnt lgkmcnt(6)
  v_mfma_f32_32x32x16_bf16 v[48:63], v[88:91], v[200:203], v[48:63]
  ds_read_b64_tr_b16 v[84:85], v11 offset:30720
  ds_read_b64_tr_b16 v[86:87], v14 offset:30720
  ds_read_b128 v[212:215], v7 offset:43008
  v_add_f32 v68, v68, v70
  v_add_f32 v72, v72, v74
  s_waitcnt lgkmcnt(6)
  v_mfma_f32_32x32x16_bf16 v[48:63], v[92:95], v[204:207], v[48:63]
  ds_read_b64_tr_b16 v[88:89], v11 offset:32768
  ds_read_b64_tr_b16 v[90:91], v14 offset:32768
  ds_read_b128 v[216:219], v7 offset:45056
  v_add_f32 v76, v76, v78
  s_waitcnt lgkmcnt(6)
  v_mfma_f32_32x32x16_bf16 v[48:63], v[80:83], v[208:211], v[48:63]
  ds_read_b64_tr_b16 v[92:93], v11 offset:34816
  ds_read_b64_tr_b16 v[94:95], v14 offset:34816
  ds_read_b128 v[220:223], v7 offset:47104
  v_add_f32 v64, v64, v68
  v_add_f32 v72, v72, v76
  s_waitcnt lgkmcnt(6)
  v_mfma_f32_32x32x16_bf16 v[48:63], v[84:87], v[212:215], v[48:63]
  s_barrier
  ds_read_b64_tr_b16 v[80:81], v11 offset:36864
  ds_read_b64_tr_b16 v[82:83], v14 offset:36864
  ds_read_b128 v[224:227], v7 offset:49152
  v_add_f32 v64, v64, v72
  s_waitcnt lgkmcnt(6)
  v_mfma_f32_32x32x16_bf16 v[48:63], v[88:91], v[216:219], v[48:63]
  ds_read_b64_tr_b16 v[84:85], v11 offset:38912
  ds_read_b64_tr_b16 v[86:87], v14 offset:38912
  ds_read_b128 v[228:231], v7 offset:51200
  v_mov_b32 v30, v64
  s_nop 1
  v_permlane32_swap_b32 v64, v30
  s_waitcnt lgkmcnt(6)
  v_mfma_f32_32x32x16_bf16 v[48:63], v[92:95], v[220:223], v[48:63]
  ds_read_b64_tr_b16 v[88:89], v11 offset:45056
  ds_read_b64_tr_b16 v[90:91], v14 offset:45056
  ds_read_b128 v[232:235], v7 offset:53248
  v_mul_f32 v122, 0xbb000000, v64
  s_waitcnt lgkmcnt(6)
  v_mfma_f32_32x32x16_bf16 v[48:63], v[80:83], v[224:227], v[48:63]
  ds_read_b64_tr_b16 v[92:93], v11 offset:47104
  ds_read_b64_tr_b16 v[94:95], v14 offset:47104
  ds_read_b128 v[236:239], v7 offset:55296
  v_mul_f32 v30, 0x3b000000, v30
  v_fma_f32 v30, -v122, v122, v30
  s_waitcnt lgkmcnt(6)
  v_mfma_f32_32x32x16_bf16 v[48:63], v[84:87], v[228:231], v[48:63]
  s_barrier
  ds_read_b64_tr_b16 v[80:81], v11 offset:49152
  ds_read_b64_tr_b16 v[82:83], v14 offset:49152
  ds_read_b128 v[240:243], v7 offset:57344
  v_max_f32 v30, 0, v30
  s_waitcnt lgkmcnt(6)
  v_mfma_f32_32x32x16_bf16 v[48:63], v[88:91], v[232:235], v[48:63]
  ds_read_b64_tr_b16 v[84:85], v11 offset:51200
  ds_read_b64_tr_b16 v[86:87], v14 offset:51200
  ds_read_b128 v[244:247], v7 offset:59392
  v_add_f32 v29, 0x3727c5ac, v30
  v_rsq_f32 v126, v29
  s_waitcnt lgkmcnt(6)
  v_mfma_f32_32x32x16_bf16 v[48:63], v[92:95], v[236:239], v[48:63]
  ds_read_b64_tr_b16 v[88:89], v11 offset:53248
  ds_read_b64_tr_b16 v[90:91], v14 offset:53248
  ds_read_b128 v[248:251], v7 offset:61440
  v_mul_f32 v127, v122, v126
  s_waitcnt lgkmcnt(6)
  v_mfma_f32_32x32x16_bf16 v[48:63], v[80:83], v[240:243], v[48:63]
  ds_read_b64_tr_b16 v[92:93], v11 offset:55296
  ds_read_b64_tr_b16 v[94:95], v14 offset:55296
  ds_read_b128 v[252:255], v7 offset:63488
  v_mov_b32 v29, v126
  v_rcp_f32 v125, v29
  s_waitcnt lgkmcnt(6)
  v_mfma_f32_32x32x16_bf16 v[48:63], v[84:87], v[244:247], v[48:63]
  v_mul_f32 v123, 0xc0135761, v29
  s_waitcnt lgkmcnt(3)
  v_mfma_f32_32x32x16_bf16 v[48:63], v[88:91], v[248:251], v[48:63]
  v_mul_f32 v30, v29, v29
  v_mul_f32 v30, v30, v29
  s_waitcnt lgkmcnt(0)
  v_mfma_f32_32x32x16_bf16 v[48:63], v[92:95], v[252:255], v[48:63]
  v_mul_f32 v124, 0xbdd2d3e8, v30
  ds_read_b128 v[116:119], v111 offset:1024
  ds_read_b128 v[106:109], v111 offset:1056
  s_barrier
  ds_read_b64_tr_b16 v[80:81], v11 offset:57344
  ds_read_b64_tr_b16 v[82:83], v14 offset:57344
  ds_read_b64_tr_b16 v[84:85], v11 offset:59392
  ds_read_b64_tr_b16 v[86:87], v14 offset:59392
  ds_read_b64_tr_b16 v[88:89], v12 offset:8192
  ds_read_b64_tr_b16 v[90:91], v15 offset:8192
  s_waitcnt lgkmcnt(4)
  v_mfma_f32_32x32x16_bf16 v[64:79], v[80:83], v[128:131], 0
  ds_read_b64_tr_b16 v[92:93], v12 offset:10240
  ds_read_b64_tr_b16 v[94:95], v15 offset:10240
  v_fmac_f32 v48, v116, v122
  v_fmac_f32 v49, v117, v122
  v_fmac_f32 v50, v118, v122
  v_fmac_f32 v51, v119, v122
  s_waitcnt lgkmcnt(4)
  v_mfma_f32_32x32x16_bf16 v[64:79], v[84:87], v[132:135], v[64:79]
  ds_read_b64_tr_b16 v[80:81], v12 offset:12288
  ds_read_b64_tr_b16 v[82:83], v15 offset:12288
  ds_read_b128 v[116:119], v111 offset:1088
  v_mul_f32 v112, v48, v48
  v_mul_f32 v113, v49, v49
  v_mul_f32 v114, v50, v50
  v_mul_f32 v115, v51, v51
  v_fma_f32 v112, v112, v124, v123
  v_fma_f32 v113, v113, v124, v123
  s_waitcnt lgkmcnt(5)
  v_mfma_f32_32x32x16_bf16 v[64:79], v[88:91], v[136:139], v[64:79]
  ds_read_b64_tr_b16 v[84:85], v12 offset:14336
  ds_read_b64_tr_b16 v[86:87], v15 offset:14336
  v_fma_f32 v114, v114, v124, v123
  v_fma_f32 v115, v115, v124, v123
  v_mul_f32 v112, v112, v48
  v_mul_f32 v113, v113, v49
  v_mul_f32 v114, v114, v50
  s_waitcnt lgkmcnt(5)
  v_mfma_f32_32x32x16_bf16 v[64:79], v[92:95], v[140:143], v[64:79]
  ds_read_b64_tr_b16 v[88:89], v12 offset:16384
  ds_read_b64_tr_b16 v[90:91], v15 offset:16384
  v_mul_f32 v115, v115, v51
  v_exp_f32 v112, v112
  v_exp_f32 v113, v113
  s_waitcnt lgkmcnt(5)
  v_mfma_f32_32x32x16_bf16 v[64:79], v[80:83], v[144:147], v[64:79]
  ds_read_b64_tr_b16 v[92:93], v12 offset:18432
  ds_read_b64_tr_b16 v[94:95], v15 offset:18432
  v_exp_f32 v114, v114
  v_exp_f32_e64 v115, v115
  v_fma_f32 v112, v112, v125, v125
  v_fma_f32 v113, v113, v125, v125
  s_waitcnt lgkmcnt(4)
  v_mfma_f32_32x32x16_bf16 v[64:79], v[84:87], v[148:151], v[64:79]
  s_barrier
  ds_read_b64_tr_b16 v[80:81], v11 offset:4096
  ds_read_b64_tr_b16 v[82:83], v14 offset:4096
  v_fma_f32 v114, v114, v125, v125
  v_fma_f32 v115, v115, v125, v125
  v_rcp_f32 v112, v112
  v_rcp_f32 v113, v113
  s_waitcnt lgkmcnt(4)
  v_mfma_f32_32x32x16_bf16 v[64:79], v[88:91], v[152:155], v[64:79]
  ds_read_b64_tr_b16 v[84:85], v11 offset:6144
  ds_read_b64_tr_b16 v[86:87], v14 offset:6144
  v_rcp_f32 v114, v114
  v_rcp_f32 v115, v115
  v_mul_f32 v112, v112, v48
  s_waitcnt lgkmcnt(4)
  v_mfma_f32_32x32x16_bf16 v[64:79], v[92:95], v[156:159], v[64:79]
  ds_read_b64_tr_b16 v[88:89], v11 offset:40960
  ds_read_b64_tr_b16 v[90:91], v14 offset:40960
  v_mul_f32 v113, v113, v49
  v_mul_f32 v114, v114, v50
  v_mul_f32 v115, v115, v51
  v_cvt_pk_bf16_f32 v96, v112, v113
  v_cvt_pk_bf16_f32 v97, v114, v115
  v_fmac_f32 v52, v106, v122
  s_waitcnt lgkmcnt(4)
  v_mfma_f32_32x32x16_bf16 v[64:79], v[80:83], v[160:163], v[64:79]
  ds_read_b64_tr_b16 v[92:93], v11 offset:43008
  ds_read_b64_tr_b16 v[94:95], v14 offset:43008
  v_fmac_f32 v53, v107, v122
  v_fmac_f32 v54, v108, v122
  v_fmac_f32 v55, v109, v122
  s_waitcnt lgkmcnt(4)
  v_mfma_f32_32x32x16_bf16 v[64:79], v[84:87], v[164:167], v[64:79]
  ds_read_b64_tr_b16 v[80:81], v11 offset:61440
  ds_read_b64_tr_b16 v[82:83], v14 offset:61440
  ds_read_b128 v[106:109], v111 offset:1120
  v_mul_f32 v112, v52, v52
  v_mul_f32 v113, v53, v53
  v_mul_f32 v114, v54, v54
  v_mul_f32 v115, v55, v55
  v_fma_f32 v112, v112, v124, v123
  v_fma_f32 v113, v113, v124, v123
  s_waitcnt lgkmcnt(5)
  v_mfma_f32_32x32x16_bf16 v[64:79], v[88:91], v[168:171], v[64:79]
  ds_read_b64_tr_b16 v[84:85], v11 offset:63488
  ds_read_b64_tr_b16 v[86:87], v14 offset:63488
  v_fma_f32 v114, v114, v124, v123
  v_fma_f32 v115, v115, v124, v123
  v_mul_f32 v112, v112, v52
  v_mul_f32 v113, v113, v53
  v_mul_f32 v114, v114, v54
  v_mul_f32 v115, v115, v55
  s_waitcnt lgkmcnt(5)
  v_mfma_f32_32x32x16_bf16 v[64:79], v[92:95], v[172:175], v[64:79]
  ds_read_b64_tr_b16 v[88:89], v12 offset:0
  ds_read_b64_tr_b16 v[90:91], v15 offset:0
  v_exp_f32 v112, v112
  v_exp_f32 v113, v113
  v_exp_f32 v114, v114
  s_waitcnt lgkmcnt(5)
  v_mfma_f32_32x32x16_bf16 v[64:79], v[80:83], v[176:179], v[64:79]
  ds_read_b64_tr_b16 v[92:93], v12 offset:2048
  ds_read_b64_tr_b16 v[94:95], v15 offset:2048
  v_exp_f32_e64 v115, v115
  v_fma_f32 v112, v112, v125, v125
  v_fma_f32 v113, v113, v125, v125
  v_fma_f32 v114, v114, v125, v125
  s_waitcnt lgkmcnt(4)
  v_mfma_f32_32x32x16_bf16 v[64:79], v[84:87], v[180:183], v[64:79]
  s_barrier
  ds_read_b64_tr_b16 v[80:81], v11 offset:0
  ds_read_b64_tr_b16 v[82:83], v14 offset:0
  v_fma_f32 v115, v115, v125, v125
  v_rcp_f32 v112, v112
  v_rcp_f32 v113, v113
  s_waitcnt lgkmcnt(4)
  v_mfma_f32_32x32x16_bf16 v[64:79], v[88:91], v[184:187], v[64:79]
  ds_read_b64_tr_b16 v[84:85], v11 offset:2048
  ds_read_b64_tr_b16 v[86:87], v14 offset:2048
  v_rcp_f32 v114, v114
  v_rcp_f32 v115, v115
  v_mul_f32 v112, v112, v52
  v_mul_f32 v113, v113, v53
  s_waitcnt lgkmcnt(4)
  v_mfma_f32_32x32x16_bf16 v[64:79], v[92:95], v[188:191], v[64:79]
  ds_read_b64_tr_b16 v[88:89], v11 offset:8192
  ds_read_b64_tr_b16 v[90:91], v14 offset:8192
  v_mul_f32 v114, v114, v54
  v_mul_f32 v115, v115, v55
  v_cvt_pk_bf16_f32 v98, v112, v113
  v_cvt_pk_bf16_f32 v99, v114, v115
  v_fmac_f32 v56, v116, v122
  s_waitcnt lgkmcnt(4)
  v_mfma_f32_32x32x16_bf16 v[64:79], v[80:83], v[192:195], v[64:79]
  ds_read_b64_tr_b16 v[92:93], v11 offset:10240
  ds_read_b64_tr_b16 v[94:95], v14 offset:10240
  v_fmac_f32 v57, v117, v122
  v_fmac_f32 v58, v118, v122
  v_fmac_f32 v59, v119, v122
  v_mul_f32 v112, v56, v56
  v_mul_f32 v113, v57, v57
  s_waitcnt lgkmcnt(4)
  v_mfma_f32_32x32x16_bf16 v[64:79], v[84:87], v[196:199], v[64:79]
  ds_read_b64_tr_b16 v[80:81], v11 offset:12288
  ds_read_b64_tr_b16 v[82:83], v14 offset:12288
  v_mul_f32 v114, v58, v58
  v_mul_f32 v115, v59, v59
  v_fma_f32 v112, v112, v124, v123
  v_fma_f32 v113, v113, v124, v123
  v_fma_f32 v114, v114, v124, v123
  v_fma_f32 v115, v115, v124, v123
  s_waitcnt lgkmcnt(4)
  v_mfma_f32_32x32x16_bf16 v[64:79], v[88:91], v[200:203], v[64:79]
  ds_read_b64_tr_b16 v[84:85], v11 offset:14336
  ds_read_b64_tr_b16 v[86:87], v14 offset:14336
  v_mul_f32 v112, v112, v56
  v_mul_f32 v113, v113, v57
  v_mul_f32 v114, v114, v58
  v_mul_f32 v115, v115, v59
  v_exp_f32 v112, v112
  s_waitcnt lgkmcnt(4)
  v_mfma_f32_32x32x16_bf16 v[64:79], v[92:95], v[204:207], v[64:79]
  ds_read_b64_tr_b16 v[88:89], v10 offset:28672
  ds_read_b64_tr_b16 v[90:91], v13 offset:28672
  v_exp_f32 v113, v113
  v_exp_f32 v114, v114
  s_waitcnt lgkmcnt(4)
  v_mfma_f32_32x32x16_bf16 v[64:79], v[80:83], v[208:211], v[64:79]
  ds_read_b64_tr_b16 v[92:93], v10 offset:30720
  ds_read_b64_tr_b16 v[94:95], v13 offset:30720
  v_exp_f32_e64 v115, v115
  v_fma_f32 v112, v112, v125, v125
  v_fma_f32 v113, v113, v125, v125
  v_fma_f32 v114, v114, v125, v125
  v_fma_f32 v115, v115, v125, v125
  s_waitcnt lgkmcnt(4)
  v_mfma_f32_32x32x16_bf16 v[64:79], v[84:87], v[212:215], v[64:79]
  s_barrier
  ds_read_b64_tr_b16 v[80:81], v10 offset:32768
  ds_read_b64_tr_b16 v[82:83], v13 offset:32768
  v_rcp_f32 v112, v112
  v_rcp_f32 v113, v113
  v_rcp_f32 v114, v114
  s_waitcnt lgkmcnt(4)
  v_mfma_f32_32x32x16_bf16 v[64:79], v[88:91], v[216:219], v[64:79]
  ds_read_b64_tr_b16 v[84:85], v10 offset:34816
  ds_read_b64_tr_b16 v[86:87], v13 offset:34816
  v_rcp_f32 v115, v115
  v_mul_f32 v112, v112, v56
  v_mul_f32 v113, v113, v57
  v_mul_f32 v114, v114, v58
  s_waitcnt lgkmcnt(4)
  v_mfma_f32_32x32x16_bf16 v[64:79], v[92:95], v[220:223], v[64:79]
  ds_read_b64_tr_b16 v[88:89], v10 offset:36864
  ds_read_b64_tr_b16 v[90:91], v13 offset:36864
  v_mul_f32 v115, v115, v59
  v_cvt_pk_bf16_f32 v100, v112, v113
  v_cvt_pk_bf16_f32 v101, v114, v115
  v_fmac_f32 v60, v106, v122
  v_fmac_f32 v61, v107, v122
  v_fmac_f32 v62, v108, v122
  s_waitcnt lgkmcnt(4)
  v_mfma_f32_32x32x16_bf16 v[64:79], v[80:83], v[224:227], v[64:79]
  ds_read_b64_tr_b16 v[92:93], v10 offset:38912
  ds_read_b64_tr_b16 v[94:95], v13 offset:38912
  v_fmac_f32 v63, v109, v122
  v_mul_f32 v112, v60, v60
  v_mul_f32 v113, v61, v61
  v_mul_f32 v114, v62, v62
  v_mul_f32 v115, v63, v63
  s_waitcnt lgkmcnt(4)
  v_mfma_f32_32x32x16_bf16 v[64:79], v[84:87], v[228:231], v[64:79]
  ds_read_b64_tr_b16 v[80:81], v10 offset:40960
  ds_read_b64_tr_b16 v[82:83], v13 offset:40960
  v_fma_f32 v112, v112, v124, v123
  v_fma_f32 v113, v113, v124, v123
  v_fma_f32 v114, v114, v124, v123
  v_fma_f32 v115, v115, v124, v123
  v_mul_f32 v112, v112, v60
  s_waitcnt lgkmcnt(4)
  v_mfma_f32_32x32x16_bf16 v[64:79], v[88:91], v[232:235], v[64:79]
  ds_read_b64_tr_b16 v[84:85], v10 offset:43008
  ds_read_b64_tr_b16 v[86:87], v13 offset:43008
  v_mul_f32 v113, v113, v61
  v_mul_f32 v114, v114, v62
  v_mul_f32 v115, v115, v63
  v_exp_f32 v112, v112
  s_waitcnt lgkmcnt(4)
  v_mfma_f32_32x32x16_bf16 v[64:79], v[92:95], v[236:239], v[64:79]
  ds_read_b64_tr_b16 v[88:89], v10 offset:45056
  ds_read_b64_tr_b16 v[90:91], v13 offset:45056
  v_exp_f32 v113, v113
  v_exp_f32 v114, v114
  v_exp_f32 v115, v115
  s_waitcnt lgkmcnt(4)
  v_mfma_f32_32x32x16_bf16 v[64:79], v[80:83], v[240:243], v[64:79]
  ds_read_b64_tr_b16 v[92:93], v10 offset:47104
  ds_read_b64_tr_b16 v[94:95], v13 offset:47104
  v_fma_f32 v112, v112, v125, v125
  v_fma_f32 v113, v113, v125, v125
  v_fma_f32 v114, v114, v125, v125
  v_fma_f32 v115, v115, v125, v125
  v_rcp_f32 v112, v112
  s_waitcnt lgkmcnt(4)
  v_mfma_f32_32x32x16_bf16 v[64:79], v[84:87], v[244:247], v[64:79]
  v_rcp_f32 v113, v113
  v_rcp_f32 v114, v114
  v_rcp_f32 v115, v115
  s_waitcnt lgkmcnt(2)
  v_mfma_f32_32x32x16_bf16 v[64:79], v[88:91], v[248:251], v[64:79]
  v_mul_f32 v112, v112, v60
  v_mul_f32 v113, v113, v61
  v_mul_f32 v114, v114, v62
  v_mul_f32_e64 v115, v115, v63
  v_cvt_pk_bf16_f32 v102, v112, v113
  s_waitcnt lgkmcnt(0)
  v_mfma_f32_32x32x16_bf16 v[64:79], v[92:95], v[252:255], v[64:79]
  v_cvt_pk_bf16_f32 v103, v114, v115
  s_add_u32 s70, s67, 0
  s_sub_u32 s54, s70, s83
  v_add_u32 v31, s54, v16
  buffer_store_dwordx4 v[96:99], v16, s[4:7], s70 offen
  buffer_store_dwordx4 v[100:103], v16, s[4:7], s70 offen offset:2048
  ds_write_b128 v31, v[96:99] offset:0
  ds_write_b128 v31, v[100:103] offset:2048
  ds_read_b128 v[116:119], v111 offset:1280
  ds_read_b128 v[106:109], v111 offset:1312
  s_barrier
  s_nop 0
  ds_read_b64_tr_b16 v[80:81], v10 offset:49152
  ds_read_b64_tr_b16 v[82:83], v13 offset:49152
  ds_read_b64_tr_b16 v[84:85], v10 offset:51200
  ds_read_b64_tr_b16 v[86:87], v13 offset:51200
  ds_read_b64_tr_b16 v[88:89], v10 offset:53248
  ds_read_b64_tr_b16 v[90:91], v13 offset:53248
  s_waitcnt lgkmcnt(4)
  v_mfma_f32_32x32x16_bf16 v[48:63], v[80:83], v[128:131], 0
  ds_read_b64_tr_b16 v[92:93], v10 offset:55296
  ds_read_b64_tr_b16 v[94:95], v13 offset:55296
  v_fmac_f32 v64, v116, v122
  v_fmac_f32 v65, v117, v122
  v_fmac_f32 v66, v118, v122
  v_fmac_f32 v67, v119, v122
  s_waitcnt lgkmcnt(4)
  v_mfma_f32_32x32x16_bf16 v[48:63], v[84:87], v[132:135], v[48:63]
  ds_read_b64_tr_b16 v[80:81], v10 offset:57344
  ds_read_b64_tr_b16 v[82:83], v13 offset:57344
  ds_read_b128 v[116:119], v111 offset:1344
  v_mul_f32 v112, v64, v64
  v_mul_f32 v113, v65, v65
  v_mul_f32 v114, v66, v66
  v_mul_f32 v115, v67, v67
  v_fma_f32 v112, v112, v124, v123
  v_fma_f32 v113, v113, v124, v123
  s_waitcnt lgkmcnt(5)
  v_mfma_f32_32x32x16_bf16 v[48:63], v[88:91], v[136:139], v[48:63]
  ds_read_b64_tr_b16 v[84:85], v10 offset:59392
  ds_read_b64_tr_b16 v[86:87], v13 offset:59392
  v_fma_f32 v114, v114, v124, v123
  v_fma_f32 v115, v115, v124, v123
  v_mul_f32 v112, v112, v64
  v_mul_f32 v113, v113, v65
  v_mul_f32 v114, v114, v66
  s_waitcnt lgkmcnt(5)
  v_mfma_f32_32x32x16_bf16 v[48:63], v[92:95], v[140:143], v[48:63]
  ds_read_b64_tr_b16 v[88:89], v10 offset:61440
  ds_read_b64_tr_b16 v[90:91], v13 offset:61440
  v_mul_f32 v115, v115, v67
  v_exp_f32 v112, v112
  v_exp_f32 v113, v113
  s_waitcnt lgkmcnt(5)
  v_mfma_f32_32x32x16_bf16 v[48:63], v[80:83], v[144:147], v[48:63]
  ds_read_b64_tr_b16 v[92:93], v10 offset:63488
  ds_read_b64_tr_b16 v[94:95], v13 offset:63488
  v_exp_f32 v114, v114
  v_exp_f32_e64 v115, v115
  v_fma_f32 v112, v112, v125, v125
  v_fma_f32 v113, v113, v125, v125
  s_waitcnt lgkmcnt(4)
  v_mfma_f32_32x32x16_bf16 v[48:63], v[84:87], v[148:151], v[48:63]
  s_barrier
  ds_read_b64_tr_b16 v[80:81], v11 offset:16384
  ds_read_b64_tr_b16 v[82:83], v14 offset:16384
  v_fma_f32 v114, v114, v125, v125
  v_fma_f32 v115, v115, v125, v125
  v_rcp_f32 v112, v112
  v_rcp_f32 v113, v113
  s_waitcnt lgkmcnt(4)
  v_mfma_f32_32x32x16_bf16 v[48:63], v[88:91], v[152:155], v[48:63]
  ds_read_b64_tr_b16 v[84:85], v11 offset:18432
  ds_read_b64_tr_b16 v[86:87], v14 offset:18432
  v_rcp_f32 v114, v114
  v_rcp_f32 v115, v115
  v_mul_f32 v112, v112, v64
  s_waitcnt lgkmcnt(4)
  v_mfma_f32_32x32x16_bf16 v[48:63], v[92:95], v[156:159], v[48:63]
  ds_read_b64_tr_b16 v[88:89], v11 offset:20480
  ds_read_b64_tr_b16 v[90:91], v14 offset:20480
  v_mul_f32 v113, v113, v65
  v_mul_f32 v114, v114, v66
  v_mul_f32 v115, v115, v67
  v_cvt_pk_bf16_f32 v96, v112, v113
  v_cvt_pk_bf16_f32 v97, v114, v115
  v_fmac_f32 v68, v106, v122
  s_waitcnt lgkmcnt(4)
  v_mfma_f32_32x32x16_bf16 v[48:63], v[80:83], v[160:163], v[48:63]
  ds_read_b64_tr_b16 v[92:93], v11 offset:22528
  ds_read_b64_tr_b16 v[94:95], v14 offset:22528
  v_fmac_f32 v69, v107, v122
  v_fmac_f32 v70, v108, v122
  v_fmac_f32 v71, v109, v122
  s_waitcnt lgkmcnt(4)
  v_mfma_f32_32x32x16_bf16 v[48:63], v[84:87], v[164:167], v[48:63]
  ds_read_b64_tr_b16 v[80:81], v11 offset:24576
  ds_read_b64_tr_b16 v[82:83], v14 offset:24576
  ds_read_b128 v[106:109], v111 offset:1376
  v_mul_f32 v112, v68, v68
  v_mul_f32 v113, v69, v69
  v_mul_f32 v114, v70, v70
  v_mul_f32 v115, v71, v71
  v_fma_f32 v112, v112, v124, v123
  v_fma_f32 v113, v113, v124, v123
  s_waitcnt lgkmcnt(5)
  v_mfma_f32_32x32x16_bf16 v[48:63], v[88:91], v[168:171], v[48:63]
  ds_read_b64_tr_b16 v[84:85], v11 offset:26624
  ds_read_b64_tr_b16 v[86:87], v14 offset:26624
  v_fma_f32 v114, v114, v124, v123
  v_fma_f32 v115, v115, v124, v123
  v_mul_f32 v112, v112, v68
  v_mul_f32 v113, v113, v69
  v_mul_f32 v114, v114, v70
  v_mul_f32 v115, v115, v71
  s_waitcnt lgkmcnt(5)
  v_mfma_f32_32x32x16_bf16 v[48:63], v[92:95], v[172:175], v[48:63]
  ds_read_b64_tr_b16 v[88:89], v11 offset:28672
  ds_read_b64_tr_b16 v[90:91], v14 offset:28672
  v_exp_f32 v112, v112
  v_exp_f32 v113, v113
  v_exp_f32 v114, v114
  s_waitcnt lgkmcnt(5)
  v_mfma_f32_32x32x16_bf16 v[48:63], v[80:83], v[176:179], v[48:63]
  ds_read_b64_tr_b16 v[92:93], v11 offset:30720
  ds_read_b64_tr_b16 v[94:95], v14 offset:30720
  v_exp_f32_e64 v115, v115
  v_fma_f32 v112, v112, v125, v125
  v_fma_f32 v113, v113, v125, v125
  v_fma_f32 v114, v114, v125, v125
  s_waitcnt lgkmcnt(4)
  v_mfma_f32_32x32x16_bf16 v[48:63], v[84:87], v[180:183], v[48:63]
  s_barrier
  s_mul_i32 s53, s61, 4096
  s_add_u32 s53, s53, 32768
  ds_read_b64_tr_b16 v[80:81], v11 offset:32768
  ds_read_b64_tr_b16 v[82:83], v14 offset:32768
  v_fma_f32 v115, v115, v125, v125
  v_rcp_f32 v112, v112
  v_rcp_f32 v113, v113
  s_waitcnt lgkmcnt(4)
  v_mfma_f32_32x32x16_bf16 v[48:63], v[88:91], v[184:187], v[48:63]
  ds_read_b64_tr_b16 v[84:85], v11 offset:34816
  ds_read_b64_tr_b16 v[86:87], v14 offset:34816
  v_rcp_f32 v114, v114
  v_rcp_f32 v115, v115
  v_mul_f32 v112, v112, v68
  v_mul_f32 v113, v113, v69
  s_waitcnt lgkmcnt(4)
  v_mfma_f32_32x32x16_bf16 v[48:63], v[92:95], v[188:191], v[48:63]
  ds_read_b64_tr_b16 v[88:89], v11 offset:36864
  ds_read_b64_tr_b16 v[90:91], v14 offset:36864
  v_mul_f32 v114, v114, v70
  v_mul_f32 v115, v115, v71
  v_cvt_pk_bf16_f32 v98, v112, v113
  v_cvt_pk_bf16_f32 v99, v114, v115
  v_fmac_f32 v72, v116, v122
  s_waitcnt lgkmcnt(4)
  v_mfma_f32_32x32x16_bf16 v[48:63], v[80:83], v[192:195], v[48:63]
  ds_read_b64_tr_b16 v[92:93], v11 offset:38912
  ds_read_b64_tr_b16 v[94:95], v14 offset:38912
  v_fmac_f32 v73, v117, v122
  v_fmac_f32 v74, v118, v122
  v_fmac_f32 v75, v119, v122
  v_mul_f32 v112, v72, v72
  v_mul_f32 v113, v73, v73
  s_waitcnt lgkmcnt(4)
  v_mfma_f32_32x32x16_bf16 v[48:63], v[84:87], v[196:199], v[48:63]
  ds_read_b64_tr_b16 v[80:81], v11 offset:4096
  ds_read_b64_tr_b16 v[82:83], v14 offset:4096
  v_mul_f32 v114, v74, v74
  v_mul_f32 v115, v75, v75
  v_fma_f32 v112, v112, v124, v123
  v_fma_f32 v113, v113, v124, v123
  v_fma_f32 v114, v114, v124, v123
  v_fma_f32 v115, v115, v124, v123
  s_waitcnt lgkmcnt(4)
  v_mfma_f32_32x32x16_bf16 v[48:63], v[88:91], v[200:203], v[48:63]
  ds_read_b64_tr_b16 v[84:85], v11 offset:6144
  ds_read_b64_tr_b16 v[86:87], v14 offset:6144
  v_mul_f32 v112, v112, v72
  v_mul_f32 v113, v113, v73
  v_mul_f32 v114, v114, v74
  v_mul_f32 v115, v115, v75
  v_exp_f32 v112, v112
  s_waitcnt lgkmcnt(4)
  v_mfma_f32_32x32x16_bf16 v[48:63], v[92:95], v[204:207], v[48:63]
  ds_read_b64_tr_b16 v[88:89], v11 offset:40960
  ds_read_b64_tr_b16 v[90:91], v14 offset:40960
  v_exp_f32 v113, v113
  v_exp_f32 v114, v114
  s_waitcnt lgkmcnt(4)
  v_mfma_f32_32x32x16_bf16 v[48:63], v[80:83], v[208:211], v[48:63]
  ds_read_b64_tr_b16 v[92:93], v11 offset:43008
  ds_read_b64_tr_b16 v[94:95], v14 offset:43008
  v_exp_f32_e64 v115, v115
  v_fma_f32 v112, v112, v125, v125
  v_fma_f32 v113, v113, v125, v125
  v_fma_f32 v114, v114, v125, v125
  v_fma_f32 v115, v115, v125, v125
  v_lshlrev_b32 v110, 4, v1
  v_add_u32 v110, s53, v110
  s_waitcnt lgkmcnt(4)
  v_mfma_f32_32x32x16_bf16 v[48:63], v[84:87], v[212:215], v[48:63]
  s_barrier
  ds_read_b64_tr_b16 v[80:81], v11 offset:45056
  ds_read_b64_tr_b16 v[82:83], v14 offset:45056
  v_rcp_f32 v112, v112
  v_rcp_f32 v113, v113
  v_rcp_f32 v114, v114
  s_waitcnt lgkmcnt(4)
  v_mfma_f32_32x32x16_bf16 v[48:63], v[88:91], v[216:219], v[48:63]
  ds_read_b64_tr_b16 v[84:85], v11 offset:47104
  ds_read_b64_tr_b16 v[86:87], v14 offset:47104
  v_rcp_f32 v115, v115
  v_mul_f32 v112, v112, v72
  v_mul_f32 v113, v113, v73
  v_mul_f32 v114, v114, v74
  s_waitcnt lgkmcnt(4)
  v_mfma_f32_32x32x16_bf16 v[48:63], v[92:95], v[220:223], v[48:63]
  ds_read_b64_tr_b16 v[88:89], v11 offset:49152
  ds_read_b64_tr_b16 v[90:91], v14 offset:49152
  v_mul_f32 v115, v115, v75
  v_cvt_pk_bf16_f32 v100, v112, v113
  v_cvt_pk_bf16_f32 v101, v114, v115
  v_fmac_f32 v76, v106, v122
  v_fmac_f32 v77, v107, v122
  v_fmac_f32 v78, v108, v122
  s_waitcnt lgkmcnt(4)
  v_mfma_f32_32x32x16_bf16 v[48:63], v[80:83], v[224:227], v[48:63]
  ds_read_b64_tr_b16 v[92:93], v11 offset:51200
  ds_read_b64_tr_b16 v[94:95], v14 offset:51200
  v_fmac_f32 v79, v109, v122
  v_mul_f32 v112, v76, v76
  v_mul_f32 v113, v77, v77
  v_mul_f32 v114, v78, v78
  v_mul_f32 v115, v79, v79
  s_waitcnt lgkmcnt(4)
  v_mfma_f32_32x32x16_bf16 v[48:63], v[84:87], v[228:231], v[48:63]
  ds_read_b64_tr_b16 v[80:81], v11 offset:53248
  ds_read_b64_tr_b16 v[82:83], v14 offset:53248
  v_fma_f32 v112, v112, v124, v123
  v_fma_f32 v113, v113, v124, v123
  v_fma_f32 v114, v114, v124, v123
  v_fma_f32 v115, v115, v124, v123
  v_mul_f32 v112, v112, v76
  s_waitcnt lgkmcnt(4)
PAD_15:
  s_cbranch_execz L_TRAMP
  s_nop 0
  v_mfma_f32_32x32x16_bf16 v[48:63], v[88:91], v[232:235], v[48:63]
  ds_read_b64_tr_b16 v[84:85], v11 offset:55296
  ds_read_b64_tr_b16 v[86:87], v14 offset:55296
  v_mul_f32 v113, v113, v77
  v_mul_f32 v114, v114, v78
  v_mul_f32 v115, v115, v79
  v_exp_f32 v112, v112
  s_waitcnt lgkmcnt(4)
  v_mfma_f32_32x32x16_bf16 v[48:63], v[92:95], v[236:239], v[48:63]
  ds_read_b64_tr_b16 v[88:89], v11 offset:0
  ds_read_b64_tr_b16 v[90:91], v14 offset:0
  v_exp_f32 v113, v113
  v_exp_f32 v114, v114
  v_exp_f32 v115, v115
  s_waitcnt lgkmcnt(4)
  v_mfma_f32_32x32x16_bf16 v[48:63], v[80:83], v[240:243], v[48:63]
  ds_read_b64_tr_b16 v[92:93], v11 offset:2048
  ds_read_b64_tr_b16 v[94:95], v14 offset:2048
  v_fma_f32 v112, v112, v125, v125
  v_fma_f32 v113, v113, v125, v125
  v_fma_f32 v114, v114, v125, v125
  v_fma_f32 v115, v115, v125, v125
  v_rcp_f32 v112, v112
  s_waitcnt lgkmcnt(4)
  v_mfma_f32_32x32x16_bf16 v[48:63], v[84:87], v[244:247], v[48:63]
  v_rcp_f32 v113, v113
  v_rcp_f32 v114, v114
  v_rcp_f32 v115, v115
  s_waitcnt lgkmcnt(2)
  v_mfma_f32_32x32x16_bf16 v[48:63], v[88:91], v[248:251], v[48:63]
  v_mul_f32 v112, v112, v76
  v_mul_f32 v113, v113, v77
  v_mul_f32 v114, v114, v78
  v_mul_f32_e64 v115, v115, v79
  v_cvt_pk_bf16_f32 v102, v112, v113
  s_waitcnt lgkmcnt(0)
  v_mfma_f32_32x32x16_bf16 v[48:63], v[92:95], v[252:255], v[48:63]
  v_cvt_pk_bf16_f32 v103, v114, v115
  s_add_u32 s70, s67, 8192
  s_sub_u32 s54, s70, s83
  v_add_u32_e64 v31, s54, v16
  buffer_store_dwordx4 v[96:99], v16, s[4:7], s70 offen
  buffer_store_dwordx4 v[100:103], v16, s[4:7], s70 offen offset:2048
  ds_write_b128 v31, v[96:99] offset:0
  ds_write_b128 v31, v[100:103] offset:2048
  ds_read_b128 v[116:119], v111 offset:1536
  ds_read_b128 v[106:109], v111 offset:1568
  s_barrier
  s_cmp_lg_u32 s64, 0
  s_nop 0
  s_cbranch_scc1 CV1_15
  ds_read_b64_tr_b16 v[80:81], v104 offset:8192
  ds_read_b64_tr_b16 v[82:83], v105 offset:8192
  ds_read_b64_tr_b16 v[84:85], v104 offset:9216
  ds_read_b64_tr_b16 v[86:87], v105 offset:9216
  ds_read_b64_tr_b16 v[88:89], v104 offset:10240
  ds_read_b64_tr_b16 v[90:91], v105 offset:10240
  s_waitcnt lgkmcnt(4)
  v_mfma_f32_32x32x16_bf16 v[64:79], v[80:83], v[128:131], 0
  ds_read_b64_tr_b16 v[92:93], v104 offset:11264
  ds_read_b64_tr_b16 v[94:95], v105 offset:11264
  v_fmac_f32 v48, v116, v122
  v_fmac_f32 v49, v117, v122
  v_fmac_f32 v50, v118, v122
  v_fmac_f32 v51, v119, v122
  s_waitcnt lgkmcnt(4)
  v_mfma_f32_32x32x16_bf16 v[64:79], v[84:87], v[132:135], v[64:79]
  ds_read_b64_tr_b16 v[80:81], v104 offset:12288
  ds_read_b64_tr_b16 v[82:83], v105 offset:12288
  ds_read_b128 v[116:119], v111 offset:1600
  v_mul_f32 v112, v48, v48
  v_mul_f32 v113, v49, v49
  v_mul_f32 v114, v50, v50
  v_mul_f32 v115, v51, v51
  v_fma_f32 v112, v112, v124, v123
  v_fma_f32 v113, v113, v124, v123
  v_fma_f32 v114, v114, v124, v123
  v_fma_f32 v115, v115, v124, v123
  v_mul_f32 v112, v112, v48
  v_mul_f32 v113, v113, v49
  v_mul_f32 v114, v114, v50
  v_mul_f32 v115, v115, v51
  v_exp_f32 v112, v112
  v_exp_f32 v113, v113
  s_waitcnt lgkmcnt(5)
  v_mfma_f32_32x32x16_bf16 v[64:79], v[88:91], v[136:139], v[64:79]
  ds_read_b64_tr_b16 v[84:85], v104 offset:13312
  ds_read_b64_tr_b16 v[86:87], v105 offset:13312
  v_exp_f32 v114, v114
  v_exp_f32_e64 v115, v115
  v_fma_f32 v112, v112, v125, v125
  v_fma_f32 v113, v113, v125, v125
  v_fma_f32 v114, v114, v125, v125
  v_fma_f32 v115, v115, v125, v125
  v_rcp_f32 v112, v112
  v_rcp_f32 v113, v113
  s_waitcnt lgkmcnt(5)
  v_mfma_f32_32x32x16_bf16 v[64:79], v[92:95], v[140:143], v[64:79]
  ds_read_b64_tr_b16 v[88:89], v104 offset:14336
  ds_read_b64_tr_b16 v[90:91], v105 offset:14336
  v_rcp_f32 v114, v114
  v_rcp_f32 v115, v115
  v_mul_f32 v112, v112, v48
  v_mul_f32 v113, v113, v49
  v_mul_f32 v114, v114, v50
  v_mul_f32_e64 v115, v115, v51
  v_cvt_pk_bf16_f32 v96, v112, v113
  v_cvt_pk_bf16_f32 v97, v114, v115
  v_fmac_f32 v52, v106, v122
  s_waitcnt lgkmcnt(5)
  v_mfma_f32_32x32x16_bf16 v[64:79], v[80:83], v[144:147], v[64:79]
  ds_read_b64_tr_b16 v[92:93], v104 offset:15360
  ds_read_b64_tr_b16 v[94:95], v105 offset:15360
  v_fmac_f32 v53, v107, v122
  v_fmac_f32 v54, v108, v122
  v_fmac_f32 v55, v109, v122
  s_waitcnt lgkmcnt(4)
  v_mfma_f32_32x32x16_bf16 v[64:79], v[84:87], v[148:151], v[64:79]
  ds_read_b64_tr_b16 v[80:81], v104 offset:57344
  ds_read_b64_tr_b16 v[82:83], v105 offset:57344
  ds_read_b128 v[106:109], v111 offset:1632
  v_mul_f32 v112, v52, v52
  v_mul_f32 v113, v53, v53
  v_mul_f32 v114, v54, v54
  v_mul_f32 v115, v55, v55
  v_fma_f32 v112, v112, v124, v123
  v_fma_f32 v113, v113, v124, v123
  v_fma_f32 v114, v114, v124, v123
  v_fma_f32 v115, v115, v124, v123
  v_mul_f32 v112, v112, v52
  v_mul_f32 v113, v113, v53
  v_mul_f32 v114, v114, v54
  v_mul_f32 v115, v115, v55
  v_exp_f32 v112, v112
  v_exp_f32 v113, v113
  v_exp_f32 v114, v114
  s_waitcnt lgkmcnt(5)
  v_mfma_f32_32x32x16_bf16 v[64:79], v[88:91], v[152:155], v[64:79]
  ds_read_b64_tr_b16 v[84:85], v104 offset:58368
  ds_read_b64_tr_b16 v[86:87], v105 offset:58368
  v_exp_f32_e64 v115, v115
  v_fma_f32 v112, v112, v125, v125
  v_fma_f32 v113, v113, v125, v125
  v_fma_f32 v114, v114, v125, v125
  v_fma_f32 v115, v115, v125, v125
  v_rcp_f32 v112, v112
  v_rcp_f32 v113, v113
  s_waitcnt lgkmcnt(5)
  v_mfma_f32_32x32x16_bf16 v[64:79], v[92:95], v[156:159], v[64:79]
  ds_read_b64_tr_b16 v[88:89], v104 offset:59392
  ds_read_b64_tr_b16 v[90:91], v105 offset:59392
  v_rcp_f32 v114, v114
  v_rcp_f32 v115, v115
  v_mul_f32 v112, v112, v52
  v_mul_f32 v113, v113, v53
  v_mul_f32 v114, v114, v54
  v_mul_f32_e64 v115, v115, v55
  v_cvt_pk_bf16_f32 v98, v112, v113
  v_cvt_pk_bf16_f32 v99, v114, v115
  v_fmac_f32 v56, v116, v122
  s_waitcnt lgkmcnt(5)
  v_mfma_f32_32x32x16_bf16 v[64:79], v[80:83], v[160:163], v[64:79]
  ds_read_b64_tr_b16 v[92:93], v104 offset:60416
  ds_read_b64_tr_b16 v[94:95], v105 offset:60416
  v_fmac_f32 v57, v117, v122
  v_fmac_f32 v58, v118, v122
  v_fmac_f32 v59, v119, v122
  v_mul_f32 v112, v56, v56
  v_mul_f32 v113, v57, v57
  v_mul_f32 v114, v58, v58
  v_mul_f32_e64 v115, v59, v59
  v_fma_f32 v112, v112, v124, v123
  v_fma_f32 v113, v113, v124, v123
  v_fma_f32 v114, v114, v124, v123
  v_fma_f32 v115, v115, v124, v123
  s_waitcnt lgkmcnt(4)
  v_mfma_f32_32x32x16_bf16 v[64:79], v[84:87], v[164:167], v[64:79]
  ds_read_b64_tr_b16 v[80:81], v104 offset:61440
  ds_read_b64_tr_b16 v[82:83], v105 offset:61440
  v_mul_f32 v112, v112, v56
  v_mul_f32 v113, v113, v57
  v_mul_f32 v114, v114, v58
  v_mul_f32 v115, v115, v59
  v_exp_f32 v112, v112
  v_exp_f32 v113, v113
  v_exp_f32 v114, v114
  s_waitcnt lgkmcnt(4)
  v_mfma_f32_32x32x16_bf16 v[64:79], v[88:91], v[168:171], v[64:79]
  ds_read_b64_tr_b16 v[84:85], v104 offset:62464
  ds_read_b64_tr_b16 v[86:87], v105 offset:62464
  v_exp_f32 v115, v115
  v_fma_f32 v112, v112, v125, v125
  v_fma_f32 v113, v113, v125, v125
  v_fma_f32 v114, v114, v125, v125
  v_fma_f32 v115, v115, v125, v125
  v_rcp_f32 v112, v112
  v_rcp_f32 v113, v113
  v_rcp_f32 v114, v114
  s_waitcnt lgkmcnt(4)
  v_mfma_f32_32x32x16_bf16 v[64:79], v[92:95], v[172:175], v[64:79]
  ds_read_b64_tr_b16 v[88:89], v104 offset:63488
  ds_read_b64_tr_b16 v[90:91], v105 offset:63488
  v_rcp_f32 v115, v115
  v_mul_f32 v112, v112, v56
  v_mul_f32 v113, v113, v57
  v_mul_f32 v114, v114, v58
  v_mul_f32_e64 v115, v115, v59
  v_cvt_pk_bf16_f32 v100, v112, v113
  v_cvt_pk_bf16_f32 v101, v114, v115
  v_fmac_f32 v60, v106, v122
  v_fmac_f32 v61, v107, v122
  v_fmac_f32 v62, v108, v122
  s_waitcnt lgkmcnt(4)
  v_mfma_f32_32x32x16_bf16 v[64:79], v[80:83], v[176:179], v[64:79]
  ds_read_b64_tr_b16 v[92:93], v104 offset:64512
  ds_read_b64_tr_b16 v[94:95], v105 offset:64512
  v_fmac_f32 v63, v109, v122
  v_mul_f32 v112, v60, v60
  v_mul_f32 v113, v61, v61
  v_mul_f32 v114, v62, v62
  v_mul_f32_e64 v115, v63, v63
  v_fma_f32 v112, v112, v124, v123
  v_fma_f32 v113, v113, v124, v123
  v_fma_f32 v114, v114, v124, v123
  v_fma_f32 v115, v115, v124, v123
  v_mul_f32 v112, v112, v60
  s_waitcnt lgkmcnt(4)
  v_mfma_f32_32x32x16_bf16 v[64:79], v[84:87], v[180:183], v[64:79]
  v_mul_f32 v113, v113, v61
  v_mul_f32 v114, v114, v62
  v_mul_f32 v115, v115, v63
  v_exp_f32 v112, v112
  v_exp_f32 v113, v113
  v_exp_f32 v114, v114
  v_exp_f32 v115, v115
  s_waitcnt lgkmcnt(2)
  v_mfma_f32_32x32x16_bf16 v[64:79], v[88:91], v[184:187], v[64:79]
  v_fma_f32 v112, v112, v125, v125
  v_fma_f32 v113, v113, v125, v125
  v_fma_f32 v114, v114, v125, v125
  v_fma_f32 v115, v115, v125, v125
  v_rcp_f32 v112, v112
  v_rcp_f32 v113, v113
  v_rcp_f32 v114, v114
  v_rcp_f32 v115, v115
  s_waitcnt lgkmcnt(0)
  v_mfma_f32_32x32x16_bf16 v[64:79], v[92:95], v[188:191], v[64:79]
  v_mul_f32 v112, v112, v60
  v_mul_f32 v113, v113, v61
  v_mul_f32 v114, v114, v62
  v_mul_f32_e64 v115, v115, v63
  v_cvt_pk_bf16_f32 v102, v112, v113
  v_cvt_pk_bf16_f32 v103, v114, v115
  s_add_u32 s70, s67, 16384
  s_sub_u32 s54, s70, s83
  v_add_u32 v31, s54, v16
  buffer_store_dwordx4 v[96:99], v16, s[4:7], s70 offen
  buffer_store_dwordx4 v[100:103], v16, s[4:7], s70 offen offset:2048
  ds_write_b128 v31, v[96:99] offset:0
  ds_write_b128 v31, v[100:103] offset:2048
  ds_write_b128 v110, v[72:75] offset:0
  ds_write_b128 v110, v[76:79] offset:1024
  v_xor_b32 v110, 2048, v110
  s_lshl_b32 s53, s56, 1
  s_sub_u32 s53, s53, 0
  v_add_u32 v111, s53, v27
  s_sub_u32 s70, s68, 0
  s_waitcnt lgkmcnt(0)
  s_branch CVE_16
CV1_15:
PAD_16:
  s_cbranch_execz L_TRAMP
  s_nop 0
  ds_read_b64_tr_b16 v[80:81], v104 offset:16384
  ds_read_b64_tr_b16 v[82:83], v105 offset:16384
  ds_read_b64_tr_b16 v[84:85], v104 offset:17408
  ds_read_b64_tr_b16 v[86:87], v105 offset:17408
  ds_read_b64_tr_b16 v[88:89], v104 offset:18432
  ds_read_b64_tr_b16 v[90:91], v105 offset:18432
  s_waitcnt lgkmcnt(4)
  v_mfma_f32_32x32x16_bf16 v[64:79], v[80:83], v[192:195], 0
  ds_read_b64_tr_b16 v[92:93], v104 offset:19456
  ds_read_b64_tr_b16 v[94:95], v105 offset:19456
  v_fmac_f32 v48, v116, v122
  v_fmac_f32 v49, v117, v122
  v_fmac_f32 v50, v118, v122
  v_fmac_f32 v51, v119, v122
  s_waitcnt lgkmcnt(4)
  v_mfma_f32_32x32x16_bf16 v[64:79], v[84:87], v[196:199], v[64:79]
  ds_read_b64_tr_b16 v[80:81], v104 offset:20480
  ds_read_b64_tr_b16 v[82:83], v105 offset:20480
  ds_read_b128 v[116:119], v111 offset:1600
  v_mul_f32 v112, v48, v48
  v_mul_f32 v113, v49, v49
  v_mul_f32 v114, v50, v50
  v_mul_f32 v115, v51, v51
  v_fma_f32 v112, v112, v124, v123
  v_fma_f32 v113, v113, v124, v123
  v_fma_f32 v114, v114, v124, v123
  v_fma_f32 v115, v115, v124, v123
  v_mul_f32 v112, v112, v48
  v_mul_f32 v113, v113, v49
  v_mul_f32 v114, v114, v50
  v_mul_f32 v115, v115, v51
  v_exp_f32 v112, v112
  v_exp_f32 v113, v113
  s_waitcnt lgkmcnt(5)
  v_mfma_f32_32x32x16_bf16 v[64:79], v[88:91], v[200:203], v[64:79]
  ds_read_b64_tr_b16 v[84:85], v104 offset:21504
  ds_read_b64_tr_b16 v[86:87], v105 offset:21504
  v_exp_f32 v114, v114
  v_exp_f32_e64 v115, v115
  v_fma_f32 v112, v112, v125, v125
  v_fma_f32 v113, v113, v125, v125
  v_fma_f32 v114, v114, v125, v125
  v_fma_f32 v115, v115, v125, v125
  v_rcp_f32 v112, v112
  v_rcp_f32 v113, v113
  s_waitcnt lgkmcnt(5)
  v_mfma_f32_32x32x16_bf16 v[64:79], v[92:95], v[204:207], v[64:79]
  ds_read_b64_tr_b16 v[88:89], v104 offset:22528
  ds_read_b64_tr_b16 v[90:91], v105 offset:22528
  v_rcp_f32 v114, v114
  v_rcp_f32 v115, v115
  v_mul_f32 v112, v112, v48
  v_mul_f32 v113, v113, v49
  v_mul_f32 v114, v114, v50
  v_mul_f32_e64 v115, v115, v51
  v_cvt_pk_bf16_f32 v96, v112, v113
  v_cvt_pk_bf16_f32 v97, v114, v115
  v_fmac_f32 v52, v106, v122
  s_waitcnt lgkmcnt(5)
  v_mfma_f32_32x32x16_bf16 v[64:79], v[80:83], v[208:211], v[64:79]
  ds_read_b64_tr_b16 v[92:93], v104 offset:23552
  ds_read_b64_tr_b16 v[94:95], v105 offset:23552
  v_fmac_f32 v53, v107, v122
  v_fmac_f32 v54, v108, v122
  v_fmac_f32 v55, v109, v122
  s_waitcnt lgkmcnt(4)
  v_mfma_f32_32x32x16_bf16 v[64:79], v[84:87], v[212:215], v[64:79]
  ds_read_b64_tr_b16 v[80:81], v104 offset:4096
  ds_read_b64_tr_b16 v[82:83], v105 offset:4096
  ds_read_b128 v[106:109], v111 offset:1632
  v_mul_f32 v112, v52, v52
  v_mul_f32 v113, v53, v53
  v_mul_f32 v114, v54, v54
  v_mul_f32 v115, v55, v55
  v_fma_f32 v112, v112, v124, v123
  v_fma_f32 v113, v113, v124, v123
  v_fma_f32 v114, v114, v124, v123
  v_fma_f32 v115, v115, v124, v123
  v_mul_f32 v112, v112, v52
  v_mul_f32 v113, v113, v53
  v_mul_f32 v114, v114, v54
  v_mul_f32 v115, v115, v55
  v_exp_f32 v112, v112
  v_exp_f32 v113, v113
  v_exp_f32 v114, v114
  s_waitcnt lgkmcnt(5)
  v_mfma_f32_32x32x16_bf16 v[64:79], v[88:91], v[216:219], v[64:79]
  ds_read_b64_tr_b16 v[84:85], v104 offset:5120
  ds_read_b64_tr_b16 v[86:87], v105 offset:5120
  v_exp_f32_e64 v115, v115
  v_fma_f32 v112, v112, v125, v125
  v_fma_f32 v113, v113, v125, v125
  v_fma_f32 v114, v114, v125, v125
  v_fma_f32 v115, v115, v125, v125
  v_rcp_f32 v112, v112
  v_rcp_f32 v113, v113
  s_waitcnt lgkmcnt(5)
  v_mfma_f32_32x32x16_bf16 v[64:79], v[92:95], v[220:223], v[64:79]
  ds_read_b64_tr_b16 v[88:89], v104 offset:6144
  ds_read_b64_tr_b16 v[90:91], v105 offset:6144
  v_rcp_f32 v114, v114
  v_rcp_f32 v115, v115
  v_mul_f32 v112, v112, v52
  v_mul_f32 v113, v113, v53
  v_mul_f32 v114, v114, v54
  v_mul_f32_e64 v115, v115, v55
  v_cvt_pk_bf16_f32 v98, v112, v113
  v_cvt_pk_bf16_f32 v99, v114, v115
  v_fmac_f32 v56, v116, v122
  s_waitcnt lgkmcnt(5)
  v_mfma_f32_32x32x16_bf16 v[64:79], v[80:83], v[224:227], v[64:79]
  ds_read_b64_tr_b16 v[92:93], v104 offset:7168
  ds_read_b64_tr_b16 v[94:95], v105 offset:7168
  v_fmac_f32 v57, v117, v122
  v_fmac_f32 v58, v118, v122
  v_fmac_f32 v59, v119, v122
  v_mul_f32 v112, v56, v56
  v_mul_f32 v113, v57, v57
  v_mul_f32 v114, v58, v58
  v_mul_f32_e64 v115, v59, v59
  v_fma_f32 v112, v112, v124, v123
  v_fma_f32 v113, v113, v124, v123
  v_fma_f32 v114, v114, v124, v123
  v_fma_f32 v115, v115, v124, v123
  s_waitcnt lgkmcnt(4)
  v_mfma_f32_32x32x16_bf16 v[64:79], v[84:87], v[228:231], v[64:79]
  ds_read_b64_tr_b16 v[80:81], v104 offset:24576
  ds_read_b64_tr_b16 v[82:83], v105 offset:24576
  v_mul_f32 v112, v112, v56
  v_mul_f32 v113, v113, v57
  v_mul_f32 v114, v114, v58
  v_mul_f32 v115, v115, v59
  v_exp_f32 v112, v112
  v_exp_f32 v113, v113
  v_exp_f32 v114, v114
  s_waitcnt lgkmcnt(4)
  v_mfma_f32_32x32x16_bf16 v[64:79], v[88:91], v[232:235], v[64:79]
  ds_read_b64_tr_b16 v[84:85], v104 offset:25600
  ds_read_b64_tr_b16 v[86:87], v105 offset:25600
  v_exp_f32 v115, v115
  v_fma_f32 v112, v112, v125, v125
  v_fma_f32 v113, v113, v125, v125
  v_fma_f32 v114, v114, v125, v125
  v_fma_f32 v115, v115, v125, v125
  v_rcp_f32 v112, v112
  v_rcp_f32 v113, v113
  v_rcp_f32 v114, v114
  s_waitcnt lgkmcnt(4)
  v_mfma_f32_32x32x16_bf16 v[64:79], v[92:95], v[236:239], v[64:79]
  ds_read_b64_tr_b16 v[88:89], v104 offset:26624
  ds_read_b64_tr_b16 v[90:91], v105 offset:26624
  v_rcp_f32 v115, v115
  v_mul_f32 v112, v112, v56
  v_mul_f32 v113, v113, v57
  v_mul_f32 v114, v114, v58
  v_mul_f32_e64 v115, v115, v59
  v_cvt_pk_bf16_f32 v100, v112, v113
  v_cvt_pk_bf16_f32 v101, v114, v115
  v_fmac_f32 v60, v106, v122
  v_fmac_f32 v61, v107, v122
  v_fmac_f32 v62, v108, v122
  s_waitcnt lgkmcnt(4)
  v_mfma_f32_32x32x16_bf16 v[64:79], v[80:83], v[240:243], v[64:79]
  ds_read_b64_tr_b16 v[92:93], v104 offset:27648
  ds_read_b64_tr_b16 v[94:95], v105 offset:27648
  v_fmac_f32 v63, v109, v122
  v_mul_f32 v112, v60, v60
  v_mul_f32 v113, v61, v61
  v_mul_f32 v114, v62, v62
  v_mul_f32_e64 v115, v63, v63
  v_fma_f32 v112, v112, v124, v123
  v_fma_f32 v113, v113, v124, v123
  v_fma_f32 v114, v114, v124, v123
  v_fma_f32 v115, v115, v124, v123
  v_mul_f32 v112, v112, v60
  s_waitcnt lgkmcnt(4)
  v_mfma_f32_32x32x16_bf16 v[64:79], v[84:87], v[244:247], v[64:79]
  v_mul_f32 v113, v113, v61
  v_mul_f32 v114, v114, v62
  v_mul_f32 v115, v115, v63
  v_exp_f32 v112, v112
  v_exp_f32 v113, v113
  v_exp_f32 v114, v114
  v_exp_f32 v115, v115
  s_waitcnt lgkmcnt(2)
  v_mfma_f32_32x32x16_bf16 v[64:79], v[88:91], v[248:251], v[64:79]
  v_fma_f32 v112, v112, v125, v125
  v_fma_f32 v113, v113, v125, v125
  v_fma_f32 v114, v114, v125, v125
  v_fma_f32 v115, v115, v125, v125
  v_rcp_f32 v112, v112
  v_rcp_f32 v113, v113
  v_rcp_f32 v114, v114
  v_rcp_f32 v115, v115
  s_waitcnt lgkmcnt(0)
  v_mfma_f32_32x32x16_bf16 v[64:79], v[92:95], v[252:255], v[64:79]
  v_mul_f32 v112, v112, v60
  v_mul_f32 v113, v113, v61
  v_mul_f32 v114, v114, v62
  v_mul_f32_e64 v115, v115, v63
  v_cvt_pk_bf16_f32 v102, v112, v113
  v_cvt_pk_bf16_f32 v103, v114, v115
  s_add_u32 s70, s67, 16384
  s_sub_u32 s54, s70, s83
  v_add_u32 v31, s54, v16
  buffer_store_dwordx4 v[96:99], v16, s[4:7], s70 offen
  buffer_store_dwordx4 v[100:103], v16, s[4:7], s70 offen offset:2048
  ds_write_b128 v31, v[96:99] offset:0
  ds_write_b128 v31, v[100:103] offset:2048
  ds_write_b128 v110, v[64:67] offset:2048
  ds_write_b128 v110, v[68:71] offset:3072
  v_mov_b32 v64, v72
  v_mov_b32 v65, v73
  v_mov_b32 v66, v74
  v_mov_b32 v67, v75
  v_mov_b32 v68, v76
  v_mov_b32 v69, v77
  v_mov_b32 v70, v78
  v_mov_b32 v71, v79
  v_xor_b32 v110, 0, v110
  s_lshl_b32 s53, s56, 1
  s_sub_u32 s53, s53, 64
  v_add_u32 v111, s53, v27
  s_sub_u32 s70, s68, 2048
  s_waitcnt lgkmcnt(0)
CVE_16:
  s_barrier
  ds_read_b128 v[72:75], v110
  ds_read_b128 v[76:79], v110 offset:1024
  ds_read_b128 v[116:119], v111 offset:1024
  ds_read_b128 v[106:109], v111 offset:1056
  s_waitcnt lgkmcnt(3)
  v_pk_add_f32 v[64:65], v[64:65], v[72:73]
  v_pk_add_f32 v[66:67], v[66:67], v[74:75]
  s_waitcnt lgkmcnt(2)
  v_pk_add_f32 v[68:69], v[68:69], v[76:77]
  v_pk_add_f32 v[70:71], v[70:71], v[78:79]
  s_waitcnt lgkmcnt(1)
  s_nop 0
  v_pk_fma_f32 v[64:65], v[116:117], v[122:123], v[64:65] op_sel:[0,0,0] op_sel_hi:[1,0,1]
  v_pk_fma_f32 v[66:67], v[118:119], v[122:123], v[66:67] op_sel:[0,0,0] op_sel_hi:[1,0,1]
  v_pk_mul_f32 v[112:113], v[64:65], v[64:65] op_sel:[0,0] op_sel_hi:[1,1]
  v_pk_mul_f32 v[114:115], v[66:67], v[66:67] op_sel:[0,0] op_sel_hi:[1,1]
  v_pk_fma_f32 v[112:113], v[112:113], v[124:125], v[122:123] op_sel:[0,0,1] op_sel_hi:[1,0,1]
  v_pk_fma_f32 v[114:115], v[114:115], v[124:125], v[122:123] op_sel:[0,0,1] op_sel_hi:[1,0,1]
  v_pk_mul_f32 v[112:113], v[112:113], v[64:65] op_sel:[0,0] op_sel_hi:[1,1]
  v_pk_mul_f32 v[114:115], v[114:115], v[66:67] op_sel:[0,0] op_sel_hi:[1,1]
  v_exp_f32 v112, v112
  v_exp_f32 v113, v113
  v_exp_f32 v114, v114
  v_exp_f32 v115, v115
  v_pk_fma_f32 v[112:113], v[112:113], v[124:125], v[124:125] op_sel:[0,1,1] op_sel_hi:[1,1,1]
  v_pk_fma_f32 v[114:115], v[114:115], v[124:125], v[124:125] op_sel:[0,1,1] op_sel_hi:[1,1,1]
  v_rcp_f32 v112, v112
  v_rcp_f32 v113, v113
  v_rcp_f32 v114, v114
  v_rcp_f32 v115, v115
  v_pk_mul_f32 v[112:113], v[112:113], v[64:65] op_sel:[0,0] op_sel_hi:[1,1]
  v_pk_mul_f32 v[114:115], v[114:115], v[66:67] op_sel:[0,0] op_sel_hi:[1,1]
  v_cvt_pk_bf16_f32 v96, v112, v113
  v_cvt_pk_bf16_f32 v97, v114, v115
  s_waitcnt lgkmcnt(0)
  s_nop 0
  v_pk_fma_f32 v[68:69], v[106:107], v[122:123], v[68:69] op_sel:[0,0,0] op_sel_hi:[1,0,1]
  v_pk_fma_f32 v[70:71], v[108:109], v[122:123], v[70:71] op_sel:[0,0,0] op_sel_hi:[1,0,1]
  v_pk_mul_f32 v[112:113], v[68:69], v[68:69] op_sel:[0,0] op_sel_hi:[1,1]
  v_pk_mul_f32 v[114:115], v[70:71], v[70:71] op_sel:[0,0] op_sel_hi:[1,1]
  v_pk_fma_f32 v[112:113], v[112:113], v[124:125], v[122:123] op_sel:[0,0,1] op_sel_hi:[1,0,1]
  v_pk_fma_f32 v[114:115], v[114:115], v[124:125], v[122:123] op_sel:[0,0,1] op_sel_hi:[1,0,1]
  v_pk_mul_f32 v[112:113], v[112:113], v[68:69] op_sel:[0,0] op_sel_hi:[1,1]
  v_pk_mul_f32 v[114:115], v[114:115], v[70:71] op_sel:[0,0] op_sel_hi:[1,1]
  v_exp_f32 v112, v112
  v_exp_f32 v113, v113
  v_exp_f32 v114, v114
  v_exp_f32 v115, v115
  v_pk_fma_f32 v[112:113], v[112:113], v[124:125], v[124:125] op_sel:[0,1,1] op_sel_hi:[1,1,1]
  v_pk_fma_f32 v[114:115], v[114:115], v[124:125], v[124:125] op_sel:[0,1,1] op_sel_hi:[1,1,1]
  v_rcp_f32 v112, v112
  v_rcp_f32 v113, v113
  v_rcp_f32 v114, v114
  v_rcp_f32 v115, v115
  v_pk_mul_f32 v[112:113], v[112:113], v[68:69] op_sel:[0,0] op_sel_hi:[1,1]
  v_pk_mul_f32 v[114:115], v[114:115], v[70:71] op_sel:[0,0] op_sel_hi:[1,1]
  v_cvt_pk_bf16_f32 v98, v112, v113
  v_cvt_pk_bf16_f32 v99, v114, v115
  buffer_store_dwordx4 v[96:99], v16, s[4:7], s70 offen
  s_barrier
  s_nop 0
  ds_read_b64_tr_b16 v[128:129], v10 offset:28672
  ds_read_b64_tr_b16 v[130:131], v13 offset:28672
  ds_read_b64_tr_b16 v[132:133], v10 offset:30720
  ds_read_b64_tr_b16 v[134:135], v13 offset:30720
  ds_read_b64_tr_b16 v[136:137], v10 offset:40960
  ds_read_b64_tr_b16 v[138:139], v13 offset:40960
  ds_read_b64_tr_b16 v[140:141], v10 offset:43008
  ds_read_b64_tr_b16 v[142:143], v13 offset:43008
  ds_read_b64_tr_b16 v[144:145], v10 offset:45056
  ds_read_b64_tr_b16 v[146:147], v13 offset:45056
  ds_read_b64_tr_b16 v[148:149], v10 offset:47104
  ds_read_b64_tr_b16 v[150:151], v13 offset:47104
  ds_read_b64_tr_b16 v[152:153], v10 offset:49152
  ds_read_b64_tr_b16 v[154:155], v13 offset:49152
  ds_read_b64_tr_b16 v[156:157], v10 offset:51200
  ds_read_b64_tr_b16 v[158:159], v13 offset:51200
  ds_read_b64_tr_b16 v[160:161], v10 offset:53248
  ds_read_b64_tr_b16 v[162:163], v13 offset:53248
  ds_read_b64_tr_b16 v[164:165], v10 offset:55296
  ds_read_b64_tr_b16 v[166:167], v13 offset:55296
  ds_read_b64_tr_b16 v[168:169], v10 offset:57344
  ds_read_b64_tr_b16 v[170:171], v13 offset:57344
  ds_read_b64_tr_b16 v[172:173], v10 offset:59392
  ds_read_b64_tr_b16 v[174:175], v13 offset:59392
  ds_read_b64_tr_b16 v[176:177], v10 offset:61440
  ds_read_b64_tr_b16 v[178:179], v13 offset:61440
  ds_read_b64_tr_b16 v[180:181], v10 offset:63488
  ds_read_b64_tr_b16 v[182:183], v13 offset:63488
  ds_read_b64_tr_b16 v[184:185], v11 offset:28672
  ds_read_b64_tr_b16 v[186:187], v14 offset:28672
  ds_read_b64_tr_b16 v[188:189], v11 offset:30720
  ds_read_b64_tr_b16 v[190:191], v14 offset:30720
  ds_read_b64_tr_b16 v[192:193], v11 offset:32768
  ds_read_b64_tr_b16 v[194:195], v14 offset:32768
  ds_read_b64_tr_b16 v[196:197], v11 offset:34816
  ds_read_b64_tr_b16 v[198:199], v14 offset:34816
  ds_read_b64_tr_b16 v[200:201], v11 offset:0
  ds_read_b64_tr_b16 v[202:203], v14 offset:0
  ds_read_b64_tr_b16 v[204:205], v11 offset:2048
  ds_read_b64_tr_b16 v[206:207], v14 offset:2048
  s_waitcnt vmcnt(0)
  s_barrier
  s_sub_u32 s54, s70, s83
  v_add_u32 v31, s54, v16
  ds_write_b128 v31, v[96:99] offset:0
  ds_read_b64_tr_b16 v[208:209], v11 offset:36864
  ds_read_b64_tr_b16 v[210:211], v14 offset:36864
  ds_read_b64_tr_b16 v[212:213], v11 offset:38912
  ds_read_b64_tr_b16 v[214:215], v14 offset:38912
  ds_read_b64_tr_b16 v[216:217], v11 offset:40960
  ds_read_b64_tr_b16 v[218:219], v14 offset:40960
  ds_read_b64_tr_b16 v[220:221], v11 offset:43008
  ds_read_b64_tr_b16 v[222:223], v14 offset:43008
  ds_read_b64_tr_b16 v[224:225], v11 offset:45056
  ds_read_b64_tr_b16 v[226:227], v14 offset:45056
  ds_read_b64_tr_b16 v[228:229], v11 offset:47104
  ds_read_b64_tr_b16 v[230:231], v14 offset:47104
  ds_read_b64_tr_b16 v[232:233], v11 offset:49152
  ds_read_b64_tr_b16 v[234:235], v14 offset:49152
  ds_read_b64_tr_b16 v[236:237], v11 offset:51200
  ds_read_b64_tr_b16 v[238:239], v14 offset:51200
  ds_read_b64_tr_b16 v[240:241], v11 offset:53248
  ds_read_b64_tr_b16 v[242:243], v14 offset:53248
  ds_read_b64_tr_b16 v[244:245], v11 offset:55296
  ds_read_b64_tr_b16 v[246:247], v14 offset:55296
  ds_read_b64_tr_b16 v[248:249], v12 offset:0
  ds_read_b64_tr_b16 v[250:251], v15 offset:0
  ds_read_b64_tr_b16 v[252:253], v12 offset:2048
  ds_read_b64_tr_b16 v[254:255], v15 offset:2048
  s_waitcnt lgkmcnt(0)
  s_barrier
  v_and_b32_e64 v29, 31, v1
  v_lshl_add_u32 v29, s61, 5, v29
  v_lshlrev_b32 v29, 10, v29
  v_lshrrev_b32 v30, 5, v1
  v_lshl_add_u32 v48, v30, 4, v29
  s_lshl_b32 s70, s46, 16
  s_lshl_b32 s54, s45, 7
  s_add_u32 s70, s70, s54
  v_and_b32 v29, 31, v1
  v_lshl_add_u32 v29, s61, 5, v29
  v_lshrrev_b32_e64 v30, 5, v1
  v_lshl_add_u32 v30, s64, 2, v30
  v_and_b32 v31, 7, v1
  v_xor_b32 v30, v30, v31
  v_lshlrev_b32_e64 v29, 7, v29
  v_lshl_add_u32 v50, v30, 4, v29
  v_xor_b32 v51, 32, v50
  v_lshrrev_b32 v29, 3, v1
  v_xor_b32_e64 v30, v29, v31
  v_lshl_add_u32 v29, s44, 4, v29
  v_lshlrev_b32_e64 v52, 7, v29
  v_lshl_add_u32 v52, v30, 4, v52
  v_lshlrev_b32_e64 v53, 10, v29
  v_lshl_add_u32 v53, v31, 4, v53
  s_add_u32 s69, s70, 8192
  s_barrier
  s_nop 0
  ds_read_b64_tr_b16 v[80:81], v12 offset:4096
  ds_read_b64_tr_b16 v[82:83], v15 offset:4096
  ds_read_b128 v[96:99], v7 offset:0
  ds_read_b64_tr_b16 v[84:85], v12 offset:6144
  ds_read_b64_tr_b16 v[86:87], v15 offset:6144
PAD_17:
  s_cbranch_execz L_TRAMP
  s_nop 0
  ds_read_b128 v[100:103], v7 offset:2048
  ds_read_b64_tr_b16 v[88:89], v12 offset:8192
  ds_read_b64_tr_b16 v[90:91], v15 offset:8192
  ds_read_b128 v[104:107], v7 offset:4096
  s_waitcnt lgkmcnt(6)
  v_mfma_f32_32x32x16_bf16 v[32:47], v[80:83], v[96:99], v[32:47]
  ds_read_b64_tr_b16 v[92:93], v12 offset:10240
  ds_read_b64_tr_b16 v[94:95], v15 offset:10240
  ds_read_b128 v[108:111], v7 offset:6144
  s_waitcnt lgkmcnt(6)
  v_mfma_f32_32x32x16_bf16 v[32:47], v[84:87], v[100:103], v[32:47]
  s_barrier
  ds_read_b64_tr_b16 v[80:81], v12 offset:12288
  ds_read_b64_tr_b16 v[82:83], v15 offset:12288
  ds_read_b128 v[96:99], v7 offset:8192
  s_waitcnt lgkmcnt(6)
  v_mfma_f32_32x32x16_bf16 v[32:47], v[88:91], v[104:107], v[32:47]
  ds_read_b64_tr_b16 v[84:85], v12 offset:14336
  ds_read_b64_tr_b16 v[86:87], v15 offset:14336
  ds_read_b128 v[100:103], v7 offset:10240
  s_waitcnt lgkmcnt(6)
  v_mfma_f32_32x32x16_bf16 v[32:47], v[92:95], v[108:111], v[32:47]
  ds_read_b64_tr_b16 v[88:89], v12 offset:16384
  ds_read_b64_tr_b16 v[90:91], v15 offset:16384
  ds_read_b128 v[104:107], v7 offset:12288
  s_waitcnt lgkmcnt(6)
  v_mfma_f32_32x32x16_bf16 v[32:47], v[80:83], v[96:99], v[32:47]
  ds_read_b64_tr_b16 v[92:93], v12 offset:18432
  ds_read_b64_tr_b16 v[94:95], v15 offset:18432
  ds_read_b128 v[108:111], v7 offset:14336
  s_waitcnt lgkmcnt(6)
  v_mfma_f32_32x32x16_bf16 v[32:47], v[84:87], v[100:103], v[32:47]
  s_barrier
  ds_read_b64_tr_b16 v[80:81], v12 offset:20480
  ds_read_b64_tr_b16 v[82:83], v15 offset:20480
  ds_read_b128 v[96:99], v7 offset:16384
  s_waitcnt lgkmcnt(6)
  v_mfma_f32_32x32x16_bf16 v[32:47], v[88:91], v[104:107], v[32:47]
  ds_read_b64_tr_b16 v[84:85], v12 offset:22528
  ds_read_b64_tr_b16 v[86:87], v15 offset:22528
  ds_read_b128 v[100:103], v7 offset:18432
  s_waitcnt lgkmcnt(6)
  v_mfma_f32_32x32x16_bf16 v[32:47], v[92:95], v[108:111], v[32:47]
  ds_read_b64_tr_b16 v[88:89], v12 offset:24576
  ds_read_b64_tr_b16 v[90:91], v15 offset:24576
  ds_read_b128 v[104:107], v7 offset:20480
  s_waitcnt lgkmcnt(6)
  v_mfma_f32_32x32x16_bf16 v[32:47], v[80:83], v[96:99], v[32:47]
  ds_read_b64_tr_b16 v[92:93], v12 offset:26624
  ds_read_b64_tr_b16 v[94:95], v15 offset:26624
  ds_read_b128 v[108:111], v7 offset:22528
  s_waitcnt lgkmcnt(6)
  v_mfma_f32_32x32x16_bf16 v[32:47], v[84:87], v[100:103], v[32:47]
  ds_read_b64_tr_b16 v[80:81], v11 offset:4096
  ds_read_b64_tr_b16 v[82:83], v14 offset:4096
  ds_read_b128 v[96:99], v7 offset:24576
  s_waitcnt lgkmcnt(6)
  v_mfma_f32_32x32x16_bf16 v[32:47], v[88:91], v[104:107], v[32:47]
  ds_read_b64_tr_b16 v[84:85], v11 offset:6144
  ds_read_b64_tr_b16 v[86:87], v14 offset:6144
  ds_read_b128 v[100:103], v7 offset:26624
  s_waitcnt lgkmcnt(6)
  v_mfma_f32_32x32x16_bf16 v[32:47], v[92:95], v[108:111], v[32:47]
  ds_read_b64_tr_b16 v[88:89], v11 offset:8192
  ds_read_b64_tr_b16 v[90:91], v14 offset:8192
  ds_read_b128 v[104:107], v7 offset:28672
  s_waitcnt lgkmcnt(6)
  v_mfma_f32_32x32x16_bf16 v[32:47], v[80:83], v[96:99], v[32:47]
  ds_read_b64_tr_b16 v[92:93], v11 offset:10240
  ds_read_b64_tr_b16 v[94:95], v14 offset:10240
  ds_read_b128 v[108:111], v7 offset:30720
  s_waitcnt lgkmcnt(6)
  v_mfma_f32_32x32x16_bf16 v[32:47], v[84:87], v[100:103], v[32:47]
  s_barrier
  ds_read_b64_tr_b16 v[80:81], v11 offset:12288
  ds_read_b64_tr_b16 v[82:83], v14 offset:12288
  ds_read_b128 v[96:99], v7 offset:40960
  s_waitcnt lgkmcnt(6)
  v_mfma_f32_32x32x16_bf16 v[32:47], v[88:91], v[104:107], v[32:47]
  ds_read_b64_tr_b16 v[84:85], v11 offset:14336
  ds_read_b64_tr_b16 v[86:87], v14 offset:14336
  ds_read_b128 v[100:103], v7 offset:43008
  s_waitcnt lgkmcnt(6)
  v_mfma_f32_32x32x16_bf16 v[32:47], v[92:95], v[108:111], v[32:47]
  ds_read_b64_tr_b16 v[88:89], v11 offset:16384
  ds_read_b64_tr_b16 v[90:91], v14 offset:16384
  ds_read_b128 v[104:107], v7 offset:45056
  s_waitcnt lgkmcnt(6)
  v_mfma_f32_32x32x16_bf16 v[32:47], v[80:83], v[96:99], v[32:47]
  ds_read_b64_tr_b16 v[92:93], v11 offset:18432
  ds_read_b64_tr_b16 v[94:95], v14 offset:18432
  ds_read_b128 v[108:111], v7 offset:47104
  s_waitcnt lgkmcnt(6)
  v_mfma_f32_32x32x16_bf16 v[32:47], v[84:87], v[100:103], v[32:47]
  ds_read_b64_tr_b16 v[80:81], v11 offset:20480
  ds_read_b64_tr_b16 v[82:83], v14 offset:20480
  ds_read_b128 v[96:99], v7 offset:49152
  s_waitcnt lgkmcnt(6)
  v_mfma_f32_32x32x16_bf16 v[32:47], v[88:91], v[104:107], v[32:47]
  ds_read_b64_tr_b16 v[84:85], v11 offset:22528
  ds_read_b64_tr_b16 v[86:87], v14 offset:22528
  ds_read_b128 v[100:103], v7 offset:51200
  s_waitcnt lgkmcnt(6)
  v_mfma_f32_32x32x16_bf16 v[32:47], v[92:95], v[108:111], v[32:47]
  ds_read_b64_tr_b16 v[88:89], v11 offset:24576
  ds_read_b64_tr_b16 v[90:91], v14 offset:24576
  ds_read_b128 v[104:107], v7 offset:53248
  s_waitcnt lgkmcnt(6)
  v_mfma_f32_32x32x16_bf16 v[32:47], v[80:83], v[96:99], v[32:47]
  ds_read_b64_tr_b16 v[92:93], v11 offset:26624
  ds_read_b64_tr_b16 v[94:95], v14 offset:26624
  ds_read_b128 v[108:111], v7 offset:55296
  s_waitcnt lgkmcnt(6)
  v_mfma_f32_32x32x16_bf16 v[32:47], v[84:87], v[100:103], v[32:47]
  s_barrier
  ds_read_b64_tr_b16 v[80:81], v11 offset:57344
  ds_read_b64_tr_b16 v[82:83], v14 offset:57344
  ds_read_b128 v[96:99], v7 offset:57344
  s_waitcnt lgkmcnt(6)
  v_mfma_f32_32x32x16_bf16 v[32:47], v[88:91], v[104:107], v[32:47]
  ds_read_b64_tr_b16 v[84:85], v11 offset:59392
  ds_read_b64_tr_b16 v[86:87], v14 offset:59392
  ds_read_b128 v[100:103], v7 offset:59392
  s_waitcnt lgkmcnt(6)
  v_mfma_f32_32x32x16_bf16 v[32:47], v[92:95], v[108:111], v[32:47]
  ds_read_b64_tr_b16 v[88:89], v11 offset:61440
  ds_read_b64_tr_b16 v[90:91], v14 offset:61440
  ds_read_b128 v[104:107], v7 offset:61440
  s_waitcnt lgkmcnt(6)
  v_mfma_f32_32x32x16_bf16 v[32:47], v[80:83], v[96:99], v[32:47]
  ds_read_b64_tr_b16 v[92:93], v11 offset:63488
  ds_read_b64_tr_b16 v[94:95], v14 offset:63488
  ds_read_b128 v[108:111], v7 offset:63488
  s_waitcnt lgkmcnt(6)
  v_mfma_f32_32x32x16_bf16 v[32:47], v[84:87], v[100:103], v[32:47]
  ds_read_b64_tr_b16 v[80:81], v10 offset:32768
  ds_read_b64_tr_b16 v[82:83], v13 offset:32768
  ds_read_b128 v[96:99], v7 offset:0
  s_waitcnt lgkmcnt(6)
  v_mfma_f32_32x32x16_bf16 v[32:47], v[88:91], v[104:107], v[32:47]
  ds_read_b64_tr_b16 v[84:85], v10 offset:34816
  ds_read_b64_tr_b16 v[86:87], v13 offset:34816
  ds_read_b128 v[100:103], v7 offset:2048
  s_waitcnt lgkmcnt(6)
  v_mfma_f32_32x32x16_bf16 v[32:47], v[92:95], v[108:111], v[32:47]
  ds_read_b64_tr_b16 v[88:89], v10 offset:36864
  ds_read_b64_tr_b16 v[90:91], v13 offset:36864
  ds_read_b128 v[104:107], v8 offset:0
  s_waitcnt lgkmcnt(6)
  v_mfma_f32_32x32x16_bf16 v[32:47], v[80:83], v[96:99], v[32:47]
  ds_read_b64_tr_b16 v[92:93], v10 offset:38912
  ds_read_b64_tr_b16 v[94:95], v13 offset:38912
  ds_read_b128 v[108:111], v8 offset:2048
  s_waitcnt lgkmcnt(6)
  v_mfma_f32_32x32x16_bf16 v[32:47], v[84:87], v[100:103], v[32:47]
  s_barrier
  ds_read_b64_tr_b16 v[80:81], v10 offset:8192
  ds_read_b64_tr_b16 v[82:83], v13 offset:8192
  ds_read_b128 v[96:99], v7 offset:4096
  s_waitcnt lgkmcnt(6)
  v_mfma_f32_32x32x16_bf16 v[32:47], v[88:91], v[104:107], v[32:47]
  ds_read_b64_tr_b16 v[84:85], v10 offset:10240
  ds_read_b64_tr_b16 v[86:87], v13 offset:10240
  ds_read_b128 v[100:103], v7 offset:6144
  s_waitcnt lgkmcnt(6)
  v_mfma_f32_32x32x16_bf16 v[32:47], v[92:95], v[108:111], v[32:47]
  ds_read_b64_tr_b16 v[88:89], v11 offset:32768
  ds_read_b64_tr_b16 v[90:91], v14 offset:32768
  ds_read_b128 v[104:107], v8 offset:28672
  s_waitcnt lgkmcnt(6)
  v_mfma_f32_32x32x16_bf16 v[32:47], v[80:83], v[96:99], v[32:47]
  ds_read_b64_tr_b16 v[92:93], v11 offset:34816
  ds_read_b64_tr_b16 v[94:95], v14 offset:34816
  ds_read_b128 v[108:111], v8 offset:30720
  s_waitcnt lgkmcnt(6)
  v_mfma_f32_32x32x16_bf16 v[32:47], v[84:87], v[100:103], v[32:47]
  ds_read_b64_tr_b16 v[80:81], v10 offset:12288
  ds_read_b64_tr_b16 v[82:83], v13 offset:12288
  ds_read_b128 v[96:99], v8 offset:36864
  s_waitcnt lgkmcnt(6)
  v_mfma_f32_32x32x16_bf16 v[32:47], v[88:91], v[104:107], v[32:47]
  ds_read_b64_tr_b16 v[84:85], v10 offset:14336
  ds_read_b64_tr_b16 v[86:87], v13 offset:14336
  ds_read_b128 v[100:103], v8 offset:38912
  s_waitcnt lgkmcnt(6)
  v_mfma_f32_32x32x16_bf16 v[32:47], v[92:95], v[108:111], v[32:47]
  ds_read_b64_tr_b16 v[88:89], v10 offset:20480
  ds_read_b64_tr_b16 v[90:91], v13 offset:20480
  ds_read_b128 v[104:107], v7 offset:16384
  s_waitcnt lgkmcnt(6)
  v_mfma_f32_32x32x16_bf16 v[32:47], v[80:83], v[96:99], v[32:47]
  ds_read_b64_tr_b16 v[92:93], v10 offset:22528
  ds_read_b64_tr_b16 v[94:95], v13 offset:22528
  ds_read_b128 v[108:111], v7 offset:18432
  s_waitcnt lgkmcnt(6)
  v_mfma_f32_32x32x16_bf16 v[32:47], v[84:87], v[100:103], v[32:47]
  s_barrier
  ds_read_b64_tr_b16 v[80:81], v11 offset:4096
  ds_read_b64_tr_b16 v[82:83], v14 offset:4096
  ds_read_b128 v[96:99], v7 offset:24576
  s_waitcnt lgkmcnt(6)
  v_mfma_f32_32x32x16_bf16 v[32:47], v[88:91], v[104:107], v[32:47]
  ds_read_b64_tr_b16 v[84:85], v11 offset:6144
  ds_read_b64_tr_b16 v[86:87], v14 offset:6144
  ds_read_b128 v[100:103], v7 offset:26624
  s_waitcnt lgkmcnt(6)
  v_mfma_f32_32x32x16_bf16 v[32:47], v[92:95], v[108:111], v[32:47]
  ds_read_b64_tr_b16 v[88:89], v10 offset:40960
  ds_read_b64_tr_b16 v[90:91], v13 offset:40960
  ds_read_b128 v[104:107], v7 offset:28672
  s_waitcnt lgkmcnt(6)
  v_mfma_f32_32x32x16_bf16 v[32:47], v[80:83], v[96:99], v[32:47]
  ds_read_b64_tr_b16 v[92:93], v10 offset:43008
  ds_read_b64_tr_b16 v[94:95], v13 offset:43008
  ds_read_b128 v[108:111], v7 offset:30720
  s_waitcnt lgkmcnt(6)
  v_mfma_f32_32x32x16_bf16 v[32:47], v[84:87], v[100:103], v[32:47]
  ds_read_b64_tr_b16 v[80:81], v10 offset:49152
  ds_read_b64_tr_b16 v[82:83], v13 offset:49152
  ds_read_b128 v[96:99], v7 offset:45056
  s_waitcnt lgkmcnt(6)
  v_mfma_f32_32x32x16_bf16 v[32:47], v[88:91], v[104:107], v[32:47]
  ds_read_b64_tr_b16 v[84:85], v10 offset:51200
  ds_read_b64_tr_b16 v[86:87], v13 offset:51200
  ds_read_b128 v[100:103], v7 offset:47104
  s_waitcnt lgkmcnt(6)
  v_mfma_f32_32x32x16_bf16 v[32:47], v[92:95], v[108:111], v[32:47]
  ds_read_b64_tr_b16 v[88:89], v11 offset:12288
  ds_read_b64_tr_b16 v[90:91], v14 offset:12288
  ds_read_b128 v[104:107], v8 offset:8192
  s_waitcnt lgkmcnt(6)
  v_mfma_f32_32x32x16_bf16 v[32:47], v[80:83], v[96:99], v[32:47]
  ds_read_b64_tr_b16 v[92:93], v11 offset:14336
  ds_read_b64_tr_b16 v[94:95], v14 offset:14336
  ds_read_b128 v[108:111], v8 offset:10240
  s_waitcnt lgkmcnt(6)
  v_mfma_f32_32x32x16_bf16 v[32:47], v[84:87], v[100:103], v[32:47]
  s_barrier
  ds_read_b64_tr_b16 v[80:81], v10 offset:0
  ds_read_b64_tr_b16 v[82:83], v13 offset:0
  ds_read_b128 v[96:99], v8 offset:16384
  s_waitcnt lgkmcnt(6)
  v_mfma_f32_32x32x16_bf16 v[32:47], v[88:91], v[104:107], v[32:47]
  ds_read_b64_tr_b16 v[84:85], v10 offset:2048
  ds_read_b64_tr_b16 v[86:87], v13 offset:2048
  ds_read_b128 v[100:103], v8 offset:18432
  s_waitcnt lgkmcnt(6)
  v_mfma_f32_32x32x16_bf16 v[32:47], v[92:95], v[108:111], v[32:47]
  ds_read_b64_tr_b16 v[88:89], v10 offset:53248
  ds_read_b64_tr_b16 v[90:91], v13 offset:53248
  ds_read_b128 v[104:107], v7 offset:32768
  s_waitcnt lgkmcnt(6)
  v_mfma_f32_32x32x16_bf16 v[32:47], v[80:83], v[96:99], v[32:47]
  ds_read_b64_tr_b16 v[92:93], v10 offset:55296
  ds_read_b64_tr_b16 v[94:95], v13 offset:55296
  ds_read_b128 v[108:111], v7 offset:34816
  s_waitcnt lgkmcnt(6)
  v_mfma_f32_32x32x16_bf16 v[32:47], v[84:87], v[100:103], v[32:47]
  ds_read_b64_tr_b16 v[80:81], v10 offset:61440
  ds_read_b64_tr_b16 v[82:83], v13 offset:61440
  ds_read_b128 v[96:99], v7 offset:57344
  s_waitcnt lgkmcnt(6)
  v_mfma_f32_32x32x16_bf16 v[32:47], v[88:91], v[104:107], v[32:47]
  ds_read_b64_tr_b16 v[84:85], v10 offset:63488
  ds_read_b64_tr_b16 v[86:87], v13 offset:63488
  ds_read_b128 v[100:103], v7 offset:59392
  s_waitcnt lgkmcnt(6)
  v_mfma_f32_32x32x16_bf16 v[32:47], v[92:95], v[108:111], v[32:47]
  ds_read_b64_tr_b16 v[88:89], v11 offset:24576
  ds_read_b64_tr_b16 v[90:91], v14 offset:24576
  ds_read_b128 v[104:107], v8 offset:20480
  s_waitcnt lgkmcnt(6)
  v_mfma_f32_32x32x16_bf16 v[32:47], v[80:83], v[96:99], v[32:47]
  ds_read_b64_tr_b16 v[92:93], v11 offset:26624
  ds_read_b64_tr_b16 v[94:95], v14 offset:26624
  ds_read_b128 v[108:111], v8 offset:22528
  s_waitcnt lgkmcnt(6)
  v_mfma_f32_32x32x16_bf16 v[32:47], v[84:87], v[100:103], v[32:47]
  s_barrier
  ds_read_b64_tr_b16 v[80:81], v10 offset:4096
  ds_read_b64_tr_b16 v[82:83], v13 offset:4096
  ds_read_b128 v[96:99], v8 offset:40960
  s_waitcnt lgkmcnt(6)
  v_mfma_f32_32x32x16_bf16 v[32:47], v[88:91], v[104:107], v[32:47]
  ds_read_b64_tr_b16 v[84:85], v10 offset:6144
  ds_read_b64_tr_b16 v[86:87], v13 offset:6144
  ds_read_b128 v[100:103], v8 offset:43008
  s_waitcnt lgkmcnt(6)
  v_mfma_f32_32x32x16_bf16 v[32:47], v[92:95], v[108:111], v[32:47]
  ds_read_b64_tr_b16 v[88:89], v10 offset:12288
  ds_read_b64_tr_b16 v[90:91], v13 offset:12288
  ds_read_b128 v[104:107], v7 offset:8192
  s_waitcnt lgkmcnt(6)
  v_mfma_f32_32x32x16_bf16 v[32:47], v[80:83], v[96:99], v[32:47]
  ds_read_b64_tr_b16 v[92:93], v10 offset:14336
  ds_read_b64_tr_b16 v[94:95], v13 offset:14336
  ds_read_b128 v[108:111], v7 offset:10240
  s_waitcnt lgkmcnt(6)
  v_mfma_f32_32x32x16_bf16 v[32:47], v[84:87], v[100:103], v[32:47]
  ds_read_b64_tr_b16 v[80:81], v11 offset:0
  ds_read_b64_tr_b16 v[82:83], v14 offset:0
  ds_read_b128 v[96:99], v7 offset:36864
  s_waitcnt lgkmcnt(6)
  v_mfma_f32_32x32x16_bf16 v[32:47], v[88:91], v[104:107], v[32:47]
  ds_read_b64_tr_b16 v[84:85], v11 offset:2048
  ds_read_b64_tr_b16 v[86:87], v14 offset:2048
  ds_read_b128 v[100:103], v7 offset:38912
  s_waitcnt lgkmcnt(6)
  v_mfma_f32_32x32x16_bf16 v[32:47], v[92:95], v[108:111], v[32:47]
  ds_read_b64_tr_b16 v[88:89], v11 offset:32768
  ds_read_b64_tr_b16 v[90:91], v14 offset:32768
  ds_read_b128 v[104:107], v8 offset:28672
  s_waitcnt lgkmcnt(6)
  v_mfma_f32_32x32x16_bf16 v[32:47], v[80:83], v[96:99], v[32:47]
  ds_read_b64_tr_b16 v[92:93], v11 offset:34816
  ds_read_b64_tr_b16 v[94:95], v14 offset:34816
  ds_read_b128 v[108:111], v8 offset:30720
  s_waitcnt lgkmcnt(6)
  v_mfma_f32_32x32x16_bf16 v[32:47], v[84:87], v[100:103], v[32:47]
  s_barrier
  ds_read_b64_tr_b16 v[80:81], v10 offset:16384
  ds_read_b64_tr_b16 v[82:83], v13 offset:16384
  ds_read_b128 v[96:99], v8 offset:36864
  s_waitcnt lgkmcnt(6)
  v_mfma_f32_32x32x16_bf16 v[32:47], v[88:91], v[104:107], v[32:47]
  ds_read_b64_tr_b16 v[84:85], v10 offset:18432
  ds_read_b64_tr_b16 v[86:87], v13 offset:18432
  ds_read_b128 v[100:103], v8 offset:38912
  s_waitcnt lgkmcnt(6)
  v_mfma_f32_32x32x16_bf16 v[32:47], v[92:95], v[108:111], v[32:47]
  ds_read_b64_tr_b16 v[88:89], v10 offset:24576
  ds_read_b64_tr_b16 v[90:91], v13 offset:24576
  ds_read_b128 v[104:107], v7 offset:20480
  s_waitcnt lgkmcnt(6)
  v_mfma_f32_32x32x16_bf16 v[32:47], v[80:83], v[96:99], v[32:47]
  ds_read_b64_tr_b16 v[92:93], v10 offset:26624
  ds_read_b64_tr_b16 v[94:95], v13 offset:26624
  ds_read_b128 v[108:111], v7 offset:22528
  s_waitcnt lgkmcnt(6)
  v_mfma_f32_32x32x16_bf16 v[32:47], v[84:87], v[100:103], v[32:47]
  ds_read_b64_tr_b16 v[80:81], v10 offset:40960
  ds_read_b64_tr_b16 v[82:83], v13 offset:40960
  ds_read_b128 v[96:99], v7 offset:28672
  s_waitcnt lgkmcnt(6)
  v_mfma_f32_32x32x16_bf16 v[32:47], v[88:91], v[104:107], v[32:47]
  ds_read_b64_tr_b16 v[84:85], v10 offset:43008
  ds_read_b64_tr_b16 v[86:87], v13 offset:43008
  ds_read_b128 v[100:103], v7 offset:30720
  s_waitcnt lgkmcnt(6)
  v_mfma_f32_32x32x16_bf16 v[32:47], v[92:95], v[108:111], v[32:47]
  ds_read_b64_tr_b16 v[88:89], v10 offset:49152
  ds_read_b64_tr_b16 v[90:91], v13 offset:49152
  ds_read_b128 v[104:107], v7 offset:45056
  s_waitcnt lgkmcnt(6)
  v_mfma_f32_32x32x16_bf16 v[32:47], v[80:83], v[96:99], v[32:47]
  ds_read_b64_tr_b16 v[92:93], v10 offset:51200
  ds_read_b64_tr_b16 v[94:95], v13 offset:51200
  ds_read_b128 v[108:111], v7 offset:47104
  s_waitcnt lgkmcnt(6)
  v_mfma_f32_32x32x16_bf16 v[32:47], v[84:87], v[100:103], v[32:47]
  s_barrier
  ds_read_b64_tr_b16 v[80:81], v10 offset:0
  ds_read_b64_tr_b16 v[82:83], v13 offset:0
  ds_read_b128 v[96:99], v8 offset:4096
  s_waitcnt lgkmcnt(6)
  v_mfma_f32_32x32x16_bf16 v[32:47], v[88:91], v[104:107], v[32:47]
  ds_read_b64_tr_b16 v[84:85], v10 offset:2048
  ds_read_b64_tr_b16 v[86:87], v13 offset:2048
  ds_read_b128 v[100:103], v8 offset:6144
  s_waitcnt lgkmcnt(6)
  v_mfma_f32_32x32x16_bf16 v[32:47], v[92:95], v[108:111], v[32:47]
  ds_read_b64_tr_b16 v[88:89], v10 offset:53248
  ds_read_b64_tr_b16 v[90:91], v13 offset:53248
  ds_read_b128 v[104:107], v7 offset:32768
  s_waitcnt lgkmcnt(6)
  v_mfma_f32_32x32x16_bf16 v[32:47], v[80:83], v[96:99], v[32:47]
  ds_read_b64_tr_b16 v[92:93], v10 offset:55296
  ds_read_b64_tr_b16 v[94:95], v13 offset:55296
  ds_read_b128 v[108:111], v7 offset:34816
  s_waitcnt lgkmcnt(6)
  v_mfma_f32_32x32x16_bf16 v[32:47], v[84:87], v[100:103], v[32:47]
  ds_read_b64_tr_b16 v[80:81], v10 offset:61440
  ds_read_b64_tr_b16 v[82:83], v13 offset:61440
  ds_read_b128 v[96:99], v7 offset:57344
  s_waitcnt lgkmcnt(6)
  v_mfma_f32_32x32x16_bf16 v[32:47], v[88:91], v[104:107], v[32:47]
  ds_read_b64_tr_b16 v[84:85], v10 offset:63488
  ds_read_b64_tr_b16 v[86:87], v13 offset:63488
  ds_read_b128 v[100:103], v7 offset:59392
  s_waitcnt lgkmcnt(6)
  v_mfma_f32_32x32x16_bf16 v[32:47], v[92:95], v[108:111], v[32:47]
  ds_read_b64_tr_b16 v[88:89], v11 offset:12288
  ds_read_b64_tr_b16 v[90:91], v14 offset:12288
  ds_read_b128 v[104:107], v8 offset:8192
  s_waitcnt lgkmcnt(6)
  v_mfma_f32_32x32x16_bf16 v[32:47], v[80:83], v[96:99], v[32:47]
  ds_read_b64_tr_b16 v[92:93], v11 offset:14336
  ds_read_b64_tr_b16 v[94:95], v14 offset:14336
  ds_read_b128 v[108:111], v8 offset:10240
  s_waitcnt lgkmcnt(6)
  v_mfma_f32_32x32x16_bf16 v[32:47], v[84:87], v[100:103], v[32:47]
  s_barrier
  ds_read_b128 v[96:99], v8 offset:16384
  s_waitcnt lgkmcnt(4)
  v_mfma_f32_32x32x16_bf16 v[32:47], v[88:91], v[104:107], v[32:47]
  ds_read_b128 v[100:103], v8 offset:18432
  s_waitcnt lgkmcnt(2)
  v_mfma_f32_32x32x16_bf16 v[32:47], v[92:95], v[108:111], v[32:47]
  ds_read_b128 v[104:107], v7 offset:4096
  s_waitcnt lgkmcnt(2)
  v_mfma_f32_32x32x16_bf16 v[32:47], v[128:131], v[96:99], v[32:47]
  ds_read_b128 v[108:111], v7 offset:6144
  s_waitcnt lgkmcnt(2)
  v_mfma_f32_32x32x16_bf16 v[32:47], v[132:135], v[100:103], v[32:47]
  ds_read_b128 v[96:99], v7 offset:8192
  s_waitcnt lgkmcnt(2)
  v_mfma_f32_32x32x16_bf16 v[32:47], v[136:139], v[104:107], v[32:47]
  ds_read_b128 v[100:103], v7 offset:10240
  s_waitcnt lgkmcnt(2)
  v_mfma_f32_32x32x16_bf16 v[32:47], v[140:143], v[108:111], v[32:47]
  ds_read_b128 v[104:107], v7 offset:12288
  s_waitcnt lgkmcnt(2)
  v_mfma_f32_32x32x16_bf16 v[32:47], v[144:147], v[96:99], v[32:47]
  ds_read_b128 v[108:111], v7 offset:14336
  s_waitcnt lgkmcnt(2)
  v_mfma_f32_32x32x16_bf16 v[32:47], v[148:151], v[100:103], v[32:47]
  s_barrier
  ds_read_b128 v[96:99], v7 offset:36864
  s_waitcnt lgkmcnt(2)
  v_mfma_f32_32x32x16_bf16 v[32:47], v[152:155], v[104:107], v[32:47]
  ds_read_b128 v[100:103], v7 offset:38912
  s_waitcnt lgkmcnt(2)
  v_mfma_f32_32x32x16_bf16 v[32:47], v[156:159], v[108:111], v[32:47]
  ds_read_b128 v[104:107], v8 offset:0
  s_waitcnt lgkmcnt(2)
  v_mfma_f32_32x32x16_bf16 v[32:47], v[160:163], v[96:99], v[32:47]
  ds_read_b128 v[108:111], v8 offset:2048
  s_waitcnt lgkmcnt(2)
  v_mfma_f32_32x32x16_bf16 v[32:47], v[164:167], v[100:103], v[32:47]
  ds_read_b128 v[96:99], v8 offset:20480
  s_waitcnt lgkmcnt(2)
  v_mfma_f32_32x32x16_bf16 v[32:47], v[168:171], v[104:107], v[32:47]
  ds_read_b128 v[100:103], v8 offset:22528
  s_waitcnt lgkmcnt(2)
  v_mfma_f32_32x32x16_bf16 v[32:47], v[172:175], v[108:111], v[32:47]
  ds_read_b128 v[104:107], v8 offset:24576
  s_waitcnt lgkmcnt(2)
  v_mfma_f32_32x32x16_bf16 v[32:47], v[176:179], v[96:99], v[32:47]
  ds_read_b128 v[108:111], v8 offset:26624
  s_waitcnt lgkmcnt(2)
  v_mfma_f32_32x32x16_bf16 v[32:47], v[180:183], v[100:103], v[32:47]
  s_barrier
  ds_read_b128 v[96:99], v8 offset:40960
  s_waitcnt lgkmcnt(2)
  v_mfma_f32_32x32x16_bf16 v[32:47], v[184:187], v[104:107], v[32:47]
  ds_read_b128 v[100:103], v8 offset:43008
  s_waitcnt lgkmcnt(2)
  v_mfma_f32_32x32x16_bf16 v[32:47], v[188:191], v[108:111], v[32:47]
  ds_read_b128 v[104:107], v7 offset:16384
  s_waitcnt lgkmcnt(2)
  v_mfma_f32_32x32x16_bf16 v[32:47], v[192:195], v[96:99], v[32:47]
  ds_read_b128 v[108:111], v7 offset:18432
  s_waitcnt lgkmcnt(2)
  v_mfma_f32_32x32x16_bf16 v[32:47], v[196:199], v[100:103], v[32:47]
  ds_read_b128 v[96:99], v7 offset:20480
  s_waitcnt lgkmcnt(2)
  v_mfma_f32_32x32x16_bf16 v[32:47], v[200:203], v[104:107], v[32:47]
  ds_read_b128 v[100:103], v7 offset:22528
  s_waitcnt lgkmcnt(2)
  v_mfma_f32_32x32x16_bf16 v[32:47], v[204:207], v[108:111], v[32:47]
  ds_read_b128 v[104:107], v7 offset:24576
  s_waitcnt lgkmcnt(2)
  v_mfma_f32_32x32x16_bf16 v[32:47], v[208:211], v[96:99], v[32:47]
  ds_read_b128 v[108:111], v7 offset:26624
  s_waitcnt lgkmcnt(2)
  v_mfma_f32_32x32x16_bf16 v[32:47], v[212:215], v[100:103], v[32:47]
  s_barrier
  ds_read_b128 v[96:99], v7 offset:28672
  s_waitcnt lgkmcnt(2)
  v_mfma_f32_32x32x16_bf16 v[32:47], v[216:219], v[104:107], v[32:47]
  ds_read_b128 v[100:103], v7 offset:30720
  s_waitcnt lgkmcnt(2)
  v_mfma_f32_32x32x16_bf16 v[32:47], v[220:223], v[108:111], v[32:47]
  ds_read_b128 v[104:107], v7 offset:40960
  s_waitcnt lgkmcnt(2)
  v_mfma_f32_32x32x16_bf16 v[32:47], v[224:227], v[96:99], v[32:47]
  ds_read_b128 v[108:111], v7 offset:43008
  s_waitcnt lgkmcnt(2)
  v_mfma_f32_32x32x16_bf16 v[32:47], v[228:231], v[100:103], v[32:47]
  s_barrier
  ds_read_b128 v[96:99], v7 offset:0
  s_waitcnt lgkmcnt(2)
  v_mfma_f32_32x32x16_bf16 v[32:47], v[232:235], v[104:107], v[32:47]
  ds_read_b128 v[100:103], v7 offset:2048
  s_waitcnt lgkmcnt(2)
  v_mfma_f32_32x32x16_bf16 v[32:47], v[236:239], v[108:111], v[32:47]
  ds_read_b128 v[104:107], v7 offset:32768
  s_waitcnt lgkmcnt(2)
  v_mfma_f32_32x32x16_bf16 v[32:47], v[240:243], v[96:99], v[32:47]
  ds_read_b128 v[108:111], v7 offset:34816
  s_waitcnt lgkmcnt(2)
  v_mfma_f32_32x32x16_bf16 v[32:47], v[244:247], v[100:103], v[32:47]
  s_waitcnt lgkmcnt(1)
  v_mfma_f32_32x32x16_bf16 v[32:47], v[248:251], v[104:107], v[32:47]
  s_waitcnt lgkmcnt(0)
  v_mfma_f32_32x32x16_bf16 v[32:47], v[252:255], v[108:111], v[32:47]
  s_nop 11
  v_cvt_pk_bf16_f32 v96, v32, v33
  v_cvt_pk_bf16_f32 v97, v34, v35
  v_cvt_pk_bf16_f32 v98, v36, v37
  v_cvt_pk_bf16_f32 v99, v38, v39
  v_cvt_pk_bf16_f32 v100, v40, v41
  v_cvt_pk_bf16_f32 v101, v42, v43
  v_cvt_pk_bf16_f32 v102, v44, v45
  v_cvt_pk_bf16_f32 v103, v46, v47
  v_permlane32_swap_b32 v96, v98
  v_permlane32_swap_b32 v97, v99
  v_permlane32_swap_b32 v100, v102
  v_permlane32_swap_b32 v101, v103
  ds_write_b128 v50, v[96:99] offset:4096
  ds_write_b128 v51, v[100:103] offset:4096
  s_waitcnt lgkmcnt(0)
  s_barrier
  ds_read_b128 v[96:99], v52 offset:4096
  ds_read_b128 v[100:103], v52 offset:5120
  s_waitcnt lgkmcnt(1)
  buffer_store_dwordx4 v[96:99], v53, s[36:39], s70 offen
  s_waitcnt lgkmcnt(0)
  buffer_store_dwordx4 v[100:103], v53, s[36:39], s69 offen
  s_endpgm
  .p2align 12
L_HELPER:
PAD_18:
  s_cbranch_execz L_TRAMP
  s_nop 0
  v_and_b32 v122, 15, v1
  v_lshlrev_b32 v122, 2, v122
  v_add_u32 v122, 159744, v122
  v_and_b32_e64 v31, 48, v1
  v_add_u32 v120, 159744, v31
  s_lshl_b32 s53, s44, 6
  s_add_u32 s53, s53, 2048
  v_add_u32 v126, s53, v120
  v_add_u32_e64 v127, s53, v122
  v_bfe_u32 v29, v1, 4, 1
  v_lshrrev_b32_e64 v30, 5, v1
  v_lshl_add_u32 v31, v29, 1, v30
  v_lshl_add_u32 v123, v31, 6, v122
  v_and_b32 v31, 15, v1
  v_lshlrev_b32 v31, 4, v31
  v_lshl_add_u32 v31, v29, 10, v31
  v_lshl_add_u32 v31, v30, 8, v31
  s_lshl_b32 s53, s44, 11
  v_add_u32 v121, s53, v31
  s_waitcnt vmcnt(11)
  s_barrier
  s_add_u32 m0, s47, 24576
  s_add_u32 s48, s45, 2
  s_and_b32 s48, s48, 7
  s_mul_i32 s48, s48, 128
  buffer_load_dwordx4 v40, s[8:11], s48 offen lds
  s_add_u32 m0, s47, 28672
  s_add_u32 s48, s45, 2
  s_and_b32 s48, s48, 7
  s_mul_i32 s48, s48, 128
  buffer_load_dwordx4 v41, s[8:11], s48 offen lds
  s_add_u32 m0, s47, 32768
  s_add_u32 s48, s45, 2
  s_and_b32 s48, s48, 7
  s_mul_i32 s48, s48, 128
  buffer_load_dwordx4 v42, s[8:11], s48 offen lds
  s_waitcnt vmcnt(13)
  s_add_u32 m0, s47, 90112
  s_add_u32 s48, s98, 2
  s_and_b32 s48, s48, 15
  s_mul_i32 s48, s48, 98304
  buffer_load_dwordx4 v3, s[12:15], s48 offen lds
  s_waitcnt vmcnt(13)
  s_add_u32 m0, s47, 94208
  s_add_u32 s48, s98, 2
  s_and_b32 s48, s48, 15
  s_mul_i32 s48, s48, 98304
  s_add_u32 s48, s48, 1024
  buffer_load_dwordx4 v3, s[12:15], s48 offen lds
  s_waitcnt vmcnt(8)
  s_barrier
  s_add_u32 m0, s47, 98304
  s_add_u32 s48, s98, 2
  s_and_b32 s48, s48, 15
  s_mul_i32 s48, s48, 98304
  s_add_u32 s48, s48, 2048
  buffer_load_dwordx4 v3, s[12:15], s48 offen lds
  s_add_u32 m0, s47, 102400
  s_add_u32 s48, s98, 3
  s_and_b32 s48, s48, 15
  s_mul_i32 s48, s48, 98304
  buffer_load_dwordx4 v3, s[12:15], s48 offen lds
  s_add_u32 m0, s47, 106496
  s_add_u32 s48, s98, 3
  s_and_b32 s48, s48, 15
  s_mul_i32 s48, s48, 98304
  s_add_u32 s48, s48, 1024
  buffer_load_dwordx4 v3, s[12:15], s48 offen lds
  s_add_u32 m0, s47, 110592
  s_add_u32 s48, s98, 3
  s_and_b32 s48, s48, 15
  s_mul_i32 s48, s48, 98304
  s_add_u32 s48, s48, 2048
  buffer_load_dwordx4 v3, s[12:15], s48 offen lds
  s_add_u32 m0, s47, 36864
  s_add_u32 s48, s45, 3
  s_and_b32 s48, s48, 7
  s_mul_i32 s48, s48, 128
  buffer_load_dwordx4 v40, s[8:11], s48 offen lds
  s_waitcnt vmcnt(10)
  s_barrier
  s_add_u32 m0, s47, 40960
  s_add_u32 s48, s45, 3
  s_and_b32 s48, s48, 7
  s_mul_i32 s48, s48, 128
  buffer_load_dwordx4 v41, s[8:11], s48 offen lds
  s_add_u32 m0, s47, 45056
  s_add_u32 s48, s45, 3
  s_and_b32 s48, s48, 7
  s_mul_i32 s48, s48, 128
  buffer_load_dwordx4 v42, s[8:11], s48 offen lds
  s_add_u32 m0, s47, 65536
  s_add_u32 s48, s98, 4
  s_and_b32 s48, s48, 15
  s_mul_i32 s48, s48, 98304
  buffer_load_dwordx4 v3, s[12:15], s48 offen lds
  s_add_u32 m0, s47, 69632
  s_add_u32 s48, s98, 4
  s_and_b32 s48, s48, 15
  s_mul_i32 s48, s48, 98304
  s_add_u32 s48, s48, 1024
  buffer_load_dwordx4 v3, s[12:15], s48 offen lds
  s_waitcnt vmcnt(13)
  s_add_u32 m0, s47, 73728
  s_add_u32 s48, s98, 4
  s_and_b32 s48, s48, 15
  s_mul_i32 s48, s48, 98304
  s_add_u32 s48, s48, 2048
  buffer_load_dwordx4 v3, s[12:15], s48 offen lds
  s_waitcnt vmcnt(9)
  s_barrier
  s_add_u32 m0, s47, 77824
  s_add_u32 s48, s98, 5
  s_and_b32 s48, s48, 15
  s_mul_i32 s48, s48, 98304
  buffer_load_dwordx4 v3, s[12:15], s48 offen lds
  s_add_u32 m0, s47, 81920
  s_add_u32 s48, s98, 5
  s_and_b32 s48, s48, 15
  s_mul_i32 s48, s48, 98304
  s_add_u32 s48, s48, 1024
  buffer_load_dwordx4 v3, s[12:15], s48 offen lds
  s_add_u32 m0, s47, 86016
  s_add_u32 s48, s98, 5
  s_and_b32 s48, s48, 15
  s_mul_i32 s48, s48, 98304
  s_add_u32 s48, s48, 2048
  buffer_load_dwordx4 v3, s[12:15], s48 offen lds
  s_add_u32 m0, s47, 49152
  s_add_u32 s48, s45, 4
  s_and_b32 s48, s48, 7
  s_mul_i32 s48, s48, 128
  buffer_load_dwordx4 v40, s[8:11], s48 offen lds
  s_add_u32 m0, s47, 53248
  s_add_u32 s48, s45, 4
  s_and_b32 s48, s48, 7
  s_mul_i32 s48, s48, 128
  buffer_load_dwordx4 v41, s[8:11], s48 offen lds
  s_waitcnt vmcnt(13)
  s_add_u32 m0, s47, 57344
  s_add_u32 s48, s45, 4
  s_and_b32 s48, s48, 7
  s_mul_i32 s48, s48, 128
  buffer_load_dwordx4 v42, s[8:11], s48 offen lds
  s_waitcnt vmcnt(12)
  s_barrier
  s_add_u32 m0, s47, 90112
  s_add_u32 s48, s98, 6
  s_and_b32 s48, s48, 15
  s_mul_i32 s48, s48, 98304
  buffer_load_dwordx4 v3, s[12:15], s48 offen lds
  s_add_u32 m0, s47, 94208
  s_add_u32 s48, s98, 6
  s_and_b32 s48, s48, 15
  s_mul_i32 s48, s48, 98304
  s_add_u32 s48, s48, 1024
  buffer_load_dwordx4 v3, s[12:15], s48 offen lds
  s_waitcnt vmcnt(13)
  s_add_u32 m0, s47, 98304
  s_add_u32 s48, s98, 6
  s_and_b32 s48, s48, 15
  s_mul_i32 s48, s48, 98304
  s_add_u32 s48, s48, 2048
  buffer_load_dwordx4 v3, s[12:15], s48 offen lds
  s_waitcnt vmcnt(13)
  s_add_u32 m0, s47, 114688
  s_add_u32 s48, s98, 7
  s_and_b32 s48, s48, 15
  s_mul_i32 s48, s48, 98304
  buffer_load_dwordx4 v3, s[12:15], s48 offen lds
  s_waitcnt vmcnt(13)
  s_add_u32 m0, s47, 118784
  s_add_u32 s48, s98, 7
  s_and_b32 s48, s48, 15
  s_mul_i32 s48, s48, 98304
  s_add_u32 s48, s48, 1024
  buffer_load_dwordx4 v3, s[12:15], s48 offen lds
  s_waitcnt vmcnt(11)
  s_barrier
  s_add_u32 m0, s47, 102400
  s_add_u32 s48, s98, 7
  s_and_b32 s48, s48, 15
  s_mul_i32 s48, s48, 98304
  s_add_u32 s48, s48, 2048
  buffer_load_dwordx4 v3, s[12:15], s48 offen lds
  s_add_u32 m0, s47, 0
  s_add_u32 s48, s45, 5
  s_and_b32 s48, s48, 7
  s_mul_i32 s48, s48, 128
  buffer_load_dwordx4 v40, s[8:11], s48 offen lds
  s_add_u32 m0, s47, 4096
  s_add_u32 s48, s45, 5
  s_and_b32 s48, s48, 7
  s_mul_i32 s48, s48, 128
  buffer_load_dwordx4 v41, s[8:11], s48 offen lds
  s_waitcnt vmcnt(13)
  s_add_u32 m0, s47, 8192
  s_add_u32 s48, s45, 5
  s_and_b32 s48, s48, 7
  s_mul_i32 s48, s48, 128
  buffer_load_dwordx4 v42, s[8:11], s48 offen lds
  s_waitcnt vmcnt(13)
  s_add_u32 m0, s47, 106496
  s_add_u32 s48, s98, 8
  s_and_b32 s48, s48, 15
  s_mul_i32 s48, s48, 98304
  buffer_load_dwordx4 v3, s[12:15], s48 offen lds
  s_waitcnt vmcnt(13)
  s_add_u32 m0, s47, 110592
  s_add_u32 s48, s98, 8
  s_and_b32 s48, s48, 15
  s_mul_i32 s48, s48, 98304
  s_add_u32 s48, s48, 1024
  buffer_load_dwordx4 v3, s[12:15], s48 offen lds
  s_barrier
  s_waitcnt vmcnt(13)
  s_add_u32 m0, s47, 65536
  s_add_u32 s48, s98, 8
  s_and_b32 s48, s48, 15
  s_mul_i32 s48, s48, 98304
  s_add_u32 s48, s48, 2048
  buffer_load_dwordx4 v3, s[12:15], s48 offen lds
  s_waitcnt vmcnt(13)
  s_add_u32 m0, s47, 69632
  s_add_u32 s48, s98, 9
  s_and_b32 s48, s48, 15
  s_mul_i32 s48, s48, 98304
  buffer_load_dwordx4 v3, s[12:15], s48 offen lds
  s_waitcnt vmcnt(13)
  s_add_u32 m0, s47, 73728
  s_add_u32 s48, s98, 9
  s_and_b32 s48, s48, 15
  s_mul_i32 s48, s48, 98304
  s_add_u32 s48, s48, 1024
  buffer_load_dwordx4 v3, s[12:15], s48 offen lds
  s_waitcnt vmcnt(13)
  s_add_u32 m0, s47, 122880
  s_add_u32 s48, s98, 9
  s_and_b32 s48, s48, 15
  s_mul_i32 s48, s48, 98304
  s_add_u32 s48, s48, 2048
  buffer_load_dwordx4 v3, s[12:15], s48 offen lds
  s_waitcnt vmcnt(13)
  s_add_u32 m0, s47, 12288
  s_add_u32 s48, s45, 6
  s_and_b32 s48, s48, 7
  s_mul_i32 s48, s48, 128
  buffer_load_dwordx4 v40, s[8:11], s48 offen lds
  s_waitcnt vmcnt(13)
  s_barrier
  s_add_u32 m0, s47, 16384
  s_add_u32 s48, s45, 6
  s_and_b32 s48, s48, 7
  s_mul_i32 s48, s48, 128
  buffer_load_dwordx4 v41, s[8:11], s48 offen lds
  s_waitcnt vmcnt(13)
  s_add_u32 m0, s47, 20480
  s_add_u32 s48, s45, 6
  s_and_b32 s48, s48, 7
  s_mul_i32 s48, s48, 128
  buffer_load_dwordx4 v42, s[8:11], s48 offen lds
  s_waitcnt vmcnt(13)
  s_add_u32 m0, s47, 77824
  s_add_u32 s48, s98, 10
  s_and_b32 s48, s48, 15
  s_mul_i32 s48, s48, 98304
  buffer_load_dwordx4 v3, s[12:15], s48 offen lds
  s_waitcnt vmcnt(13)
  s_add_u32 m0, s47, 81920
  s_add_u32 s48, s98, 10
  s_and_b32 s48, s48, 15
  s_mul_i32 s48, s48, 98304
  s_add_u32 s48, s48, 1024
  buffer_load_dwordx4 v3, s[12:15], s48 offen lds
  s_waitcnt vmcnt(13)
  s_add_u32 m0, s47, 86016
  s_add_u32 s48, s98, 10
  s_and_b32 s48, s48, 15
  s_mul_i32 s48, s48, 98304
  s_add_u32 s48, s48, 2048
  buffer_load_dwordx4 v3, s[12:15], s48 offen lds
  s_waitcnt vmcnt(13)
  s_add_u32 m0, s47, 126976
  s_add_u32 s48, s98, 11
  s_and_b32 s48, s48, 15
  s_mul_i32 s48, s48, 98304
  buffer_load_dwordx4 v3, s[12:15], s48 offen lds
  s_barrier
  s_waitcnt vmcnt(13)
  s_add_u32 m0, s47, 90112
  s_add_u32 s48, s98, 11
  s_and_b32 s48, s48, 15
  s_mul_i32 s48, s48, 98304
  s_add_u32 s48, s48, 1024
  buffer_load_dwordx4 v3, s[12:15], s48 offen lds
  s_waitcnt vmcnt(13)
  s_add_u32 m0, s47, 94208
  s_add_u32 s48, s98, 11
  s_and_b32 s48, s48, 15
  s_mul_i32 s48, s48, 98304
  s_add_u32 s48, s48, 2048
  buffer_load_dwordx4 v3, s[12:15], s48 offen lds
  s_waitcnt vmcnt(13)
  s_add_u32 m0, s47, 24576
  s_add_u32 s48, s45, 7
  s_and_b32 s48, s48, 7
  s_mul_i32 s48, s48, 128
  buffer_load_dwordx4 v40, s[8:11], s48 offen lds
  s_waitcnt vmcnt(13)
  s_add_u32 m0, s47, 28672
  s_add_u32 s48, s45, 7
  s_and_b32 s48, s48, 7
  s_mul_i32 s48, s48, 128
  buffer_load_dwordx4 v41, s[8:11], s48 offen lds
  s_waitcnt vmcnt(13)
  s_add_u32 m0, s47, 32768
  s_add_u32 s48, s45, 7
  s_and_b32 s48, s48, 7
  s_mul_i32 s48, s48, 128
  buffer_load_dwordx4 v42, s[8:11], s48 offen lds
  s_barrier
  s_waitcnt vmcnt(13)
  s_add_u32 m0, s47, 98304
  s_add_u32 s48, s98, 12
  s_and_b32 s48, s48, 15
  s_mul_i32 s48, s48, 98304
  buffer_load_dwordx4 v3, s[12:15], s48 offen lds
  s_waitcnt vmcnt(13)
  s_add_u32 m0, s47, 102400
  s_add_u32 s48, s98, 12
  s_and_b32 s48, s48, 15
  s_mul_i32 s48, s48, 98304
  s_add_u32 s48, s48, 1024
  buffer_load_dwordx4 v3, s[12:15], s48 offen lds
  s_waitcnt vmcnt(13)
  s_add_u32 m0, s47, 114688
  s_add_u32 s48, s98, 12
  s_and_b32 s48, s48, 15
  s_mul_i32 s48, s48, 98304
  s_add_u32 s48, s48, 2048
  buffer_load_dwordx4 v3, s[12:15], s48 offen lds
  s_waitcnt vmcnt(13)
  s_add_u32 m0, s47, 118784
  s_add_u32 s48, s98, 13
  s_and_b32 s48, s48, 15
  s_mul_i32 s48, s48, 98304
  buffer_load_dwordx4 v3, s[12:15], s48 offen lds
  s_waitcnt vmcnt(13)
  s_add_u32 m0, s47, 131072
  s_add_u32 s48, s98, 13
  s_and_b32 s48, s48, 15
  s_mul_i32 s48, s48, 98304
  s_add_u32 s48, s48, 1024
  buffer_load_dwordx4 v3, s[12:15], s48 offen lds
  s_waitcnt vmcnt(13)
  s_add_u32 m0, s47, 135168
  s_add_u32 s48, s98, 13
  s_and_b32 s48, s48, 15
  s_mul_i32 s48, s48, 98304
  s_add_u32 s48, s48, 2048
  buffer_load_dwordx4 v3, s[12:15], s48 offen lds
  s_barrier
  s_waitcnt vmcnt(13)
  s_add_u32 m0, s47, 65536
  s_add_u32 s48, s98, 14
  s_and_b32 s48, s48, 15
  s_mul_i32 s48, s48, 98304
  buffer_load_dwordx4 v3, s[12:15], s48 offen lds
  s_waitcnt vmcnt(13)
  s_add_u32 m0, s47, 106496
  s_add_u32 s48, s98, 14
  s_and_b32 s48, s48, 15
  s_mul_i32 s48, s48, 98304
  s_add_u32 s48, s48, 1024
  buffer_load_dwordx4 v3, s[12:15], s48 offen lds
  s_waitcnt vmcnt(13)
  s_add_u32 m0, s47, 110592
  s_add_u32 s48, s98, 14
  s_and_b32 s48, s48, 15
  s_mul_i32 s48, s48, 98304
  s_add_u32 s48, s48, 2048
  buffer_load_dwordx4 v3, s[12:15], s48 offen lds
  s_waitcnt vmcnt(13)
  s_add_u32 m0, s47, 139264
  s_add_u32 s48, s98, 15
  s_and_b32 s48, s48, 15
  s_mul_i32 s48, s48, 98304
  buffer_load_dwordx4 v3, s[12:15], s48 offen lds
  s_waitcnt vmcnt(13)
  s_add_u32 m0, s47, 143360
  s_add_u32 s48, s98, 15
  s_and_b32 s48, s48, 15
  s_mul_i32 s48, s48, 98304
  s_add_u32 s48, s48, 1024
  buffer_load_dwordx4 v3, s[12:15], s48 offen lds
  s_barrier
  s_waitcnt vmcnt(13)
  s_add_u32 m0, s47, 69632
  s_add_u32 s48, s98, 15
  s_and_b32 s48, s48, 15
  s_mul_i32 s48, s48, 98304
  s_add_u32 s48, s48, 2048
  buffer_load_dwordx4 v3, s[12:15], s48 offen lds
  s_lshl_b32 s53, s46, 3
  s_add_u32 s53, s53, s45
  s_or_b32 s54, s71, 0
  s_cmp_eq_u32 s44, 2
  s_cselect_b32 s53, s53, 2130706432
  v_mov_b32 v29, s54
  v_mov_b32 v30, 0
  s_mov_b64 exec, 1
  buffer_store_byte v29, v30, s[40:43], s53 offen sc1
  s_mov_b64 exec, -1
  s_lshl_b32 s90, s2, 11
  s_lshl_b32 s91, s45, 7
  s_sub_u32 s90, s90, s91
  s_mul_i32 s91, s44, 512
  s_add_u32 s90, s90, s91
  v_lshlrev_b32 v0, 7, v1
  s_mov_b64 exec, 0xf
  buffer_load_dword v21, v0, s[20:23], s90 offen
  s_mov_b64 exec, -1
  s_lshl_b32 s90, s2, 11
  s_lshl_b32 s91, s45, 7
  s_sub_u32 s90, s90, s91
  s_mul_i32 s91, s44, 512
  s_add_u32 s90, s90, s91
  v_lshlrev_b32 v0, 7, v1
  s_mov_b64 exec, 0xf
  buffer_load_dword v21, v0, s[24:27], s90 offen
  s_mov_b64 exec, -1
  s_waitcnt vmcnt(13)
  s_add_u32 m0, s47, 122880
  s_add_u32 s48, s82, 0
  buffer_load_dwordx4 v4, s[76:79], s48 offen lds
  s_waitcnt vmcnt(13)
  s_add_u32 m0, s47, 147456
  s_add_u32 s48, s82, 114688
  buffer_load_dwordx4 v4, s[76:79], s48 offen lds
  s_barrier
  s_waitcnt vmcnt(13)
  s_add_u32 m0, s47, 36864
  s_add_u32 s48, s98, 0
  s_and_b32 s48, s48, 15
  s_mul_i32 s48, s48, 32768
  buffer_load_dwordx4 v2, s[16:19], s48 offen lds
  s_waitcnt vmcnt(13)
  s_add_u32 m0, s47, 40960
  s_add_u32 s48, s98, 1
  s_and_b32 s48, s48, 15
  s_mul_i32 s48, s48, 32768
  buffer_load_dwordx4 v2, s[16:19], s48 offen lds
  s_waitcnt vmcnt(13)
  s_add_u32 m0, s47, 45056
  s_add_u32 s48, s98, 2
  s_and_b32 s48, s48, 15
  s_mul_i32 s48, s48, 32768
  buffer_load_dwordx4 v2, s[16:19], s48 offen lds
  s_waitcnt vmcnt(13)
  s_add_u32 m0, s47, 49152
  s_add_u32 s48, s98, 3
  s_and_b32 s48, s48, 15
  s_mul_i32 s48, s48, 32768
  buffer_load_dwordx4 v2, s[16:19], s48 offen lds
  s_waitcnt vmcnt(13)
  s_add_u32 m0, s47, 53248
  s_add_u32 s48, s98, 4
  s_and_b32 s48, s48, 15
  s_mul_i32 s48, s48, 32768
  buffer_load_dwordx4 v2, s[16:19], s48 offen lds
  s_barrier
  s_barrier
  s_waitcnt vmcnt(13)
  s_barrier
  s_waitcnt vmcnt(10)
  s_barrier
  s_add_u32 m0, s47, 20480
  s_add_u32 s48, s98, 5
  s_and_b32 s48, s48, 15
  s_mul_i32 s48, s48, 32768
  buffer_load_dwordx4 v2, s[16:19], s48 offen lds
  s_barrier
  s_add_u32 m0, s47, 24576
  s_add_u32 s48, s98, 6
  s_and_b32 s48, s48, 15
  s_mul_i32 s48, s48, 32768
  buffer_load_dwordx4 v2, s[16:19], s48 offen lds
  s_add_u32 m0, s47, 28672
  s_add_u32 s48, s98, 7
  s_and_b32 s48, s48, 15
  s_mul_i32 s48, s48, 32768
  buffer_load_dwordx4 v2, s[16:19], s48 offen lds
  s_add_u32 m0, s47, 32768
  s_add_u32 s48, s98, 8
  s_and_b32 s48, s48, 15
  s_mul_i32 s48, s48, 32768
  buffer_load_dwordx4 v2, s[16:19], s48 offen lds
  s_waitcnt vmcnt(13)
  s_add_u32 m0, s47, 57344
  s_add_u32 s48, s98, 9
  s_and_b32 s48, s48, 15
  s_mul_i32 s48, s48, 32768
  buffer_load_dwordx4 v2, s[16:19], s48 offen lds
  s_waitcnt vmcnt(13)
  s_add_u32 m0, s47, 61440
  s_add_u32 s48, s98, 10
  s_and_b32 s48, s48, 15
  s_mul_i32 s48, s48, 32768
  buffer_load_dwordx4 v2, s[16:19], s48 offen lds
  s_waitcnt vmcnt(13)
  s_add_u32 m0, s47, 65536
  s_add_u32 s48, s98, 11
  s_and_b32 s48, s48, 15
  s_mul_i32 s48, s48, 32768
  buffer_load_dwordx4 v2, s[16:19], s48 offen lds
  s_waitcnt vmcnt(13)
  s_add_u32 m0, s47, 69632
  s_add_u32 s48, s98, 12
  s_and_b32 s48, s48, 15
  s_mul_i32 s48, s48, 32768
  buffer_load_dwordx4 v2, s[16:19], s48 offen lds
  s_waitcnt vmcnt(13)
  s_add_u32 m0, s47, 73728
  s_add_u32 s48, s98, 13
  s_and_b32 s48, s48, 15
  s_mul_i32 s48, s48, 32768
  buffer_load_dwordx4 v2, s[16:19], s48 offen lds
  s_waitcnt vmcnt(13)
  s_add_u32 m0, s47, 77824
  s_add_u32 s48, s98, 14
  s_and_b32 s48, s48, 15
  s_mul_i32 s48, s48, 32768
  buffer_load_dwordx4 v2, s[16:19], s48 offen lds
  s_waitcnt vmcnt(13)
  s_add_u32 m0, s47, 81920
  s_add_u32 s48, s98, 15
  s_and_b32 s48, s48, 15
  s_mul_i32 s48, s48, 32768
  buffer_load_dwordx4 v2, s[16:19], s48 offen lds
  s_barrier
  s_waitcnt vmcnt(8)
  s_add_u32 m0, s47, 86016
  s_add_u32 s48, s98, 0
  s_and_b32 s48, s48, 15
  s_mul_i32 s48, s48, 32768
  buffer_load_dwordx4 v2, s[20:23], s48 offen lds
  s_waitcnt vmcnt(8)
  s_add_u32 m0, s47, 90112
  s_add_u32 s48, s98, 1
  s_and_b32 s48, s48, 15
  s_mul_i32 s48, s48, 32768
  buffer_load_dwordx4 v2, s[20:23], s48 offen lds
  s_waitcnt vmcnt(8)
  s_add_u32 m0, s47, 94208
  s_add_u32 s48, s98, 2
  s_and_b32 s48, s48, 15
  s_mul_i32 s48, s48, 32768
  buffer_load_dwordx4 v2, s[20:23], s48 offen lds
  s_waitcnt vmcnt(8)
  s_add_u32 m0, s47, 98304
  s_add_u32 s48, s98, 3
  s_and_b32 s48, s48, 15
  s_mul_i32 s48, s48, 32768
  buffer_load_dwordx4 v2, s[20:23], s48 offen lds
  s_waitcnt vmcnt(8)
  s_add_u32 m0, s47, 102400
  s_add_u32 s48, s98, 4
  s_and_b32 s48, s48, 15
  s_mul_i32 s48, s48, 32768
  buffer_load_dwordx4 v2, s[20:23], s48 offen lds
  s_waitcnt vmcnt(8)
  s_add_u32 m0, s47, 106496
  s_add_u32 s48, s98, 5
  s_and_b32 s48, s48, 15
  s_mul_i32 s48, s48, 32768
  buffer_load_dwordx4 v2, s[20:23], s48 offen lds
  s_waitcnt vmcnt(8)
  s_add_u32 m0, s47, 110592
  s_add_u32 s48, s98, 6
  s_and_b32 s48, s48, 15
  s_mul_i32 s48, s48, 32768
  buffer_load_dwordx4 v2, s[20:23], s48 offen lds
  s_waitcnt vmcnt(8)
  s_add_u32 m0, s47, 114688
  s_add_u32 s48, s98, 7
  s_and_b32 s48, s48, 15
  s_mul_i32 s48, s48, 32768
  buffer_load_dwordx4 v2, s[20:23], s48 offen lds
  s_sub_u32 s53, s46, 1
  s_max_i32 s53, s53, 0
  s_min_i32 s53, s53, 29
  s_lshl_b32 s53, s53, 3
  s_mov_b32 s54, 0x80808080
  s_mov_b64 exec, 0x3f
  buffer_load_dword v26, v28, s[40:43], s53 offen sc1
  s_mov_b64 exec, -1
  s_barrier
  s_add_u32 m0, s47, 118784
  s_add_u32 s48, s98, 8
  s_and_b32 s48, s48, 15
  s_mul_i32 s48, s48, 32768
  buffer_load_dwordx4 v2, s[20:23], s48 offen lds
  s_add_u32 m0, s47, 126976
  s_add_u32 s48, s98, 9
  s_and_b32 s48, s48, 15
  s_mul_i32 s48, s48, 32768
  buffer_load_dwordx4 v2, s[20:23], s48 offen lds
  s_add_u32 m0, s47, 131072
  s_add_u32 s48, s98, 10
  s_and_b32 s48, s48, 15
  s_mul_i32 s48, s48, 32768
  buffer_load_dwordx4 v2, s[20:23], s48 offen lds
  s_add_u32 m0, s47, 135168
  s_add_u32 s48, s98, 11
  s_and_b32 s48, s48, 15
  s_mul_i32 s48, s48, 32768
  buffer_load_dwordx4 v2, s[20:23], s48 offen lds
  s_waitcnt vmcnt(13)
  s_add_u32 m0, s47, 139264
  s_add_u32 s48, s98, 12
  s_and_b32 s48, s48, 15
  s_mul_i32 s48, s48, 32768
  buffer_load_dwordx4 v2, s[20:23], s48 offen lds
  s_waitcnt vmcnt(13)
  s_add_u32 m0, s47, 143360
  s_add_u32 s48, s98, 13
  s_and_b32 s48, s48, 15
  s_mul_i32 s48, s48, 32768
  buffer_load_dwordx4 v2, s[20:23], s48 offen lds
  s_barrier
  s_sub_u32 s53, s46, 1
  s_max_i32 s53, s53, 0
  s_min_i32 s53, s53, 29
  s_lshl_b32 s53, s53, 3
  s_mov_b32 s54, 0x80808080
  s_waitcnt vmcnt(6)
  v_mov_b32 v30, v26
  s_cmp_gt_u32 s44, 0
  s_cbranch_scc1 HSK_3
  s_mov_b64 exec, 0x3f
  v_and_b32 v31, s54, v26
  v_cmp_ne_u32 vcc, s54, v31
  s_cbranch_vccz HPK_6
  s_mov_b32 s58, s52
HPL_4:
  buffer_load_dword v26, v28, s[40:43], s53 offen sc1
  s_add_u32 s58, s58, 1
  s_cmp_gt_u32 s58, 400000
  s_waitcnt vmcnt(0)
  s_cbranch_scc1 HPD_5
  v_and_b32 v31, s54, v26
  v_cmp_ne_u32 vcc, s54, v31
  s_cbranch_vccnz HPL_4
  s_mov_b32 s58, 0
HPD_5:
  s_mov_b32 s52, s58
HPK_6:
  s_mov_b64 exec, -1
  s_mul_i32 s54, s71, 0x01010101
  v_cmp_eq_u32 vcc, s54, v26
  s_lshl_b32 s54, s46, 3
  s_sub_u32 s53, s54, s53
  s_lshr_b32 s53, s53, 2
  s_lshr_b32 s53, vcc_lo, s53
  s_and_b32 s53, s53, 3
  s_cmp_eq_u32 s53, 3
  s_cselect_b32 s51, 1, 0
HSK_3:
  s_cmp_lg_u32 s44, 0
  s_cbranch_scc1 HSK_7
  v_mov_b32 v29, 1
  v_mov_b32 v30, 0
  s_mov_b64 exec, 1
  s_cmp_eq_u32 s51, 0
  s_cbranch_scc1 HSL_8
  buffer_store_dword v29, v30, s[4:7], s57 offen
  s_branch HSD_9
HSL_8:
  buffer_wbl2 sc1
  s_waitcnt vmcnt(0)
  buffer_store_dword v29, v30, s[4:7], s57 offen sc1
HSD_9:
  s_mov_b64 exec, -1
HSK_7:
  s_mov_b64 exec, 0
  s_cmp_lg_u32 s44, 1
  s_cbranch_scc1 HPF_10
  s_call_b64 s[96:97], L_TRAMP
HPF_10:
  s_cmp_lg_u32 s44, 2
  s_cbranch_scc1 HPF_11
  s_call_b64 s[96:97], L_TRAMP
HPF_11:
  s_cmp_lg_u32 s44, 3
  s_cbranch_scc1 HPF_12
  s_call_b64 s[96:97], PAD_3
HPF_12:
  s_mov_b64 exec, -1
  s_cmp_lg_u32 s44, 0
  s_cbranch_scc1 HSK_13
  s_mov_b64 exec, 0xff
  s_mov_b32 s58, s52
HPL_14:
  buffer_load_dword v29, v28, s[4:7], s92 offen sc1
  s_add_u32 s58, s58, 1
  s_cmp_gt_u32 s58, 400000
  s_waitcnt vmcnt(0)
  s_cbranch_scc1 HPD_15
  v_cmp_gt_u32 vcc, 1, v29
  s_cbranch_vccnz HPL_14
  s_mov_b32 s58, 0
HPD_15:
  s_mov_b32 s52, s58
HPK_16:
  s_mov_b64 exec, -1
PAD_19:
  s_cbranch_execz L_TRAMP
  s_nop 0
  s_cmp_lg_u32 s51, 0
  s_cbranch_scc1 HFA_17
  buffer_inv sc1
  s_waitcnt vmcnt(0)
HFA_17:
HSK_13:
  s_barrier
  s_add_u32 m0, s47, 8192
  s_add_u32 s48, s98, 2
  s_and_b32 s48, s48, 15
  s_mul_i32 s48, s48, 4096
  s_add_u32 s48, s48, s49
  buffer_load_dwordx4 v6, s[4:7], s48 offen sc1 lds
  s_add_u32 m0, s47, 12288
  s_add_u32 s48, s98, 3
  s_and_b32 s48, s48, 15
  s_mul_i32 s48, s48, 4096
  s_add_u32 s48, s48, s49
  buffer_load_dwordx4 v6, s[4:7], s48 offen sc1 lds
  s_add_u32 m0, s47, 16384
  s_add_u32 s48, s98, 4
  s_and_b32 s48, s48, 15
  s_mul_i32 s48, s48, 4096
  s_add_u32 s48, s48, s49
  buffer_load_dwordx4 v6, s[4:7], s48 offen sc1 lds
  s_add_u32 m0, s47, 20480
  s_add_u32 s48, s98, 5
  s_and_b32 s48, s48, 15
  s_mul_i32 s48, s48, 4096
  s_add_u32 s48, s48, s49
  buffer_load_dwordx4 v6, s[4:7], s48 offen sc1 lds
  s_add_u32 m0, s47, 24576
  s_add_u32 s48, s98, 6
  s_and_b32 s48, s48, 15
  s_mul_i32 s48, s48, 4096
  s_add_u32 s48, s48, s49
  buffer_load_dwordx4 v6, s[4:7], s48 offen sc1 lds
  s_add_u32 m0, s47, 28672
  s_add_u32 s48, s98, 7
  s_and_b32 s48, s48, 15
  s_mul_i32 s48, s48, 4096
  s_add_u32 s48, s48, s49
  buffer_load_dwordx4 v6, s[4:7], s48 offen sc1 lds
  s_add_u32 m0, s47, 32768
  s_add_u32 s48, s98, 8
  s_and_b32 s48, s48, 15
  s_mul_i32 s48, s48, 4096
  s_add_u32 s48, s48, s49
  buffer_load_dwordx4 v6, s[4:7], s48 offen sc1 lds
  s_add_u32 m0, s47, 36864
  s_add_u32 s48, s98, 9
  s_and_b32 s48, s48, 15
  s_mul_i32 s48, s48, 4096
  s_add_u32 s48, s48, s49
  buffer_load_dwordx4 v6, s[4:7], s48 offen sc1 lds
  s_waitcnt vmcnt(8)
  s_barrier
  s_add_u32 m0, s47, 40960
  s_add_u32 s48, s98, 10
  s_and_b32 s48, s48, 15
  s_mul_i32 s48, s48, 4096
  s_add_u32 s48, s48, s49
  buffer_load_dwordx4 v6, s[4:7], s48 offen sc1 lds
  s_add_u32 m0, s47, 45056
  s_add_u32 s48, s98, 11
  s_and_b32 s48, s48, 15
  s_mul_i32 s48, s48, 4096
  s_add_u32 s48, s48, s49
  buffer_load_dwordx4 v6, s[4:7], s48 offen sc1 lds
  s_waitcnt vmcnt(8)
  s_barrier
  s_add_u32 m0, s47, 49152
  s_add_u32 s48, s98, 12
  s_and_b32 s48, s48, 15
  s_mul_i32 s48, s48, 4096
  s_add_u32 s48, s48, s49
  buffer_load_dwordx4 v6, s[4:7], s48 offen sc1 lds
  s_add_u32 m0, s47, 53248
  s_add_u32 s48, s98, 13
  s_and_b32 s48, s48, 15
  s_mul_i32 s48, s48, 4096
  s_add_u32 s48, s48, s49
  buffer_load_dwordx4 v6, s[4:7], s48 offen sc1 lds
  s_waitcnt vmcnt(8)
  s_barrier
  s_add_u32 m0, s47, 57344
  s_add_u32 s48, s98, 14
  s_and_b32 s48, s48, 15
  s_mul_i32 s48, s48, 4096
  s_add_u32 s48, s48, s49
  buffer_load_dwordx4 v6, s[4:7], s48 offen sc1 lds
  s_add_u32 m0, s47, 61440
  s_add_u32 s48, s98, 15
  s_and_b32 s48, s48, 15
  s_mul_i32 s48, s48, 4096
  s_add_u32 s48, s48, s49
  buffer_load_dwordx4 v6, s[4:7], s48 offen sc1 lds
  s_waitcnt vmcnt(8)
  s_barrier
  s_add_u32 m0, s47, 65536
  s_add_u32 s48, s98, 14
  s_and_b32 s48, s48, 15
  s_mul_i32 s48, s48, 32768
  buffer_load_dwordx4 v2, s[20:23], s48 offen lds
  s_add_u32 m0, s47, 69632
  s_add_u32 s48, s98, 15
  s_and_b32 s48, s48, 15
  s_mul_i32 s48, s48, 32768
  buffer_load_dwordx4 v2, s[20:23], s48 offen lds
  s_add_u32 m0, s47, 73728
  s_mov_b32 s48, 0
  buffer_load_dwordx4 v2, s[24:27], s48 offen lds
  s_waitcnt vmcnt(9)
  s_barrier
  s_add_u32 m0, s47, 77824
  s_mov_b32 s48, 32768
  buffer_load_dwordx4 v2, s[24:27], s48 offen lds
  s_add_u32 m0, s47, 81920
  s_mov_b32 s48, 65536
  buffer_load_dwordx4 v2, s[24:27], s48 offen lds
  s_waitcnt vmcnt(9)
  s_barrier
  s_add_u32 m0, s47, 122880
  s_mov_b32 s48, 98304
  buffer_load_dwordx4 v2, s[24:27], s48 offen lds
  s_add_u32 m0, s47, 147456
  s_mov_b32 s48, 131072
  buffer_load_dwordx4 v2, s[24:27], s48 offen lds
  s_waitcnt vmcnt(9)
  s_barrier
  s_waitcnt vmcnt(8)
  s_add_u32 m0, s47, 151552
  s_mov_b32 s48, 163840
  buffer_load_dwordx4 v2, s[24:27], s48 offen lds
  s_waitcnt vmcnt(8)
  s_add_u32 m0, s47, 155648
  s_mov_b32 s48, 196608
  buffer_load_dwordx4 v2, s[24:27], s48 offen lds
  s_barrier
  s_waitcnt vmcnt(7)
  s_barrier
  s_waitcnt vmcnt(1)
  s_barrier
  s_cmp_lg_u32 s44, 0
  s_cbranch_scc1 HSK_18
  v_mov_b32 v29, 2
  v_mov_b32 v30, 0
  s_mov_b64 exec, 1
  s_cmp_eq_u32 s51, 0
  s_cbranch_scc1 HSL_19
  buffer_store_dword v29, v30, s[4:7], s57 offen
  s_branch HSD_20
HSL_19:
  buffer_wbl2 sc1
  s_waitcnt vmcnt(0)
  buffer_store_dword v29, v30, s[4:7], s57 offen sc1
HSD_20:
  s_mov_b64 exec, -1
HSK_18:
  s_mov_b64 exec, 0
  s_cmp_lg_u32 s44, 1
  s_cbranch_scc1 HPF_21
  s_call_b64 s[96:97], L_TRAMP
HPF_21:
  s_cmp_lg_u32 s44, 2
  s_cbranch_scc1 HPF_22
  s_call_b64 s[96:97], PAD_4
HPF_22:
  s_cmp_lg_u32 s44, 3
  s_cbranch_scc1 HPF_23
  s_call_b64 s[96:97], PAD_5
HPF_23:
  s_mov_b64 exec, -1
  s_cmp_lg_u32 s44, 0
  s_cbranch_scc1 HSK_24
  s_mov_b64 exec, 0xff
  s_mov_b32 s58, s52
HPL_25:
  buffer_load_dword v29, v28, s[4:7], s92 offen sc1
  s_add_u32 s58, s58, 1
  s_cmp_gt_u32 s58, 400000
  s_waitcnt vmcnt(0)
  s_cbranch_scc1 HPD_26
  v_cmp_gt_u32 vcc, 2, v29
  s_cbranch_vccnz HPL_25
  s_mov_b32 s58, 0
HPD_26:
  s_mov_b32 s52, s58
HPK_27:
  s_mov_b64 exec, -1
  s_cmp_lg_u32 s51, 0
  s_cbranch_scc1 HFA_28
  buffer_inv sc1
  s_waitcnt vmcnt(0)
HFA_28:
HSK_24:
  s_waitcnt vmcnt(0)
  s_barrier
  s_add_u32 m0, s47, 8192
  s_add_u32 s48, s98, 2
  s_and_b32 s48, s48, 15
  s_mul_i32 s48, s48, 4096
  s_add_u32 s48, s48, s50
  buffer_load_dwordx4 v6, s[4:7], s48 offen sc1 lds
  s_add_u32 m0, s47, 12288
  s_add_u32 s48, s98, 3
  s_and_b32 s48, s48, 15
  s_mul_i32 s48, s48, 4096
  s_add_u32 s48, s48, s50
  buffer_load_dwordx4 v6, s[4:7], s48 offen sc1 lds
  s_barrier
  s_add_u32 m0, s47, 65536
  s_add_u32 s48, s80, 0
  buffer_load_dwordx4 v6, s[4:7], s48 offen sc1 lds
  s_add_u32 m0, s47, 69632
  s_add_u32 s48, s80, 4096
  buffer_load_dwordx4 v6, s[4:7], s48 offen sc1 lds
  s_add_u32 m0, s47, 16384
  s_add_u32 s48, s98, 4
  s_and_b32 s48, s48, 15
  s_mul_i32 s48, s48, 4096
  s_add_u32 s48, s48, s50
  buffer_load_dwordx4 v6, s[4:7], s48 offen sc1 lds
  s_add_u32 m0, s47, 20480
  s_add_u32 s48, s98, 5
  s_and_b32 s48, s48, 15
  s_mul_i32 s48, s48, 4096
  s_add_u32 s48, s48, s50
  buffer_load_dwordx4 v6, s[4:7], s48 offen sc1 lds
  s_add_u32 m0, s47, 24576
  s_add_u32 s48, s98, 6
  s_and_b32 s48, s48, 15
  s_mul_i32 s48, s48, 4096
  s_add_u32 s48, s48, s50
  buffer_load_dwordx4 v6, s[4:7], s48 offen sc1 lds
  s_add_u32 m0, s47, 28672
  s_add_u32 s48, s98, 7
  s_and_b32 s48, s48, 15
  s_mul_i32 s48, s48, 4096
  s_add_u32 s48, s48, s50
  buffer_load_dwordx4 v6, s[4:7], s48 offen sc1 lds
  s_add_u32 m0, s47, 32768
  s_add_u32 s48, s98, 8
  s_and_b32 s48, s48, 15
  s_mul_i32 s48, s48, 4096
  s_add_u32 s48, s48, s50
  buffer_load_dwordx4 v6, s[4:7], s48 offen sc1 lds
  s_waitcnt vmcnt(7)
  s_barrier
  s_add_u32 m0, s47, 36864
  s_add_u32 s48, s98, 9
  s_and_b32 s48, s48, 15
  s_mul_i32 s48, s48, 4096
  s_add_u32 s48, s48, s50
  buffer_load_dwordx4 v6, s[4:7], s48 offen sc1 lds
  s_add_u32 m0, s47, 40960
  s_add_u32 s48, s98, 10
  s_and_b32 s48, s48, 15
  s_mul_i32 s48, s48, 4096
  s_add_u32 s48, s48, s50
  buffer_load_dwordx4 v6, s[4:7], s48 offen sc1 lds
  s_add_u32 m0, s47, 45056
  s_add_u32 s48, s98, 11
  s_and_b32 s48, s48, 15
  s_mul_i32 s48, s48, 4096
  s_add_u32 s48, s48, s50
  buffer_load_dwordx4 v6, s[4:7], s48 offen sc1 lds
  s_add_u32 m0, s47, 49152
  s_add_u32 s48, s98, 12
  s_and_b32 s48, s48, 15
  s_mul_i32 s48, s48, 4096
  s_add_u32 s48, s48, s50
  buffer_load_dwordx4 v6, s[4:7], s48 offen sc1 lds
  s_waitcnt vmcnt(7)
  s_barrier
  s_add_u32 m0, s47, 53248
  s_add_u32 s48, s98, 13
  s_and_b32 s48, s48, 15
  s_mul_i32 s48, s48, 4096
  s_add_u32 s48, s48, s50
  buffer_load_dwordx4 v6, s[4:7], s48 offen sc1 lds
  s_add_u32 m0, s47, 57344
  s_add_u32 s48, s98, 14
  s_and_b32 s48, s48, 15
  s_mul_i32 s48, s48, 4096
  s_add_u32 s48, s48, s50
  buffer_load_dwordx4 v6, s[4:7], s48 offen sc1 lds
  s_add_u32 m0, s47, 61440
  s_add_u32 s48, s98, 15
  s_and_b32 s48, s48, 15
  s_mul_i32 s48, s48, 4096
  s_add_u32 s48, s48, s50
  buffer_load_dwordx4 v6, s[4:7], s48 offen sc1 lds
  s_waitcnt vmcnt(8)
  s_barrier
  s_lshl_b32 s53, s2, 2
  s_add_u32 s53, s53, 8192
  s_cmp_eq_u32 s44, 2
  s_cselect_b32 s53, s53, 2130706432
  v_mov_b32 v29, 1
  v_mov_b32 v30, 0
  s_mov_b64 exec, 1
  buffer_store_dword v29, v30, s[4:7], s53 offen sc1
  s_mov_b64 exec, -1
  s_add_u32 m0, s47, 69632
  s_mov_b32 s48, 229376
  buffer_load_dwordx4 v2, s[24:27], s48 offen lds
  s_add_u32 m0, s47, 86016
  s_mov_b32 s48, 262144
  buffer_load_dwordx4 v2, s[24:27], s48 offen lds
  s_waitcnt vmcnt(9)
  s_barrier
  s_add_u32 m0, s47, 90112
  s_mov_b32 s48, 294912
  buffer_load_dwordx4 v2, s[24:27], s48 offen lds
  s_add_u32 m0, s47, 94208
  s_mov_b32 s48, 327680
  buffer_load_dwordx4 v2, s[24:27], s48 offen lds
  s_add_u32 m0, s47, 98304
  s_mov_b32 s48, 360448
  buffer_load_dwordx4 v2, s[24:27], s48 offen lds
  s_waitcnt vmcnt(10)
  s_barrier
  s_add_u32 m0, s47, 102400
  s_mov_b32 s48, 393216
  buffer_load_dwordx4 v2, s[24:27], s48 offen lds
  s_add_u32 m0, s47, 106496
  s_mov_b32 s48, 425984
  buffer_load_dwordx4 v2, s[24:27], s48 offen lds
  s_waitcnt vmcnt(10)
  s_barrier
  s_waitcnt vmcnt(8)
  s_add_u32 m0, s47, 110592
  s_mov_b32 s48, 458752
  buffer_load_dwordx4 v2, s[24:27], s48 offen lds
  s_waitcnt vmcnt(8)
  s_add_u32 m0, s47, 114688
  s_mov_b32 s48, 491520
  buffer_load_dwordx4 v2, s[24:27], s48 offen lds
  s_barrier
  s_waitcnt vmcnt(8)
  s_add_u32 m0, s47, 118784
  s_add_u32 s48, s98, 0
  s_and_b32 s48, s48, 15
  s_mul_i32 s48, s48, 114688
  s_add_u32 s48, s48, s55
  buffer_load_dwordx4 v4, s[28:31], s48 offen lds
  s_waitcnt vmcnt(8)
  s_add_u32 m0, s47, 126976
  s_add_u32 s48, s98, 1
  s_and_b32 s48, s48, 15
  s_mul_i32 s48, s48, 114688
  s_add_u32 s48, s48, s55
  buffer_load_dwordx4 v4, s[28:31], s48 offen lds
  s_waitcnt vmcnt(8)
  s_add_u32 m0, s47, 131072
  s_add_u32 s48, s98, 2
  s_and_b32 s48, s48, 15
  s_mul_i32 s48, s48, 114688
  s_add_u32 s48, s48, s55
  buffer_load_dwordx4 v4, s[28:31], s48 offen lds
  s_waitcnt vmcnt(8)
  s_add_u32 m0, s47, 135168
  s_add_u32 s48, s98, 3
  s_and_b32 s48, s48, 15
  s_mul_i32 s48, s48, 114688
  s_add_u32 s48, s48, s55
  buffer_load_dwordx4 v4, s[28:31], s48 offen lds
  s_waitcnt vmcnt(4)
  s_barrier
  s_barrier
  s_cmp_lg_u32 s44, 0
  s_cbranch_scc1 HSK_29
  v_mov_b32 v29, 3
  v_mov_b32 v30, 0
  s_mov_b64 exec, 1
  s_cmp_eq_u32 s51, 0
  s_cbranch_scc1 HSL_30
  buffer_store_dword v29, v30, s[4:7], s57 offen
  s_branch HSD_31
HSL_30:
  buffer_wbl2 sc1
  s_waitcnt vmcnt(0)
  buffer_store_dword v29, v30, s[4:7], s57 offen sc1
HSD_31:
  s_mov_b64 exec, -1
HSK_29:
  s_mov_b64 exec, 0
  s_cmp_lg_u32 s44, 1
  s_cbranch_scc1 HPF_32
  s_call_b64 s[96:97], PAD_20
HPF_32:
  s_cmp_lg_u32 s44, 2
  s_cbranch_scc1 HPF_33
  s_call_b64 s[96:97], PAD_6
HPF_33:
  s_cmp_lg_u32 s44, 3
  s_cbranch_scc1 HPF_34
  s_call_b64 s[96:97], PAD_7
HPF_34:
  s_mov_b64 exec, -1
  s_add_u32 s53, s61, 1
  s_lshl_b32 s53, s53, 4
  v_and_b32 v29, 15, v1
  v_lshrrev_b32_e64 v30, 4, v1
  v_cmp_gt_u32 s[62:63], s53, v1
  v_lshlrev_b32 v31, 4, v1
  s_lshl_b32 s54, s46, 11
  s_lshl_b32 s69, s44, 9
  s_add_u32 s54, s54, s69
  s_add_u32 s54, s54, 65536
  s_mul_i32 s69, s64, 31
  s_cmp_eq_u32 s46, s69
  s_cselect_b32 s54, 2130706432, s54
  v_add_u32_e64 v31, s54, v31
  v_mov_b32 v44, 2130706432
  v_cndmask_b32 v44, v44, v31, s[62:63]
  v_lshl_add_u32 v29, s44, 4, v29
  v_mul_u32_u24 v29, 1088, v29
  s_sub_u32 s54, 1, s61
  s_cmp_eq_u32 s64, 0
  s_cselect_b32 s54, s54, 66
  v_add_u32_e64 v30, s54, v30
  v_lshl_add_u32 v45, v30, 4, v29
  s_cmp_lg_u32 s44, 0
  s_cbranch_scc1 HSK_35
  s_mov_b64 exec, 0xff
  s_mov_b32 s58, s52
HPL_36:
  buffer_load_dword v29, v28, s[4:7], s92 offen sc1
  s_add_u32 s58, s58, 1
  s_cmp_gt_u32 s58, 400000
  s_waitcnt vmcnt(0)
  s_cbranch_scc1 HPD_37
  v_cmp_gt_u32 vcc, 3, v29
  s_cbranch_vccnz HPL_36
  s_mov_b32 s58, 0
HPD_37:
  s_mov_b32 s52, s58
HPK_38:
  s_mov_b64 exec, -1
  s_cmp_lg_u32 s51, 0
  s_cbranch_scc1 HFA_39
  buffer_inv sc1
  s_waitcnt vmcnt(0)
HFA_39:
HSK_35:
  s_waitcnt vmcnt(0)
  s_barrier
  s_add_u32 m0, s73, 32
  s_add_u32 s48, s49, 0
  buffer_load_dwordx4 v6, s[4:7], s48 offen sc1 lds
  s_add_u32 m0, s73, 17440
  s_add_u32 s48, s49, 16384
  buffer_load_dwordx4 v6, s[4:7], s48 offen sc1 lds
  s_add_u32 m0, s73, 4384
  s_add_u32 s48, s49, 4096
  buffer_load_dwordx4 v6, s[4:7], s48 offen sc1 lds
  s_add_u32 m0, s73, 21792
  s_add_u32 s48, s49, 20480
  buffer_load_dwordx4 v6, s[4:7], s48 offen sc1 lds
  s_add_u32 m0, s73, 8736
  s_add_u32 s48, s49, 8192
  buffer_load_dwordx4 v6, s[4:7], s48 offen sc1 lds
  s_add_u32 m0, s73, 26144
  s_add_u32 s48, s49, 24576
  buffer_load_dwordx4 v6, s[4:7], s48 offen sc1 lds
  s_add_u32 m0, s73, 13088
  s_add_u32 s48, s49, 12288
  buffer_load_dwordx4 v6, s[4:7], s48 offen sc1 lds
  s_add_u32 m0, s73, 30496
  s_add_u32 s48, s49, 28672
  buffer_load_dwordx4 v6, s[4:7], s48 offen sc1 lds
  s_mov_b32 s70, 0
  s_nop 0
  buffer_load_dwordx4 v[40:43], v44, s[4:7], s70 offen sc1
  s_add_u32 m0, s73, 34848
  s_add_u32 s48, s49, 32768
  buffer_load_dwordx4 v6, s[4:7], s48 offen sc1 lds
  s_add_u32 m0, s73, 52256
  s_add_u32 s48, s49, 49152
  buffer_load_dwordx4 v6, s[4:7], s48 offen sc1 lds
  s_waitcnt vmcnt(7)
  s_barrier
  s_add_u32 m0, s73, 39200
  s_add_u32 s48, s49, 36864
  buffer_load_dwordx4 v6, s[4:7], s48 offen sc1 lds
  s_add_u32 m0, s73, 56608
  s_add_u32 s48, s49, 53248
  buffer_load_dwordx4 v6, s[4:7], s48 offen sc1 lds
  s_add_u32 m0, s73, 43552
  s_add_u32 s48, s49, 40960
  buffer_load_dwordx4 v6, s[4:7], s48 offen sc1 lds
  s_add_u32 m0, s73, 60960
  s_add_u32 s48, s49, 57344
  buffer_load_dwordx4 v6, s[4:7], s48 offen sc1 lds
  s_add_u32 m0, s73, 47904
  s_add_u32 s48, s49, 45056
  buffer_load_dwordx4 v6, s[4:7], s48 offen sc1 lds
  s_waitcnt vmcnt(8)
  s_barrier
  s_add_u32 m0, s73, 65312
  s_add_u32 s48, s49, 61440
  buffer_load_dwordx4 v6, s[4:7], s48 offen sc1 lds
  s_add_u32 m0, s47, 69632
  s_add_u32 s48, s98, 4
  s_and_b32 s48, s48, 15
  s_mul_i32 s48, s48, 114688
  s_add_u32 s48, s48, s55
  buffer_load_dwordx4 v4, s[28:31], s48 offen lds
  s_add_u32 m0, s47, 73728
  s_add_u32 s48, s98, 5
  s_and_b32 s48, s48, 15
  s_mul_i32 s48, s48, 114688
  s_add_u32 s48, s48, s55
  buffer_load_dwordx4 v4, s[28:31], s48 offen lds
  s_add_u32 m0, s47, 77824
  s_add_u32 s48, s98, 6
  s_and_b32 s48, s48, 15
  s_mul_i32 s48, s48, 114688
  s_add_u32 s48, s48, s55
  buffer_load_dwordx4 v4, s[28:31], s48 offen lds
  s_add_u32 m0, s47, 81920
  s_add_u32 s48, s98, 7
  s_and_b32 s48, s48, 15
  s_mul_i32 s48, s48, 114688
  s_add_u32 s48, s48, s55
  buffer_load_dwordx4 v4, s[28:31], s48 offen lds
  s_add_u32 m0, s47, 86016
  s_add_u32 s48, s98, 8
  s_and_b32 s48, s48, 15
  s_mul_i32 s48, s48, 114688
  s_add_u32 s48, s48, s55
  buffer_load_dwordx4 v4, s[28:31], s48 offen lds
  s_waitcnt vmcnt(9)
  s_barrier
  s_add_u32 m0, s47, 90112
  s_add_u32 s48, s98, 9
  s_and_b32 s48, s48, 15
  s_mul_i32 s48, s48, 114688
  s_add_u32 s48, s48, s55
  buffer_load_dwordx4 v4, s[28:31], s48 offen lds
  s_add_u32 m0, s47, 94208
  s_add_u32 s48, s98, 10
  s_and_b32 s48, s48, 15
  s_mul_i32 s48, s48, 114688
  s_add_u32 s48, s48, s55
  buffer_load_dwordx4 v4, s[28:31], s48 offen lds
  s_add_u32 m0, s47, 98304
  s_add_u32 s48, s98, 11
  s_and_b32 s48, s48, 15
  s_mul_i32 s48, s48, 114688
  s_add_u32 s48, s48, s55
  buffer_load_dwordx4 v4, s[28:31], s48 offen lds
  s_mov_b32 s53, 0
  s_mov_b32 s54, 0x80808080
  s_mov_b32 exec_hi, -1
  buffer_load_dword v26, v28, s[40:43], s53 offen sc1
  s_mov_b64 exec, -1
  s_waitcnt vmcnt(9)
  s_barrier
  v_max_u32 v29, v40, v41
  v_max3_u32 v29, v29, v42, v43
  v_cmp_eq_u32 vcc, -1, v29
  s_cbranch_vccz HPK_42
  s_mov_b32 s58, s52
HPL_40:
  buffer_load_dwordx4 v[40:43], v44, s[4:7], s70 offen sc1
  s_add_u32 s58, s58, 1
  s_cmp_gt_u32 s58, 400000
  s_waitcnt vmcnt(0)
  s_cbranch_scc1 HPD_41
  v_max_u32_e64 v29, v40, v41
  v_max3_u32 v29, v29, v42, v43
  v_cmp_eq_u32 vcc, -1, v29
  s_cbranch_vccnz HPL_40
  s_mov_b32 s58, 0
HPD_41:
  s_mov_b32 s52, s58
HPK_42:
  s_cmp_eq_u32 s61, 1
  s_cselect_b32 exec_lo, -1, 0xffff
  s_mov_b32 exec_hi, 0
  ds_write_b128 v45, v[40:43]
  s_mov_b64 exec, -1
  s_waitcnt lgkmcnt(0)
  s_barrier
  s_mul_i32 s90, s2, 7168
  s_lshl_b32 s91, s45, 7
  s_sub_u32 s90, s90, s91
  s_mul_i32 s91, s44, 1792
  s_add_u32 s90, s90, s91
  v_lshlrev_b32_e64 v0, 7, v1
  s_mov_b64 exec, 0x3fff
  buffer_load_dword v21, v0, s[32:35], s90 offen
  s_mov_b64 exec, -1
  s_add_u32 m0, s47, 102400
  s_add_u32 s48, s98, 12
  s_and_b32 s48, s48, 15
  s_mul_i32 s48, s48, 114688
  s_add_u32 s48, s48, s55
  buffer_load_dwordx4 v4, s[28:31], s48 offen lds
  s_add_u32 m0, s47, 106496
  s_add_u32 s48, s98, 13
  s_and_b32 s48, s48, 15
  s_mul_i32 s48, s48, 114688
  s_add_u32 s48, s48, s55
  buffer_load_dwordx4 v4, s[28:31], s48 offen lds
  s_add_u32 m0, s47, 110592
  s_add_u32 s48, s98, 14
  s_and_b32 s48, s48, 15
  s_mul_i32 s48, s48, 114688
  s_add_u32 s48, s48, s55
  buffer_load_dwordx4 v4, s[28:31], s48 offen lds
  s_add_u32 m0, s47, 114688
  s_add_u32 s48, s98, 15
  s_and_b32 s48, s48, 15
  s_mul_i32 s48, s48, 114688
  s_add_u32 s48, s48, s55
  buffer_load_dwordx4 v4, s[28:31], s48 offen lds
  s_waitcnt vmcnt(13)
  s_add_u32 m0, s47, 122880
  s_add_u32 s48, s98, 0
  s_and_b32 s48, s48, 15
  s_mul_i32 s48, s48, 114688
  s_add_u32 s48, s48, 128
  s_add_u32 s48, s48, s55
  buffer_load_dwordx4 v4, s[28:31], s48 offen lds
  s_barrier
  s_mov_b32 s53, 0
  s_mov_b32 s54, 0x80808080
  s_waitcnt vmcnt(6)
  v_mov_b32 v30, v26
  s_cmp_gt_u32 s44, 0
  s_cbranch_scc1 HSK_43
  s_mov_b32 exec_hi, -1
  v_and_b32 v31, s54, v26
  v_cmp_ne_u32 vcc, s54, v31
  s_cbranch_vccz HPK_46
  s_mov_b32 s58, s52
HPL_44:
  buffer_load_dword v26, v28, s[40:43], s53 offen sc1
  s_add_u32 s58, s58, 1
  s_cmp_gt_u32 s58, 400000
  s_waitcnt vmcnt(0)
  s_cbranch_scc1 HPD_45
  v_and_b32 v31, s54, v26
  v_cmp_ne_u32 vcc, s54, v31
  s_cbranch_vccnz HPL_44
  s_mov_b32 s58, 0
HPD_45:
  s_mov_b32 s52, s58
HPK_46:
  s_mov_b64 exec, -1
HSK_43:
  s_mul_i32 s53, s45, 7
  s_lshr_b32 s53, s53, 1
  s_lshl_b32 s53, s53, 5
  s_add_u32 s53, s53, 8192
  s_mov_b32 exec_hi, 0
  buffer_load_dword v26, v28, s[4:7], s53 offen sc1
  s_mov_b64 exec, -1
  s_barrier
  s_add_u32 m0, s47, 139264
  s_add_u32 s48, s98, 1
  s_and_b32 s48, s48, 15
  s_mul_i32 s48, s48, 114688
  s_add_u32 s48, s48, 128
  s_add_u32 s48, s48, s55
  buffer_load_dwordx4 v4, s[28:31], s48 offen lds
  s_add_u32 m0, s47, 143360
  s_add_u32 s48, s98, 2
  s_and_b32 s48, s48, 15
  s_mul_i32 s48, s48, 114688
  s_add_u32 s48, s48, 128
  s_add_u32 s48, s48, s55
  buffer_load_dwordx4 v4, s[28:31], s48 offen lds
  s_add_u32 m0, s47, 147456
  s_add_u32 s48, s98, 3
  s_and_b32 s48, s48, 15
  s_mul_i32 s48, s48, 114688
  s_add_u32 s48, s48, 128
  s_add_u32 s48, s48, s55
  buffer_load_dwordx4 v4, s[28:31], s48 offen lds
  s_barrier
  s_cmp_lg_u32 s44, 0
  s_cbranch_scc1 HSK_47
  v_mov_b32 v29, 4
  v_mov_b32 v30, 0
  s_mov_b64 exec, 1
  s_cmp_eq_u32 s51, 0
  s_cbranch_scc1 HSL_48
  buffer_store_dword v29, v30, s[4:7], s57 offen
  s_branch HSD_49
HSL_48:
  buffer_wbl2 sc1
  s_waitcnt vmcnt(0)
  buffer_store_dword v29, v30, s[4:7], s57 offen sc1
HSD_49:
  s_mov_b64 exec, -1
HSK_47:
  s_mov_b64 exec, 0
  s_cmp_lg_u32 s44, 1
  s_cbranch_scc1 HPF_50
  s_call_b64 s[96:97], PAD_8
HPF_50:
  s_cmp_lg_u32 s44, 2
  s_cbranch_scc1 HPF_51
  s_call_b64 s[96:97], PAD_21
HPF_51:
  s_cmp_lg_u32 s44, 3
  s_cbranch_scc1 HPF_52
  s_call_b64 s[96:97], PAD_9
HPF_52:
  s_mov_b64 exec, -1
  s_mul_i32 s53, s45, 7
  s_lshr_b32 s53, s53, 1
  s_lshl_b32 s53, s53, 5
  s_add_u32 s53, s53, 8192
  s_waitcnt vmcnt(3)
  v_mov_b32 v30, v26
  s_cmp_gt_u32 s44, 0
  s_cbranch_scc1 HSK_53
  s_mov_b32 exec_hi, 0
  v_cmp_ne_u32 vcc, 1, v26
  s_cbranch_vccz HPK_56
  s_mov_b32 s58, s52
HPL_54:
  buffer_load_dword v26, v28, s[4:7], s53 offen sc1
  s_add_u32 s58, s58, 1
  s_cmp_gt_u32 s58, 400000
  s_waitcnt vmcnt(0)
  s_cbranch_scc1 HPD_55
  v_cmp_ne_u32 vcc, 1, v26
  s_cbranch_vccnz HPL_54
  s_mov_b32 s58, 0
HPD_55:
  s_mov_b32 s52, s58
HPK_56:
  s_mov_b64 exec, -1
HSK_53:
  s_cmp_lg_u32 s44, 0
  s_cbranch_scc1 HSK_57
  s_mov_b64 exec, 0xff
  s_mov_b32 s58, s52
HPL_58:
  buffer_load_dword v29, v28, s[4:7], s92 offen sc1
  s_add_u32 s58, s58, 1
  s_cmp_gt_u32 s58, 400000
  s_waitcnt vmcnt(0)
  s_cbranch_scc1 HPD_59
  v_cmp_gt_u32 vcc, 4, v29
  s_cbranch_vccnz HPL_58
  s_mov_b32 s58, 0
HPD_59:
  s_mov_b32 s52, s58
HPK_60:
  s_mov_b64 exec, -1
PAD_20:
  s_cbranch_execz L_TRAMP
  s_nop 0
  s_cmp_lg_u32 s51, 0
  s_cbranch_scc1 HFA_61
  buffer_inv sc1
  s_waitcnt vmcnt(0)
HFA_61:
HSK_57:
  s_barrier
  s_add_u32 m0, s47, 8192
  s_add_u32 s48, s98, 2
  s_and_b32 s48, s48, 15
  s_mul_i32 s48, s48, 4096
  s_add_u32 s48, s48, s50
  buffer_load_dwordx4 v6, s[4:7], s48 offen sc1 lds
  s_add_u32 m0, s47, 12288
  s_add_u32 s48, s98, 3
  s_and_b32 s48, s48, 15
  s_mul_i32 s48, s48, 4096
  s_add_u32 s48, s48, s50
  buffer_load_dwordx4 v6, s[4:7], s48 offen sc1 lds
  s_add_u32 m0, s47, 65536
  s_add_u32 s48, s80, 0
  buffer_load_dwordx4 v6, s[4:7], s48 offen sc1 lds
  s_add_u32 m0, s47, 151552
  s_add_u32 s48, s80, 4096
  buffer_load_dwordx4 v6, s[4:7], s48 offen sc1 lds
  s_barrier
  s_add_u32 m0, s47, 16384
  s_add_u32 s48, s98, 4
  s_and_b32 s48, s48, 15
  s_mul_i32 s48, s48, 4096
  s_add_u32 s48, s48, s50
  buffer_load_dwordx4 v6, s[4:7], s48 offen sc1 lds
  s_add_u32 m0, s47, 20480
  s_add_u32 s48, s98, 5
  s_and_b32 s48, s48, 15
  s_mul_i32 s48, s48, 4096
  s_add_u32 s48, s48, s50
  buffer_load_dwordx4 v6, s[4:7], s48 offen sc1 lds
  s_add_u32 m0, s47, 24576
  s_add_u32 s48, s98, 6
  s_and_b32 s48, s48, 15
  s_mul_i32 s48, s48, 4096
  s_add_u32 s48, s48, s50
  buffer_load_dwordx4 v6, s[4:7], s48 offen sc1 lds
  s_add_u32 m0, s47, 28672
  s_add_u32 s48, s98, 7
  s_and_b32 s48, s48, 15
  s_mul_i32 s48, s48, 4096
  s_add_u32 s48, s48, s50
  buffer_load_dwordx4 v6, s[4:7], s48 offen sc1 lds
  s_add_u32 m0, s47, 32768
  s_add_u32 s48, s98, 8
  s_and_b32 s48, s48, 15
  s_mul_i32 s48, s48, 4096
  s_add_u32 s48, s48, s50
  buffer_load_dwordx4 v6, s[4:7], s48 offen sc1 lds
  s_waitcnt vmcnt(7)
  s_barrier
  s_add_u32 m0, s47, 36864
  s_add_u32 s48, s98, 9
  s_and_b32 s48, s48, 15
  s_mul_i32 s48, s48, 4096
  s_add_u32 s48, s48, s50
  buffer_load_dwordx4 v6, s[4:7], s48 offen sc1 lds
  s_add_u32 m0, s47, 40960
  s_add_u32 s48, s98, 10
  s_and_b32 s48, s48, 15
  s_mul_i32 s48, s48, 4096
  s_add_u32 s48, s48, s50
  buffer_load_dwordx4 v6, s[4:7], s48 offen sc1 lds
  s_add_u32 m0, s47, 45056
  s_add_u32 s48, s98, 11
  s_and_b32 s48, s48, 15
  s_mul_i32 s48, s48, 4096
  s_add_u32 s48, s48, s50
  buffer_load_dwordx4 v6, s[4:7], s48 offen sc1 lds
  s_add_u32 m0, s47, 49152
  s_add_u32 s48, s98, 12
  s_and_b32 s48, s48, 15
  s_mul_i32 s48, s48, 4096
  s_add_u32 s48, s48, s50
  buffer_load_dwordx4 v6, s[4:7], s48 offen sc1 lds
  s_waitcnt vmcnt(7)
  s_barrier
  s_add_u32 m0, s47, 53248
  s_add_u32 s48, s98, 13
  s_and_b32 s48, s48, 15
  s_mul_i32 s48, s48, 4096
  s_add_u32 s48, s48, s50
  buffer_load_dwordx4 v6, s[4:7], s48 offen sc1 lds
  s_add_u32 m0, s47, 57344
  s_add_u32 s48, s98, 14
  s_and_b32 s48, s48, 15
  s_mul_i32 s48, s48, 4096
  s_add_u32 s48, s48, s50
  buffer_load_dwordx4 v6, s[4:7], s48 offen sc1 lds
  s_add_u32 m0, s47, 61440
  s_add_u32 s48, s98, 15
  s_and_b32 s48, s48, 15
  s_mul_i32 s48, s48, 4096
  s_add_u32 s48, s48, s50
  buffer_load_dwordx4 v6, s[4:7], s48 offen sc1 lds
  s_waitcnt vmcnt(8)
  s_barrier
  s_add_u32 m0, s47, 69632
  s_add_u32 s48, s98, 4
  s_and_b32 s48, s48, 15
  s_mul_i32 s48, s48, 114688
  s_add_u32 s48, s48, 128
  s_add_u32 s48, s48, s55
  buffer_load_dwordx4 v4, s[28:31], s48 offen lds
  s_add_u32 m0, s47, 118784
  s_add_u32 s48, s98, 5
  s_and_b32 s48, s48, 15
  s_mul_i32 s48, s48, 114688
  s_add_u32 s48, s48, 128
  s_add_u32 s48, s48, s55
  buffer_load_dwordx4 v4, s[28:31], s48 offen lds
  s_add_u32 m0, s47, 126976
  s_add_u32 s48, s98, 6
  s_and_b32 s48, s48, 15
  s_mul_i32 s48, s48, 114688
  s_add_u32 s48, s48, 128
  s_add_u32 s48, s48, s55
  buffer_load_dwordx4 v4, s[28:31], s48 offen lds
  s_add_u32 m0, s47, 131072
  s_add_u32 s48, s98, 7
  s_and_b32 s48, s48, 15
  s_mul_i32 s48, s48, 114688
  s_add_u32 s48, s48, 128
  s_add_u32 s48, s48, s55
  buffer_load_dwordx4 v4, s[28:31], s48 offen lds
  s_waitcnt vmcnt(10)
  s_barrier
  v_lshlrev_b32_e64 v0, 4, v1
  s_mul_i32 s91, s45, 896
  s_cmp_eq_u32 s44, 1
  s_nop 0
  s_cselect_b32 s91, s91, 2130706432
  s_add_u32 s90, s91, 196608
  buffer_load_dwordx4 v[128:131], v0, s[4:7], s90 offen sc1
  s_add_u32 s90, s91, 203776
  buffer_load_dwordx4 v[132:135], v0, s[4:7], s90 offen sc1
  s_add_u32 s90, s91, 210944
  buffer_load_dwordx4 v[136:139], v0, s[4:7], s90 offen sc1
  s_add_u32 s90, s91, 218112
  buffer_load_dwordx4 v[140:143], v0, s[4:7], s90 offen sc1
  s_add_u32 s90, s91, 225280
  buffer_load_dwordx4 v[144:147], v0, s[4:7], s90 offen sc1
  s_add_u32 s90, s91, 232448
  buffer_load_dwordx4 v[148:151], v0, s[4:7], s90 offen sc1
  s_add_u32 s90, s91, 239616
  buffer_load_dwordx4 v[152:155], v0, s[4:7], s90 offen sc1
  s_add_u32 s90, s91, 246784
  buffer_load_dwordx4 v[156:159], v0, s[4:7], s90 offen sc1
  s_waitcnt vmcnt(16)
  s_barrier
  s_waitcnt vmcnt(13)
  s_add_u32 m0, s47, 28672
  s_add_u32 s48, s98, 8
  s_and_b32 s48, s48, 15
  s_mul_i32 s48, s48, 114688
  s_add_u32 s48, s48, 128
  s_add_u32 s48, s48, s55
  buffer_load_dwordx4 v4, s[28:31], s48 offen lds
  s_waitcnt vmcnt(13)
  s_add_u32 m0, s47, 32768
  s_add_u32 s48, s98, 9
  s_and_b32 s48, s48, 15
  s_mul_i32 s48, s48, 114688
  s_add_u32 s48, s48, 128
  s_add_u32 s48, s48, s55
  buffer_load_dwordx4 v4, s[28:31], s48 offen lds
  s_barrier
  s_waitcnt vmcnt(13)
  s_add_u32 m0, s47, 36864
  s_add_u32 s48, s98, 10
  s_and_b32 s48, s48, 15
  s_mul_i32 s48, s48, 114688
  s_add_u32 s48, s48, 128
  s_add_u32 s48, s48, s55
  buffer_load_dwordx4 v4, s[28:31], s48 offen lds
  s_waitcnt vmcnt(13)
  s_add_u32 m0, s47, 40960
  s_add_u32 s48, s98, 11
  s_and_b32 s48, s48, 15
  s_mul_i32 s48, s48, 114688
  s_add_u32 s48, s48, 128
  s_add_u32 s48, s48, s55
  buffer_load_dwordx4 v4, s[28:31], s48 offen lds
  s_barrier
  s_waitcnt vmcnt(13)
  s_add_u32 m0, s47, 45056
  s_add_u32 s48, s98, 12
  s_and_b32 s48, s48, 15
  s_mul_i32 s48, s48, 114688
  s_add_u32 s48, s48, 128
  s_add_u32 s48, s48, s55
  buffer_load_dwordx4 v4, s[28:31], s48 offen lds
  s_waitcnt vmcnt(13)
  s_add_u32 m0, s47, 49152
  s_add_u32 s48, s98, 13
  s_and_b32 s48, s48, 15
  s_mul_i32 s48, s48, 114688
  s_add_u32 s48, s48, 128
  s_add_u32 s48, s48, s55
  buffer_load_dwordx4 v4, s[28:31], s48 offen lds
  s_waitcnt vmcnt(13)
  s_add_u32 m0, s47, 65536
  s_add_u32 s48, s98, 14
  s_and_b32 s48, s48, 15
  s_mul_i32 s48, s48, 114688
  s_add_u32 s48, s48, 128
  s_add_u32 s48, s48, s55
  buffer_load_dwordx4 v4, s[28:31], s48 offen lds
  s_waitcnt vmcnt(7)
  v_mov_b32 v29, v159
  s_cmp_lg_u32 s44, 1
  s_cbranch_scc1 HSK_62
  v_pk_add_f32 v[128:129], v[128:129], v[144:145]
  v_pk_add_f32 v[130:131], v[130:131], v[146:147]
  v_pk_add_f32 v[132:133], v[132:133], v[148:149]
  v_pk_add_f32 v[134:135], v[134:135], v[150:151]
  v_pk_add_f32 v[136:137], v[136:137], v[152:153]
  v_pk_add_f32 v[138:139], v[138:139], v[154:155]
  v_pk_add_f32 v[140:141], v[140:141], v[156:157]
  v_pk_add_f32 v[142:143], v[142:143], v[158:159]
  v_pk_add_f32 v[128:129], v[128:129], v[136:137]
  v_pk_add_f32 v[130:131], v[130:131], v[138:139]
  v_pk_add_f32 v[132:133], v[132:133], v[140:141]
  v_pk_add_f32 v[134:135], v[134:135], v[142:143]
  v_pk_add_f32 v[128:129], v[128:129], v[132:133]
  v_pk_add_f32 v[130:131], v[130:131], v[134:135]
  v_lshlrev_b32_e64 v29, 4, v1
  v_add_u32 v29, 162816, v29
  ds_write_b128 v29, v[128:131]
  s_waitcnt lgkmcnt(0)
HSK_62:
  s_barrier
  s_add_u32 m0, s47, 53248
  s_add_u32 s48, s98, 15
  s_and_b32 s48, s48, 15
  s_mul_i32 s48, s48, 114688
  s_add_u32 s48, s48, 128
  s_add_u32 s48, s48, s55
  buffer_load_dwordx4 v4, s[28:31], s48 offen lds
  s_add_u32 m0, s47, 57344
  s_add_u32 s48, s98, 0
  s_and_b32 s48, s48, 15
  s_mul_i32 s48, s48, 114688
  s_add_u32 s48, s48, 256
  s_add_u32 s48, s48, s55
  buffer_load_dwordx4 v4, s[28:31], s48 offen lds
  s_add_u32 m0, s47, 61440
  s_add_u32 s48, s98, 1
  s_and_b32 s48, s48, 15
  s_mul_i32 s48, s48, 114688
  s_add_u32 s48, s48, 256
  s_add_u32 s48, s48, s55
  buffer_load_dwordx4 v4, s[28:31], s48 offen lds
  s_add_u32 m0, s47, 73728
  s_add_u32 s48, s98, 2
  s_and_b32 s48, s48, 15
  s_mul_i32 s48, s48, 114688
  s_add_u32 s48, s48, 256
  s_add_u32 s48, s48, s55
  buffer_load_dwordx4 v4, s[28:31], s48 offen lds
  s_add_u32 m0, s47, 77824
  s_add_u32 s48, s98, 3
  s_and_b32 s48, s48, 15
  s_mul_i32 s48, s48, 114688
  s_add_u32 s48, s48, 256
  s_add_u32 s48, s48, s55
  buffer_load_dwordx4 v4, s[28:31], s48 offen lds
  s_add_u32 m0, s47, 81920
  s_add_u32 s48, s98, 4
  s_and_b32 s48, s48, 15
  s_mul_i32 s48, s48, 114688
  s_add_u32 s48, s48, 256
  s_add_u32 s48, s48, s55
  buffer_load_dwordx4 v4, s[28:31], s48 offen lds
  s_add_u32 m0, s47, 86016
  s_add_u32 s48, s98, 5
  s_and_b32 s48, s48, 15
  s_mul_i32 s48, s48, 114688
  s_add_u32 s48, s48, 256
  s_add_u32 s48, s48, s55
  buffer_load_dwordx4 v4, s[28:31], s48 offen lds
  s_waitcnt vmcnt(13)
  s_add_u32 m0, s47, 90112
  s_add_u32 s48, s98, 6
  s_and_b32 s48, s48, 15
  s_mul_i32 s48, s48, 114688
  s_add_u32 s48, s48, 256
  s_add_u32 s48, s48, s55
  buffer_load_dwordx4 v4, s[28:31], s48 offen lds
  s_waitcnt vmcnt(11)
  s_barrier
  s_add_u32 m0, s47, 94208
  s_add_u32 s48, s98, 7
  s_and_b32 s48, s48, 15
  s_mul_i32 s48, s48, 114688
  s_add_u32 s48, s48, 256
  s_add_u32 s48, s48, s55
  buffer_load_dwordx4 v4, s[28:31], s48 offen lds
  s_add_u32 m0, s47, 98304
  s_add_u32 s48, s98, 8
  s_and_b32 s48, s48, 15
  s_mul_i32 s48, s48, 114688
  s_add_u32 s48, s48, 256
  s_add_u32 s48, s48, s55
  buffer_load_dwordx4 v4, s[28:31], s48 offen lds
  s_add_u32 m0, s47, 102400
  s_add_u32 s48, s98, 9
  s_and_b32 s48, s48, 15
  s_mul_i32 s48, s48, 114688
  s_add_u32 s48, s48, 256
  s_add_u32 s48, s48, s55
  buffer_load_dwordx4 v4, s[28:31], s48 offen lds
  s_waitcnt vmcnt(13)
  s_add_u32 m0, s47, 106496
  s_add_u32 s48, s98, 10
  s_and_b32 s48, s48, 15
  s_mul_i32 s48, s48, 114688
  s_add_u32 s48, s48, 256
  s_add_u32 s48, s48, s55
  buffer_load_dwordx4 v4, s[28:31], s48 offen lds
  s_waitcnt vmcnt(12)
  s_barrier
  s_add_u32 m0, s47, 69632
  s_add_u32 s48, s98, 11
  s_and_b32 s48, s48, 15
  s_mul_i32 s48, s48, 114688
  s_add_u32 s48, s48, 256
  s_add_u32 s48, s48, s55
  buffer_load_dwordx4 v4, s[28:31], s48 offen lds
  s_add_u32 m0, s47, 110592
  s_add_u32 s48, s98, 12
  s_and_b32 s48, s48, 15
  s_mul_i32 s48, s48, 114688
  s_add_u32 s48, s48, 256
  s_add_u32 s48, s48, s55
  buffer_load_dwordx4 v4, s[28:31], s48 offen lds
  s_waitcnt vmcnt(13)
  s_add_u32 m0, s47, 114688
  s_add_u32 s48, s98, 13
  s_and_b32 s48, s48, 15
  s_mul_i32 s48, s48, 114688
  s_add_u32 s48, s48, 256
  s_add_u32 s48, s48, s55
  buffer_load_dwordx4 v4, s[28:31], s48 offen lds
  s_waitcnt vmcnt(13)
  s_add_u32 m0, s47, 118784
  s_add_u32 s48, s98, 14
  s_and_b32 s48, s48, 15
  s_mul_i32 s48, s48, 114688
  s_add_u32 s48, s48, 256
  s_add_u32 s48, s48, s55
  buffer_load_dwordx4 v4, s[28:31], s48 offen lds
  s_waitcnt vmcnt(13)
  s_barrier
  s_lshr_b32 s90, s2, 3
  s_lshl_b32 s90, s90, 2
  s_add_u32 s90, s90, s44
  s_mul_i32 s90, s90, 10240
  s_lshl_b32 s91, s45, 7
  s_sub_u32 s90, s90, s91
  s_add_u32 s90, s90, 384
  v_mul_u32_u24 v0, 1024, v1
  v_add_u32 v0, s90, v0
  s_mov_b64 exec, 0x3ff
  buffer_load_dword v21, v0, s[32:35], 0 offen
  s_mov_b64 exec, -1
  s_waitcnt vmcnt(13)
  s_add_u32 m0, s47, 28672
  s_add_u32 s48, s98, 15
  s_and_b32 s48, s48, 15
  s_mul_i32 s48, s48, 114688
  s_add_u32 s48, s48, 256
  s_add_u32 s48, s48, s55
  buffer_load_dwordx4 v4, s[28:31], s48 offen lds
  s_waitcnt vmcnt(13)
  s_add_u32 m0, s47, 122880
  s_add_u32 s48, s45, 0
  s_and_b32 s48, s48, 7
  s_mul_i32 s48, s48, 229376
  s_add_u32 s48, s48, s56
  buffer_load_dwordx4 v5, s[28:31], s48 offen lds
  s_waitcnt vmcnt(13)
  s_add_u32 m0, s47, 126976
  s_add_u32 s48, s45, 1
  s_and_b32 s48, s48, 7
  s_mul_i32 s48, s48, 229376
  s_add_u32 s48, s48, s56
  buffer_load_dwordx4 v5, s[28:31], s48 offen lds
  s_waitcnt vmcnt(10)
  s_barrier
  s_waitcnt vmcnt(6)
  s_barrier
  s_add_u32 m0, s47, 65536
  s_add_u32 s48, s45, 2
  s_and_b32 s48, s48, 7
  s_mul_i32 s48, s48, 229376
  s_add_u32 s48, s48, s56
  buffer_load_dwordx4 v5, s[28:31], s48 offen lds
  s_add_u32 m0, s47, 73728
  s_add_u32 s48, s45, 3
  s_and_b32 s48, s48, 7
  s_mul_i32 s48, s48, 229376
  s_add_u32 s48, s48, s56
  buffer_load_dwordx4 v5, s[28:31], s48 offen lds
  s_add_u32 m0, s47, 32768
  s_add_u32 s48, s99, 40
  s_sub_u32 s100, s48, 56
  s_cselect_b32 s48, s48, s100
  s_mul_i32 s48, s48, 32768
  buffer_load_dwordx4 v2, s[32:35], s48 offen lds
  s_add_u32 m0, s47, 36864
  s_add_u32 s48, s99, 41
  s_sub_u32 s100, s48, 56
  s_cselect_b32 s48, s48, s100
  s_mul_i32 s48, s48, 32768
  buffer_load_dwordx4 v2, s[32:35], s48 offen lds
  s_waitcnt vmcnt(8)
  s_barrier
  s_add_u32 m0, s47, 77824
  s_add_u32 s48, s45, 4
  s_and_b32 s48, s48, 7
  s_mul_i32 s48, s48, 229376
  s_add_u32 s48, s48, s56
  buffer_load_dwordx4 v5, s[28:31], s48 offen lds
  s_add_u32 m0, s47, 81920
  s_add_u32 s48, s45, 5
  s_and_b32 s48, s48, 7
  s_mul_i32 s48, s48, 229376
  s_add_u32 s48, s48, s56
  buffer_load_dwordx4 v5, s[28:31], s48 offen lds
  s_add_u32 m0, s47, 86016
  s_add_u32 s48, s45, 6
  s_and_b32 s48, s48, 7
  s_mul_i32 s48, s48, 229376
  s_add_u32 s48, s48, s56
  buffer_load_dwordx4 v5, s[28:31], s48 offen lds
  s_waitcnt vmcnt(8)
  s_barrier
  s_add_u32 m0, s47, 90112
  s_add_u32 s48, s45, 7
  s_and_b32 s48, s48, 7
  s_mul_i32 s48, s48, 229376
  s_add_u32 s48, s48, s56
  buffer_load_dwordx4 v5, s[28:31], s48 offen lds
  s_add_u32 m0, s47, 49152
  s_add_u32 s48, s99, 42
  s_sub_u32 s100, s48, 56
  s_cselect_b32 s48, s48, s100
  s_mul_i32 s48, s48, 32768
  buffer_load_dwordx4 v2, s[32:35], s48 offen lds
  s_add_u32 m0, s47, 53248
  s_add_u32 s48, s99, 43
  s_sub_u32 s100, s48, 56
  s_cselect_b32 s48, s48, s100
  s_mul_i32 s48, s48, 32768
  buffer_load_dwordx4 v2, s[32:35], s48 offen lds
  s_add_u32 m0, s47, 57344
  s_add_u32 s48, s99, 44
  s_sub_u32 s100, s48, 56
  s_cselect_b32 s48, s48, s100
  s_mul_i32 s48, s48, 32768
  buffer_load_dwordx4 v2, s[32:35], s48 offen lds
  s_add_u32 m0, s47, 61440
  s_add_u32 s48, s99, 45
  s_sub_u32 s100, s48, 56
  s_cselect_b32 s48, s48, s100
  s_mul_i32 s48, s48, 32768
  buffer_load_dwordx4 v2, s[32:35], s48 offen lds
  s_add_u32 m0, s47, 94208
  s_add_u32 s48, s99, 46
  s_sub_u32 s100, s48, 56
  s_cselect_b32 s48, s48, s100
  s_mul_i32 s48, s48, 32768
  buffer_load_dwordx4 v2, s[32:35], s48 offen lds
  s_waitcnt vmcnt(13)
  s_add_u32 m0, s47, 98304
  s_add_u32 s48, s99, 47
  s_sub_u32 s100, s48, 56
  s_cselect_b32 s48, s48, s100
  s_mul_i32 s48, s48, 32768
  buffer_load_dwordx4 v2, s[32:35], s48 offen lds
  s_waitcnt vmcnt(13)
  s_add_u32 m0, s47, 102400
  s_add_u32 s48, s99, 48
  s_sub_u32 s100, s48, 56
  s_cselect_b32 s48, s48, s100
  s_mul_i32 s48, s48, 32768
  buffer_load_dwordx4 v2, s[32:35], s48 offen lds
  s_waitcnt vmcnt(13)
  s_add_u32 m0, s47, 106496
  s_add_u32 s48, s99, 49
  s_sub_u32 s100, s48, 56
  s_cselect_b32 s48, s48, s100
  s_mul_i32 s48, s48, 32768
  buffer_load_dwordx4 v2, s[32:35], s48 offen lds
  s_waitcnt vmcnt(8)
  s_barrier
  s_add_u32 m0, s47, 28672
  s_add_u32 s48, s99, 50
  s_sub_u32 s100, s48, 56
  s_cselect_b32 s48, s48, s100
  s_mul_i32 s48, s48, 32768
  buffer_load_dwordx4 v2, s[32:35], s48 offen lds
  s_add_u32 m0, s47, 69632
  s_add_u32 s48, s99, 51
  s_sub_u32 s100, s48, 56
  s_cselect_b32 s48, s48, s100
  s_mul_i32 s48, s48, 32768
  buffer_load_dwordx4 v2, s[32:35], s48 offen lds
  s_add_u32 m0, s47, 110592
  s_add_u32 s48, s99, 52
  s_sub_u32 s100, s48, 56
  s_cselect_b32 s48, s48, s100
  s_mul_i32 s48, s48, 32768
  buffer_load_dwordx4 v2, s[32:35], s48 offen lds
  s_add_u32 m0, s47, 114688
  s_add_u32 s48, s99, 53
  s_sub_u32 s100, s48, 56
  s_cselect_b32 s48, s48, s100
  s_mul_i32 s48, s48, 32768
  buffer_load_dwordx4 v2, s[32:35], s48 offen lds
  s_add_u32 m0, s47, 118784
  s_add_u32 s48, s99, 54
  s_sub_u32 s100, s48, 56
  s_cselect_b32 s48, s48, s100
  s_mul_i32 s48, s48, 32768
  buffer_load_dwordx4 v2, s[32:35], s48 offen lds
  s_add_u32 m0, s47, 131072
  s_add_u32 s48, s99, 55
  s_sub_u32 s100, s48, 56
  s_cselect_b32 s48, s48, s100
  s_mul_i32 s48, s48, 32768
  buffer_load_dwordx4 v2, s[32:35], s48 offen lds
  s_waitcnt vmcnt(13)
  s_add_u32 m0, s47, 135168
  s_add_u32 s48, s99, 0
  s_sub_u32 s100, s48, 56
  s_cselect_b32 s48, s48, s100
  s_mul_i32 s48, s48, 32768
  buffer_load_dwordx4 v2, s[32:35], s48 offen lds
  s_waitcnt vmcnt(13)
  s_add_u32 m0, s47, 139264
  s_add_u32 s48, s99, 1
  s_sub_u32 s100, s48, 56
  s_cselect_b32 s48, s48, s100
  s_mul_i32 s48, s48, 32768
  buffer_load_dwordx4 v2, s[32:35], s48 offen lds
  s_waitcnt vmcnt(13)
  s_add_u32 m0, s47, 143360
  s_add_u32 s48, s99, 2
  s_sub_u32 s100, s48, 56
  s_cselect_b32 s48, s48, s100
  s_mul_i32 s48, s48, 32768
  buffer_load_dwordx4 v2, s[32:35], s48 offen lds
  s_waitcnt vmcnt(13)
  s_add_u32 m0, s47, 147456
  s_add_u32 s48, s99, 3
  s_sub_u32 s100, s48, 56
  s_cselect_b32 s48, s48, s100
  s_mul_i32 s48, s48, 32768
  buffer_load_dwordx4 v2, s[32:35], s48 offen lds
  s_waitcnt vmcnt(13)
  s_add_u32 m0, s47, 151552
  s_add_u32 s48, s99, 4
  s_sub_u32 s100, s48, 56
  s_cselect_b32 s48, s48, s100
  s_mul_i32 s48, s48, 32768
  buffer_load_dwordx4 v2, s[32:35], s48 offen lds
  s_waitcnt vmcnt(13)
  s_add_u32 m0, s47, 155648
  s_add_u32 s48, s99, 5
  s_sub_u32 s100, s48, 56
  s_cselect_b32 s48, s48, s100
  s_mul_i32 s48, s48, 32768
  buffer_load_dwordx4 v2, s[32:35], s48 offen lds
  s_waitcnt vmcnt(9)
  s_barrier
  s_waitcnt vmcnt(8)
  s_add_u32 m0, s47, 65536
  s_add_u32 s48, s99, 6
  s_sub_u32 s100, s48, 56
  s_cselect_b32 s48, s48, s100
  s_mul_i32 s48, s48, 32768
  buffer_load_dwordx4 v2, s[32:35], s48 offen lds
  s_waitcnt vmcnt(8)
  s_add_u32 m0, s47, 73728
  s_add_u32 s48, s99, 7
  s_sub_u32 s100, s48, 56
  s_cselect_b32 s48, s48, s100
  s_mul_i32 s48, s48, 32768
  buffer_load_dwordx4 v2, s[32:35], s48 offen lds
  s_waitcnt vmcnt(8)
  s_add_u32 m0, s47, 77824
  s_add_u32 s48, s99, 8
  s_sub_u32 s100, s48, 56
  s_cselect_b32 s48, s48, s100
  s_mul_i32 s48, s48, 32768
  buffer_load_dwordx4 v2, s[32:35], s48 offen lds
  s_waitcnt vmcnt(8)
  s_add_u32 m0, s47, 81920
  s_add_u32 s48, s99, 9
  s_sub_u32 s100, s48, 56
  s_cselect_b32 s48, s48, s100
  s_mul_i32 s48, s48, 32768
  buffer_load_dwordx4 v2, s[32:35], s48 offen lds
  s_waitcnt vmcnt(8)
  s_add_u32 m0, s47, 86016
  s_add_u32 s48, s99, 10
  s_sub_u32 s100, s48, 56
  s_cselect_b32 s48, s48, s100
  s_mul_i32 s48, s48, 32768
  buffer_load_dwordx4 v2, s[32:35], s48 offen lds
  s_waitcnt vmcnt(8)
  s_add_u32 m0, s47, 90112
  s_add_u32 s48, s99, 11
  s_sub_u32 s100, s48, 56
  s_cselect_b32 s48, s48, s100
  s_mul_i32 s48, s48, 32768
  buffer_load_dwordx4 v2, s[32:35], s48 offen lds
  s_waitcnt vmcnt(8)
  s_add_u32 m0, s47, 122880
  s_add_u32 s48, s99, 12
  s_sub_u32 s100, s48, 56
  s_cselect_b32 s48, s48, s100
  s_mul_i32 s48, s48, 32768
  buffer_load_dwordx4 v2, s[32:35], s48 offen lds
  s_waitcnt vmcnt(8)
  s_add_u32 m0, s47, 126976
  s_add_u32 s48, s99, 13
  s_sub_u32 s100, s48, 56
  s_cselect_b32 s48, s48, s100
  s_mul_i32 s48, s48, 32768
  buffer_load_dwordx4 v2, s[32:35], s48 offen lds
  s_barrier
  s_add_u32 m0, s47, 40960
  s_add_u32 s48, s99, 14
  s_sub_u32 s100, s48, 56
  s_cselect_b32 s48, s48, s100
  s_mul_i32 s48, s48, 32768
  buffer_load_dwordx4 v2, s[32:35], s48 offen lds
  s_add_u32 m0, s47, 45056
  s_add_u32 s48, s99, 15
  s_sub_u32 s100, s48, 56
  s_cselect_b32 s48, s48, s100
  s_mul_i32 s48, s48, 32768
  buffer_load_dwordx4 v2, s[32:35], s48 offen lds
  s_waitcnt vmcnt(9)
  s_barrier
  s_cmp_lg_u32 s44, 0
  s_cbranch_scc1 HSK_63
  v_mov_b32 v29, 5
  v_mov_b32 v30, 0
  s_mov_b64 exec, 1
  s_cmp_eq_u32 s51, 0
  s_cbranch_scc1 HSL_64
  buffer_store_dword v29, v30, s[4:7], s57 offen
  s_branch HSD_65
HSL_64:
  buffer_wbl2 sc1
  s_waitcnt vmcnt(0)
  buffer_store_dword v29, v30, s[4:7], s57 offen sc1
HSD_65:
  s_mov_b64 exec, -1
HSK_63:
  s_mov_b64 exec, 0
  s_cmp_lg_u32 s44, 1
  s_cbranch_scc1 HPF_66
  s_call_b64 s[96:97], L_TRAMP
HPF_66:
  s_cmp_lg_u32 s44, 2
  s_cbranch_scc1 HPF_67
  s_call_b64 s[96:97], PAD_10
HPF_67:
  s_cmp_lg_u32 s44, 3
  s_cbranch_scc1 HPF_68
  s_call_b64 s[96:97], PAD_22
HPF_68:
  s_mov_b64 exec, -1
  s_cmp_lg_u32 s44, 0
  s_cbranch_scc1 HSK_69
  s_mov_b64 exec, 0xff
  s_mov_b32 s58, s52
HPL_70:
  buffer_load_dword v29, v28, s[4:7], s92 offen sc1
  s_add_u32 s58, s58, 1
  s_cmp_gt_u32 s58, 400000
  s_waitcnt vmcnt(0)
  s_cbranch_scc1 HPD_71
  v_cmp_gt_u32 vcc, 5, v29
  s_cbranch_vccnz HPL_70
  s_mov_b32 s58, 0
HPD_71:
  s_mov_b32 s52, s58
HPK_72:
  s_mov_b64 exec, -1
PAD_21:
  s_cbranch_execz L_TRAMP
  s_nop 0
  s_cmp_lg_u32 s51, 0
  s_cbranch_scc1 HFA_73
  buffer_inv sc1
  s_waitcnt vmcnt(0)
HFA_73:
HSK_69:
  s_waitcnt vmcnt(4)
  s_barrier
  s_add_u32 m0, s47, 28672
  s_add_u32 s48, s99, 7
  s_sub_u32 s100, s48, 56
  s_cselect_b32 s48, s48, s100
  s_mul_i32 s48, s48, 4096
  s_add_u32 s48, s48, s49
  buffer_load_dwordx4 v6, s[4:7], s48 offen sc1 lds
  s_add_u32 m0, s47, 32768
  s_add_u32 s48, s99, 8
  s_sub_u32 s100, s48, 56
  s_cselect_b32 s48, s48, s100
  s_mul_i32 s48, s48, 4096
  s_add_u32 s48, s48, s49
  buffer_load_dwordx4 v6, s[4:7], s48 offen sc1 lds
  s_add_u32 m0, s47, 36864
  s_add_u32 s48, s99, 9
  s_sub_u32 s100, s48, 56
  s_cselect_b32 s48, s48, s100
  s_mul_i32 s48, s48, 4096
  s_add_u32 s48, s48, s49
  buffer_load_dwordx4 v6, s[4:7], s48 offen sc1 lds
  s_add_u32 m0, s47, 49152
  s_add_u32 s48, s99, 10
  s_sub_u32 s100, s48, 56
  s_cselect_b32 s48, s48, s100
  s_mul_i32 s48, s48, 4096
  s_add_u32 s48, s48, s49
  buffer_load_dwordx4 v6, s[4:7], s48 offen sc1 lds
  s_add_u32 m0, s47, 53248
  s_add_u32 s48, s99, 11
  s_sub_u32 s100, s48, 56
  s_cselect_b32 s48, s48, s100
  s_mul_i32 s48, s48, 4096
  s_add_u32 s48, s48, s49
  buffer_load_dwordx4 v6, s[4:7], s48 offen sc1 lds
  s_waitcnt vmcnt(5)
  s_barrier
  s_add_u32 m0, s47, 57344
  s_add_u32 s48, s99, 12
  s_sub_u32 s100, s48, 56
  s_cselect_b32 s48, s48, s100
  s_mul_i32 s48, s48, 4096
  s_add_u32 s48, s48, s49
  buffer_load_dwordx4 v6, s[4:7], s48 offen sc1 lds
  s_add_u32 m0, s47, 61440
  s_add_u32 s48, s99, 13
  s_sub_u32 s100, s48, 56
  s_cselect_b32 s48, s48, s100
  s_mul_i32 s48, s48, 4096
  s_add_u32 s48, s48, s49
  buffer_load_dwordx4 v6, s[4:7], s48 offen sc1 lds
  s_add_u32 m0, s47, 69632
  s_add_u32 s48, s99, 14
  s_sub_u32 s100, s48, 56
  s_cselect_b32 s48, s48, s100
  s_mul_i32 s48, s48, 4096
  s_add_u32 s48, s48, s49
  buffer_load_dwordx4 v6, s[4:7], s48 offen sc1 lds
  s_barrier
  s_add_u32 m0, s47, 0
  s_add_u32 s48, s99, 15
  s_sub_u32 s100, s48, 56
  s_cselect_b32 s48, s48, s100
  s_mul_i32 s48, s48, 4096
  s_add_u32 s48, s48, s49
  buffer_load_dwordx4 v6, s[4:7], s48 offen sc1 lds
  s_add_u32 m0, s47, 94208
  s_add_u32 s48, s99, 16
  s_sub_u32 s100, s48, 56
  s_cselect_b32 s48, s48, s100
  s_mul_i32 s48, s48, 4096
  s_add_u32 s48, s48, s49
  buffer_load_dwordx4 v6, s[4:7], s48 offen sc1 lds
  s_waitcnt vmcnt(9)
  s_barrier
  s_add_u32 m0, s47, 4096
  s_add_u32 s48, s99, 16
  s_sub_u32 s100, s48, 56
  s_cselect_b32 s48, s48, s100
  s_mul_i32 s48, s48, 32768
  buffer_load_dwordx4 v2, s[32:35], s48 offen lds
  s_add_u32 m0, s47, 8192
  s_add_u32 s48, s99, 17
  s_sub_u32 s100, s48, 56
  s_cselect_b32 s48, s48, s100
  s_mul_i32 s48, s48, 4096
  s_add_u32 s48, s48, s49
  buffer_load_dwordx4 v6, s[4:7], s48 offen sc1 lds
  s_add_u32 m0, s47, 98304
  s_add_u32 s48, s99, 17
  s_sub_u32 s100, s48, 56
  s_cselect_b32 s48, s48, s100
  s_mul_i32 s48, s48, 32768
  buffer_load_dwordx4 v2, s[32:35], s48 offen lds
  s_add_u32 m0, s47, 102400
  s_add_u32 s48, s99, 18
  s_sub_u32 s100, s48, 56
  s_cselect_b32 s48, s48, s100
  s_mul_i32 s48, s48, 4096
  s_add_u32 s48, s48, s49
  buffer_load_dwordx4 v6, s[4:7], s48 offen sc1 lds
  s_add_u32 m0, s47, 106496
  s_add_u32 s48, s99, 18
  s_sub_u32 s100, s48, 56
  s_cselect_b32 s48, s48, s100
  s_mul_i32 s48, s48, 32768
  buffer_load_dwordx4 v2, s[32:35], s48 offen lds
  s_waitcnt vmcnt(10)
  s_barrier
  s_add_u32 m0, s47, 12288
  s_add_u32 s48, s99, 19
  s_sub_u32 s100, s48, 56
  s_cselect_b32 s48, s48, s100
  s_mul_i32 s48, s48, 4096
  s_add_u32 s48, s48, s49
  buffer_load_dwordx4 v6, s[4:7], s48 offen sc1 lds
  s_add_u32 m0, s47, 16384
  s_add_u32 s48, s99, 19
  s_sub_u32 s100, s48, 56
  s_cselect_b32 s48, s48, s100
  s_mul_i32 s48, s48, 32768
  buffer_load_dwordx4 v2, s[32:35], s48 offen lds
  s_add_u32 m0, s47, 20480
  s_add_u32 s48, s99, 20
  s_sub_u32 s100, s48, 56
  s_cselect_b32 s48, s48, s100
  s_mul_i32 s48, s48, 4096
  s_add_u32 s48, s48, s49
  buffer_load_dwordx4 v6, s[4:7], s48 offen sc1 lds
  s_waitcnt vmcnt(9)
  s_barrier
  s_add_u32 m0, s47, 24576
  s_add_u32 s48, s99, 20
  s_sub_u32 s100, s48, 56
  s_cselect_b32 s48, s48, s100
  s_mul_i32 s48, s48, 32768
  buffer_load_dwordx4 v2, s[32:35], s48 offen lds
  s_add_u32 m0, s47, 28672
  s_add_u32 s48, s99, 21
  s_sub_u32 s100, s48, 56
  s_cselect_b32 s48, s48, s100
  s_mul_i32 s48, s48, 4096
  s_add_u32 s48, s48, s49
  buffer_load_dwordx4 v6, s[4:7], s48 offen sc1 lds
  s_add_u32 m0, s47, 32768
  s_add_u32 s48, s99, 21
  s_sub_u32 s100, s48, 56
  s_cselect_b32 s48, s48, s100
  s_mul_i32 s48, s48, 32768
  buffer_load_dwordx4 v2, s[32:35], s48 offen lds
  s_add_u32 m0, s47, 36864
  s_add_u32 s48, s99, 22
  s_sub_u32 s100, s48, 56
  s_cselect_b32 s48, s48, s100
  s_mul_i32 s48, s48, 4096
  s_add_u32 s48, s48, s49
  buffer_load_dwordx4 v6, s[4:7], s48 offen sc1 lds
  s_add_u32 m0, s47, 49152
  s_add_u32 s48, s99, 22
  s_sub_u32 s100, s48, 56
  s_cselect_b32 s48, s48, s100
  s_mul_i32 s48, s48, 32768
  buffer_load_dwordx4 v2, s[32:35], s48 offen lds
  s_waitcnt vmcnt(13)
  s_add_u32 m0, s47, 65536
  s_add_u32 s48, s99, 23
  s_sub_u32 s100, s48, 56
  s_cselect_b32 s48, s48, s100
  s_mul_i32 s48, s48, 4096
  s_add_u32 s48, s48, s49
  buffer_load_dwordx4 v6, s[4:7], s48 offen sc1 lds
  s_waitcnt vmcnt(13)
  s_add_u32 m0, s47, 73728
  s_add_u32 s48, s99, 23
  s_sub_u32 s100, s48, 56
  s_cselect_b32 s48, s48, s100
  s_mul_i32 s48, s48, 32768
  buffer_load_dwordx4 v2, s[32:35], s48 offen lds
  s_waitcnt vmcnt(8)
  s_barrier
  s_add_u32 m0, s47, 40960
  s_add_u32 s48, s99, 24
  s_sub_u32 s100, s48, 56
  s_cselect_b32 s48, s48, s100
  s_mul_i32 s48, s48, 4096
  s_add_u32 s48, s48, s49
  buffer_load_dwordx4 v6, s[4:7], s48 offen sc1 lds
  s_add_u32 m0, s47, 53248
  s_add_u32 s48, s99, 24
  s_sub_u32 s100, s48, 56
  s_cselect_b32 s48, s48, s100
  s_mul_i32 s48, s48, 32768
  buffer_load_dwordx4 v2, s[32:35], s48 offen lds
  s_add_u32 m0, s47, 57344
  s_add_u32 s48, s99, 25
  s_sub_u32 s100, s48, 56
  s_cselect_b32 s48, s48, s100
  s_mul_i32 s48, s48, 4096
  s_add_u32 s48, s48, s49
  buffer_load_dwordx4 v6, s[4:7], s48 offen sc1 lds
  s_add_u32 m0, s47, 61440
  s_add_u32 s48, s99, 25
  s_sub_u32 s100, s48, 56
  s_cselect_b32 s48, s48, s100
  s_mul_i32 s48, s48, 32768
  buffer_load_dwordx4 v2, s[32:35], s48 offen lds
  s_add_u32 m0, s47, 69632
  s_add_u32 s48, s99, 26
  s_sub_u32 s100, s48, 56
  s_cselect_b32 s48, s48, s100
  s_mul_i32 s48, s48, 4096
  s_add_u32 s48, s48, s49
  buffer_load_dwordx4 v6, s[4:7], s48 offen sc1 lds
  s_add_u32 m0, s47, 77824
  s_add_u32 s48, s99, 26
  s_sub_u32 s100, s48, 56
  s_cselect_b32 s48, s48, s100
  s_mul_i32 s48, s48, 32768
  buffer_load_dwordx4 v2, s[32:35], s48 offen lds
  s_waitcnt vmcnt(13)
  s_add_u32 m0, s47, 81920
  s_add_u32 s48, s99, 27
  s_sub_u32 s100, s48, 56
  s_cselect_b32 s48, s48, s100
  s_mul_i32 s48, s48, 4096
  s_add_u32 s48, s48, s49
  buffer_load_dwordx4 v6, s[4:7], s48 offen sc1 lds
  s_waitcnt vmcnt(13)
  s_add_u32 m0, s47, 86016
  s_add_u32 s48, s99, 27
  s_sub_u32 s100, s48, 56
  s_cselect_b32 s48, s48, s100
  s_mul_i32 s48, s48, 32768
  buffer_load_dwordx4 v2, s[32:35], s48 offen lds
  s_waitcnt vmcnt(8)
  s_barrier
  s_add_u32 m0, s47, 0
  s_add_u32 s48, s99, 28
  s_sub_u32 s100, s48, 56
  s_cselect_b32 s48, s48, s100
  s_mul_i32 s48, s48, 4096
  s_add_u32 s48, s48, s49
  buffer_load_dwordx4 v6, s[4:7], s48 offen sc1 lds
  s_add_u32 m0, s47, 4096
  s_add_u32 s48, s99, 28
  s_sub_u32 s100, s48, 56
  s_cselect_b32 s48, s48, s100
  s_mul_i32 s48, s48, 32768
  buffer_load_dwordx4 v2, s[32:35], s48 offen lds
  s_add_u32 m0, s47, 8192
  s_add_u32 s48, s99, 29
  s_sub_u32 s100, s48, 56
  s_cselect_b32 s48, s48, s100
  s_mul_i32 s48, s48, 4096
  s_add_u32 s48, s48, s49
  buffer_load_dwordx4 v6, s[4:7], s48 offen sc1 lds
  s_add_u32 m0, s47, 45056
  s_add_u32 s48, s99, 29
  s_sub_u32 s100, s48, 56
  s_cselect_b32 s48, s48, s100
  s_mul_i32 s48, s48, 32768
  buffer_load_dwordx4 v2, s[32:35], s48 offen lds
  s_add_u32 m0, s47, 90112
  s_add_u32 s48, s99, 30
  s_sub_u32 s100, s48, 56
  s_cselect_b32 s48, s48, s100
  s_mul_i32 s48, s48, 4096
  s_add_u32 s48, s48, s49
  buffer_load_dwordx4 v6, s[4:7], s48 offen sc1 lds
  s_add_u32 m0, s47, 94208
  s_add_u32 s48, s99, 30
  s_sub_u32 s100, s48, 56
  s_cselect_b32 s48, s48, s100
  s_mul_i32 s48, s48, 32768
  buffer_load_dwordx4 v2, s[32:35], s48 offen lds
  s_waitcnt vmcnt(13)
  s_add_u32 m0, s47, 98304
  s_add_u32 s48, s99, 31
  s_sub_u32 s100, s48, 56
  s_cselect_b32 s48, s48, s100
  s_mul_i32 s48, s48, 4096
  s_add_u32 s48, s48, s49
  buffer_load_dwordx4 v6, s[4:7], s48 offen sc1 lds
  s_waitcnt vmcnt(13)
  s_add_u32 m0, s47, 102400
  s_add_u32 s48, s99, 31
  s_sub_u32 s100, s48, 56
  s_cselect_b32 s48, s48, s100
  s_mul_i32 s48, s48, 32768
  buffer_load_dwordx4 v2, s[32:35], s48 offen lds
  s_waitcnt vmcnt(8)
  s_barrier
  s_add_u32 m0, s47, 12288
  s_add_u32 s48, s99, 32
  s_sub_u32 s100, s48, 56
  s_cselect_b32 s48, s48, s100
  s_mul_i32 s48, s48, 4096
  s_add_u32 s48, s48, s49
  buffer_load_dwordx4 v6, s[4:7], s48 offen sc1 lds
  s_add_u32 m0, s47, 16384
  s_add_u32 s48, s99, 32
  s_sub_u32 s100, s48, 56
  s_cselect_b32 s48, s48, s100
  s_mul_i32 s48, s48, 32768
  buffer_load_dwordx4 v2, s[32:35], s48 offen lds
  s_add_u32 m0, s47, 20480
  s_add_u32 s48, s99, 33
  s_sub_u32 s100, s48, 56
  s_cselect_b32 s48, s48, s100
  s_mul_i32 s48, s48, 4096
  s_add_u32 s48, s48, s49
  buffer_load_dwordx4 v6, s[4:7], s48 offen sc1 lds
  s_add_u32 m0, s47, 24576
  s_add_u32 s48, s99, 33
  s_sub_u32 s100, s48, 56
  s_cselect_b32 s48, s48, s100
  s_mul_i32 s48, s48, 32768
  buffer_load_dwordx4 v2, s[32:35], s48 offen lds
  s_add_u32 m0, s47, 28672
  s_add_u32 s48, s99, 34
  s_sub_u32 s100, s48, 56
  s_cselect_b32 s48, s48, s100
  s_mul_i32 s48, s48, 4096
  s_add_u32 s48, s48, s49
  buffer_load_dwordx4 v6, s[4:7], s48 offen sc1 lds
  s_add_u32 m0, s47, 32768
  s_add_u32 s48, s99, 34
  s_sub_u32 s100, s48, 56
  s_cselect_b32 s48, s48, s100
  s_mul_i32 s48, s48, 32768
  buffer_load_dwordx4 v2, s[32:35], s48 offen lds
  s_waitcnt vmcnt(13)
  s_add_u32 m0, s47, 36864
  s_add_u32 s48, s99, 35
  s_sub_u32 s100, s48, 56
  s_cselect_b32 s48, s48, s100
  s_mul_i32 s48, s48, 4096
  s_add_u32 s48, s48, s49
  buffer_load_dwordx4 v6, s[4:7], s48 offen sc1 lds
  s_waitcnt vmcnt(13)
  s_add_u32 m0, s47, 49152
  s_add_u32 s48, s99, 35
  s_sub_u32 s100, s48, 56
  s_cselect_b32 s48, s48, s100
  s_mul_i32 s48, s48, 32768
  buffer_load_dwordx4 v2, s[32:35], s48 offen lds
  s_waitcnt vmcnt(8)
  s_barrier
  s_add_u32 m0, s47, 40960
  s_add_u32 s48, s99, 36
  s_sub_u32 s100, s48, 56
  s_cselect_b32 s48, s48, s100
  s_mul_i32 s48, s48, 4096
  s_add_u32 s48, s48, s49
  buffer_load_dwordx4 v6, s[4:7], s48 offen sc1 lds
  s_add_u32 m0, s47, 53248
  s_add_u32 s48, s99, 36
  s_sub_u32 s100, s48, 56
  s_cselect_b32 s48, s48, s100
  s_mul_i32 s48, s48, 32768
  buffer_load_dwordx4 v2, s[32:35], s48 offen lds
  s_add_u32 m0, s47, 57344
  s_add_u32 s48, s99, 37
  s_sub_u32 s100, s48, 56
  s_cselect_b32 s48, s48, s100
  s_mul_i32 s48, s48, 4096
  s_add_u32 s48, s48, s49
  buffer_load_dwordx4 v6, s[4:7], s48 offen sc1 lds
  s_add_u32 m0, s47, 61440
  s_add_u32 s48, s99, 37
  s_sub_u32 s100, s48, 56
  s_cselect_b32 s48, s48, s100
  s_mul_i32 s48, s48, 32768
  buffer_load_dwordx4 v2, s[32:35], s48 offen lds
  s_add_u32 m0, s47, 65536
  s_add_u32 s48, s99, 38
  s_sub_u32 s100, s48, 56
  s_cselect_b32 s48, s48, s100
  s_mul_i32 s48, s48, 4096
  s_add_u32 s48, s48, s49
  buffer_load_dwordx4 v6, s[4:7], s48 offen sc1 lds
  s_add_u32 m0, s47, 69632
  s_add_u32 s48, s99, 38
  s_sub_u32 s100, s48, 56
  s_cselect_b32 s48, s48, s100
  s_mul_i32 s48, s48, 32768
  buffer_load_dwordx4 v2, s[32:35], s48 offen lds
  s_waitcnt vmcnt(13)
  s_add_u32 m0, s47, 73728
  s_add_u32 s48, s99, 39
  s_sub_u32 s100, s48, 56
  s_cselect_b32 s48, s48, s100
  s_mul_i32 s48, s48, 4096
  s_add_u32 s48, s48, s49
  buffer_load_dwordx4 v6, s[4:7], s48 offen sc1 lds
  s_waitcnt vmcnt(13)
  s_add_u32 m0, s47, 77824
  s_add_u32 s48, s99, 39
  s_sub_u32 s100, s48, 56
  s_cselect_b32 s48, s48, s100
  s_mul_i32 s48, s48, 32768
  buffer_load_dwordx4 v2, s[32:35], s48 offen lds
  s_waitcnt vmcnt(8)
  s_barrier
  s_lshr_b32 s90, s2, 3
  s_lshl_b32 s90, s90, 2
  s_add_u32 s90, s90, s44
  s_mul_i32 s90, s90, 6144
  s_lshl_b32 s91, s45, 7
  s_sub_u32 s90, s90, s91
  s_add_u32 s90, s90, 384
  v_mul_u32_u24 v0, 1024, v1
  v_add_u32 v0, s90, v0
  s_mov_b64 exec, 0x3f
  buffer_load_dword v21, v0, s[12:15], 0 offen
  s_mov_b64 exec, -1
  s_add_u32 m0, s47, 81920
  s_add_u32 s48, s98, 0
  s_and_b32 s48, s48, 15
  s_mul_i32 s48, s48, 98304
  buffer_load_dwordx4 v3, s[12:15], s48 offen lds
  s_add_u32 m0, s47, 0
  s_add_u32 s48, s99, 40
  s_sub_u32 s100, s48, 56
  s_cselect_b32 s48, s48, s100
  s_mul_i32 s48, s48, 4096
  s_add_u32 s48, s48, s49
  buffer_load_dwordx4 v6, s[4:7], s48 offen sc1 lds
  s_add_u32 m0, s47, 4096
  s_add_u32 s48, s99, 41
  s_sub_u32 s100, s48, 56
  s_cselect_b32 s48, s48, s100
  s_mul_i32 s48, s48, 4096
  s_add_u32 s48, s48, s49
  buffer_load_dwordx4 v6, s[4:7], s48 offen sc1 lds
  s_add_u32 m0, s47, 86016
  s_add_u32 s48, s98, 0
  s_and_b32 s48, s48, 15
  s_mul_i32 s48, s48, 98304
  s_add_u32 s48, s48, 1024
  buffer_load_dwordx4 v3, s[12:15], s48 offen lds
  s_add_u32 m0, s47, 8192
  s_add_u32 s48, s99, 42
  s_sub_u32 s100, s48, 56
  s_cselect_b32 s48, s48, s100
  s_mul_i32 s48, s48, 4096
  s_add_u32 s48, s48, s49
  buffer_load_dwordx4 v6, s[4:7], s48 offen sc1 lds
  s_waitcnt vmcnt(13)
  s_add_u32 m0, s47, 45056
  s_add_u32 s48, s99, 43
  s_sub_u32 s100, s48, 56
  s_cselect_b32 s48, s48, s100
  s_mul_i32 s48, s48, 4096
  s_add_u32 s48, s48, s49
  buffer_load_dwordx4 v6, s[4:7], s48 offen sc1 lds
  s_waitcnt vmcnt(13)
  s_add_u32 m0, s47, 90112
  s_add_u32 s48, s98, 0
  s_and_b32 s48, s48, 15
  s_mul_i32 s48, s48, 98304
  s_add_u32 s48, s48, 2048
  buffer_load_dwordx4 v3, s[12:15], s48 offen lds
  s_waitcnt vmcnt(8)
  s_barrier
  s_add_u32 m0, s47, 12288
  s_add_u32 s48, s99, 44
  s_sub_u32 s100, s48, 56
  s_cselect_b32 s48, s48, s100
  s_mul_i32 s48, s48, 4096
  s_add_u32 s48, s48, s49
  buffer_load_dwordx4 v6, s[4:7], s48 offen sc1 lds
  s_add_u32 m0, s47, 16384
  s_add_u32 s48, s99, 45
  s_sub_u32 s100, s48, 56
  s_cselect_b32 s48, s48, s100
  s_mul_i32 s48, s48, 4096
  s_add_u32 s48, s48, s49
  buffer_load_dwordx4 v6, s[4:7], s48 offen sc1 lds
  s_add_u32 m0, s47, 94208
  s_add_u32 s48, s98, 1
  s_and_b32 s48, s48, 15
  s_mul_i32 s48, s48, 98304
  buffer_load_dwordx4 v3, s[12:15], s48 offen lds
  s_add_u32 m0, s47, 20480
  s_add_u32 s48, s99, 46
  s_sub_u32 s100, s48, 56
  s_cselect_b32 s48, s48, s100
  s_mul_i32 s48, s48, 4096
  s_add_u32 s48, s48, s49
  buffer_load_dwordx4 v6, s[4:7], s48 offen sc1 lds
  s_add_u32 m0, s47, 24576
  s_add_u32 s48, s99, 47
  s_sub_u32 s100, s48, 56
  s_cselect_b32 s48, s48, s100
  s_mul_i32 s48, s48, 4096
  s_add_u32 s48, s48, s49
  buffer_load_dwordx4 v6, s[4:7], s48 offen sc1 lds
  s_add_u32 m0, s47, 98304
  s_add_u32 s48, s98, 1
  s_and_b32 s48, s48, 15
  s_mul_i32 s48, s48, 98304
  s_add_u32 s48, s48, 1024
  buffer_load_dwordx4 v3, s[12:15], s48 offen lds
  s_waitcnt vmcnt(13)
  s_add_u32 m0, s47, 28672
  s_add_u32 s48, s99, 48
  s_sub_u32 s100, s48, 56
  s_cselect_b32 s48, s48, s100
  s_mul_i32 s48, s48, 4096
  s_add_u32 s48, s48, s49
  buffer_load_dwordx4 v6, s[4:7], s48 offen sc1 lds
  s_waitcnt vmcnt(13)
  s_add_u32 m0, s47, 32768
  s_add_u32 s48, s99, 49
  s_sub_u32 s100, s48, 56
  s_cselect_b32 s48, s48, s100
  s_mul_i32 s48, s48, 4096
  s_add_u32 s48, s48, s49
  buffer_load_dwordx4 v6, s[4:7], s48 offen sc1 lds
  s_waitcnt vmcnt(9)
  s_barrier
  s_add_u32 m0, s47, 65536
  s_add_u32 s48, s98, 1
  s_and_b32 s48, s48, 15
  s_mul_i32 s48, s48, 98304
  s_add_u32 s48, s48, 2048
  buffer_load_dwordx4 v3, s[12:15], s48 offen lds
  s_add_u32 m0, s47, 36864
  s_add_u32 s48, s99, 50
  s_sub_u32 s100, s48, 56
  s_cselect_b32 s48, s48, s100
  s_mul_i32 s48, s48, 4096
  s_add_u32 s48, s48, s49
  buffer_load_dwordx4 v6, s[4:7], s48 offen sc1 lds
  s_add_u32 m0, s47, 40960
  s_add_u32 s48, s99, 51
  s_sub_u32 s100, s48, 56
  s_cselect_b32 s48, s48, s100
  s_mul_i32 s48, s48, 4096
  s_add_u32 s48, s48, s49
  buffer_load_dwordx4 v6, s[4:7], s48 offen sc1 lds
  s_add_u32 m0, s47, 69632
  s_add_u32 s48, s98, 2
  s_and_b32 s48, s48, 15
  s_mul_i32 s48, s48, 98304
  buffer_load_dwordx4 v3, s[12:15], s48 offen lds
  s_add_u32 m0, s47, 49152
  s_add_u32 s48, s99, 52
  s_sub_u32 s100, s48, 56
  s_cselect_b32 s48, s48, s100
  s_mul_i32 s48, s48, 4096
  s_add_u32 s48, s48, s49
  buffer_load_dwordx4 v6, s[4:7], s48 offen sc1 lds
  s_waitcnt vmcnt(13)
  s_add_u32 m0, s47, 53248
  s_add_u32 s48, s99, 53
  s_sub_u32 s100, s48, 56
  s_cselect_b32 s48, s48, s100
  s_mul_i32 s48, s48, 4096
  s_add_u32 s48, s48, s49
  buffer_load_dwordx4 v6, s[4:7], s48 offen sc1 lds
  s_waitcnt vmcnt(9)
  s_barrier
  s_add_u32 m0, s47, 73728
  s_add_u32 s48, s98, 2
  s_and_b32 s48, s48, 15
  s_mul_i32 s48, s48, 98304
  s_add_u32 s48, s48, 1024
  buffer_load_dwordx4 v3, s[12:15], s48 offen lds
  s_add_u32 m0, s47, 0
  s_add_u32 s48, s99, 54
  s_sub_u32 s100, s48, 56
  s_cselect_b32 s48, s48, s100
  s_mul_i32 s48, s48, 4096
  s_add_u32 s48, s48, s49
  buffer_load_dwordx4 v6, s[4:7], s48 offen sc1 lds
  s_add_u32 m0, s47, 4096
  s_add_u32 s48, s99, 55
  s_sub_u32 s100, s48, 56
  s_cselect_b32 s48, s48, s100
  s_mul_i32 s48, s48, 4096
  s_add_u32 s48, s48, s49
  buffer_load_dwordx4 v6, s[4:7], s48 offen sc1 lds
  s_add_u32 m0, s47, 77824
  s_add_u32 s48, s98, 2
  s_and_b32 s48, s48, 15
  s_mul_i32 s48, s48, 98304
  s_add_u32 s48, s48, 2048
  buffer_load_dwordx4 v3, s[12:15], s48 offen lds
  s_add_u32 m0, s47, 102400
  s_add_u32 s48, s98, 3
  s_and_b32 s48, s48, 15
  s_mul_i32 s48, s48, 98304
  buffer_load_dwordx4 v3, s[12:15], s48 offen lds
  s_waitcnt vmcnt(13)
  s_add_u32 m0, s47, 106496
  s_add_u32 s48, s98, 3
  s_and_b32 s48, s48, 15
  s_mul_i32 s48, s48, 98304
  s_add_u32 s48, s48, 1024
  buffer_load_dwordx4 v3, s[12:15], s48 offen lds
  s_waitcnt vmcnt(9)
  s_barrier
  s_lshr_b32 s90, s2, 3
  s_lshl_b32 s90, s90, 2
  s_add_u32 s90, s90, s44
  s_mul_i32 s90, s90, 6144
  s_lshl_b32 s91, s45, 7
  s_sub_u32 s90, s90, s91
  s_add_u32 s90, s90, 786816
  v_mul_u32_u24 v0, 1024, v1
  v_add_u32 v0, s90, v0
  s_mov_b64 exec, 0x3f
  buffer_load_dword v21, v0, s[12:15], 0 offen
  s_mov_b64 exec, -1
  s_add_u32 m0, s47, 110592
  s_add_u32 s48, s98, 3
  s_and_b32 s48, s48, 15
  s_mul_i32 s48, s48, 98304
  s_add_u32 s48, s48, 2048
  buffer_load_dwordx4 v3, s[12:15], s48 offen lds
  s_add_u32 m0, s47, 114688
  s_add_u32 s48, s98, 4
  s_and_b32 s48, s48, 15
  s_mul_i32 s48, s48, 98304
  buffer_load_dwordx4 v3, s[12:15], s48 offen lds
  s_add_u32 m0, s47, 118784
  s_add_u32 s48, s98, 4
  s_and_b32 s48, s48, 15
  s_mul_i32 s48, s48, 98304
  s_add_u32 s48, s48, 1024
  buffer_load_dwordx4 v3, s[12:15], s48 offen lds
  s_waitcnt vmcnt(10)
  s_barrier
  s_waitcnt vmcnt(8)
  s_add_u32 m0, s47, 122880
  s_add_u32 s48, s98, 4
  s_and_b32 s48, s48, 15
  s_mul_i32 s48, s48, 98304
  s_add_u32 s48, s48, 2048
  buffer_load_dwordx4 v3, s[12:15], s48 offen lds
  s_waitcnt vmcnt(8)
  s_barrier
  s_add_u32 m0, s47, 126976
  s_add_u32 s48, s98, 5
  s_and_b32 s48, s48, 15
  s_mul_i32 s48, s48, 98304
  buffer_load_dwordx4 v3, s[12:15], s48 offen lds
  s_waitcnt vmcnt(8)
  s_add_u32 m0, s47, 131072
  s_add_u32 s48, s98, 5
  s_and_b32 s48, s48, 15
  s_mul_i32 s48, s48, 98304
  s_add_u32 s48, s48, 1024
  buffer_load_dwordx4 v3, s[12:15], s48 offen lds
  s_waitcnt vmcnt(8)
  s_add_u32 m0, s47, 135168
  s_add_u32 s48, s98, 5
  s_and_b32 s48, s48, 15
  s_mul_i32 s48, s48, 98304
  s_add_u32 s48, s48, 2048
  buffer_load_dwordx4 v3, s[12:15], s48 offen lds
  s_barrier
  s_add_u32 m0, s47, 139264
  s_add_u32 s48, s98, 6
  s_and_b32 s48, s48, 15
  s_mul_i32 s48, s48, 98304
  buffer_load_dwordx4 v3, s[12:15], s48 offen lds
  s_add_u32 m0, s47, 143360
  s_add_u32 s48, s98, 6
  s_and_b32 s48, s48, 15
  s_mul_i32 s48, s48, 98304
  s_add_u32 s48, s48, 1024
  buffer_load_dwordx4 v3, s[12:15], s48 offen lds
  s_add_u32 m0, s47, 147456
  s_add_u32 s48, s98, 6
  s_and_b32 s48, s48, 15
  s_mul_i32 s48, s48, 98304
  s_add_u32 s48, s48, 2048
  buffer_load_dwordx4 v3, s[12:15], s48 offen lds
  s_add_u32 m0, s47, 151552
  s_add_u32 s48, s98, 7
  s_and_b32 s48, s48, 15
  s_mul_i32 s48, s48, 98304
  buffer_load_dwordx4 v3, s[12:15], s48 offen lds
  s_add_u32 m0, s47, 155648
  s_add_u32 s48, s98, 7
  s_and_b32 s48, s48, 15
  s_mul_i32 s48, s48, 98304
  s_add_u32 s48, s48, 1024
  buffer_load_dwordx4 v3, s[12:15], s48 offen lds
  s_waitcnt vmcnt(10)
  s_barrier
  s_cmp_lg_u32 s44, 0
  s_cbranch_scc1 HSK_74
  v_mov_b32 v29, 6
  v_mov_b32 v30, 0
  s_mov_b64 exec, 1
  s_cmp_eq_u32 s51, 0
  s_cbranch_scc1 HSL_75
  buffer_store_dword v29, v30, s[4:7], s57 offen
  s_branch HSD_76
HSL_75:
  buffer_wbl2 sc1
  s_waitcnt vmcnt(0)
  buffer_store_dword v29, v30, s[4:7], s57 offen sc1
HSD_76:
  s_mov_b64 exec, -1
HSK_74:
PAD_22:
  s_cbranch_execz L_TRAMP
  s_nop 0
  s_mov_b64 exec, 0
  s_cmp_lg_u32 s44, 1
  s_cbranch_scc1 HPF_77
  s_call_b64 s[96:97], L_TRAMP
HPF_77:
  s_cmp_lg_u32 s44, 2
  s_cbranch_scc1 HPF_78
  s_call_b64 s[96:97], PAD_23
HPF_78:
  s_cmp_lg_u32 s44, 3
  s_cbranch_scc1 HPF_79
  s_call_b64 s[96:97], PAD_11
HPF_79:
  s_mov_b64 exec, -1
  v_bfe_u32 v29, v1, 4, 1
  v_bfe_u32 v30, v1, 2, 2
  v_lshl_add_u32 v17, v29, 2, v30
  v_lshrrev_b32_e64 v31, 5, v1
  v_lshl_add_u32 v17, v31, 4, v17
  v_lshlrev_b32 v17, 7, v17
  v_and_b32 v30, 2, v30
  v_or_b32 v29, v29, v30
  v_xor_b32 v29, s44, v29
  v_lshl_add_u32 v17, v29, 5, v17
  v_and_b32_e64 v30, 3, v1
  v_lshl_add_u32 v17, v30, 3, v17
  v_add_u32 v18, 0x20000, v17
  v_add_u32 v17, 0x10000, v17
  v_bfe_u32 v29, v1, 4, 1
  v_bfe_u32 v30, v1, 2, 2
  v_lshl_add_u32 v22, v29, 2, v30
  v_add_u32 v22, 8, v22
  v_lshrrev_b32 v31, 5, v1
  v_lshl_add_u32 v22, v31, 4, v22
  v_lshlrev_b32 v22, 7, v22
  v_and_b32 v30, 2, v30
  v_xor_b32 v29, 1, v29
  v_or_b32 v29, v29, v30
  v_xor_b32_e64 v29, s44, v29
  v_lshl_add_u32 v22, v29, 5, v22
  v_and_b32_e64 v30, 3, v1
  v_lshl_add_u32 v22, v30, 3, v22
  v_add_u32 v23, 0x20000, v22
  v_add_u32 v22, 0x10000, v22
  v_and_b32 v122, 15, v1
  v_lshlrev_b32 v122, 2, v122
  v_add_u32 v122, 159744, v122
  v_and_b32_e64 v31, 48, v1
  v_add_u32 v120, 159744, v31
  s_lshl_b32 s53, s44, 6
  s_add_u32 s53, s53, 2048
  v_add_u32 v126, s53, v120
  v_add_u32_e64 v127, s53, v122
  v_bfe_u32 v29, v1, 4, 1
  v_lshrrev_b32_e64 v30, 5, v1
  v_lshl_add_u32 v31, v29, 1, v30
  v_lshl_add_u32 v123, v31, 6, v122
  v_and_b32 v31, 15, v1
  v_lshlrev_b32 v31, 4, v31
  v_lshl_add_u32 v31, v29, 10, v31
  v_lshl_add_u32 v31, v30, 8, v31
  s_lshl_b32 s53, s44, 11
  v_add_u32 v121, s53, v31
  s_cmp_lg_u32 s44, 0
  s_cbranch_scc1 HSK_80
  s_mov_b64 exec, 0xff
  s_mov_b32 s58, s52
HPL_81:
  buffer_load_dword v29, v28, s[4:7], s92 offen sc1
  s_add_u32 s58, s58, 1
  s_cmp_gt_u32 s58, 400000
  s_waitcnt vmcnt(0)
  s_cbranch_scc1 HPD_82
  v_cmp_gt_u32 vcc, 6, v29
  s_cbranch_vccnz HPL_81
  s_mov_b32 s58, 0
HPD_82:
  s_mov_b32 s52, s58
HPK_83:
  s_mov_b64 exec, -1
  s_cmp_lg_u32 s51, 0
  s_cbranch_scc1 HFA_84
  buffer_inv sc1
  s_waitcnt vmcnt(0)
HFA_84:
HSK_80:
  s_waitcnt vmcnt(8)
  s_barrier
  s_add_u32 m0, s47, 8192
  s_add_u32 s48, s98, 2
  s_and_b32 s48, s48, 15
  s_mul_i32 s48, s48, 4096
  s_add_u32 s48, s48, s50
  buffer_load_dwordx4 v6, s[4:7], s48 offen sc1 lds
  s_add_u32 m0, s47, 12288
  s_add_u32 s48, s98, 3
  s_and_b32 s48, s48, 15
  s_mul_i32 s48, s48, 4096
  s_add_u32 s48, s48, s50
  buffer_load_dwordx4 v6, s[4:7], s48 offen sc1 lds
  s_barrier
  s_add_u32 m0, s47, 16384
  s_add_u32 s48, s98, 4
  s_and_b32 s48, s48, 15
  s_mul_i32 s48, s48, 4096
  s_add_u32 s48, s48, s50
  buffer_load_dwordx4 v6, s[4:7], s48 offen sc1 lds
  s_add_u32 m0, s47, 20480
  s_add_u32 s48, s98, 5
  s_and_b32 s48, s48, 15
  s_mul_i32 s48, s48, 4096
  s_add_u32 s48, s48, s50
  buffer_load_dwordx4 v6, s[4:7], s48 offen sc1 lds
  s_add_u32 m0, s47, 24576
  s_add_u32 s48, s98, 6
  s_and_b32 s48, s48, 15
  s_mul_i32 s48, s48, 4096
  s_add_u32 s48, s48, s50
  buffer_load_dwordx4 v6, s[4:7], s48 offen sc1 lds
  s_add_u32 m0, s47, 28672
  s_add_u32 s48, s98, 7
  s_and_b32 s48, s48, 15
  s_mul_i32 s48, s48, 4096
  s_add_u32 s48, s48, s50
  buffer_load_dwordx4 v6, s[4:7], s48 offen sc1 lds
  s_waitcnt vmcnt(13)
  s_add_u32 m0, s47, 32768
  s_add_u32 s48, s98, 8
  s_and_b32 s48, s48, 15
  s_mul_i32 s48, s48, 4096
  s_add_u32 s48, s48, s50
  buffer_load_dwordx4 v6, s[4:7], s48 offen sc1 lds
  s_waitcnt vmcnt(13)
  s_add_u32 m0, s47, 36864
  s_add_u32 s48, s98, 9
  s_and_b32 s48, s48, 15
  s_mul_i32 s48, s48, 4096
  s_add_u32 s48, s48, s50
  buffer_load_dwordx4 v6, s[4:7], s48 offen sc1 lds
  s_waitcnt vmcnt(13)
  s_add_u32 m0, s47, 40960
  s_add_u32 s48, s98, 10
  s_and_b32 s48, s48, 15
  s_mul_i32 s48, s48, 4096
  s_add_u32 s48, s48, s50
  s_nop 0
  buffer_load_dwordx4 v6, s[4:7], s48 offen sc1 lds
  ds_read_b64_tr_b16 v[128:129], v17 offset:20480
  ds_read_b64_tr_b16 v[130:131], v22 offset:20480
  ds_read_b64_tr_b16 v[192:193], v17 offset:24576
  ds_read_b64_tr_b16 v[194:195], v22 offset:24576
  ds_read_b64_tr_b16 v[132:133], v17 offset:32768
  ds_read_b64_tr_b16 v[134:135], v22 offset:32768
  ds_read_b64_tr_b16 v[196:197], v17 offset:0
  ds_read_b64_tr_b16 v[198:199], v22 offset:0
  s_waitcnt vmcnt(7)
  s_waitcnt lgkmcnt(0)
  s_barrier
  s_add_u32 s53, s57, 4096
  s_cmp_eq_u32 s44, 0
  s_cselect_b32 s53, s53, 2130706432
  v_mov_b32 v29, 1
  v_mov_b32 v30, 0
  s_mov_b64 exec, 1
  buffer_store_dword v29, v30, s[4:7], s53 offen sc1
  s_mov_b64 exec, -1
  s_add_u32 m0, s47, 81920
  s_add_u32 s48, s80, 0
  s_nop 0
  buffer_load_dwordx4 v6, s[4:7], s48 offen sc1 lds
  s_add_u32 m0, s47, 86016
  s_add_u32 s48, s80, 4096
  buffer_load_dwordx4 v6, s[4:7], s48 offen sc1 lds
  s_add_u32 m0, s47, 45056
  s_add_u32 s48, s98, 11
  s_and_b32 s48, s48, 15
  s_mul_i32 s48, s48, 4096
  s_add_u32 s48, s48, s50
  buffer_load_dwordx4 v6, s[4:7], s48 offen sc1 lds
  s_add_u32 m0, s47, 90112
  s_add_u32 s48, s98, 7
  s_and_b32 s48, s48, 15
  s_mul_i32 s48, s48, 98304
  s_add_u32 s48, s48, 2048
  buffer_load_dwordx4 v3, s[12:15], s48 offen lds
  s_add_u32 m0, s47, 49152
  s_add_u32 s48, s98, 12
  s_and_b32 s48, s48, 15
  s_mul_i32 s48, s48, 4096
  s_add_u32 s48, s48, s50
  buffer_load_dwordx4 v6, s[4:7], s48 offen sc1 lds
  s_add_u32 m0, s47, 94208
  s_add_u32 s48, s98, 8
  s_and_b32 s48, s48, 15
  s_mul_i32 s48, s48, 98304
  buffer_load_dwordx4 v3, s[12:15], s48 offen lds
  s_waitcnt vmcnt(13)
  s_add_u32 m0, s47, 53248
  s_add_u32 s48, s98, 13
  s_and_b32 s48, s48, 15
  s_mul_i32 s48, s48, 4096
  s_add_u32 s48, s48, s50
  buffer_load_dwordx4 v6, s[4:7], s48 offen sc1 lds
  ds_read_b64_tr_b16 v[136:137], v17 offset:8192
  ds_read_b64_tr_b16 v[138:139], v22 offset:8192
  ds_read_b64_tr_b16 v[200:201], v17 offset:12288
  ds_read_b64_tr_b16 v[202:203], v22 offset:12288
  ds_read_b64_tr_b16 v[140:141], v17 offset:40960
  ds_read_b64_tr_b16 v[142:143], v22 offset:40960
  ds_read_b64_tr_b16 v[204:205], v17 offset:45056
  ds_read_b64_tr_b16 v[206:207], v22 offset:45056
  s_waitcnt vmcnt(13)
  s_waitcnt lgkmcnt(0)
  s_barrier
  s_lshr_b32 s90, s2, 3
  s_lshl_b32 s90, s90, 2
  s_add_u32 s90, s90, s44
  s_mul_i32 s90, s90, 4096
  s_lshl_b32 s91, s45, 7
  s_sub_u32 s90, s90, s91
  s_add_u32 s90, s90, 384
  v_mul_u32_u24 v0, 1024, v1
  v_add_u32 v0, s90, v0
  s_mov_b64 exec, 0xf
  buffer_load_dword v21, v0, s[16:19], 0 offen
  s_mov_b64 exec, -1
  s_waitcnt vmcnt(13)
  s_add_u32 m0, s47, 65536
  s_add_u32 s48, s98, 8
  s_and_b32 s48, s48, 15
  s_mul_i32 s48, s48, 98304
  s_add_u32 s48, s48, 1024
  buffer_load_dwordx4 v3, s[12:15], s48 offen lds
  s_waitcnt vmcnt(13)
  s_add_u32 m0, s47, 69632
  s_add_u32 s48, s98, 8
  s_and_b32 s48, s48, 15
  s_mul_i32 s48, s48, 98304
  s_add_u32 s48, s48, 2048
  buffer_load_dwordx4 v3, s[12:15], s48 offen lds
  s_waitcnt vmcnt(13)
  s_add_u32 m0, s47, 73728
  s_add_u32 s48, s98, 9
  s_and_b32 s48, s48, 15
  s_mul_i32 s48, s48, 98304
  buffer_load_dwordx4 v3, s[12:15], s48 offen lds
  s_waitcnt vmcnt(13)
  s_add_u32 m0, s47, 77824
  s_add_u32 s48, s98, 9
  s_and_b32 s48, s48, 15
  s_mul_i32 s48, s48, 98304
  s_add_u32 s48, s48, 1024
  buffer_load_dwordx4 v3, s[12:15], s48 offen lds
  s_waitcnt vmcnt(13)
  s_add_u32 m0, s47, 98304
  s_add_u32 s48, s98, 9
  s_and_b32 s48, s48, 15
  s_mul_i32 s48, s48, 98304
  s_add_u32 s48, s48, 2048
  buffer_load_dwordx4 v3, s[12:15], s48 offen lds
  s_waitcnt vmcnt(13)
  s_add_u32 m0, s47, 57344
  s_add_u32 s48, s98, 14
  s_and_b32 s48, s48, 15
  s_mul_i32 s48, s48, 4096
  s_add_u32 s48, s48, s50
  buffer_load_dwordx4 v6, s[4:7], s48 offen sc1 lds
  ds_read_b64_tr_b16 v[144:145], v17 offset:53248
  ds_read_b64_tr_b16 v[146:147], v22 offset:53248
  ds_read_b64_tr_b16 v[208:209], v17 offset:57344
  ds_read_b64_tr_b16 v[210:211], v22 offset:57344
  ds_read_b64_tr_b16 v[148:149], v18 offset:0
  ds_read_b64_tr_b16 v[150:151], v23 offset:0
  ds_read_b64_tr_b16 v[212:213], v18 offset:4096
  ds_read_b64_tr_b16 v[214:215], v23 offset:4096
  s_waitcnt vmcnt(10)
  s_waitcnt lgkmcnt(0)
  s_barrier
  s_add_u32 s53, s92, 3968
  s_mov_b64 exec, 0xff
  buffer_load_dword v26, v28, s[4:7], s53 offen sc1
  s_mov_b64 exec, -1
  s_add_u32 m0, s47, 102400
  s_add_u32 s48, s98, 10
  s_and_b32 s48, s48, 15
  s_mul_i32 s48, s48, 98304
  buffer_load_dwordx4 v3, s[12:15], s48 offen lds
  s_add_u32 m0, s47, 106496
  s_add_u32 s48, s98, 10
  s_and_b32 s48, s48, 15
  s_mul_i32 s48, s48, 98304
  s_add_u32 s48, s48, 1024
  buffer_load_dwordx4 v3, s[12:15], s48 offen lds
  s_add_u32 m0, s47, 110592
  s_add_u32 s48, s98, 10
  s_and_b32 s48, s48, 15
  s_mul_i32 s48, s48, 98304
  s_add_u32 s48, s48, 2048
  buffer_load_dwordx4 v3, s[12:15], s48 offen lds
  s_waitcnt vmcnt(13)
  s_add_u32 m0, s47, 61440
  s_add_u32 s48, s98, 15
  s_and_b32 s48, s48, 15
  s_mul_i32 s48, s48, 4096
  s_add_u32 s48, s48, s50
  buffer_load_dwordx4 v6, s[4:7], s48 offen sc1 lds
  s_waitcnt vmcnt(13)
  s_add_u32 m0, s47, 114688
  s_add_u32 s48, s98, 11
  s_and_b32 s48, s48, 15
  s_mul_i32 s48, s48, 98304
  buffer_load_dwordx4 v3, s[12:15], s48 offen lds
  s_waitcnt vmcnt(13)
  s_add_u32 m0, s47, 118784
  s_add_u32 s48, s98, 11
  s_and_b32 s48, s48, 15
  s_mul_i32 s48, s48, 98304
  s_add_u32 s48, s48, 1024
  buffer_load_dwordx4 v3, s[12:15], s48 offen lds
  s_waitcnt vmcnt(13)
  s_add_u32 m0, s47, 122880
  s_add_u32 s48, s98, 11
  s_and_b32 s48, s48, 15
  s_nop 0
  s_mul_i32 s48, s48, 98304
  s_add_u32 s48, s48, 2048
  buffer_load_dwordx4 v3, s[12:15], s48 offen lds
  ds_read_b64_tr_b16 v[152:153], v18 offset:12288
  ds_read_b64_tr_b16 v[154:155], v23 offset:12288
  ds_read_b64_tr_b16 v[216:217], v18 offset:16384
  ds_read_b64_tr_b16 v[218:219], v23 offset:16384
  ds_read_b64_tr_b16 v[156:157], v18 offset:24576
  ds_read_b64_tr_b16 v[158:159], v23 offset:24576
  ds_read_b64_tr_b16 v[220:221], v17 offset:24576
  ds_read_b64_tr_b16 v[222:223], v22 offset:24576
  s_mul_i32 s83, s61, 4096
  s_add_u32 s83, s83, 81920
  v_add_u32 v46, s83, v28
  s_waitcnt vmcnt(9)
  s_waitcnt lgkmcnt(0)
  s_barrier
  s_add_u32 m0, s47, 126976
  s_add_u32 s48, s98, 12
  s_and_b32 s48, s48, 15
  s_mul_i32 s48, s48, 98304
  buffer_load_dwordx4 v3, s[12:15], s48 offen lds
  s_add_u32 m0, s47, 131072
  s_add_u32 s48, s98, 12
  s_and_b32 s48, s48, 15
  s_mul_i32 s48, s48, 98304
  s_add_u32 s48, s48, 1024
  buffer_load_dwordx4 v3, s[12:15], s48 offen lds
  s_add_u32 m0, s47, 135168
  s_add_u32 s48, s98, 12
  s_and_b32 s48, s48, 15
  s_mul_i32 s48, s48, 98304
  s_add_u32 s48, s48, 2048
  buffer_load_dwordx4 v3, s[12:15], s48 offen lds
  s_add_u32 m0, s47, 139264
  s_add_u32 s48, s98, 13
  s_and_b32 s48, s48, 15
  s_mul_i32 s48, s48, 98304
  buffer_load_dwordx4 v3, s[12:15], s48 offen lds
  s_add_u32 m0, s47, 143360
  s_add_u32 s48, s98, 13
  s_and_b32 s48, s48, 15
  s_mul_i32 s48, s48, 98304
  s_add_u32 s48, s48, 1024
  buffer_load_dwordx4 v3, s[12:15], s48 offen lds
  s_waitcnt vmcnt(13)
  s_add_u32 m0, s47, 147456
  s_add_u32 s48, s98, 13
  s_and_b32 s48, s48, 15
  s_mul_i32 s48, s48, 98304
  s_add_u32 s48, s48, 2048
  buffer_load_dwordx4 v3, s[12:15], s48 offen lds
  s_waitcnt vmcnt(13)
  s_add_u32 m0, s47, 151552
  s_add_u32 s48, s98, 14
  s_and_b32 s48, s48, 15
  s_mul_i32 s48, s48, 98304
  buffer_load_dwordx4 v3, s[12:15], s48 offen lds
  s_waitcnt vmcnt(13)
  s_add_u32 m0, s47, 20480
  s_add_u32 s48, s98, 0
  s_and_b32 s48, s48, 15
  s_mul_i32 s48, s48, 32768
  buffer_load_dwordx4 v2, s[16:19], s48 offen lds
  s_waitcnt vmcnt(13)
  s_add_u32 m0, s47, 24576
  s_add_u32 s48, s98, 1
  s_and_b32 s48, s48, 15
  s_mul_i32 s48, s48, 32768
  buffer_load_dwordx4 v2, s[16:19], s48 offen lds
  ds_read_b64_tr_b16 v[160:161], v17 offset:0
  ds_read_b64_tr_b16 v[162:163], v22 offset:0
  ds_read_b64_tr_b16 v[224:225], v17 offset:4096
  ds_read_b64_tr_b16 v[226:227], v22 offset:4096
  ds_read_b64_tr_b16 v[164:165], v17 offset:12288
  ds_read_b64_tr_b16 v[166:167], v22 offset:12288
  ds_read_b64_tr_b16 v[228:229], v17 offset:32768
  ds_read_b64_tr_b16 v[230:231], v22 offset:32768
  ds_read2st64_b32 v[88:89], v46 offset0:0 offset1:1
  ds_read2st64_b32 v[90:91], v46 offset0:2 offset1:3
  ds_read2st64_b32 v[92:93], v46 offset0:4 offset1:5
  ds_read2st64_b32 v[94:95], v46 offset0:6 offset1:7
  s_waitcnt vmcnt(9)
  s_waitcnt lgkmcnt(0)
  s_barrier
  s_add_u32 m0, s47, 65536
  s_add_u32 s48, s98, 14
  s_and_b32 s48, s48, 15
  s_mul_i32 s48, s48, 98304
  s_add_u32 s48, s48, 1024
  buffer_load_dwordx4 v3, s[12:15], s48 offen lds
  s_add_u32 m0, s47, 69632
  s_add_u32 s48, s98, 14
  s_and_b32 s48, s48, 15
  s_mul_i32 s48, s48, 98304
  s_add_u32 s48, s48, 2048
  buffer_load_dwordx4 v3, s[12:15], s48 offen lds
  s_add_u32 m0, s47, 73728
  s_add_u32 s48, s98, 15
  s_and_b32 s48, s48, 15
  s_mul_i32 s48, s48, 98304
  buffer_load_dwordx4 v3, s[12:15], s48 offen lds
  s_add_u32 m0, s47, 90112
  s_add_u32 s48, s98, 15
  s_and_b32 s48, s48, 15
  s_mul_i32 s48, s48, 98304
  s_add_u32 s48, s48, 1024
  buffer_load_dwordx4 v3, s[12:15], s48 offen lds
  s_add_u32 m0, s47, 94208
  s_add_u32 s48, s98, 15
  s_and_b32 s48, s48, 15
  s_mul_i32 s48, s48, 98304
  s_add_u32 s48, s48, 2048
  buffer_load_dwordx4 v3, s[12:15], s48 offen lds
  s_waitcnt vmcnt(13)
  s_add_u32 m0, s47, 28672
  s_add_u32 s48, s98, 2
  s_and_b32 s48, s48, 15
  s_mul_i32 s48, s48, 32768
  buffer_load_dwordx4 v2, s[16:19], s48 offen lds
  s_waitcnt vmcnt(13)
  s_add_u32 m0, s47, 32768
  s_add_u32 s48, s98, 3
  s_and_b32 s48, s48, 15
  s_mul_i32 s48, s48, 32768
  buffer_load_dwordx4 v2, s[16:19], s48 offen lds
  s_waitcnt vmcnt(13)
  s_add_u32 m0, s47, 155648
  s_add_u32 s48, s98, 4
  s_and_b32 s48, s48, 15
  s_mul_i32 s48, s48, 32768
  buffer_load_dwordx4 v2, s[16:19], s48 offen lds
  ds_read_b64_tr_b16 v[168:169], v17 offset:40960
  ds_read_b64_tr_b16 v[170:171], v22 offset:40960
  ds_read_b64_tr_b16 v[232:233], v17 offset:45056
  ds_read_b64_tr_b16 v[234:235], v22 offset:45056
  ds_read_b64_tr_b16 v[172:173], v17 offset:53248
  ds_read_b64_tr_b16 v[174:175], v22 offset:53248
  ds_read_b64_tr_b16 v[236:237], v17 offset:57344
  ds_read_b64_tr_b16 v[238:239], v22 offset:57344
  s_add_u32 s53, s92, 3968
  v_mov_b32 v30, v26
  s_cmp_eq_u32 s46, 0
  s_cselect_b32 s54, 1, s44
  s_cmp_lg_u32 s54, 0
  s_cbranch_scc1 HSK_85
  s_mov_b64 exec, 0xff
  v_cmp_ne_u32 vcc, 1, v26
  s_cbranch_vccz HPK_88
  s_mov_b32 s58, s52
HPL_86:
  buffer_load_dword v26, v28, s[4:7], s53 offen sc1
  s_add_u32 s58, s58, 1
  s_cmp_gt_u32 s58, 400000
  s_waitcnt vmcnt(0)
  s_cbranch_scc1 HPD_87
  v_cmp_ne_u32 vcc, 1, v26
  s_cbranch_vccnz HPL_86
  s_mov_b32 s58, 0
HPD_87:
  s_mov_b32 s52, s58
HPK_88:
  s_mov_b64 exec, -1
HSK_85:
  s_waitcnt vmcnt(11)
  s_waitcnt lgkmcnt(0)
  s_barrier
  v_lshlrev_b32 v64, 4, v1
  s_add_u32 m0, s47, 16384
  s_add_u32 s48, s59, 16384
  buffer_load_dwordx4 v6, s[4:7], s48 offen sc1 lds
  s_add_u32 m0, s47, 0
  s_add_u32 s48, s101, 0
  s_and_b32 s48, s48, 15
  s_mul_i32 s48, s48, 1024
  s_add_u32 s48, s48, s59
  buffer_load_dwordx4 v64, s[4:7], s48 offen sc1 lds
  s_add_u32 m0, s47, 4096
  s_add_u32 s48, s101, 4
  s_and_b32 s48, s48, 15
  s_mul_i32 s48, s48, 1024
  s_add_u32 s48, s48, s59
  buffer_load_dwordx4 v64, s[4:7], s48 offen sc1 lds
  s_waitcnt vmcnt(13)
  s_add_u32 m0, s47, 8192
  s_add_u32 s48, s101, 8
  s_and_b32 s48, s48, 15
  s_mul_i32 s48, s48, 1024
  s_add_u32 s48, s48, s59
  buffer_load_dwordx4 v64, s[4:7], s48 offen sc1 lds
  s_waitcnt vmcnt(13)
  s_add_u32 m0, s47, 12288
  s_add_u32 s48, s101, 12
  s_and_b32 s48, s48, 15
  s_mul_i32 s48, s48, 1024
  s_add_u32 s48, s48, s59
  buffer_load_dwordx4 v64, s[4:7], s48 offen sc1 lds
  s_waitcnt vmcnt(13)
  s_add_u32 m0, s47, 36864
  s_add_u32 s48, s98, 5
  s_and_b32 s48, s48, 15
  s_mul_i32 s48, s48, 32768
  buffer_load_dwordx4 v2, s[16:19], s48 offen lds
  s_waitcnt vmcnt(13)
  s_add_u32 m0, s47, 40960
  s_add_u32 s48, s98, 6
  s_and_b32 s48, s48, 15
  s_nop 0
  s_mul_i32 s48, s48, 32768
  buffer_load_dwordx4 v2, s[16:19], s48 offen lds
  ds_read_b64_tr_b16 v[176:177], v18 offset:0
  ds_read_b64_tr_b16 v[178:179], v23 offset:0
  ds_read_b64_tr_b16 v[240:241], v18 offset:4096
  ds_read_b64_tr_b16 v[242:243], v23 offset:4096
  ds_read_b64_tr_b16 v[180:181], v18 offset:12288
  ds_read_b64_tr_b16 v[182:183], v23 offset:12288
  ds_read_b64_tr_b16 v[244:245], v18 offset:16384
  ds_read_b64_tr_b16 v[246:247], v23 offset:16384
  ds_read2st64_b32 v[96:97], v46 offset0:8 offset1:9
  ds_read2st64_b32 v[98:99], v46 offset0:10 offset1:11
  ds_read2st64_b32 v[100:101], v46 offset0:12 offset1:13
  ds_read2st64_b32 v[102:103], v46 offset0:14 offset1:15
  s_waitcnt vmcnt(10)
  s_waitcnt lgkmcnt(0)
  s_barrier
  s_add_u32 m0, s47, 45056
  s_add_u32 s48, s98, 7
  s_and_b32 s48, s48, 15
  s_mul_i32 s48, s48, 32768
  buffer_load_dwordx4 v2, s[16:19], s48 offen lds
  s_add_u32 m0, s47, 49152
  s_add_u32 s48, s98, 8
  s_and_b32 s48, s48, 15
  s_mul_i32 s48, s48, 32768
  buffer_load_dwordx4 v2, s[16:19], s48 offen lds
  s_add_u32 m0, s47, 98304
  s_add_u32 s48, s98, 9
  s_and_b32 s48, s48, 15
  s_mul_i32 s48, s48, 32768
  buffer_load_dwordx4 v2, s[16:19], s48 offen lds
  s_add_u32 m0, s47, 102400
  s_add_u32 s48, s98, 10
  s_and_b32 s48, s48, 15
  s_mul_i32 s48, s48, 32768
  buffer_load_dwordx4 v2, s[16:19], s48 offen lds
  s_waitcnt vmcnt(13)
  s_add_u32 m0, s47, 106496
  s_add_u32 s48, s98, 11
  s_and_b32 s48, s48, 15
  s_mul_i32 s48, s48, 32768
  buffer_load_dwordx4 v2, s[16:19], s48 offen lds
  s_waitcnt vmcnt(13)
  s_add_u32 m0, s47, 110592
  s_add_u32 s48, s98, 12
  s_and_b32 s48, s48, 15
  s_mul_i32 s48, s48, 32768
  buffer_load_dwordx4 v2, s[16:19], s48 offen lds
  s_waitcnt vmcnt(13)
  s_add_u32 m0, s47, 114688
  s_add_u32 s48, s98, 13
  s_and_b32 s48, s48, 15
  s_mul_i32 s48, s48, 32768
  buffer_load_dwordx4 v2, s[16:19], s48 offen lds
  s_waitcnt vmcnt(13)
  s_add_u32 m0, s47, 118784
  s_add_u32 s48, s98, 14
  s_and_b32 s48, s48, 15
  s_mul_i32 s48, s48, 32768
  buffer_load_dwordx4 v2, s[16:19], s48 offen lds
  s_waitcnt vmcnt(13)
  s_add_u32 m0, s47, 122880
  s_add_u32 s48, s98, 15
  s_and_b32 s48, s48, 15
  s_mul_i32 s48, s48, 32768
  buffer_load_dwordx4 v2, s[16:19], s48 offen lds
  ds_read_b64_tr_b16 v[184:185], v17 offset:0
  ds_read_b64_tr_b16 v[186:187], v22 offset:0
  ds_read_b64_tr_b16 v[248:249], v17 offset:4096
  ds_read_b64_tr_b16 v[250:251], v22 offset:4096
  ds_read_b64_tr_b16 v[188:189], v17 offset:24576
  ds_read_b64_tr_b16 v[190:191], v22 offset:24576
  ds_read_b64_tr_b16 v[252:253], v17 offset:28672
  ds_read_b64_tr_b16 v[254:255], v22 offset:28672
  v_and_b32_e64 v87, 31, v1
  v_lshl_add_u32 v87, s61, 5, v87
  v_lshlrev_b32_e64 v87, 2, v87
  v_add_u32 v87, 159744, v87
  v_add_f32 v88, v88, v89
  v_add_f32 v90, v90, v91
  v_add_f32 v92, v92, v93
  v_add_f32 v94, v94, v95
  v_add_f32 v96, v96, v97
  v_add_f32 v98, v98, v99
  v_add_f32 v100, v100, v101
  v_add_f32 v102, v102, v103
  v_add_f32 v88, v88, v90
  v_add_f32 v92, v92, v94
  v_add_f32 v96, v96, v98
  v_add_f32 v100, v100, v102
  v_add_f32 v88, v88, v92
  v_add_f32 v96, v96, v100
  v_add_f32 v88, v88, v96
  v_mov_b32 v47, v88
  s_nop 1
  v_permlane32_swap_b32 v88, v47
  v_mul_f32 v104, 0xbb000000, v88
  v_mul_f32 v47, 0x3b000000, v47
  v_fma_f32 v47, -v104, v104, v47
  v_max_f32_e64 v47, 0, v47
  v_add_f32 v46, 0x3727c5ac, v47
  v_rsq_f32_e64 v108, v46
  ds_write_b32 v87, v104 offset:576
  ds_write_b32 v87, v108 offset:64
  s_waitcnt vmcnt(11)
  s_waitcnt lgkmcnt(0)
  s_barrier
  s_setprio 3
  v_and_b32 v29, 15, v1
  v_lshlrev_b32 v8, 4, v29
  v_lshrrev_b32_e64 v30, 4, v1
  v_lshl_add_u32 v8, v30, 8, v8
  ds_read_b128 v[32:35], v8 offset:0
  ds_read_b128 v[36:39], v8 offset:1024
  ds_read_b128 v[40:43], v8 offset:2048
  ds_read_b128 v[44:47], v8 offset:3072
  ds_read_b128 v[48:51], v8 offset:4096
  ds_read_b128 v[52:55], v8 offset:5120
  s_waitcnt lgkmcnt(5)
  v_mfma_f32_16x16x32_bf16 v[68:71], v[128:131], v[32:35], 0
  v_mfma_f32_16x16x32_bf16 v[72:75], v[32:35], v[192:195], 0
  ds_read_b128 v[56:59], v8 offset:6144
  v_lshrrev_b32 v29, 4, v1
  v_lshl_add_u32 v29, v29, 9, v122
  v_add_u32 v29, -143360, v29
  s_waitcnt lgkmcnt(5)
  v_mfma_f32_16x16x32_bf16 v[68:71], v[132:135], v[36:39], v[68:71]
  v_mfma_f32_16x16x32_bf16 v[72:75], v[36:39], v[196:199], v[72:75]
  ds_read_b128 v[60:63], v8 offset:7168
  ds_read2_b32 v[88:89], v29 offset0:0 offset1:16
  ds_read2_b32 v[90:91], v29 offset0:32 offset1:48
  ds_read2_b32 v[92:93], v29 offset0:64 offset1:80
  s_waitcnt lgkmcnt(8)
  v_mfma_f32_16x16x32_bf16 v[68:71], v[136:139], v[40:43], v[68:71]
PAD_23:
  s_cbranch_execz L_TRAMP
  s_nop 0
  v_mfma_f32_16x16x32_bf16 v[72:75], v[40:43], v[200:203], v[72:75]
  ds_read_b128 v[32:35], v8 offset:8192
  ds_read2_b32 v[94:95], v29 offset0:96 offset1:112
  s_waitcnt lgkmcnt(3)
  v_add_f32 v88, v88, v90
  s_waitcnt lgkmcnt(0)
  v_add_f32 v24, v92, v94
  v_mfma_f32_16x16x32_bf16 v[68:71], v[140:143], v[44:47], v[68:71]
  v_mfma_f32_16x16x32_bf16 v[72:75], v[44:47], v[204:207], v[72:75]
  ds_read_b128 v[36:39], v8 offset:9216
  v_add_f32 v24, v24, v88
  v_add_f32 v89, v89, v91
  v_add_f32_e64 v25, v93, v95
  v_mfma_f32_16x16x32_bf16 v[68:71], v[144:147], v[48:51], v[68:71]
  v_mfma_f32_16x16x32_bf16 v[72:75], v[48:51], v[208:211], v[72:75]
  ds_read_b128 v[40:43], v8 offset:10240
  v_add_f32 v25, v25, v89
  s_nop 1
  v_permlane32_swap_b32 v24, v25
  v_add_f32 v29, v24, v25
  v_mfma_f32_16x16x32_bf16 v[68:71], v[148:151], v[52:55], v[68:71]
  v_mfma_f32_16x16x32_bf16 v[72:75], v[52:55], v[212:215], v[72:75]
  ds_read_b128 v[44:47], v8 offset:11264
  v_mov_b32 v30, v29
  s_nop 1
  v_permlane16_swap_b32 v29, v30
  v_add_f32 v29, v29, v30
  v_mfma_f32_16x16x32_bf16 v[68:71], v[152:155], v[56:59], v[68:71]
  v_mfma_f32_16x16x32_bf16 v[72:75], v[56:59], v[216:219], v[72:75]
  ds_read_b128 v[48:51], v8 offset:12288
  v_mov_b32 v30, v29
  s_nop 1
  v_permlane32_swap_b32_e64 v29, v30
  v_mul_f32 v29, 0xbb000000, v29
  v_mfma_f32_16x16x32_bf16 v[68:71], v[156:159], v[60:63], v[68:71]
  v_mfma_f32_16x16x32_bf16 v[72:75], v[60:63], v[220:223], v[72:75]
  ds_read_b128 v[52:55], v8 offset:13312
  v_mul_f32 v30, 0x3b000000, v30
  v_fma_f32 v30, -v29, v29, v30
  v_max_f32_e64 v30, 0, v30
  v_mfma_f32_16x16x32_bf16 v[68:71], v[160:163], v[32:35], v[68:71]
  v_mfma_f32_16x16x32_bf16 v[72:75], v[32:35], v[224:227], v[72:75]
  ds_read_b128 v[56:59], v8 offset:14336
  v_add_f32 v30, 0x3727c5ac, v30
  v_rsq_f32_e64 v30, v30
  ds_write_b32 v122, v29 offset:512
  s_waitcnt lgkmcnt(6)
  v_mfma_f32_16x16x32_bf16 v[68:71], v[164:167], v[36:39], v[68:71]
  v_mfma_f32_16x16x32_bf16 v[72:75], v[36:39], v[228:231], v[72:75]
  ds_read_b128 v[60:63], v8 offset:15360
  ds_write_b32 v122, v30 offset:0
  v_mov_b32 v110, v30
  v_mov_b32 v111, v29
  s_waitcnt lgkmcnt(7)
  v_mfma_f32_16x16x32_bf16 v[68:71], v[168:171], v[40:43], v[68:71]
  v_mfma_f32_16x16x32_bf16 v[72:75], v[40:43], v[232:235], v[72:75]
  ds_read_b128 v[112:115], v120 offset:512
  ds_read_b128 v[116:119], v120 offset:0
  ds_read_b128 v[80:83], v126 offset:256
  s_waitcnt lgkmcnt(9)
  v_mfma_f32_16x16x32_bf16 v[68:71], v[172:175], v[44:47], v[68:71]
  v_mfma_f32_16x16x32_bf16 v[72:75], v[44:47], v[236:239], v[72:75]
  ds_read_b32 v84, v127 offset:512
  s_waitcnt lgkmcnt(9)
  v_mfma_f32_16x16x32_bf16 v[68:71], v[176:179], v[48:51], v[68:71]
  v_mfma_f32_16x16x32_bf16 v[72:75], v[48:51], v[240:243], v[72:75]
  s_waitcnt lgkmcnt(8)
  v_mfma_f32_16x16x32_bf16 v[68:71], v[180:183], v[52:55], v[68:71]
  v_mfma_f32_16x16x32_bf16 v[72:75], v[52:55], v[244:247], v[72:75]
  s_waitcnt lgkmcnt(7)
  v_mfma_f32_16x16x32_bf16 v[68:71], v[184:187], v[56:59], v[68:71]
  v_mfma_f32_16x16x32_bf16 v[72:75], v[56:59], v[248:251], v[72:75]
  s_waitcnt lgkmcnt(5)
  v_mfma_f32_16x16x32_bf16 v[68:71], v[188:191], v[60:63], v[68:71]
  v_mfma_f32_16x16x32_bf16 v[72:75], v[60:63], v[252:255], v[72:75]
  s_waitcnt lgkmcnt(1)
  s_nop 5
  v_pk_fma_f32 v[68:69], v[80:81], v[110:111], v[68:69] op_sel:[0,1,0] op_sel_hi:[1,1,1]
  s_waitcnt lgkmcnt(0)
  v_pk_fma_f32 v[72:73], v[112:113], v[84:85], v[72:73] op_sel_hi:[1,0,1]
  v_pk_fma_f32 v[70:71], v[82:83], v[110:111], v[70:71] op_sel:[0,1,0] op_sel_hi:[1,1,1]
  v_pk_fma_f32 v[74:75], v[114:115], v[84:85], v[74:75] op_sel_hi:[1,0,1]
  v_pk_mul_f32 v[68:69], v[68:69], v[110:111] op_sel_hi:[1,0]
  v_pk_mul_f32 v[72:73], v[72:73], v[116:117]
  v_pk_mul_f32 v[70:71], v[70:71], v[110:111] op_sel_hi:[1,0]
  v_pk_mul_f32 v[74:75], v[74:75], v[118:119]
  v_cvt_pk_bf16_f32 v64, v68, v69
  v_cvt_pk_bf16_f32 v65, v70, v71
  v_cvt_pk_bf16_f32 v66, v72, v73
  v_cvt_pk_bf16_f32 v67, v74, v75
  v_add_u32 v29, 77824, v6
  ds_write_b128 v29, v[64:67]
  s_setprio 0
  s_waitcnt vmcnt(0)
  s_waitcnt lgkmcnt(0)
  s_barrier
  s_lshr_b32 s90, s2, 3
  s_lshl_b32 s90, s90, 2
  s_add_u32 s90, s90, s44
  s_mul_i32 s90, s90, 4096
  s_lshl_b32 s91, s45, 7
  s_sub_u32 s90, s90, s91
  s_add_u32 s90, s90, 384
  v_mul_u32_u24 v0, 1024, v1
  v_add_u32 v0, s90, v0
  s_mov_b64 exec, 0xf
  buffer_load_dword v21, v0, s[20:23], 0 offen
  s_mov_b64 exec, -1
  s_lshr_b32 s90, s2, 3
  s_lshl_b32 s90, s90, 2
  s_add_u32 s90, s90, s44
  s_mul_i32 s90, s90, 4096
  s_lshl_b32 s91, s45, 7
  s_sub_u32 s90, s90, s91
  s_add_u32 s90, s90, 384
  v_mul_u32_u24 v0, 1024, v1
  v_add_u32 v0, s90, v0
  s_mov_b64 exec, 0xf
  buffer_load_dword v21, v0, s[24:27], 0 offen
  s_mov_b64 exec, -1
  s_add_u32 m0, s47, 65536
  s_add_u32 s48, s98, 0
  s_and_b32 s48, s48, 15
  s_mul_i32 s48, s48, 32768
  buffer_load_dwordx4 v2, s[20:23], s48 offen lds
  s_add_u32 m0, s47, 69632
  s_add_u32 s48, s98, 1
  s_and_b32 s48, s48, 15
  s_mul_i32 s48, s48, 32768
  buffer_load_dwordx4 v2, s[20:23], s48 offen lds
  s_add_u32 m0, s47, 73728
  s_add_u32 s48, s98, 2
  s_and_b32 s48, s48, 15
  s_mul_i32 s48, s48, 32768
  buffer_load_dwordx4 v2, s[20:23], s48 offen lds
  s_add_u32 m0, s47, 81920
  s_add_u32 s48, s98, 3
  s_and_b32 s48, s48, 15
  s_mul_i32 s48, s48, 32768
  buffer_load_dwordx4 v2, s[20:23], s48 offen lds
  s_add_u32 m0, s47, 86016
  s_add_u32 s48, s98, 4
  s_and_b32 s48, s48, 15
  s_mul_i32 s48, s48, 32768
  buffer_load_dwordx4 v2, s[20:23], s48 offen lds
  s_add_u32 m0, s47, 90112
  s_add_u32 s48, s98, 5
  s_and_b32 s48, s48, 15
  s_mul_i32 s48, s48, 32768
  buffer_load_dwordx4 v2, s[20:23], s48 offen lds
  s_add_u32 m0, s47, 94208
  s_add_u32 s48, s98, 6
  s_and_b32 s48, s48, 15
  s_mul_i32 s48, s48, 32768
  buffer_load_dwordx4 v2, s[20:23], s48 offen lds
  s_barrier
  s_add_u32 m0, s47, 77824
  s_add_u32 s48, s98, 7
  s_and_b32 s48, s48, 15
  s_mul_i32 s48, s48, 32768
  buffer_load_dwordx4 v2, s[20:23], s48 offen lds
  s_add_u32 m0, s47, 126976
  s_add_u32 s48, s98, 8
  s_and_b32 s48, s48, 15
  s_mul_i32 s48, s48, 32768
  buffer_load_dwordx4 v2, s[20:23], s48 offen lds
  s_add_u32 m0, s47, 131072
  s_add_u32 s48, s98, 9
  s_and_b32 s48, s48, 15
  s_mul_i32 s48, s48, 32768
  buffer_load_dwordx4 v2, s[20:23], s48 offen lds
  s_add_u32 m0, s47, 135168
  s_add_u32 s48, s98, 10
  s_and_b32 s48, s48, 15
  s_mul_i32 s48, s48, 32768
  buffer_load_dwordx4 v2, s[20:23], s48 offen lds
  s_add_u32 m0, s47, 139264
  s_add_u32 s48, s98, 11
  s_and_b32 s48, s48, 15
  s_mul_i32 s48, s48, 32768
  buffer_load_dwordx4 v2, s[20:23], s48 offen lds
  s_waitcnt vmcnt(13)
  s_add_u32 m0, s47, 143360
  s_add_u32 s48, s98, 12
  s_and_b32 s48, s48, 15
  s_mul_i32 s48, s48, 32768
  buffer_load_dwordx4 v2, s[20:23], s48 offen lds
  s_barrier
  s_cmp_lg_u32 s44, 0
  s_cbranch_scc1 HSK_89
  v_mov_b32 v29, 7
  v_mov_b32 v30, 0
  s_mov_b64 exec, 1
  s_cmp_eq_u32 s51, 0
  s_cbranch_scc1 HSL_90
  buffer_store_dword v29, v30, s[4:7], s57 offen
  s_branch HSD_91
HSL_90:
  buffer_wbl2 sc1
  s_waitcnt vmcnt(0)
  buffer_store_dword v29, v30, s[4:7], s57 offen sc1
HSD_91:
  s_mov_b64 exec, -1
HSK_89:
  s_mov_b64 exec, 0
  s_cmp_lg_u32 s44, 1
  s_cbranch_scc1 HPF_92
  s_call_b64 s[96:97], L_TRAMP
HPF_92:
  s_cmp_lg_u32 s44, 2
  s_cbranch_scc1 HPF_93
  s_call_b64 s[96:97], L_TRAMP
HPF_93:
  s_cmp_lg_u32 s44, 3
  s_cbranch_scc1 HPF_94
  s_call_b64 s[96:97], L_TRAMP
HPF_94:
  s_mov_b64 exec, -1
  s_cmp_lg_u32 s44, 0
  s_cbranch_scc1 HSK_95
  s_mov_b64 exec, 0xff
  s_mov_b32 s58, s52
HPL_96:
  buffer_load_dword v29, v28, s[4:7], s92 offen sc1
  s_add_u32 s58, s58, 1
  s_cmp_gt_u32 s58, 400000
  s_waitcnt vmcnt(0)
  s_cbranch_scc1 HPD_97
  v_cmp_gt_u32 vcc, 7, v29
  s_cbranch_vccnz HPL_96
  s_mov_b32 s58, 0
HPD_97:
  s_mov_b32 s52, s58
HPK_98:
  s_mov_b64 exec, -1
  s_cmp_lg_u32 s51, 0
  s_cbranch_scc1 HFA_99
  buffer_inv sc1
  s_waitcnt vmcnt(0)
HFA_99:
HSK_95:
  s_waitcnt vmcnt(8)
  s_barrier
  s_add_u32 m0, s47, 8192
  s_add_u32 s48, s98, 2
  s_and_b32 s48, s48, 15
  s_mul_i32 s48, s48, 4096
  s_add_u32 s48, s48, s49
  buffer_load_dwordx4 v6, s[4:7], s48 offen sc1 lds
  s_add_u32 m0, s47, 12288
  s_add_u32 s48, s98, 3
  s_and_b32 s48, s48, 15
  s_mul_i32 s48, s48, 4096
  s_add_u32 s48, s48, s49
  buffer_load_dwordx4 v6, s[4:7], s48 offen sc1 lds
  s_waitcnt vmcnt(6)
  s_barrier
  s_add_u32 m0, s47, 16384
  s_add_u32 s48, s98, 4
  s_and_b32 s48, s48, 15
  s_mul_i32 s48, s48, 4096
  s_add_u32 s48, s48, s49
  buffer_load_dwordx4 v6, s[4:7], s48 offen sc1 lds
  s_add_u32 m0, s47, 20480
  s_add_u32 s48, s98, 5
  s_and_b32 s48, s48, 15
  s_mul_i32 s48, s48, 4096
  s_add_u32 s48, s48, s49
  buffer_load_dwordx4 v6, s[4:7], s48 offen sc1 lds
  s_add_u32 m0, s47, 24576
  s_add_u32 s48, s98, 6
  s_and_b32 s48, s48, 15
  s_mul_i32 s48, s48, 4096
  s_add_u32 s48, s48, s49
  buffer_load_dwordx4 v6, s[4:7], s48 offen sc1 lds
  s_add_u32 m0, s47, 28672
  s_add_u32 s48, s98, 7
  s_and_b32 s48, s48, 15
  s_mul_i32 s48, s48, 4096
  s_add_u32 s48, s48, s49
  buffer_load_dwordx4 v6, s[4:7], s48 offen sc1 lds
  s_add_u32 m0, s47, 32768
  s_add_u32 s48, s98, 8
  s_and_b32 s48, s48, 15
  s_mul_i32 s48, s48, 4096
  s_add_u32 s48, s48, s49
  buffer_load_dwordx4 v6, s[4:7], s48 offen sc1 lds
  s_add_u32 m0, s47, 36864
  s_add_u32 s48, s98, 9
  s_and_b32 s48, s48, 15
  s_mul_i32 s48, s48, 4096
  s_add_u32 s48, s48, s49
  buffer_load_dwordx4 v6, s[4:7], s48 offen sc1 lds
  s_add_u32 m0, s47, 40960
  s_add_u32 s48, s98, 10
  s_and_b32 s48, s48, 15
  s_mul_i32 s48, s48, 4096
  s_add_u32 s48, s48, s49
  buffer_load_dwordx4 v6, s[4:7], s48 offen sc1 lds
  s_waitcnt vmcnt(7)
  s_barrier
  s_add_u32 m0, s47, 45056
  s_add_u32 s48, s98, 11
  s_and_b32 s48, s48, 15
  s_mul_i32 s48, s48, 4096
  s_add_u32 s48, s48, s49
  buffer_load_dwordx4 v6, s[4:7], s48 offen sc1 lds
  s_add_u32 m0, s47, 49152
  s_add_u32 s48, s98, 12
  s_and_b32 s48, s48, 15
  s_mul_i32 s48, s48, 4096
  s_add_u32 s48, s48, s49
  buffer_load_dwordx4 v6, s[4:7], s48 offen sc1 lds
  s_waitcnt vmcnt(7)
  s_barrier
  s_add_u32 m0, s47, 53248
  s_add_u32 s48, s98, 13
  s_and_b32 s48, s48, 15
  s_mul_i32 s48, s48, 4096
  s_add_u32 s48, s48, s49
  buffer_load_dwordx4 v6, s[4:7], s48 offen sc1 lds
  s_add_u32 m0, s47, 57344
  s_add_u32 s48, s98, 14
  s_and_b32 s48, s48, 15
  s_mul_i32 s48, s48, 4096
  s_add_u32 s48, s48, s49
  buffer_load_dwordx4 v6, s[4:7], s48 offen sc1 lds
  s_waitcnt vmcnt(7)
  s_barrier
  s_add_u32 m0, s47, 61440
  s_add_u32 s48, s98, 15
  s_and_b32 s48, s48, 15
  s_mul_i32 s48, s48, 4096
  s_add_u32 s48, s48, s49
  buffer_load_dwordx4 v6, s[4:7], s48 offen sc1 lds
  s_add_u32 m0, s47, 98304
  s_add_u32 s48, s98, 13
  s_and_b32 s48, s48, 15
  s_mul_i32 s48, s48, 32768
  buffer_load_dwordx4 v2, s[20:23], s48 offen lds
  s_add_u32 m0, s47, 102400
  s_add_u32 s48, s98, 14
  s_and_b32 s48, s48, 15
  s_mul_i32 s48, s48, 32768
  buffer_load_dwordx4 v2, s[20:23], s48 offen lds
  s_waitcnt vmcnt(8)
  s_barrier
  s_add_u32 m0, s47, 106496
  s_add_u32 s48, s98, 15
  s_and_b32 s48, s48, 15
  s_mul_i32 s48, s48, 32768
  buffer_load_dwordx4 v2, s[20:23], s48 offen lds
  s_add_u32 m0, s47, 110592
  s_mov_b32 s48, 0
  buffer_load_dwordx4 v2, s[24:27], s48 offen lds
  s_waitcnt vmcnt(8)
  s_barrier
  s_nop 0
  s_add_u32 m0, s47, 114688
  s_mov_b32 s48, 32768
  buffer_load_dwordx4 v2, s[24:27], s48 offen lds
  s_add_u32 m0, s47, 118784
  s_mov_b32 s48, 65536
  buffer_load_dwordx4 v2, s[24:27], s48 offen lds
  s_waitcnt vmcnt(8)
  s_barrier
  s_add_u32 m0, s47, 122880
  s_mov_b32 s48, 98304
  buffer_load_dwordx4 v2, s[24:27], s48 offen lds
  s_waitcnt vmcnt(8)
  s_add_u32 m0, s47, 147456
  s_mov_b32 s48, 131072
  buffer_load_dwordx4 v2, s[24:27], s48 offen lds
  s_waitcnt vmcnt(8)
  s_barrier
  s_add_u32 m0, s47, 151552
  s_mov_b32 s48, 163840
  buffer_load_dwordx4 v2, s[24:27], s48 offen lds
  s_waitcnt vmcnt(8)
  s_add_u32 m0, s47, 155648
  s_mov_b32 s48, 196608
  buffer_load_dwordx4 v2, s[24:27], s48 offen lds
  s_barrier
  s_waitcnt vmcnt(4)
  s_barrier
  s_cmp_lg_u32 s44, 0
  s_cbranch_scc1 HSK_100
  v_mov_b32 v29, 8
  v_mov_b32 v30, 0
  s_mov_b64 exec, 1
  s_cmp_eq_u32 s51, 0
  s_cbranch_scc1 HSL_101
  buffer_store_dword v29, v30, s[4:7], s57 offen
  s_branch HSD_102
HSL_101:
  buffer_wbl2 sc1
  s_waitcnt vmcnt(0)
  buffer_store_dword v29, v30, s[4:7], s57 offen sc1
HSD_102:
  s_mov_b64 exec, -1
HSK_100:
  s_mov_b64 exec, 0
  s_cmp_lg_u32 s44, 1
  s_cbranch_scc1 HPF_103
  s_call_b64 s[96:97], L_TRAMP
HPF_103:
  s_cmp_lg_u32 s44, 2
  s_cbranch_scc1 HPF_104
  s_call_b64 s[96:97], L_TRAMP
HPF_104:
  s_cmp_lg_u32 s44, 3
  s_cbranch_scc1 HPF_105
  s_call_b64 s[96:97], PAD_12
HPF_105:
  s_mov_b64 exec, -1
  s_cmp_lg_u32 s44, 0
  s_cbranch_scc1 HSK_106
  s_mov_b64 exec, 0xff
  s_mov_b32 s58, s52
HPL_107:
  buffer_load_dword v29, v28, s[4:7], s92 offen sc1
  s_add_u32 s58, s58, 1
  s_cmp_gt_u32 s58, 400000
  s_waitcnt vmcnt(0)
  s_cbranch_scc1 HPD_108
  v_cmp_gt_u32 vcc, 8, v29
  s_cbranch_vccnz HPL_107
  s_mov_b32 s58, 0
HPD_108:
  s_mov_b32 s52, s58
HPK_109:
  s_mov_b64 exec, -1
  s_cmp_lg_u32 s51, 0
  s_cbranch_scc1 HFA_110
  buffer_inv sc1
  s_waitcnt vmcnt(0)
HFA_110:
HSK_106:
  s_waitcnt vmcnt(2)
  s_barrier
  s_add_u32 m0, s47, 8192
  s_add_u32 s48, s98, 2
  s_and_b32 s48, s48, 15
  s_mul_i32 s48, s48, 4096
  s_add_u32 s48, s48, s50
  buffer_load_dwordx4 v6, s[4:7], s48 offen sc1 lds
  s_add_u32 m0, s47, 12288
  s_add_u32 s48, s98, 3
  s_and_b32 s48, s48, 15
  s_mul_i32 s48, s48, 4096
  s_add_u32 s48, s48, s50
  buffer_load_dwordx4 v6, s[4:7], s48 offen sc1 lds
  s_waitcnt vmcnt(2)
  s_barrier
  s_add_u32 m0, s47, 65536
  s_add_u32 s48, s80, 0
  s_nop 0
  buffer_load_dwordx4 v6, s[4:7], s48 offen sc1 lds
  s_add_u32 m0, s47, 69632
  s_add_u32 s48, s80, 4096
  buffer_load_dwordx4 v6, s[4:7], s48 offen sc1 lds
  s_add_u32 m0, s47, 16384
  s_add_u32 s48, s98, 4
  s_and_b32 s48, s48, 15
  s_mul_i32 s48, s48, 4096
  s_add_u32 s48, s48, s50
  buffer_load_dwordx4 v6, s[4:7], s48 offen sc1 lds
  s_add_u32 m0, s47, 20480
  s_add_u32 s48, s98, 5
  s_and_b32 s48, s48, 15
  s_mul_i32 s48, s48, 4096
  s_add_u32 s48, s48, s50
  buffer_load_dwordx4 v6, s[4:7], s48 offen sc1 lds
  s_add_u32 m0, s47, 24576
  s_add_u32 s48, s98, 6
  s_and_b32 s48, s48, 15
  s_mul_i32 s48, s48, 4096
  s_add_u32 s48, s48, s50
  buffer_load_dwordx4 v6, s[4:7], s48 offen sc1 lds
  s_add_u32 m0, s47, 28672
  s_add_u32 s48, s98, 7
  s_and_b32 s48, s48, 15
  s_mul_i32 s48, s48, 4096
  s_add_u32 s48, s48, s50
  buffer_load_dwordx4 v6, s[4:7], s48 offen sc1 lds
  s_add_u32 m0, s47, 32768
  s_add_u32 s48, s98, 8
  s_and_b32 s48, s48, 15
  s_mul_i32 s48, s48, 4096
  s_add_u32 s48, s48, s50
  buffer_load_dwordx4 v6, s[4:7], s48 offen sc1 lds
  s_waitcnt vmcnt(7)
  s_barrier
  s_add_u32 m0, s47, 36864
  s_add_u32 s48, s98, 9
  s_and_b32 s48, s48, 15
  s_mul_i32 s48, s48, 4096
  s_add_u32 s48, s48, s50
  buffer_load_dwordx4 v6, s[4:7], s48 offen sc1 lds
  s_add_u32 m0, s47, 40960
  s_add_u32 s48, s98, 10
  s_and_b32 s48, s48, 15
  s_mul_i32 s48, s48, 4096
  s_add_u32 s48, s48, s50
  buffer_load_dwordx4 v6, s[4:7], s48 offen sc1 lds
  s_add_u32 m0, s47, 45056
  s_add_u32 s48, s98, 11
  s_and_b32 s48, s48, 15
  s_mul_i32 s48, s48, 4096
  s_add_u32 s48, s48, s50
  buffer_load_dwordx4 v6, s[4:7], s48 offen sc1 lds
  s_add_u32 m0, s47, 49152
  s_add_u32 s48, s98, 12
  s_and_b32 s48, s48, 15
  s_mul_i32 s48, s48, 4096
  s_add_u32 s48, s48, s50
  buffer_load_dwordx4 v6, s[4:7], s48 offen sc1 lds
  s_waitcnt vmcnt(7)
  s_barrier
  s_add_u32 m0, s47, 53248
  s_add_u32 s48, s98, 13
  s_and_b32 s48, s48, 15
  s_mul_i32 s48, s48, 4096
  s_add_u32 s48, s48, s50
  buffer_load_dwordx4 v6, s[4:7], s48 offen sc1 lds
  s_add_u32 m0, s47, 57344
  s_add_u32 s48, s98, 14
  s_and_b32 s48, s48, 15
  s_mul_i32 s48, s48, 4096
  s_add_u32 s48, s48, s50
  buffer_load_dwordx4 v6, s[4:7], s48 offen sc1 lds
  s_add_u32 m0, s47, 61440
  s_add_u32 s48, s98, 15
  s_and_b32 s48, s48, 15
  s_mul_i32 s48, s48, 4096
  s_add_u32 s48, s48, s50
  buffer_load_dwordx4 v6, s[4:7], s48 offen sc1 lds
  s_waitcnt vmcnt(8)
  s_barrier
  s_add_u32 m0, s47, 73728
  s_mov_b32 s48, 229376
  buffer_load_dwordx4 v2, s[24:27], s48 offen lds
  s_add_u32 m0, s47, 77824
  s_mov_b32 s48, 262144
  buffer_load_dwordx4 v2, s[24:27], s48 offen lds
  s_add_u32 m0, s47, 81920
  s_mov_b32 s48, 294912
  buffer_load_dwordx4 v2, s[24:27], s48 offen lds
  s_waitcnt vmcnt(9)
  s_barrier
  s_add_u32 m0, s47, 69632
  s_mov_b32 s48, 327680
  buffer_load_dwordx4 v2, s[24:27], s48 offen lds
  s_add_u32 m0, s47, 86016
  s_mov_b32 s48, 360448
  buffer_load_dwordx4 v2, s[24:27], s48 offen lds
  s_add_u32 m0, s47, 90112
  s_mov_b32 s48, 393216
  buffer_load_dwordx4 v2, s[24:27], s48 offen lds
  s_waitcnt vmcnt(10)
  s_barrier
  s_add_u32 m0, s47, 94208
  s_mov_b32 s48, 425984
  buffer_load_dwordx4 v2, s[24:27], s48 offen lds
  s_add_u32 m0, s47, 98304
  s_mov_b32 s48, 458752
  buffer_load_dwordx4 v2, s[24:27], s48 offen lds
  s_add_u32 m0, s47, 102400
  s_mov_b32 s48, 491520
  buffer_load_dwordx4 v2, s[24:27], s48 offen lds
  s_waitcnt vmcnt(11)
  s_barrier
  s_waitcnt vmcnt(8)
  s_add_u32 m0, s47, 106496
  s_add_u32 s48, s98, 0
  s_and_b32 s48, s48, 15
  s_mul_i32 s48, s48, 114688
  s_add_u32 s48, s48, s55
  buffer_load_dwordx4 v4, s[28:31], s48 offen lds
  s_barrier
  s_waitcnt vmcnt(8)
  s_add_u32 m0, s47, 126976
  s_add_u32 s48, s98, 1
  s_and_b32 s48, s48, 15
  s_mul_i32 s48, s48, 114688
  s_add_u32 s48, s48, s55
  buffer_load_dwordx4 v4, s[28:31], s48 offen lds
  s_waitcnt vmcnt(8)
  s_add_u32 m0, s47, 131072
  s_add_u32 s48, s98, 2
  s_and_b32 s48, s48, 15
  s_mul_i32 s48, s48, 114688
  s_add_u32 s48, s48, s55
  buffer_load_dwordx4 v4, s[28:31], s48 offen lds
  s_waitcnt vmcnt(8)
  s_add_u32 m0, s47, 135168
  s_add_u32 s48, s98, 3
  s_and_b32 s48, s48, 15
  s_mul_i32 s48, s48, 114688
  s_add_u32 s48, s48, s55
  buffer_load_dwordx4 v4, s[28:31], s48 offen lds
  s_waitcnt vmcnt(4)
  s_barrier
  s_waitcnt vmcnt(3)
  s_barrier
  s_cmp_lg_u32 s44, 0
  s_cbranch_scc1 HSK_111
  v_mov_b32 v29, 9
  v_mov_b32 v30, 0
  s_mov_b64 exec, 1
  s_cmp_eq_u32 s51, 0
  s_cbranch_scc1 HSL_112
  buffer_store_dword v29, v30, s[4:7], s57 offen
  s_branch HSD_113
HSL_112:
  buffer_wbl2 sc1
  s_waitcnt vmcnt(0)
  buffer_store_dword v29, v30, s[4:7], s57 offen sc1
HSD_113:
  s_mov_b64 exec, -1
HSK_111:
  s_mov_b64 exec, 0
  s_cmp_lg_u32 s44, 1
  s_cbranch_scc1 HPF_114
  s_call_b64 s[96:97], PAD_24
HPF_114:
  s_cmp_lg_u32 s44, 2
  s_cbranch_scc1 HPF_115
  s_call_b64 s[96:97], PAD_13
HPF_115:
  s_cmp_lg_u32 s44, 3
  s_cbranch_scc1 HPF_116
  s_call_b64 s[96:97], PAD_14
HPF_116:
  s_mov_b64 exec, -1
  s_add_u32 s53, s61, 1
  s_lshl_b32 s53, s53, 4
  v_and_b32 v29, 15, v1
  v_lshrrev_b32 v30, 4, v1
  v_cmp_gt_u32 s[62:63], s53, v1
  v_lshlrev_b32 v31, 4, v1
  s_lshl_b32 s54, s46, 11
  s_lshl_b32 s69, s44, 9
  s_add_u32 s54, s54, s69
  s_add_u32 s54, s54, 65536
  s_mul_i32 s69, s64, 31
  s_cmp_eq_u32 s46, s69
  s_cselect_b32 s54, 2130706432, s54
  v_add_u32_e64 v31, s54, v31
  v_mov_b32 v44, 2130706432
  v_cndmask_b32 v44, v44, v31, s[62:63]
  v_lshl_add_u32 v29, s44, 4, v29
  v_mul_u32_u24 v29, 1088, v29
  s_sub_u32 s54, 1, s61
  s_cmp_eq_u32 s64, 0
  s_cselect_b32 s54, s54, 66
  v_add_u32_e64 v30, s54, v30
  v_lshl_add_u32 v45, v30, 4, v29
  s_cmp_lg_u32 s44, 0
  s_cbranch_scc1 HSK_117
  s_mov_b64 exec, 0xff
  s_mov_b32 s58, s52
HPL_118:
  buffer_load_dword v29, v28, s[4:7], s92 offen sc1
  s_add_u32 s58, s58, 1
  s_cmp_gt_u32 s58, 400000
  s_waitcnt vmcnt(0)
  s_cbranch_scc1 HPD_119
  v_cmp_gt_u32 vcc, 9, v29
  s_cbranch_vccnz HPL_118
  s_mov_b32 s58, 0
HPD_119:
  s_mov_b32 s52, s58
HPK_120:
  s_mov_b64 exec, -1
  s_cmp_lg_u32 s51, 0
  s_cbranch_scc1 HFA_121
  buffer_inv sc1
  s_waitcnt vmcnt(0)
HFA_121:
HSK_117:
  s_waitcnt vmcnt(0)
  s_barrier
  s_add_u32 m0, s73, 32
  s_add_u32 s48, s49, 0
  buffer_load_dwordx4 v6, s[4:7], s48 offen sc1 lds
  s_add_u32 m0, s73, 17440
  s_add_u32 s48, s49, 16384
  buffer_load_dwordx4 v6, s[4:7], s48 offen sc1 lds
  s_add_u32 m0, s73, 4384
  s_add_u32 s48, s49, 4096
  buffer_load_dwordx4 v6, s[4:7], s48 offen sc1 lds
  s_add_u32 m0, s73, 21792
  s_add_u32 s48, s49, 20480
  buffer_load_dwordx4 v6, s[4:7], s48 offen sc1 lds
  s_add_u32 m0, s73, 8736
  s_add_u32 s48, s49, 8192
  buffer_load_dwordx4 v6, s[4:7], s48 offen sc1 lds
  s_add_u32 m0, s73, 26144
  s_add_u32 s48, s49, 24576
  buffer_load_dwordx4 v6, s[4:7], s48 offen sc1 lds
  s_add_u32 m0, s73, 13088
  s_add_u32 s48, s49, 12288
  buffer_load_dwordx4 v6, s[4:7], s48 offen sc1 lds
  s_add_u32 m0, s73, 30496
  s_add_u32 s48, s49, 28672
  buffer_load_dwordx4 v6, s[4:7], s48 offen sc1 lds
  s_mov_b32 s70, 65536
  buffer_load_dwordx4 v[40:43], v44, s[4:7], s70 offen sc1
  s_add_u32 m0, s73, 34848
  s_add_u32 s48, s49, 32768
  buffer_load_dwordx4 v6, s[4:7], s48 offen sc1 lds
  s_add_u32 m0, s73, 52256
  s_add_u32 s48, s49, 49152
  buffer_load_dwordx4 v6, s[4:7], s48 offen sc1 lds
  s_waitcnt vmcnt(7)
  s_barrier
  s_add_u32 m0, s73, 39200
  s_add_u32 s48, s49, 36864
  buffer_load_dwordx4 v6, s[4:7], s48 offen sc1 lds
  s_add_u32 m0, s73, 56608
PAD_24:
  s_cbranch_execz L_TRAMP
  s_nop 0
  s_add_u32 s48, s49, 53248
  buffer_load_dwordx4 v6, s[4:7], s48 offen sc1 lds
  s_add_u32 m0, s73, 43552
  s_add_u32 s48, s49, 40960
  buffer_load_dwordx4 v6, s[4:7], s48 offen sc1 lds
  s_add_u32 m0, s73, 60960
  s_add_u32 s48, s49, 57344
  buffer_load_dwordx4 v6, s[4:7], s48 offen sc1 lds
  s_add_u32 m0, s73, 47904
  s_add_u32 s48, s49, 45056
  buffer_load_dwordx4 v6, s[4:7], s48 offen sc1 lds
  s_waitcnt vmcnt(8)
  s_barrier
  s_add_u32 m0, s73, 65312
  s_add_u32 s48, s49, 61440
  buffer_load_dwordx4 v6, s[4:7], s48 offen sc1 lds
  s_add_u32 m0, s47, 69632
  s_add_u32 s48, s98, 4
  s_and_b32 s48, s48, 15
  s_mul_i32 s48, s48, 114688
  s_add_u32 s48, s48, s55
  buffer_load_dwordx4 v4, s[28:31], s48 offen lds
  s_add_u32 m0, s47, 73728
  s_add_u32 s48, s98, 5
  s_and_b32 s48, s48, 15
  s_mul_i32 s48, s48, 114688
  s_add_u32 s48, s48, s55
  buffer_load_dwordx4 v4, s[28:31], s48 offen lds
  s_add_u32 m0, s47, 77824
  s_add_u32 s48, s98, 6
  s_and_b32 s48, s48, 15
  s_mul_i32 s48, s48, 114688
  s_add_u32 s48, s48, s55
  buffer_load_dwordx4 v4, s[28:31], s48 offen lds
  s_add_u32 m0, s47, 81920
  s_add_u32 s48, s98, 7
  s_and_b32 s48, s48, 15
  s_mul_i32 s48, s48, 114688
  s_add_u32 s48, s48, s55
  buffer_load_dwordx4 v4, s[28:31], s48 offen lds
  s_add_u32 m0, s47, 86016
  s_add_u32 s48, s98, 8
  s_and_b32 s48, s48, 15
  s_mul_i32 s48, s48, 114688
  s_add_u32 s48, s48, s55
  buffer_load_dwordx4 v4, s[28:31], s48 offen lds
  s_waitcnt vmcnt(9)
  s_barrier
  s_add_u32 m0, s47, 90112
  s_add_u32 s48, s98, 9
  s_and_b32 s48, s48, 15
  s_mul_i32 s48, s48, 114688
  s_add_u32 s48, s48, s55
  buffer_load_dwordx4 v4, s[28:31], s48 offen lds
  s_add_u32 m0, s47, 94208
  s_add_u32 s48, s98, 10
  s_and_b32 s48, s48, 15
  s_mul_i32 s48, s48, 114688
  s_add_u32 s48, s48, s55
  buffer_load_dwordx4 v4, s[28:31], s48 offen lds
  s_add_u32 m0, s47, 98304
  s_add_u32 s48, s98, 11
  s_and_b32 s48, s48, 15
  s_mul_i32 s48, s48, 114688
  s_add_u32 s48, s48, s55
  buffer_load_dwordx4 v4, s[28:31], s48 offen lds
  s_waitcnt vmcnt(8)
  s_barrier
  s_add_u32 m0, s47, 102400
  s_add_u32 s48, s98, 12
  s_and_b32 s48, s48, 15
  s_mul_i32 s48, s48, 114688
  s_add_u32 s48, s48, s55
  buffer_load_dwordx4 v4, s[28:31], s48 offen lds
  v_max_u32 v29, v40, v41
  v_max3_u32 v29, v29, v42, v43
  v_cmp_eq_u32 vcc, -1, v29
  s_cbranch_vccz HPK_124
  s_mov_b32 s58, s52
HPL_122:
  buffer_load_dwordx4 v[40:43], v44, s[4:7], s70 offen sc1
  s_add_u32 s58, s58, 1
  s_cmp_gt_u32 s58, 400000
  s_waitcnt vmcnt(0)
  s_cbranch_scc1 HPD_123
  v_max_u32_e64 v29, v40, v41
  v_max3_u32 v29, v29, v42, v43
  v_cmp_eq_u32 vcc, -1, v29
  s_cbranch_vccnz HPL_122
  s_mov_b32 s58, 0
HPD_123:
  s_mov_b32 s52, s58
HPK_124:
  s_cmp_eq_u32 s61, 1
  s_cselect_b32 exec_lo, -1, 0xffff
  s_mov_b32 exec_hi, 0
  ds_write_b128 v45, v[40:43]
  s_mov_b64 exec, -1
  s_waitcnt lgkmcnt(0)
  s_barrier
  s_lshr_b32 s90, s2, 3
  s_lshl_b32 s90, s90, 2
  s_add_u32 s90, s90, s44
  s_mul_i32 s90, s90, 4096
  s_lshl_b32 s91, s45, 7
  s_sub_u32 s90, s90, s91
  s_add_u32 s90, s90, 1311104
  v_mul_u32_u24 v0, 1024, v1
  v_add_u32 v0, s90, v0
  s_mov_b64 exec, 0xf
  buffer_load_dword v21, v0, s[32:35], 0 offen
  s_mov_b64 exec, -1
  s_add_u32 m0, s47, 110592
  s_add_u32 s48, s98, 13
  s_and_b32 s48, s48, 15
  s_mul_i32 s48, s48, 114688
  s_add_u32 s48, s48, s55
  buffer_load_dwordx4 v4, s[28:31], s48 offen lds
  s_add_u32 m0, s47, 114688
  s_add_u32 s48, s98, 14
  s_and_b32 s48, s48, 15
  s_mul_i32 s48, s48, 114688
  s_add_u32 s48, s48, s55
  buffer_load_dwordx4 v4, s[28:31], s48 offen lds
  s_add_u32 m0, s47, 118784
  s_add_u32 s48, s98, 15
  s_and_b32 s48, s48, 15
  s_mul_i32 s48, s48, 114688
  s_add_u32 s48, s48, s55
  buffer_load_dwordx4 v4, s[28:31], s48 offen lds
  s_add_u32 m0, s47, 122880
  s_add_u32 s48, s98, 0
  s_and_b32 s48, s48, 15
  s_mul_i32 s48, s48, 114688
  s_add_u32 s48, s48, 128
  s_add_u32 s48, s48, s55
  buffer_load_dwordx4 v4, s[28:31], s48 offen lds
  s_waitcnt vmcnt(13)
  s_barrier
  s_waitcnt vmcnt(6)
  s_barrier
  s_add_u32 m0, s47, 139264
  s_add_u32 s48, s98, 1
  s_and_b32 s48, s48, 15
  s_mul_i32 s48, s48, 114688
  s_add_u32 s48, s48, 128
  s_add_u32 s48, s48, s55
  buffer_load_dwordx4 v4, s[28:31], s48 offen lds
  s_add_u32 m0, s47, 143360
  s_add_u32 s48, s98, 2
  s_and_b32 s48, s48, 15
  s_mul_i32 s48, s48, 114688
  s_add_u32 s48, s48, 128
  s_add_u32 s48, s48, s55
  buffer_load_dwordx4 v4, s[28:31], s48 offen lds
  s_add_u32 m0, s47, 147456
  s_add_u32 s48, s98, 3
  s_and_b32 s48, s48, 15
  s_mul_i32 s48, s48, 114688
  s_add_u32 s48, s48, 128
  s_add_u32 s48, s48, s55
  buffer_load_dwordx4 v4, s[28:31], s48 offen lds
  s_waitcnt vmcnt(5)
  s_barrier
  s_cmp_lg_u32 s44, 0
  s_cbranch_scc1 HSK_125
  v_mov_b32 v29, 10
  v_mov_b32 v30, 0
  s_mov_b64 exec, 1
  s_cmp_eq_u32 s51, 0
  s_cbranch_scc1 HSL_126
  buffer_store_dword v29, v30, s[4:7], s57 offen
  s_branch HSD_127
HSL_126:
  buffer_wbl2 sc1
  s_waitcnt vmcnt(0)
  buffer_store_dword v29, v30, s[4:7], s57 offen sc1
HSD_127:
  s_mov_b64 exec, -1
HSK_125:
  s_mov_b64 exec, 0
  s_cmp_lg_u32 s44, 1
  s_cbranch_scc1 HPF_128
  s_call_b64 s[96:97], PAD_15
HPF_128:
  s_cmp_lg_u32 s44, 2
  s_cbranch_scc1 HPF_129
  s_call_b64 s[96:97], PAD_25
HPF_129:
  s_cmp_lg_u32 s44, 3
  s_cbranch_scc1 HPF_130
  s_call_b64 s[96:97], PAD_16
HPF_130:
  s_mov_b64 exec, -1
  s_cmp_lg_u32 s44, 0
  s_cbranch_scc1 HSK_131
  s_mov_b64 exec, 0xff
  s_mov_b32 s58, s52
HPL_132:
  buffer_load_dword v29, v28, s[4:7], s92 offen sc1
  s_add_u32 s58, s58, 1
  s_cmp_gt_u32 s58, 400000
  s_waitcnt vmcnt(0)
  s_cbranch_scc1 HPD_133
  v_cmp_gt_u32 vcc, 10, v29
  s_cbranch_vccnz HPL_132
  s_mov_b32 s58, 0
HPD_133:
  s_mov_b32 s52, s58
HPK_134:
  s_mov_b64 exec, -1
  s_cmp_lg_u32 s51, 0
  s_cbranch_scc1 HFA_135
  buffer_inv sc1
  s_waitcnt vmcnt(0)
HFA_135:
HSK_131:
  s_waitcnt vmcnt(3)
  s_barrier
  s_add_u32 m0, s47, 8192
  s_add_u32 s48, s98, 2
  s_and_b32 s48, s48, 15
  s_mul_i32 s48, s48, 4096
  s_add_u32 s48, s48, s50
  buffer_load_dwordx4 v6, s[4:7], s48 offen sc1 lds
  s_add_u32 m0, s47, 12288
  s_add_u32 s48, s98, 3
  s_and_b32 s48, s48, 15
  s_mul_i32 s48, s48, 4096
  s_add_u32 s48, s48, s50
  buffer_load_dwordx4 v6, s[4:7], s48 offen sc1 lds
  s_add_u32 m0, s47, 65536
  s_add_u32 s48, s80, 0
  buffer_load_dwordx4 v6, s[4:7], s48 offen sc1 lds
  s_add_u32 m0, s47, 151552
  s_add_u32 s48, s80, 4096
  buffer_load_dwordx4 v6, s[4:7], s48 offen sc1 lds
  s_waitcnt vmcnt(4)
  s_barrier
  s_add_u32 m0, s47, 16384
  s_add_u32 s48, s98, 4
  s_and_b32 s48, s48, 15
  s_mul_i32 s48, s48, 4096
  s_add_u32 s48, s48, s50
  buffer_load_dwordx4 v6, s[4:7], s48 offen sc1 lds
  s_add_u32 m0, s47, 20480
  s_add_u32 s48, s98, 5
  s_and_b32 s48, s48, 15
  s_mul_i32 s48, s48, 4096
  s_add_u32 s48, s48, s50
  buffer_load_dwordx4 v6, s[4:7], s48 offen sc1 lds
  s_add_u32 m0, s47, 24576
  s_add_u32 s48, s98, 6
  s_and_b32 s48, s48, 15
  s_mul_i32 s48, s48, 4096
  s_add_u32 s48, s48, s50
  buffer_load_dwordx4 v6, s[4:7], s48 offen sc1 lds
  s_add_u32 m0, s47, 28672
  s_add_u32 s48, s98, 7
  s_and_b32 s48, s48, 15
  s_mul_i32 s48, s48, 4096
  s_add_u32 s48, s48, s50
  buffer_load_dwordx4 v6, s[4:7], s48 offen sc1 lds
  s_add_u32 m0, s47, 32768
  s_add_u32 s48, s98, 8
  s_and_b32 s48, s48, 15
  s_mul_i32 s48, s48, 4096
  s_add_u32 s48, s48, s50
  buffer_load_dwordx4 v6, s[4:7], s48 offen sc1 lds
  s_waitcnt vmcnt(7)
  s_barrier
  s_add_u32 m0, s47, 36864
  s_add_u32 s48, s98, 9
  s_and_b32 s48, s48, 15
  s_mul_i32 s48, s48, 4096
  s_add_u32 s48, s48, s50
  buffer_load_dwordx4 v6, s[4:7], s48 offen sc1 lds
  s_add_u32 m0, s47, 40960
  s_add_u32 s48, s98, 10
  s_and_b32 s48, s48, 15
  s_mul_i32 s48, s48, 4096
  s_add_u32 s48, s48, s50
  buffer_load_dwordx4 v6, s[4:7], s48 offen sc1 lds
  s_add_u32 m0, s47, 45056
  s_add_u32 s48, s98, 11
  s_and_b32 s48, s48, 15
  s_mul_i32 s48, s48, 4096
  s_add_u32 s48, s48, s50
  buffer_load_dwordx4 v6, s[4:7], s48 offen sc1 lds
  s_add_u32 m0, s47, 49152
  s_add_u32 s48, s98, 12
  s_and_b32 s48, s48, 15
  s_mul_i32 s48, s48, 4096
  s_add_u32 s48, s48, s50
  buffer_load_dwordx4 v6, s[4:7], s48 offen sc1 lds
  s_waitcnt vmcnt(7)
  s_barrier
  s_add_u32 m0, s47, 53248
  s_add_u32 s48, s98, 13
  s_and_b32 s48, s48, 15
  s_mul_i32 s48, s48, 4096
  s_add_u32 s48, s48, s50
  buffer_load_dwordx4 v6, s[4:7], s48 offen sc1 lds
  s_add_u32 m0, s47, 57344
  s_add_u32 s48, s98, 14
  s_and_b32 s48, s48, 15
  s_mul_i32 s48, s48, 4096
  s_add_u32 s48, s48, s50
  buffer_load_dwordx4 v6, s[4:7], s48 offen sc1 lds
  s_add_u32 m0, s47, 61440
  s_add_u32 s48, s98, 15
  s_and_b32 s48, s48, 15
  s_mul_i32 s48, s48, 4096
  s_add_u32 s48, s48, s50
  buffer_load_dwordx4 v6, s[4:7], s48 offen sc1 lds
  s_waitcnt vmcnt(8)
  s_barrier
  s_add_u32 m0, s47, 69632
  s_add_u32 s48, s98, 4
  s_and_b32 s48, s48, 15
  s_mul_i32 s48, s48, 114688
  s_add_u32 s48, s48, 128
  s_add_u32 s48, s48, s55
  buffer_load_dwordx4 v4, s[28:31], s48 offen lds
  s_add_u32 m0, s47, 106496
  s_add_u32 s48, s98, 5
  s_and_b32 s48, s48, 15
  s_mul_i32 s48, s48, 114688
  s_add_u32 s48, s48, 128
  s_add_u32 s48, s48, s55
  buffer_load_dwordx4 v4, s[28:31], s48 offen lds
  s_add_u32 m0, s47, 126976
  s_add_u32 s48, s98, 6
  s_and_b32 s48, s48, 15
  s_mul_i32 s48, s48, 114688
  s_add_u32 s48, s48, 128
  s_add_u32 s48, s48, s55
  buffer_load_dwordx4 v4, s[28:31], s48 offen lds
  s_add_u32 m0, s47, 131072
  s_add_u32 s48, s98, 7
  s_and_b32 s48, s48, 15
  s_mul_i32 s48, s48, 114688
  s_add_u32 s48, s48, 128
  s_add_u32 s48, s48, s55
  buffer_load_dwordx4 v4, s[28:31], s48 offen lds
  s_waitcnt vmcnt(10)
  s_barrier
  s_add_u32 m0, s47, 65536
  s_add_u32 s48, s98, 8
  s_and_b32 s48, s48, 15
  s_mul_i32 s48, s48, 114688
  s_add_u32 s48, s48, 128
  s_add_u32 s48, s48, s55
  buffer_load_dwordx4 v4, s[28:31], s48 offen lds
  s_add_u32 m0, s47, 73728
  s_add_u32 s48, s98, 9
  s_and_b32 s48, s48, 15
  s_mul_i32 s48, s48, 114688
  s_add_u32 s48, s48, 128
  s_add_u32 s48, s48, s55
  buffer_load_dwordx4 v4, s[28:31], s48 offen lds
  s_add_u32 m0, s47, 77824
  s_add_u32 s48, s98, 10
  s_and_b32 s48, s48, 15
  s_mul_i32 s48, s48, 114688
  s_add_u32 s48, s48, 128
  s_add_u32 s48, s48, s55
  buffer_load_dwordx4 v4, s[28:31], s48 offen lds
  s_waitcnt vmcnt(11)
  s_barrier
  s_add_u32 m0, s47, 28672
  s_add_u32 s48, s98, 11
  s_and_b32 s48, s48, 15
  s_mul_i32 s48, s48, 114688
  s_add_u32 s48, s48, 128
  s_add_u32 s48, s48, s55
  buffer_load_dwordx4 v4, s[28:31], s48 offen lds
  s_waitcnt vmcnt(10)
  s_barrier
  s_add_u32 m0, s47, 32768
  s_add_u32 s48, s98, 12
  s_and_b32 s48, s48, 15
  s_mul_i32 s48, s48, 114688
  s_add_u32 s48, s48, 128
  s_add_u32 s48, s48, s55
  buffer_load_dwordx4 v4, s[28:31], s48 offen lds
  s_add_u32 m0, s47, 36864
  s_add_u32 s48, s98, 13
  s_and_b32 s48, s48, 15
  s_mul_i32 s48, s48, 114688
  s_add_u32 s48, s48, 128
  s_add_u32 s48, s48, s55
  buffer_load_dwordx4 v4, s[28:31], s48 offen lds
  s_waitcnt vmcnt(10)
  s_barrier
  s_add_u32 m0, s47, 40960
  s_add_u32 s48, s98, 14
  s_and_b32 s48, s48, 15
  s_mul_i32 s48, s48, 114688
  s_add_u32 s48, s48, 128
  s_add_u32 s48, s48, s55
  buffer_load_dwordx4 v4, s[28:31], s48 offen lds
  s_add_u32 m0, s47, 45056
  s_add_u32 s48, s98, 15
  s_and_b32 s48, s48, 15
  s_mul_i32 s48, s48, 114688
  s_add_u32 s48, s48, 128
  s_add_u32 s48, s48, s55
  buffer_load_dwordx4 v4, s[28:31], s48 offen lds
  s_add_u32 m0, s47, 49152
  s_add_u32 s48, s98, 0
  s_and_b32 s48, s48, 15
  s_mul_i32 s48, s48, 114688
  s_add_u32 s48, s48, 256
  s_add_u32 s48, s48, s55
  buffer_load_dwordx4 v4, s[28:31], s48 offen lds
  s_barrier
  s_add_u32 m0, s47, 53248
  s_add_u32 s48, s98, 1
  s_and_b32 s48, s48, 15
  s_mul_i32 s48, s48, 114688
  s_add_u32 s48, s48, 256
  s_add_u32 s48, s48, s55
  buffer_load_dwordx4 v4, s[28:31], s48 offen lds
  s_waitcnt vmcnt(13)
  s_add_u32 m0, s47, 57344
  s_add_u32 s48, s98, 2
  s_and_b32 s48, s48, 15
  s_mul_i32 s48, s48, 114688
  s_add_u32 s48, s48, 256
  s_add_u32 s48, s48, s55
  buffer_load_dwordx4 v4, s[28:31], s48 offen lds
  s_waitcnt vmcnt(13)
  s_add_u32 m0, s47, 61440
  s_add_u32 s48, s98, 3
  s_and_b32 s48, s48, 15
  s_mul_i32 s48, s48, 114688
  s_add_u32 s48, s48, 256
  s_add_u32 s48, s48, s55
  buffer_load_dwordx4 v4, s[28:31], s48 offen lds
  s_waitcnt vmcnt(13)
  s_add_u32 m0, s47, 81920
  s_add_u32 s48, s98, 4
  s_and_b32 s48, s48, 15
  s_mul_i32 s48, s48, 114688
  s_add_u32 s48, s48, 256
  s_add_u32 s48, s48, s55
  buffer_load_dwordx4 v4, s[28:31], s48 offen lds
  s_waitcnt vmcnt(13)
  s_barrier
  s_add_u32 m0, s47, 86016
  s_add_u32 s48, s98, 5
  s_and_b32 s48, s48, 15
  s_mul_i32 s48, s48, 114688
  s_add_u32 s48, s48, 256
  s_add_u32 s48, s48, s55
  buffer_load_dwordx4 v4, s[28:31], s48 offen lds
  s_waitcnt vmcnt(13)
  s_add_u32 m0, s47, 90112
  s_add_u32 s48, s98, 6
  s_and_b32 s48, s48, 15
  s_mul_i32 s48, s48, 114688
  s_add_u32 s48, s48, 256
  s_add_u32 s48, s48, s55
  buffer_load_dwordx4 v4, s[28:31], s48 offen lds
  s_waitcnt vmcnt(13)
  s_add_u32 m0, s47, 94208
  s_add_u32 s48, s98, 7
  s_and_b32 s48, s48, 15
  s_mul_i32 s48, s48, 114688
  s_add_u32 s48, s48, 256
  s_add_u32 s48, s48, s55
  buffer_load_dwordx4 v4, s[28:31], s48 offen lds
  s_waitcnt vmcnt(13)
  s_add_u32 m0, s47, 98304
  s_add_u32 s48, s98, 8
  s_and_b32 s48, s48, 15
  s_mul_i32 s48, s48, 114688
  s_add_u32 s48, s48, 256
  s_add_u32 s48, s48, s55
  buffer_load_dwordx4 v4, s[28:31], s48 offen lds
  s_waitcnt vmcnt(13)
  s_add_u32 m0, s47, 102400
  s_add_u32 s48, s98, 9
  s_and_b32 s48, s48, 15
  s_mul_i32 s48, s48, 114688
  s_add_u32 s48, s48, 256
  s_add_u32 s48, s48, s55
  buffer_load_dwordx4 v4, s[28:31], s48 offen lds
  s_barrier
  s_waitcnt vmcnt(13)
  s_add_u32 m0, s47, 69632
  s_add_u32 s48, s98, 10
  s_and_b32 s48, s48, 15
  s_mul_i32 s48, s48, 114688
  s_add_u32 s48, s48, 256
  s_add_u32 s48, s48, s55
  buffer_load_dwordx4 v4, s[28:31], s48 offen lds
  s_waitcnt vmcnt(13)
  s_add_u32 m0, s47, 106496
  s_add_u32 s48, s98, 11
  s_and_b32 s48, s48, 15
  s_mul_i32 s48, s48, 114688
  s_add_u32 s48, s48, 256
  s_add_u32 s48, s48, s55
  buffer_load_dwordx4 v4, s[28:31], s48 offen lds
  s_waitcnt vmcnt(13)
  s_add_u32 m0, s47, 110592
  s_add_u32 s48, s98, 12
  s_and_b32 s48, s48, 15
  s_mul_i32 s48, s48, 114688
  s_add_u32 s48, s48, 256
  s_add_u32 s48, s48, s55
  buffer_load_dwordx4 v4, s[28:31], s48 offen lds
  s_waitcnt vmcnt(13)
  s_add_u32 m0, s47, 114688
  s_add_u32 s48, s98, 13
  s_and_b32 s48, s48, 15
  s_mul_i32 s48, s48, 114688
  s_add_u32 s48, s48, 256
  s_add_u32 s48, s48, s55
  buffer_load_dwordx4 v4, s[28:31], s48 offen lds
  s_waitcnt vmcnt(13)
  s_add_u32 m0, s47, 118784
  s_add_u32 s48, s98, 14
  s_and_b32 s48, s48, 15
  s_mul_i32 s48, s48, 114688
  s_add_u32 s48, s48, 256
  s_add_u32 s48, s48, s55
  buffer_load_dwordx4 v4, s[28:31], s48 offen lds
  s_barrier
  s_lshr_b32 s90, s2, 3
  s_lshl_b32 s90, s90, 2
  s_add_u32 s90, s90, s44
  s_mul_i32 s90, s90, 10240
  s_lshl_b32 s91, s45, 7
  s_sub_u32 s90, s90, s91
  s_add_u32 s90, s90, 384
  v_mul_u32_u24 v0, 1024, v1
  v_add_u32 v0, s90, v0
  s_mov_b64 exec, 0x3ff
  buffer_load_dword v21, v0, s[32:35], 0 offen
  s_mov_b64 exec, -1
  s_waitcnt vmcnt(13)
  s_add_u32 m0, s47, 65536
  s_add_u32 s48, s98, 15
  s_and_b32 s48, s48, 15
  s_mul_i32 s48, s48, 114688
  s_add_u32 s48, s48, 256
  s_add_u32 s48, s48, s55
  buffer_load_dwordx4 v4, s[28:31], s48 offen lds
  s_waitcnt vmcnt(13)
  s_add_u32 m0, s47, 73728
  s_add_u32 s48, s45, 0
  s_and_b32 s48, s48, 7
  s_mul_i32 s48, s48, 229376
  s_add_u32 s48, s48, s56
  buffer_load_dwordx4 v5, s[28:31], s48 offen lds
  s_waitcnt vmcnt(10)
  s_barrier
  s_add_u32 m0, s47, 77824
  s_add_u32 s48, s45, 1
  s_and_b32 s48, s48, 7
  s_mul_i32 s48, s48, 229376
  s_add_u32 s48, s48, s56
  buffer_load_dwordx4 v5, s[28:31], s48 offen lds
  s_waitcnt vmcnt(7)
  s_barrier
  s_add_u32 m0, s47, 122880
  s_add_u32 s48, s45, 2
  s_and_b32 s48, s48, 7
  s_mul_i32 s48, s48, 229376
  s_add_u32 s48, s48, s56
  buffer_load_dwordx4 v5, s[28:31], s48 offen lds
  s_add_u32 m0, s47, 126976
  s_add_u32 s48, s45, 3
  s_and_b32 s48, s48, 7
  s_mul_i32 s48, s48, 229376
  s_add_u32 s48, s48, s56
  buffer_load_dwordx4 v5, s[28:31], s48 offen lds
  s_add_u32 m0, s47, 28672
  s_add_u32 s48, s99, 40
  s_sub_u32 s100, s48, 56
  s_cselect_b32 s48, s48, s100
  s_mul_i32 s48, s48, 32768
  buffer_load_dwordx4 v2, s[32:35], s48 offen lds
  s_waitcnt vmcnt(7)
  s_barrier
  s_add_u32 m0, s47, 81920
  s_add_u32 s48, s45, 4
  s_and_b32 s48, s48, 7
  s_mul_i32 s48, s48, 229376
  s_add_u32 s48, s48, s56
  buffer_load_dwordx4 v5, s[28:31], s48 offen lds
  s_add_u32 m0, s47, 86016
  s_add_u32 s48, s45, 5
  s_and_b32 s48, s48, 7
  s_mul_i32 s48, s48, 229376
  s_add_u32 s48, s48, s56
  buffer_load_dwordx4 v5, s[28:31], s48 offen lds
  s_waitcnt vmcnt(7)
  s_barrier
  s_add_u32 m0, s47, 69632
  s_add_u32 s48, s45, 6
  s_and_b32 s48, s48, 7
  s_mul_i32 s48, s48, 229376
  s_add_u32 s48, s48, s56
  buffer_load_dwordx4 v5, s[28:31], s48 offen lds
  s_add_u32 m0, s47, 90112
  s_add_u32 s48, s45, 7
  s_and_b32 s48, s48, 7
  s_mul_i32 s48, s48, 229376
  s_add_u32 s48, s48, s56
  buffer_load_dwordx4 v5, s[28:31], s48 offen lds
  s_add_u32 m0, s47, 40960
  s_add_u32 s48, s99, 41
  s_sub_u32 s100, s48, 56
  s_cselect_b32 s48, s48, s100
  s_mul_i32 s48, s48, 32768
  buffer_load_dwordx4 v2, s[32:35], s48 offen lds
  s_add_u32 m0, s47, 45056
  s_add_u32 s48, s99, 42
  s_sub_u32 s100, s48, 56
  s_cselect_b32 s48, s48, s100
  s_mul_i32 s48, s48, 32768
  buffer_load_dwordx4 v2, s[32:35], s48 offen lds
  s_add_u32 m0, s47, 49152
  s_add_u32 s48, s99, 43
  s_sub_u32 s100, s48, 56
  s_cselect_b32 s48, s48, s100
  s_mul_i32 s48, s48, 32768
  buffer_load_dwordx4 v2, s[32:35], s48 offen lds
  s_add_u32 m0, s47, 53248
  s_add_u32 s48, s99, 44
  s_sub_u32 s100, s48, 56
  s_cselect_b32 s48, s48, s100
  s_mul_i32 s48, s48, 32768
  buffer_load_dwordx4 v2, s[32:35], s48 offen lds
  s_add_u32 m0, s47, 57344
  s_add_u32 s48, s99, 45
  s_sub_u32 s100, s48, 56
  s_cselect_b32 s48, s48, s100
  s_mul_i32 s48, s48, 32768
  buffer_load_dwordx4 v2, s[32:35], s48 offen lds
  s_waitcnt vmcnt(13)
  s_add_u32 m0, s47, 61440
  s_add_u32 s48, s99, 46
  s_sub_u32 s100, s48, 56
  s_cselect_b32 s48, s48, s100
  s_mul_i32 s48, s48, 32768
  buffer_load_dwordx4 v2, s[32:35], s48 offen lds
  s_waitcnt vmcnt(13)
  s_add_u32 m0, s47, 94208
  s_add_u32 s48, s99, 47
  s_sub_u32 s100, s48, 56
  s_cselect_b32 s48, s48, s100
  s_mul_i32 s48, s48, 32768
  buffer_load_dwordx4 v2, s[32:35], s48 offen lds
  s_waitcnt vmcnt(13)
  s_add_u32 m0, s47, 98304
  s_add_u32 s48, s99, 48
  s_sub_u32 s100, s48, 56
  s_cselect_b32 s48, s48, s100
  s_mul_i32 s48, s48, 32768
  buffer_load_dwordx4 v2, s[32:35], s48 offen lds
  s_waitcnt vmcnt(8)
  s_barrier
  s_add_u32 m0, s47, 65536
  s_add_u32 s48, s99, 49
  s_sub_u32 s100, s48, 56
  s_cselect_b32 s48, s48, s100
  s_mul_i32 s48, s48, 32768
  buffer_load_dwordx4 v2, s[32:35], s48 offen lds
  s_add_u32 m0, s47, 102400
  s_add_u32 s48, s99, 50
  s_sub_u32 s100, s48, 56
  s_cselect_b32 s48, s48, s100
  s_mul_i32 s48, s48, 32768
  buffer_load_dwordx4 v2, s[32:35], s48 offen lds
  s_add_u32 m0, s47, 106496
  s_add_u32 s48, s99, 51
  s_sub_u32 s100, s48, 56
  s_cselect_b32 s48, s48, s100
  s_mul_i32 s48, s48, 32768
  buffer_load_dwordx4 v2, s[32:35], s48 offen lds
  s_add_u32 m0, s47, 110592
  s_add_u32 s48, s99, 52
  s_sub_u32 s100, s48, 56
  s_cselect_b32 s48, s48, s100
  s_mul_i32 s48, s48, 32768
  buffer_load_dwordx4 v2, s[32:35], s48 offen lds
  s_add_u32 m0, s47, 114688
  s_add_u32 s48, s99, 53
  s_sub_u32 s100, s48, 56
  s_cselect_b32 s48, s48, s100
  s_mul_i32 s48, s48, 32768
  buffer_load_dwordx4 v2, s[32:35], s48 offen lds
  s_add_u32 m0, s47, 118784
  s_add_u32 s48, s99, 54
  s_sub_u32 s100, s48, 56
  s_cselect_b32 s48, s48, s100
  s_mul_i32 s48, s48, 32768
  buffer_load_dwordx4 v2, s[32:35], s48 offen lds
  s_waitcnt vmcnt(13)
  s_add_u32 m0, s47, 131072
  s_add_u32 s48, s99, 55
  s_sub_u32 s100, s48, 56
  s_cselect_b32 s48, s48, s100
  s_mul_i32 s48, s48, 32768
  buffer_load_dwordx4 v2, s[32:35], s48 offen lds
  s_waitcnt vmcnt(13)
  s_add_u32 m0, s47, 135168
  s_add_u32 s48, s99, 0
  s_sub_u32 s100, s48, 56
  s_cselect_b32 s48, s48, s100
PAD_25:
  s_cbranch_execz L_TRAMP
  s_nop 0
  s_mul_i32 s48, s48, 32768
  buffer_load_dwordx4 v2, s[32:35], s48 offen lds
  s_waitcnt vmcnt(13)
  s_add_u32 m0, s47, 139264
  s_add_u32 s48, s99, 1
  s_sub_u32 s100, s48, 56
  s_cselect_b32 s48, s48, s100
  s_mul_i32 s48, s48, 32768
  buffer_load_dwordx4 v2, s[32:35], s48 offen lds
  s_waitcnt vmcnt(13)
  s_add_u32 m0, s47, 143360
  s_add_u32 s48, s99, 2
  s_sub_u32 s100, s48, 56
  s_cselect_b32 s48, s48, s100
  s_mul_i32 s48, s48, 32768
  buffer_load_dwordx4 v2, s[32:35], s48 offen lds
  s_waitcnt vmcnt(13)
  s_add_u32 m0, s47, 147456
  s_add_u32 s48, s99, 3
  s_sub_u32 s100, s48, 56
  s_cselect_b32 s48, s48, s100
  s_mul_i32 s48, s48, 32768
  buffer_load_dwordx4 v2, s[32:35], s48 offen lds
  s_waitcnt vmcnt(13)
  s_add_u32 m0, s47, 151552
  s_add_u32 s48, s99, 4
  s_sub_u32 s100, s48, 56
  s_cselect_b32 s48, s48, s100
  s_mul_i32 s48, s48, 32768
  buffer_load_dwordx4 v2, s[32:35], s48 offen lds
  s_waitcnt vmcnt(13)
  s_add_u32 m0, s47, 155648
  s_add_u32 s48, s99, 5
  s_sub_u32 s100, s48, 56
  s_cselect_b32 s48, s48, s100
  s_mul_i32 s48, s48, 32768
  buffer_load_dwordx4 v2, s[32:35], s48 offen lds
  s_waitcnt vmcnt(10)
  s_barrier
  s_waitcnt vmcnt(8)
  s_add_u32 m0, s47, 69632
  s_add_u32 s48, s99, 6
  s_sub_u32 s100, s48, 56
  s_cselect_b32 s48, s48, s100
  s_mul_i32 s48, s48, 32768
  buffer_load_dwordx4 v2, s[32:35], s48 offen lds
  s_waitcnt vmcnt(8)
  s_add_u32 m0, s47, 73728
  s_add_u32 s48, s99, 7
  s_sub_u32 s100, s48, 56
  s_cselect_b32 s48, s48, s100
  s_mul_i32 s48, s48, 32768
  buffer_load_dwordx4 v2, s[32:35], s48 offen lds
  s_waitcnt vmcnt(8)
  s_add_u32 m0, s47, 77824
  s_add_u32 s48, s99, 8
  s_sub_u32 s100, s48, 56
  s_cselect_b32 s48, s48, s100
  s_mul_i32 s48, s48, 32768
  buffer_load_dwordx4 v2, s[32:35], s48 offen lds
  s_waitcnt vmcnt(8)
  s_add_u32 m0, s47, 81920
  s_add_u32 s48, s99, 9
  s_sub_u32 s100, s48, 56
  s_cselect_b32 s48, s48, s100
  s_mul_i32 s48, s48, 32768
  buffer_load_dwordx4 v2, s[32:35], s48 offen lds
  s_waitcnt vmcnt(8)
  s_add_u32 m0, s47, 86016
  s_add_u32 s48, s99, 10
  s_sub_u32 s100, s48, 56
  s_cselect_b32 s48, s48, s100
  s_mul_i32 s48, s48, 32768
  buffer_load_dwordx4 v2, s[32:35], s48 offen lds
  s_waitcnt vmcnt(8)
  s_add_u32 m0, s47, 90112
  s_add_u32 s48, s99, 11
  s_sub_u32 s100, s48, 56
  s_cselect_b32 s48, s48, s100
  s_mul_i32 s48, s48, 32768
  buffer_load_dwordx4 v2, s[32:35], s48 offen lds
  s_waitcnt vmcnt(8)
  s_add_u32 m0, s47, 122880
  s_add_u32 s48, s99, 12
  s_sub_u32 s100, s48, 56
  s_cselect_b32 s48, s48, s100
  s_mul_i32 s48, s48, 32768
  buffer_load_dwordx4 v2, s[32:35], s48 offen lds
  s_waitcnt vmcnt(8)
  s_add_u32 m0, s47, 126976
  s_add_u32 s48, s99, 13
  s_sub_u32 s100, s48, 56
  s_cselect_b32 s48, s48, s100
  s_mul_i32 s48, s48, 32768
  buffer_load_dwordx4 v2, s[32:35], s48 offen lds
  s_barrier
  s_add_u32 m0, s47, 32768
  s_add_u32 s48, s99, 14
  s_sub_u32 s100, s48, 56
  s_cselect_b32 s48, s48, s100
  s_mul_i32 s48, s48, 32768
  buffer_load_dwordx4 v2, s[32:35], s48 offen lds
  s_add_u32 m0, s47, 36864
  s_add_u32 s48, s99, 15
  s_sub_u32 s100, s48, 56
  s_cselect_b32 s48, s48, s100
  s_mul_i32 s48, s48, 32768
  buffer_load_dwordx4 v2, s[32:35], s48 offen lds
  s_waitcnt vmcnt(9)
  s_barrier
  s_cmp_lg_u32 s44, 0
  s_cbranch_scc1 HSK_136
  v_mov_b32 v29, 11
  v_mov_b32 v30, 0
  s_mov_b64 exec, 1
  s_cmp_eq_u32 s51, 0
  s_cbranch_scc1 HSL_137
  buffer_store_dword v29, v30, s[4:7], s57 offen
  s_branch HSD_138
HSL_137:
  buffer_wbl2 sc1
  s_waitcnt vmcnt(0)
  buffer_store_dword v29, v30, s[4:7], s57 offen sc1
HSD_138:
  s_mov_b64 exec, -1
HSK_136:
  s_mov_b64 exec, 0
  s_cmp_lg_u32 s44, 1
  s_cbranch_scc1 HPF_139
  s_call_b64 s[96:97], L_TRAMP
HPF_139:
  s_cmp_lg_u32 s44, 2
  s_cbranch_scc1 HPF_140
  s_call_b64 s[96:97], L_TRAMP
HPF_140:
  s_cmp_lg_u32 s44, 3
  s_cbranch_scc1 HPF_141
  s_call_b64 s[96:97], PAD_17
HPF_141:
  s_mov_b64 exec, -1
  s_cmp_lg_u32 s44, 0
  s_cbranch_scc1 HSK_142
  s_mov_b64 exec, 0xff
  s_mov_b32 s58, s52
HPL_143:
  buffer_load_dword v29, v28, s[4:7], s92 offen sc1
  s_add_u32 s58, s58, 1
  s_cmp_gt_u32 s58, 400000
  s_waitcnt vmcnt(0)
  s_cbranch_scc1 HPD_144
  v_cmp_gt_u32 vcc, 11, v29
  s_cbranch_vccnz HPL_143
  s_mov_b32 s58, 0
HPD_144:
  s_mov_b32 s52, s58
HPK_145:
  s_mov_b64 exec, -1
  s_cmp_lg_u32 s51, 0
  s_cbranch_scc1 HFA_146
  buffer_inv sc1
  s_waitcnt vmcnt(0)
HFA_146:
HSK_142:
  s_waitcnt vmcnt(4)
  s_barrier
  s_add_u32 m0, s47, 28672
  s_add_u32 s48, s99, 7
  s_sub_u32 s100, s48, 56
  s_cselect_b32 s48, s48, s100
  s_mul_i32 s48, s48, 4096
  s_add_u32 s48, s48, s49
  buffer_load_dwordx4 v6, s[4:7], s48 offen sc1 lds
  s_add_u32 m0, s47, 40960
  s_add_u32 s48, s99, 8
  s_sub_u32 s100, s48, 56
  s_cselect_b32 s48, s48, s100
  s_mul_i32 s48, s48, 4096
  s_add_u32 s48, s48, s49
  buffer_load_dwordx4 v6, s[4:7], s48 offen sc1 lds
  s_add_u32 m0, s47, 45056
  s_add_u32 s48, s99, 9
  s_sub_u32 s100, s48, 56
  s_cselect_b32 s48, s48, s100
  s_mul_i32 s48, s48, 4096
  s_add_u32 s48, s48, s49
  buffer_load_dwordx4 v6, s[4:7], s48 offen sc1 lds
  s_add_u32 m0, s47, 49152
  s_add_u32 s48, s99, 10
  s_sub_u32 s100, s48, 56
  s_cselect_b32 s48, s48, s100
  s_mul_i32 s48, s48, 4096
  s_add_u32 s48, s48, s49
  buffer_load_dwordx4 v6, s[4:7], s48 offen sc1 lds
  s_waitcnt vmcnt(4)
  s_barrier
  s_add_u32 m0, s47, 53248
  s_add_u32 s48, s99, 11
  s_sub_u32 s100, s48, 56
  s_cselect_b32 s48, s48, s100
  s_mul_i32 s48, s48, 4096
  s_add_u32 s48, s48, s49
  buffer_load_dwordx4 v6, s[4:7], s48 offen sc1 lds
  s_add_u32 m0, s47, 57344
  s_add_u32 s48, s99, 12
  s_sub_u32 s100, s48, 56
  s_cselect_b32 s48, s48, s100
  s_mul_i32 s48, s48, 4096
  s_add_u32 s48, s48, s49
  buffer_load_dwordx4 v6, s[4:7], s48 offen sc1 lds
  s_add_u32 m0, s47, 61440
  s_add_u32 s48, s99, 13
  s_sub_u32 s100, s48, 56
  s_cselect_b32 s48, s48, s100
  s_mul_i32 s48, s48, 4096
  s_add_u32 s48, s48, s49
  buffer_load_dwordx4 v6, s[4:7], s48 offen sc1 lds
  s_barrier
  s_add_u32 m0, s47, 0
  s_add_u32 s48, s99, 14
  s_sub_u32 s100, s48, 56
  s_cselect_b32 s48, s48, s100
  s_mul_i32 s48, s48, 4096
  s_add_u32 s48, s48, s49
  buffer_load_dwordx4 v6, s[4:7], s48 offen sc1 lds
  s_add_u32 m0, s47, 65536
  s_add_u32 s48, s99, 15
  s_sub_u32 s100, s48, 56
  s_cselect_b32 s48, s48, s100
  s_mul_i32 s48, s48, 4096
  s_add_u32 s48, s48, s49
  buffer_load_dwordx4 v6, s[4:7], s48 offen sc1 lds
  s_waitcnt vmcnt(8)
  s_barrier
  s_add_u32 m0, s47, 4096
  s_add_u32 s48, s99, 16
  s_sub_u32 s100, s48, 56
  s_cselect_b32 s48, s48, s100
  s_mul_i32 s48, s48, 4096
  s_add_u32 s48, s48, s49
  buffer_load_dwordx4 v6, s[4:7], s48 offen sc1 lds
  s_add_u32 m0, s47, 8192
  s_add_u32 s48, s99, 16
  s_sub_u32 s100, s48, 56
  s_cselect_b32 s48, s48, s100
  s_mul_i32 s48, s48, 32768
  buffer_load_dwordx4 v2, s[32:35], s48 offen lds
  s_add_u32 m0, s47, 94208
  s_add_u32 s48, s99, 17
  s_sub_u32 s100, s48, 56
  s_cselect_b32 s48, s48, s100
  s_mul_i32 s48, s48, 4096
  s_add_u32 s48, s48, s49
  buffer_load_dwordx4 v6, s[4:7], s48 offen sc1 lds
  s_add_u32 m0, s47, 98304
  s_add_u32 s48, s99, 17
  s_sub_u32 s100, s48, 56
  s_cselect_b32 s48, s48, s100
  s_mul_i32 s48, s48, 32768
  buffer_load_dwordx4 v2, s[32:35], s48 offen lds
  s_add_u32 m0, s47, 102400
  s_add_u32 s48, s99, 18
  s_sub_u32 s100, s48, 56
  s_cselect_b32 s48, s48, s100
  s_mul_i32 s48, s48, 4096
  s_add_u32 s48, s48, s49
  buffer_load_dwordx4 v6, s[4:7], s48 offen sc1 lds
  s_waitcnt vmcnt(9)
  s_barrier
  s_add_u32 m0, s47, 12288
  s_add_u32 s48, s99, 18
  s_sub_u32 s100, s48, 56
  s_cselect_b32 s48, s48, s100
  s_mul_i32 s48, s48, 32768
  buffer_load_dwordx4 v2, s[32:35], s48 offen lds
  s_add_u32 m0, s47, 16384
  s_add_u32 s48, s99, 19
  s_sub_u32 s100, s48, 56
  s_cselect_b32 s48, s48, s100
  s_mul_i32 s48, s48, 4096
  s_add_u32 s48, s48, s49
  buffer_load_dwordx4 v6, s[4:7], s48 offen sc1 lds
  s_add_u32 m0, s47, 20480
  s_add_u32 s48, s99, 19
  s_sub_u32 s100, s48, 56
  s_cselect_b32 s48, s48, s100
  s_mul_i32 s48, s48, 32768
  buffer_load_dwordx4 v2, s[32:35], s48 offen lds
  s_add_u32 m0, s47, 24576
  s_add_u32 s48, s99, 20
  s_sub_u32 s100, s48, 56
  s_cselect_b32 s48, s48, s100
  s_mul_i32 s48, s48, 4096
  s_add_u32 s48, s48, s49
  buffer_load_dwordx4 v6, s[4:7], s48 offen sc1 lds
  s_add_u32 m0, s47, 69632
  s_add_u32 s48, s99, 20
  s_sub_u32 s100, s48, 56
  s_cselect_b32 s48, s48, s100
  s_mul_i32 s48, s48, 32768
  buffer_load_dwordx4 v2, s[32:35], s48 offen lds
  s_waitcnt vmcnt(10)
  s_barrier
  s_add_u32 m0, s47, 28672
  s_add_u32 s48, s99, 21
  s_sub_u32 s100, s48, 56
  s_cselect_b32 s48, s48, s100
  s_mul_i32 s48, s48, 4096
  s_add_u32 s48, s48, s49
  buffer_load_dwordx4 v6, s[4:7], s48 offen sc1 lds
  s_add_u32 m0, s47, 40960
  s_add_u32 s48, s99, 21
  s_sub_u32 s100, s48, 56
  s_cselect_b32 s48, s48, s100
  s_mul_i32 s48, s48, 32768
  buffer_load_dwordx4 v2, s[32:35], s48 offen lds
  s_add_u32 m0, s47, 45056
  s_add_u32 s48, s99, 22
  s_sub_u32 s100, s48, 56
  s_cselect_b32 s48, s48, s100
  s_mul_i32 s48, s48, 4096
  s_add_u32 s48, s48, s49
  buffer_load_dwordx4 v6, s[4:7], s48 offen sc1 lds
  s_add_u32 m0, s47, 49152
  s_add_u32 s48, s99, 22
  s_sub_u32 s100, s48, 56
  s_cselect_b32 s48, s48, s100
  s_mul_i32 s48, s48, 32768
  buffer_load_dwordx4 v2, s[32:35], s48 offen lds
  s_waitcnt vmcnt(13)
  s_add_u32 m0, s47, 73728
  s_add_u32 s48, s99, 23
  s_sub_u32 s100, s48, 56
  s_cselect_b32 s48, s48, s100
  s_mul_i32 s48, s48, 4096
  s_add_u32 s48, s48, s49
  buffer_load_dwordx4 v6, s[4:7], s48 offen sc1 lds
  s_waitcnt vmcnt(13)
  s_add_u32 m0, s47, 77824
  s_add_u32 s48, s99, 23
  s_sub_u32 s100, s48, 56
  s_cselect_b32 s48, s48, s100
  s_mul_i32 s48, s48, 32768
  buffer_load_dwordx4 v2, s[32:35], s48 offen lds
  s_waitcnt vmcnt(13)
  s_add_u32 m0, s47, 81920
  s_add_u32 s48, s99, 24
  s_sub_u32 s100, s48, 56
  s_cselect_b32 s48, s48, s100
  s_mul_i32 s48, s48, 4096
  s_add_u32 s48, s48, s49
  buffer_load_dwordx4 v6, s[4:7], s48 offen sc1 lds
  s_waitcnt vmcnt(9)
  s_barrier
  s_add_u32 m0, s47, 0
  s_add_u32 s48, s99, 24
  s_sub_u32 s100, s48, 56
  s_cselect_b32 s48, s48, s100
  s_mul_i32 s48, s48, 32768
  buffer_load_dwordx4 v2, s[32:35], s48 offen lds
  s_add_u32 m0, s47, 32768
  s_add_u32 s48, s99, 25
  s_sub_u32 s100, s48, 56
  s_cselect_b32 s48, s48, s100
  s_mul_i32 s48, s48, 4096
  s_add_u32 s48, s48, s49
  buffer_load_dwordx4 v6, s[4:7], s48 offen sc1 lds
  s_add_u32 m0, s47, 53248
  s_add_u32 s48, s99, 25
  s_sub_u32 s100, s48, 56
  s_cselect_b32 s48, s48, s100
  s_mul_i32 s48, s48, 32768
  buffer_load_dwordx4 v2, s[32:35], s48 offen lds
  s_add_u32 m0, s47, 57344
  s_add_u32 s48, s99, 26
  s_sub_u32 s100, s48, 56
  s_cselect_b32 s48, s48, s100
  s_mul_i32 s48, s48, 4096
  s_add_u32 s48, s48, s49
  buffer_load_dwordx4 v6, s[4:7], s48 offen sc1 lds
  s_add_u32 m0, s47, 61440
  s_add_u32 s48, s99, 26
  s_sub_u32 s100, s48, 56
  s_cselect_b32 s48, s48, s100
  s_mul_i32 s48, s48, 32768
  buffer_load_dwordx4 v2, s[32:35], s48 offen lds
  s_waitcnt vmcnt(13)
  s_add_u32 m0, s47, 86016
  s_add_u32 s48, s99, 27
  s_sub_u32 s100, s48, 56
  s_cselect_b32 s48, s48, s100
  s_mul_i32 s48, s48, 4096
  s_add_u32 s48, s48, s49
  buffer_load_dwordx4 v6, s[4:7], s48 offen sc1 lds
  s_waitcnt vmcnt(13)
  s_add_u32 m0, s47, 90112
  s_add_u32 s48, s99, 27
  s_sub_u32 s100, s48, 56
  s_cselect_b32 s48, s48, s100
  s_mul_i32 s48, s48, 32768
  buffer_load_dwordx4 v2, s[32:35], s48 offen lds
  s_waitcnt vmcnt(13)
  s_add_u32 m0, s47, 106496
  s_add_u32 s48, s99, 28
  s_sub_u32 s100, s48, 56
  s_cselect_b32 s48, s48, s100
  s_mul_i32 s48, s48, 4096
  s_add_u32 s48, s48, s49
  buffer_load_dwordx4 v6, s[4:7], s48 offen sc1 lds
  s_waitcnt vmcnt(9)
  s_barrier
  s_add_u32 m0, s47, 4096
  s_add_u32 s48, s99, 28
  s_sub_u32 s100, s48, 56
  s_cselect_b32 s48, s48, s100
  s_mul_i32 s48, s48, 32768
  buffer_load_dwordx4 v2, s[32:35], s48 offen lds
  s_add_u32 m0, s47, 8192
  s_add_u32 s48, s99, 29
  s_sub_u32 s100, s48, 56
  s_cselect_b32 s48, s48, s100
  s_mul_i32 s48, s48, 4096
  s_add_u32 s48, s48, s49
  buffer_load_dwordx4 v6, s[4:7], s48 offen sc1 lds
  s_add_u32 m0, s47, 12288
  s_add_u32 s48, s99, 29
  s_sub_u32 s100, s48, 56
  s_cselect_b32 s48, s48, s100
  s_mul_i32 s48, s48, 32768
  buffer_load_dwordx4 v2, s[32:35], s48 offen lds
  s_add_u32 m0, s47, 36864
  s_add_u32 s48, s99, 30
  s_sub_u32 s100, s48, 56
  s_cselect_b32 s48, s48, s100
  s_mul_i32 s48, s48, 4096
  s_add_u32 s48, s48, s49
  buffer_load_dwordx4 v6, s[4:7], s48 offen sc1 lds
  s_add_u32 m0, s47, 65536
  s_add_u32 s48, s99, 30
  s_sub_u32 s100, s48, 56
  s_cselect_b32 s48, s48, s100
  s_mul_i32 s48, s48, 32768
  buffer_load_dwordx4 v2, s[32:35], s48 offen lds
  s_waitcnt vmcnt(13)
  s_add_u32 m0, s47, 94208
  s_add_u32 s48, s99, 31
  s_sub_u32 s100, s48, 56
  s_cselect_b32 s48, s48, s100
  s_mul_i32 s48, s48, 4096
  s_add_u32 s48, s48, s49
  buffer_load_dwordx4 v6, s[4:7], s48 offen sc1 lds
  s_waitcnt vmcnt(13)
  s_add_u32 m0, s47, 98304
  s_add_u32 s48, s99, 31
  s_sub_u32 s100, s48, 56
  s_cselect_b32 s48, s48, s100
  s_mul_i32 s48, s48, 32768
  buffer_load_dwordx4 v2, s[32:35], s48 offen lds
  s_waitcnt vmcnt(13)
  s_add_u32 m0, s47, 102400
  s_add_u32 s48, s99, 32
  s_sub_u32 s100, s48, 56
  s_cselect_b32 s48, s48, s100
  s_mul_i32 s48, s48, 4096
  s_add_u32 s48, s48, s49
  buffer_load_dwordx4 v6, s[4:7], s48 offen sc1 lds
  s_waitcnt vmcnt(9)
  s_barrier
  s_add_u32 m0, s47, 16384
  s_add_u32 s48, s99, 32
  s_sub_u32 s100, s48, 56
  s_cselect_b32 s48, s48, s100
  s_mul_i32 s48, s48, 32768
  buffer_load_dwordx4 v2, s[32:35], s48 offen lds
  s_add_u32 m0, s47, 20480
  s_add_u32 s48, s99, 33
  s_sub_u32 s100, s48, 56
  s_cselect_b32 s48, s48, s100
  s_mul_i32 s48, s48, 4096
  s_add_u32 s48, s48, s49
  buffer_load_dwordx4 v6, s[4:7], s48 offen sc1 lds
  s_add_u32 m0, s47, 24576
  s_add_u32 s48, s99, 33
  s_sub_u32 s100, s48, 56
  s_cselect_b32 s48, s48, s100
  s_mul_i32 s48, s48, 32768
  buffer_load_dwordx4 v2, s[32:35], s48 offen lds
  s_add_u32 m0, s47, 28672
  s_add_u32 s48, s99, 34
  s_sub_u32 s100, s48, 56
  s_cselect_b32 s48, s48, s100
  s_mul_i32 s48, s48, 4096
  s_add_u32 s48, s48, s49
  buffer_load_dwordx4 v6, s[4:7], s48 offen sc1 lds
  s_add_u32 m0, s47, 40960
  s_add_u32 s48, s99, 34
  s_sub_u32 s100, s48, 56
  s_cselect_b32 s48, s48, s100
  s_mul_i32 s48, s48, 32768
  buffer_load_dwordx4 v2, s[32:35], s48 offen lds
  s_waitcnt vmcnt(13)
  s_add_u32 m0, s47, 45056
  s_add_u32 s48, s99, 35
  s_sub_u32 s100, s48, 56
  s_cselect_b32 s48, s48, s100
  s_mul_i32 s48, s48, 4096
  s_add_u32 s48, s48, s49
  buffer_load_dwordx4 v6, s[4:7], s48 offen sc1 lds
  s_waitcnt vmcnt(13)
  s_add_u32 m0, s47, 49152
  s_add_u32 s48, s99, 35
  s_sub_u32 s100, s48, 56
  s_cselect_b32 s48, s48, s100
  s_mul_i32 s48, s48, 32768
  buffer_load_dwordx4 v2, s[32:35], s48 offen lds
  s_waitcnt vmcnt(13)
  s_add_u32 m0, s47, 69632
  s_add_u32 s48, s99, 36
  s_sub_u32 s100, s48, 56
  s_cselect_b32 s48, s48, s100
  s_mul_i32 s48, s48, 4096
  s_add_u32 s48, s48, s49
  buffer_load_dwordx4 v6, s[4:7], s48 offen sc1 lds
  s_waitcnt vmcnt(9)
  s_barrier
  s_add_u32 m0, s47, 0
  s_add_u32 s48, s99, 36
  s_sub_u32 s100, s48, 56
  s_cselect_b32 s48, s48, s100
  s_mul_i32 s48, s48, 32768
  buffer_load_dwordx4 v2, s[32:35], s48 offen lds
  s_add_u32 m0, s47, 32768
  s_add_u32 s48, s99, 37
  s_sub_u32 s100, s48, 56
  s_cselect_b32 s48, s48, s100
  s_mul_i32 s48, s48, 4096
  s_add_u32 s48, s48, s49
  buffer_load_dwordx4 v6, s[4:7], s48 offen sc1 lds
  s_add_u32 m0, s47, 53248
  s_add_u32 s48, s99, 37
  s_sub_u32 s100, s48, 56
  s_cselect_b32 s48, s48, s100
  s_mul_i32 s48, s48, 32768
  buffer_load_dwordx4 v2, s[32:35], s48 offen lds
  s_add_u32 m0, s47, 57344
  s_add_u32 s48, s99, 38
  s_sub_u32 s100, s48, 56
  s_cselect_b32 s48, s48, s100
  s_mul_i32 s48, s48, 4096
  s_add_u32 s48, s48, s49
  buffer_load_dwordx4 v6, s[4:7], s48 offen sc1 lds
  s_add_u32 m0, s47, 61440
  s_add_u32 s48, s99, 38
  s_sub_u32 s100, s48, 56
  s_cselect_b32 s48, s48, s100
  s_mul_i32 s48, s48, 32768
  buffer_load_dwordx4 v2, s[32:35], s48 offen lds
  s_waitcnt vmcnt(13)
  s_add_u32 m0, s47, 73728
  s_add_u32 s48, s99, 39
  s_sub_u32 s100, s48, 56
  s_cselect_b32 s48, s48, s100
  s_mul_i32 s48, s48, 4096
  s_add_u32 s48, s48, s49
  buffer_load_dwordx4 v6, s[4:7], s48 offen sc1 lds
  s_waitcnt vmcnt(13)
  s_add_u32 m0, s47, 77824
  s_add_u32 s48, s99, 39
  s_sub_u32 s100, s48, 56
  s_cselect_b32 s48, s48, s100
  s_mul_i32 s48, s48, 32768
  buffer_load_dwordx4 v2, s[32:35], s48 offen lds
  s_waitcnt vmcnt(13)
  s_add_u32 m0, s47, 81920
  s_add_u32 s48, s99, 40
  s_sub_u32 s100, s48, 56
  s_cselect_b32 s48, s48, s100
  s_mul_i32 s48, s48, 4096
  s_add_u32 s48, s48, s49
  buffer_load_dwordx4 v6, s[4:7], s48 offen sc1 lds
  s_waitcnt vmcnt(9)
  s_barrier
  s_add_u32 m0, s47, 4096
  s_add_u32 s48, s99, 41
  s_sub_u32 s100, s48, 56
  s_cselect_b32 s48, s48, s100
  s_mul_i32 s48, s48, 4096
  s_add_u32 s48, s48, s49
  buffer_load_dwordx4 v6, s[4:7], s48 offen sc1 lds
  s_add_u32 m0, s47, 8192
  s_add_u32 s48, s99, 42
  s_sub_u32 s100, s48, 56
  s_cselect_b32 s48, s48, s100
  s_mul_i32 s48, s48, 4096
  s_add_u32 s48, s48, s49
  buffer_load_dwordx4 v6, s[4:7], s48 offen sc1 lds
  s_add_u32 m0, s47, 12288
  s_add_u32 s48, s99, 43
  s_sub_u32 s100, s48, 56
  s_cselect_b32 s48, s48, s100
  s_mul_i32 s48, s48, 4096
  s_add_u32 s48, s48, s49
  buffer_load_dwordx4 v6, s[4:7], s48 offen sc1 lds
  s_add_u32 m0, s47, 36864
  s_add_u32 s48, s99, 44
  s_sub_u32 s100, s48, 56
  s_cselect_b32 s48, s48, s100
  s_mul_i32 s48, s48, 4096
  s_add_u32 s48, s48, s49
  buffer_load_dwordx4 v6, s[4:7], s48 offen sc1 lds
  s_add_u32 m0, s47, 65536
  s_add_u32 s48, s99, 45
  s_sub_u32 s100, s48, 56
  s_cselect_b32 s48, s48, s100
  s_mul_i32 s48, s48, 4096
  s_add_u32 s48, s48, s49
  buffer_load_dwordx4 v6, s[4:7], s48 offen sc1 lds
  s_waitcnt vmcnt(13)
  s_add_u32 m0, s47, 86016
  s_add_u32 s48, s99, 46
  s_sub_u32 s100, s48, 56
  s_cselect_b32 s48, s48, s100
  s_mul_i32 s48, s48, 4096
  s_add_u32 s48, s48, s49
  buffer_load_dwordx4 v6, s[4:7], s48 offen sc1 lds
  s_waitcnt vmcnt(13)
  s_add_u32 m0, s47, 90112
  s_add_u32 s48, s99, 47
  s_sub_u32 s100, s48, 56
  s_cselect_b32 s48, s48, s100
  s_mul_i32 s48, s48, 4096
  s_add_u32 s48, s48, s49
  buffer_load_dwordx4 v6, s[4:7], s48 offen sc1 lds
  s_waitcnt vmcnt(13)
  s_add_u32 m0, s47, 106496
  s_add_u32 s48, s99, 48
  s_sub_u32 s100, s48, 56
  s_cselect_b32 s48, s48, s100
  s_mul_i32 s48, s48, 4096
  s_add_u32 s48, s48, s49
  buffer_load_dwordx4 v6, s[4:7], s48 offen sc1 lds
  s_waitcnt vmcnt(9)
  s_barrier
  s_add_u32 m0, s47, 16384
  s_add_u32 s48, s99, 49
  s_sub_u32 s100, s48, 56
  s_cselect_b32 s48, s48, s100
  s_mul_i32 s48, s48, 4096
  s_add_u32 s48, s48, s49
  buffer_load_dwordx4 v6, s[4:7], s48 offen sc1 lds
  s_add_u32 m0, s47, 20480
  s_add_u32 s48, s99, 50
  s_sub_u32 s100, s48, 56
  s_cselect_b32 s48, s48, s100
  s_mul_i32 s48, s48, 4096
  s_add_u32 s48, s48, s49
  buffer_load_dwordx4 v6, s[4:7], s48 offen sc1 lds
  s_add_u32 m0, s47, 24576
  s_add_u32 s48, s99, 51
  s_sub_u32 s100, s48, 56
  s_cselect_b32 s48, s48, s100
  s_mul_i32 s48, s48, 4096
  s_add_u32 s48, s48, s49
  buffer_load_dwordx4 v6, s[4:7], s48 offen sc1 lds
  s_add_u32 m0, s47, 28672
  s_add_u32 s48, s99, 52
  s_sub_u32 s100, s48, 56
  s_cselect_b32 s48, s48, s100
  s_mul_i32 s48, s48, 4096
  s_add_u32 s48, s48, s49
  buffer_load_dwordx4 v6, s[4:7], s48 offen sc1 lds
  s_add_u32 m0, s47, 40960
  s_add_u32 s48, s99, 53
  s_sub_u32 s100, s48, 56
  s_cselect_b32 s48, s48, s100
  s_mul_i32 s48, s48, 4096
  s_add_u32 s48, s48, s49
  buffer_load_dwordx4 v6, s[4:7], s48 offen sc1 lds
  s_waitcnt vmcnt(10)
  s_barrier
  s_add_u32 m0, s47, 0
  s_add_u32 s48, s99, 54
  s_sub_u32 s100, s48, 56
  s_cselect_b32 s48, s48, s100
  s_mul_i32 s48, s48, 4096
  s_add_u32 s48, s48, s49
  buffer_load_dwordx4 v6, s[4:7], s48 offen sc1 lds
  s_add_u32 m0, s47, 32768
  s_add_u32 s48, s99, 55
  s_sub_u32 s100, s48, 56
  s_cselect_b32 s48, s48, s100
  s_mul_i32 s48, s48, 4096
  s_add_u32 s48, s48, s49
  buffer_load_dwordx4 v6, s[4:7], s48 offen sc1 lds
  s_waitcnt vmcnt(8)
  s_barrier
  s_waitcnt vmcnt(4)
  s_barrier
  s_waitcnt vmcnt(2)
  s_barrier
  s_waitcnt vmcnt(0)
  s_barrier
  s_barrier
  s_endpgm
L_END:
  s_endpgm
.section .rodata,"a"
.p2align 6
.amdhsa_kernel interleave_layers__sliding_local_dilated__mixer_s_mlp__prompt_kernel
  .amdhsa_next_free_vgpr 256
  .amdhsa_next_free_sgpr 102
  .amdhsa_accum_offset 256
  .amdhsa_group_segment_fixed_size 0
  .amdhsa_kernarg_size 88
  .amdhsa_user_sgpr_count 2
  .amdhsa_user_sgpr_kernarg_segment_ptr 1
  .amdhsa_system_sgpr_workgroup_id_x 1
.end_amdhsa_kernel
```
